```python
import torch

def _softmax(x, axis=-1):
    return torch.softmax(x, dim=axis)

def _gelu(x):
    return torch.nn.functional.gelu(x, approximate='tanh')

def _silu(x):
    return torch.nn.functional.silu(x)

def _sigmoid(x):
    return torch.sigmoid(x)

def _layernorm(x, axis=-1, eps=1e-05):
    m = x.mean(dim=axis, keepdim=True)
    v = x.var(dim=axis, keepdim=True, unbiased=False)
    return (x - m) / torch.sqrt(v + eps)

def _scatter_add(tgt, idx, src, axis=0):
    return tgt.clone().index_add_(axis, idx, src)

def _segment_sum(src, seg, n):
    out = torch.zeros((n,) + src.shape[1:], dtype=src.dtype)
    return out.index_add_(0, seg, src)

def _pad(x, pw):
    flat = tuple((v for pair in reversed(pw) for v in pair))
    return torch.nn.functional.pad(x, flat)
kernel_name = 'sequential_preLN__memory_aug_recurrent_mem_tr__mixer_gmlp__prompt'

def setup_inputs():

    _w = lambda a: (lambda t: t.to(torch.bfloat16) if t.is_floating_point() else t)(torch.as_tensor(a))

    def _A_setup():
        B, S, Dm = (1, 2048, 448)
        H, Dh = (16, 256)
        M, seg = (8, 32)
        seg = min(seg, S)
        S = S // seg * seg
        return {'x': _w((lambda *s: torch.randn(*s, dtype=torch.bfloat16) * 0.05)(B, S, Dm)), 'mem0': _w((lambda *s: torch.randn(*s, dtype=torch.bfloat16) * 0.2)(B, M, Dm)), 'Wq': _w((lambda *s: torch.randn(*s, dtype=torch.bfloat16) * 1.6)(Dm, H, Dh) * Dm ** (-0.5)), 'Wk': _w((lambda *s: torch.randn(*s, dtype=torch.bfloat16) * 1.6)(Dm, H, Dh) * Dm ** (-0.5)), 'Wv': _w((lambda *s: torch.randn(*s, dtype=torch.bfloat16) * 0.2)(Dm, H, Dh) * Dm ** (-0.5)), 'Wo': _w((lambda *s: torch.randn(*s, dtype=torch.bfloat16) * 0.2)(H, Dh, Dm) * (H * Dh) ** (-0.5)), 'seg_len': seg}
    _A_in = _A_setup()

    def _B_setup():
        B, S, D, F = (1, 2048, 448, 1792)
        Fh = F // 2
        return {'x': _w((lambda *s: torch.randn(*s, dtype=torch.bfloat16) * 0.05)(B, S, D)), 'w_in': _w((lambda *s: torch.randn(*s, dtype=torch.bfloat16) * 0.4)(D, 2 * Fh)), 'w_sp': _w(0.01 * (lambda *s: torch.randn(*s, dtype=torch.bfloat16) * 0.4)(S, S)), 'b_sp': _w(1.0 + 0.01 * (lambda *s: torch.randn(*s, dtype=torch.bfloat16) * 0.05)(S)), 'w_out': _w((lambda *s: torch.randn(*s, dtype=torch.bfloat16) * 0.05)(Fh, D))}
    _B_in = _B_setup()
    return {'A_x': _A_in['x'], 'A_mem0': _A_in['mem0'], 'A_Wq': _A_in['Wq'], 'A_Wk': _A_in['Wk'], 'A_Wv': _A_in['Wv'], 'A_Wo': _A_in['Wo'], 'A_seg_len': _A_in['seg_len'], 'B_x': _B_in['x'], 'B_w_in': _B_in['w_in'], 'B_w_sp': _B_in['w_sp'], 'B_b_sp': _B_in['b_sp'], 'B_w_out': _B_in['w_out']}

def reference(A_x, A_mem0, A_Wq, A_Wk, A_Wv, A_Wo, A_seg_len, B_x, B_w_in, B_w_sp, B_b_sp, B_w_out):

    def _A_ref(x, mem0, Wq, Wk, Wv, Wo, seg_len):
        B, S, Dm = x.shape
        H, Dh = (Wq.shape[1], Wq.shape[2])
        M = mem0.shape[1]
        scale = Dh ** (-0.5)
        n_seg = S // seg_len
        L = M + seg_len
        idx = torch.arange(L)
        mask = (idx[:, None] < M) | (idx[:, None] >= idx[None, :])
        mem = mem0
        outs = []
        for s in range(n_seg):
            xs = x[:, s * seg_len:(s + 1) * seg_len, :].clone()
            h = torch.concatenate([mem, xs], axis=1)
            q = torch.einsum('btd,dhe->bhte', h, Wq)
            k = torch.einsum('btd,dhe->bhte', h, Wk)
            v = torch.einsum('btd,dhe->bhte', h, Wv)
            scores = torch.einsum('bhqe,bhke->bhqk', q, k) * scale
            scores = torch.where(mask[None, None], scores, -1000000000.0)
            p = _softmax(scores, axis=-1)
            o = torch.einsum('bhqk,bhke->bhqe', p, v)
            o = torch.einsum('bhte,hed->btd', o, Wo)
            mem = o[:, :M, :].clone()
            outs.append(o[:, M:, :])
        return torch.concatenate(outs, axis=1)

    def _B_ref(x, w_in, w_sp, b_sp, w_out):
        B, S, D = x.shape
        F = w_in.shape[-1]
        Fh = F // 2
        z = _gelu(torch.einsum('bsd,df->bsf', x, w_in))
        z1 = z[..., :Fh].clone()
        z2 = _layernorm(z[..., Fh:], axis=-1)
        g = torch.einsum('ts,bsf->btf', w_sp, z2) + b_sp[None, :, None]
        return torch.einsum('bsf,fd->bsd', z1 * g, w_out)
    x = A_x
    h = x + _A_ref(_layernorm(x, axis=-1), A_mem0, A_Wq, A_Wk, A_Wv, A_Wo, A_seg_len)
    h2 = h + _B_ref(_layernorm(h, axis=-1), B_w_in, B_w_sp, B_b_sp, B_w_out)
    return h2
```

```asm
; @launch grid=(256,1,1) block=(256,1,1) lds=147456
.amdgcn_target "amdgcn-amd-amdhsa--gfx950"
.text
.globl sequential_preLN__memory_aug_recurrent_mem_tr__mixer_gmlp__prompt_kernel
.p2align 8
.type sequential_preLN__memory_aug_recurrent_mem_tr__mixer_gmlp__prompt_kernel,@function
sequential_preLN__memory_aug_recurrent_mem_tr__mixer_gmlp__prompt_kernel:
    s_cmp_ge_u32 s2, 256
    s_cbranch_scc1 sequential_preLN__memory_aug_recurrent_mem_tr__mixer_gmlp__prompt_kernel_done
    s_load_dwordx4 s[4:7], s[0:1], 0
    s_load_dwordx4 s[8:11], s[0:1], 16
    s_load_dwordx4 s[12:15], s[0:1], 32
    s_load_dwordx2 s[16:17], s[0:1], 112
    s_load_dwordx2 s[44:45], s[0:1], 64
    s_load_dwordx2 s[46:47], s[0:1], 88
    v_and_b32 v1, 63, v0
    v_lshrrev_b32 v2, 6, v0
    s_nop 0
    v_readfirstlane_b32 s20, v2
    v_cmp_gt_u32 s[30:31], 56, v1
    s_mov_b64 s[32:33], exec
    s_lshr_b32 s60, s2, 3
    s_and_b32 s60, s60, 15
    s_lshr_b32 s61, s2, 1
    s_and_b32 s61, s61, 3
    s_and_b32 s62, s2, 1
    s_lshl_b32 s62, s62, 2
    s_add_u32 s62, s62, s20
    s_waitcnt lgkmcnt(0)
    s_load_dwordx2 s[18:19], s[0:1], 104
    s_getreg_b32 s3, hwreg(HW_REG_XCC_ID, 0, 3)
    v_mov_b32 v254, 0
    s_waitcnt lgkmcnt(0)
    s_lshl_b32 s21, s2, 3
    s_lshl_b32 s22, s20, 1
    s_add_u32 s21, s21, s22
    s_mul_i32 s22, s21, 896
    v_lshlrev_b32 v3, 4, v1
    v_add_u32 v3, s22, v3
    v_mov_b64 v[4:5], 0
    v_mov_b64 v[6:7], 0
    v_mov_b64 v[8:9], 0
    v_mov_b64 v[10:11], 0
    s_mov_b64 exec, s[30:31]
    global_load_dwordx4 v[4:7], v3, s[4:5]
    global_load_dwordx4 v[8:11], v3, s[4:5] offset:896
    s_mov_b64 exec, s[32:33]
    v_lshrrev_b32 v40, 2, v1
    v_and_b32 v41, 3, v1
    v_lshrrev_b32 v42, 4, v1
    v_sub_u32 v42, 4, v42
    v_and_b32 v42, 3, v42
    v_xor_b32 v41, v41, v42
    v_lshlrev_b32 v42, 4, v41
    v_and_b32 v26, 15, v1
    v_lshrrev_b32 v27, 4, v1
    v_lshlrev_b32 v27, 4, v27
    v_lshrrev_b32 v12, 2, v26
    v_lshlrev_b32 v12, 3, v12
    v_and_b32 v13, 3, v26
    v_add_u32 v12, v12, v13
    s_lshl_b32 s63, s62, 6
    v_add_u32 v12, s63, v12
    v_add_u32 v13, 0, v12
    v_lshlrev_b32 v13, 13, v13
    v_add_u32 v14, v13, v27
    v_add_u32 v13, 4, v12
    v_lshlrev_b32 v13, 13, v13
    v_add_u32 v15, v13, v27
    v_add_u32 v13, 32, v12
    v_lshlrev_b32 v13, 13, v13
    v_add_u32 v16, v13, v27
    v_add_u32 v13, 36, v12
    v_lshlrev_b32 v13, 13, v13
    v_add_u32 v17, v13, v27
    s_lshl_b32 s63, s60, 9
    s_cmp_ge_u32 s2, 128
    s_cbranch_scc1 sequential_preLN__memory_aug_recurrent_mem_tr__mixer_gmlp__prompt_kernel_P_eb
    s_add_u32 s64, s8, s63
    s_addc_u32 s65, s9, 0
    s_add_u32 s66, s10, s63
    s_addc_u32 s67, s11, 0
    s_lshl_b32 s69, s20, 7
    v_add_u32 v43, s69, v42
    v_lshrrev_b32 v12, 2, v40
    v_lshlrev_b32 v12, 4, v12
    v_lshrrev_b32 v13, 1, v40
    v_and_b32 v13, 1, v13
    v_lshlrev_b32 v13, 3, v13
    v_and_b32 v25, 1, v40
    v_add3_u32 v12, v12, v13, v25
    s_mul_i32 s68, s61, 112
    v_add_u32 v12, s68, v12
    v_add_u32 v13, 0, v12
    v_lshlrev_b32 v13, 13, v13
    v_add_u32 v18, v13, v43
    v_add_u32 v13, 4, v12
    v_lshlrev_b32 v13, 13, v13
    v_add_u32 v19, v13, v43
    v_add_u32 v13, 2, v12
    v_lshlrev_b32 v13, 13, v13
    v_add_u32 v20, v13, v43
    v_add_u32 v13, 6, v12
    v_lshlrev_b32 v13, 13, v13
    v_add_u32 v21, v13, v43
    v_lshrrev_b32 v12, 3, v40
    v_lshlrev_b32 v12, 4, v12
    v_lshrrev_b32 v13, 2, v40
    v_and_b32 v13, 1, v13
    v_lshlrev_b32 v13, 1, v13
    v_add_u32 v12, v12, v13
    v_lshrrev_b32 v13, 1, v40
    v_and_b32 v13, 1, v13
    v_lshlrev_b32 v13, 3, v13
    v_and_b32 v25, 1, v40
    v_add3_u32 v12, v12, v13, v25
    v_add_u32 v12, s68, v12
    v_add_u32 v13, 64, v12
    v_lshlrev_b32 v13, 13, v13
    v_add_u32 v22, v13, v43
    v_add_u32 v13, 68, v12
    v_lshlrev_b32 v13, 13, v13
    v_add_u32 v23, v13, v43
    v_lshrrev_b32 v12, 1, v40
    v_and_b32 v12, 1, v12
    v_lshlrev_b32 v12, 3, v12
    v_lshrrev_b32 v13, 3, v40
    v_lshlrev_b32 v13, 2, v13
    v_add_u32 v12, v12, v13
    v_lshrrev_b32 v13, 2, v40
    v_and_b32 v13, 1, v13
    v_lshlrev_b32 v13, 1, v13
    v_and_b32 v25, 1, v40
    v_add3_u32 v12, v12, v13, v25
    v_add_u32 v12, s68, v12
    v_add_u32 v13, 96, v12
    v_lshlrev_b32 v13, 13, v13
    v_add_u32 v24, v13, v43
    s_mul_i32 s69, s20, 14336
    s_add_u32 s69, s69, 16384
    s_add_u32 m0, s69, 0
    s_nop 0
    global_load_lds_dwordx4 v18, s[66:67] offset:0
    s_add_u32 m0, s69, 1024
    s_nop 0
    global_load_lds_dwordx4 v19, s[66:67] offset:0
    s_add_u32 m0, s69, 2048
    s_nop 0
    global_load_lds_dwordx4 v20, s[66:67] offset:0
    s_add_u32 m0, s69, 3072
    s_nop 0
    global_load_lds_dwordx4 v21, s[66:67] offset:0
    s_add_u32 m0, s69, 4096
    s_nop 0
    global_load_lds_dwordx4 v22, s[66:67] offset:0
    s_add_u32 m0, s69, 5120
    s_nop 0
    global_load_lds_dwordx4 v23, s[66:67] offset:0
    s_add_u32 m0, s69, 6144
    s_nop 0
    global_load_lds_dwordx4 v24, s[66:67] offset:0
    s_add_u32 m0, s69, 7104
    s_nop 0
    global_load_lds_dwordx4 v18, s[66:67] offset:64
    s_add_u32 m0, s69, 8128
    s_nop 0
    global_load_lds_dwordx4 v19, s[66:67] offset:64
    s_add_u32 m0, s69, 9152
    s_nop 0
    global_load_lds_dwordx4 v20, s[66:67] offset:64
    s_add_u32 m0, s69, 10176
    s_nop 0
    global_load_lds_dwordx4 v21, s[66:67] offset:64
    s_add_u32 m0, s69, 11200
    s_nop 0
    global_load_lds_dwordx4 v22, s[66:67] offset:64
    s_add_u32 m0, s69, 12224
    s_nop 0
    global_load_lds_dwordx4 v23, s[66:67] offset:64
    s_add_u32 m0, s69, 13248
    s_nop 0
    global_load_lds_dwordx4 v24, s[66:67] offset:64
    s_branch sequential_preLN__memory_aug_recurrent_mem_tr__mixer_gmlp__prompt_kernel_P_ea
sequential_preLN__memory_aug_recurrent_mem_tr__mixer_gmlp__prompt_kernel_P_eb:
    v_mul_u32_u24 v12, 4682, v1
    v_lshrrev_b32 v12, 16, v12
    v_mul_u32_u24 v13, 14, v12
    v_sub_u32 v13, v1, v13
    v_mul_u32_u24 v12, 896, v12
    v_lshlrev_b32 v13, 4, v13
    v_add_u32 v12, v12, v13
    s_mul_i32 s68, s60, 229376
    s_mul_i32 s69, s20, 57344
    s_add_u32 s68, s68, s69
    s_mul_i32 s69, s61, 224
    s_add_u32 s68, s68, s69
    s_add_u32 s66, s14, s68
    s_addc_u32 s67, s15, 0
    s_mul_i32 s69, s20, 14336
    s_add_u32 s69, s69, 16384
    s_mov_b64 exec, s[30:31]
    s_add_u32 m0, s69, 0
    s_nop 0
    global_load_lds_dwordx4 v12, s[66:67]
    s_add_u32 s66, s66, 3584
    s_addc_u32 s67, s67, 0
    s_add_u32 m0, s69, 896
    s_nop 0
    global_load_lds_dwordx4 v12, s[66:67]
    s_add_u32 s66, s66, 3584
    s_addc_u32 s67, s67, 0
    s_add_u32 m0, s69, 1792
    s_nop 0
    global_load_lds_dwordx4 v12, s[66:67]
    s_add_u32 s66, s66, 3584
    s_addc_u32 s67, s67, 0
    s_add_u32 m0, s69, 2688
    s_nop 0
    global_load_lds_dwordx4 v12, s[66:67]
    s_add_u32 s66, s66, 3584
    s_addc_u32 s67, s67, 0
    s_add_u32 m0, s69, 3584
    s_nop 0
    global_load_lds_dwordx4 v12, s[66:67]
    s_add_u32 s66, s66, 3584
    s_addc_u32 s67, s67, 0
    s_add_u32 m0, s69, 4480
    s_nop 0
    global_load_lds_dwordx4 v12, s[66:67]
    s_add_u32 s66, s66, 3584
    s_addc_u32 s67, s67, 0
    s_add_u32 m0, s69, 5376
    s_nop 0
    global_load_lds_dwordx4 v12, s[66:67]
    s_add_u32 s66, s66, 3584
    s_addc_u32 s67, s67, 0
    s_add_u32 m0, s69, 6272
    s_nop 0
    global_load_lds_dwordx4 v12, s[66:67]
    s_add_u32 s66, s66, 3584
    s_addc_u32 s67, s67, 0
    s_add_u32 m0, s69, 7168
    s_nop 0
    global_load_lds_dwordx4 v12, s[66:67]
    s_add_u32 s66, s66, 3584
    s_addc_u32 s67, s67, 0
    s_add_u32 m0, s69, 8064
    s_nop 0
    global_load_lds_dwordx4 v12, s[66:67]
    s_add_u32 s66, s66, 3584
    s_addc_u32 s67, s67, 0
    s_add_u32 m0, s69, 8960
    s_nop 0
    global_load_lds_dwordx4 v12, s[66:67]
    s_add_u32 s66, s66, 3584
    s_addc_u32 s67, s67, 0
    s_add_u32 m0, s69, 9856
    s_nop 0
    global_load_lds_dwordx4 v12, s[66:67]
    s_add_u32 s66, s66, 3584
    s_addc_u32 s67, s67, 0
    s_add_u32 m0, s69, 10752
    s_nop 0
    global_load_lds_dwordx4 v12, s[66:67]
    s_add_u32 s66, s66, 3584
    s_addc_u32 s67, s67, 0
    s_add_u32 m0, s69, 11648
    s_nop 0
    global_load_lds_dwordx4 v12, s[66:67]
    s_add_u32 s66, s66, 3584
    s_addc_u32 s67, s67, 0
    s_add_u32 m0, s69, 12544
    s_nop 0
    global_load_lds_dwordx4 v12, s[66:67]
    s_add_u32 s66, s66, 3584
    s_addc_u32 s67, s67, 0
    s_add_u32 m0, s69, 13440
    s_nop 0
    global_load_lds_dwordx4 v12, s[66:67]
    s_mov_b64 exec, s[32:33]
    s_add_u32 s64, s12, s63
    s_addc_u32 s65, s13, 0
    s_nop 2
sequential_preLN__memory_aug_recurrent_mem_tr__mixer_gmlp__prompt_kernel_P_ea:
    s_cmp_ge_u32 s62, 7
    s_cbranch_scc1 sequential_preLN__memory_aug_recurrent_mem_tr__mixer_gmlp__prompt_kernel_P_e0
    global_load_dwordx4 a[0:3], v14, s[64:65] offset:0
    global_load_dwordx4 a[4:7], v15, s[64:65] offset:0
    global_load_dwordx4 a[8:11], v16, s[64:65] offset:0
    global_load_dwordx4 a[12:15], v17, s[64:65] offset:0
    global_load_dwordx4 a[16:19], v14, s[64:65] offset:64
    global_load_dwordx4 a[20:23], v15, s[64:65] offset:64
    global_load_dwordx4 a[24:27], v16, s[64:65] offset:64
    global_load_dwordx4 a[28:31], v17, s[64:65] offset:64
    global_load_dwordx4 a[32:35], v14, s[64:65] offset:128
    global_load_dwordx4 a[36:39], v15, s[64:65] offset:128
    global_load_dwordx4 a[40:43], v16, s[64:65] offset:128
    global_load_dwordx4 a[44:47], v17, s[64:65] offset:128
    global_load_dwordx4 a[48:51], v14, s[64:65] offset:192
    global_load_dwordx4 a[52:55], v15, s[64:65] offset:192
    global_load_dwordx4 a[56:59], v16, s[64:65] offset:192
    global_load_dwordx4 a[60:63], v17, s[64:65] offset:192
    global_load_dwordx4 a[64:67], v14, s[64:65] offset:256
    global_load_dwordx4 a[68:71], v15, s[64:65] offset:256
    global_load_dwordx4 a[72:75], v16, s[64:65] offset:256
    global_load_dwordx4 a[76:79], v17, s[64:65] offset:256
    global_load_dwordx4 a[80:83], v14, s[64:65] offset:320
    global_load_dwordx4 a[84:87], v15, s[64:65] offset:320
    global_load_dwordx4 a[88:91], v16, s[64:65] offset:320
    global_load_dwordx4 a[92:95], v17, s[64:65] offset:320
    global_load_dwordx4 a[96:99], v14, s[64:65] offset:384
    global_load_dwordx4 a[100:103], v15, s[64:65] offset:384
    global_load_dwordx4 a[104:107], v16, s[64:65] offset:384
    global_load_dwordx4 a[108:111], v17, s[64:65] offset:384
    global_load_dwordx4 a[112:115], v14, s[64:65] offset:448
    global_load_dwordx4 a[116:119], v15, s[64:65] offset:448
    global_load_dwordx4 a[120:123], v16, s[64:65] offset:448
    global_load_dwordx4 a[124:127], v17, s[64:65] offset:448
    s_waitcnt vmcnt(46)
    s_branch sequential_preLN__memory_aug_recurrent_mem_tr__mixer_gmlp__prompt_kernel_P_ej
sequential_preLN__memory_aug_recurrent_mem_tr__mixer_gmlp__prompt_kernel_P_e0:
    s_lshr_b32 s50, s2, 1
    v_mul_u32_u24 v26, 4682, v1
    v_lshrrev_b32 v26, 16, v26
    v_mul_u32_u24 v27, 14, v26
    v_sub_u32 v27, v1, v27
    v_lshlrev_b32 v27, 4, v27
    v_lshrrev_b32 v29, 4, v1
    s_cmp_ge_u32 s50, 112
    s_cbranch_scc1 sequential_preLN__memory_aug_recurrent_mem_tr__mixer_gmlp__prompt_kernel_P_p4oA
    s_mul_i32 s70, s50, 2341
    s_lshr_b32 s70, s70, 16
    s_mul_i32 s71, s70, 28
    s_sub_u32 s71, s50, s71
    s_mul_i32 s72, s71, 37
    s_lshr_b32 s72, s72, 8
    s_mul_i32 s73, s72, 7
    s_sub_u32 s73, s71, s73
    s_mul_i32 s74, s73, 229376
    s_mul_i32 s75, s70, 896
    s_add_u32 s74, s74, s75
    s_mul_i32 s75, s72, 224
    s_add_u32 s74, s74, s75
    s_mov_b32 s76, 3584
    s_mul_i32 s75, s70, 28
    s_mul_i32 s77, s72, 7
    s_add_u32 s75, s75, s77
    s_mul_i32 s75, s75, 7
    s_add_u32 s75, s75, s73
    s_lshl_b32 s75, s75, 11
    s_add_u32 s75, s75, 0x1900000
    s_mov_b32 s86, 14336
    v_lshlrev_b32 v240, 3, v29
    s_mov_b32 s87, 896
    s_mov_b32 s82, s44
    s_mov_b32 s83, s45
    s_branch sequential_preLN__memory_aug_recurrent_mem_tr__mixer_gmlp__prompt_kernel_P_p4goA
sequential_preLN__memory_aug_recurrent_mem_tr__mixer_gmlp__prompt_kernel_P_p4oA:
    s_sub_u32 s71, s50, 112
    s_mul_i32 s72, s71, 4682
    s_lshr_b32 s72, s72, 16
    s_mul_i32 s73, s72, 14
    s_sub_u32 s73, s71, s73
    s_mul_i32 s74, s73, 57344
    s_mul_i32 s75, s72, 224
    s_add_u32 s74, s74, s75
    s_mov_b32 s76, 896
    s_mul_i32 s75, s72, 196
    s_lshl_b32 s77, s73, 1
    s_add_u32 s75, s75, s77
    s_lshl_b32 s75, s75, 10
    s_add_u32 s75, s75, 0x1b00000
    s_mov_b32 s86, 28672
    v_lshlrev_b32 v240, 2, v29
    s_mov_b32 s87, 3584
    s_mov_b32 s82, s46
    s_mov_b32 s83, s47
sequential_preLN__memory_aug_recurrent_mem_tr__mixer_gmlp__prompt_kernel_P_p4goA:
    v_mul_lo_u32 v31, s76, v26
    v_add_u32 v31, v31, v27
    s_add_u32 s82, s82, s74
    s_addc_u32 s83, s83, 0
    s_lshl_b32 s77, s76, 2
    s_mov_b64 exec, s[30:31]
    s_mov_b32 m0, 0
    s_nop 0
    global_load_lds_dwordx4 v31, s[82:83]
    s_add_u32 s82, s82, s77
    s_addc_u32 s83, s83, 0
    s_mov_b32 m0, 896
    s_nop 0
    global_load_lds_dwordx4 v31, s[82:83]
    s_add_u32 s82, s82, s77
    s_addc_u32 s83, s83, 0
    s_mov_b32 m0, 1792
    s_nop 0
    global_load_lds_dwordx4 v31, s[82:83]
    s_add_u32 s82, s82, s77
    s_addc_u32 s83, s83, 0
    s_mov_b32 m0, 2688
    s_nop 0
    global_load_lds_dwordx4 v31, s[82:83]
    s_add_u32 s82, s82, s77
    s_addc_u32 s83, s83, 0
    s_mov_b32 m0, 3584
    s_nop 0
    global_load_lds_dwordx4 v31, s[82:83]
    s_add_u32 s82, s82, s77
    s_addc_u32 s83, s83, 0
    s_mov_b32 m0, 4480
    s_nop 0
    global_load_lds_dwordx4 v31, s[82:83]
    s_add_u32 s82, s82, s77
    s_addc_u32 s83, s83, 0
    s_mov_b32 m0, 5376
    s_nop 0
    global_load_lds_dwordx4 v31, s[82:83]
    s_add_u32 s82, s82, s77
    s_addc_u32 s83, s83, 0
    s_mov_b32 m0, 6272
    s_nop 0
    global_load_lds_dwordx4 v31, s[82:83]
    s_add_u32 s82, s82, s77
    s_addc_u32 s83, s83, 0
    s_mov_b32 m0, 7168
    s_nop 0
    global_load_lds_dwordx4 v31, s[82:83]
    s_add_u32 s82, s82, s77
    s_addc_u32 s83, s83, 0
    s_mov_b32 m0, 8064
    s_nop 0
    global_load_lds_dwordx4 v31, s[82:83]
    s_add_u32 s82, s82, s77
    s_addc_u32 s83, s83, 0
    s_mov_b32 m0, 8960
    s_nop 0
    global_load_lds_dwordx4 v31, s[82:83]
    s_add_u32 s82, s82, s77
    s_addc_u32 s83, s83, 0
    s_mov_b32 m0, 9856
    s_nop 0
    global_load_lds_dwordx4 v31, s[82:83]
    s_add_u32 s82, s82, s77
    s_addc_u32 s83, s83, 0
    s_mov_b32 m0, 10752
    s_nop 0
    global_load_lds_dwordx4 v31, s[82:83]
    s_add_u32 s82, s82, s77
    s_addc_u32 s83, s83, 0
    s_mov_b32 m0, 11648
    s_nop 0
    global_load_lds_dwordx4 v31, s[82:83]
    s_add_u32 s82, s82, s77
    s_addc_u32 s83, s83, 0
    s_mov_b32 m0, 12544
    s_nop 0
    global_load_lds_dwordx4 v31, s[82:83]
    s_add_u32 s82, s82, s77
    s_addc_u32 s83, s83, 0
    s_mov_b32 m0, 13440
    s_nop 0
    global_load_lds_dwordx4 v31, s[82:83]
    s_mov_b64 exec, s[32:33]
    s_add_u32 s84, s16, s75
    s_addc_u32 s85, s17, 0
    s_waitcnt vmcnt(30)
    s_nop 1
sequential_preLN__memory_aug_recurrent_mem_tr__mixer_gmlp__prompt_kernel_P_ej:
    s_cmp_lg_u32 s20, 0
    s_cbranch_scc1 sequential_preLN__memory_aug_recurrent_mem_tr__mixer_gmlp__prompt_kernel_P_notk
    s_mov_b64 exec, 1
    s_lshl_b32 s23, s3, 5
    v_mov_b32 v252, s23
    v_mov_b32 v253, 1
    global_atomic_add v254, v252, v253, s[18:19] sc0
    s_memrealtime s[24:25]
    s_waitcnt lgkmcnt(0)
    s_or_b32 s24, s24, 1
    v_mov_b32 v246, s24
    v_mov_b32 v247, 0
    v_mov_b32 v248, 252
    global_atomic_cmpswap v249, v248, v[246:247], s[18:19] sc0
    s_mov_b64 exec, s[32:33]
    s_nop 4
sequential_preLN__memory_aug_recurrent_mem_tr__mixer_gmlp__prompt_kernel_P_notk:
    s_lshl_b32 s34, s20, 1
    s_mul_i32 s34, s34, 896
    s_add_u32 s34, s34, 73728
    v_lshlrev_b32 v12, 4, v1
    v_add_u32 v12, s34, v12
    v_lshlrev_b32 v16, 16, v4
    v_and_b32 v17, 0xffff0000, v4
    v_lshlrev_b32 v18, 16, v5
    v_and_b32 v19, 0xffff0000, v5
    v_lshlrev_b32 v20, 16, v6
    v_and_b32 v21, 0xffff0000, v6
    v_lshlrev_b32 v22, 16, v7
    v_and_b32 v23, 0xffff0000, v7
    v_add_f32 v24, v16, v17
    v_add_f32 v24, v24, v18
    v_add_f32 v24, v24, v19
    v_add_f32 v24, v24, v20
    v_add_f32 v24, v24, v21
    v_add_f32 v24, v24, v22
    v_add_f32 v24, v24, v23
    s_nop 1
    v_add_f32_dpp v24, v24, v24 quad_perm:[1,0,3,2] row_mask:0xf bank_mask:0xf
    s_nop 1
    v_add_f32_dpp v24, v24, v24 quad_perm:[2,3,0,1] row_mask:0xf bank_mask:0xf
    s_nop 1
    v_add_f32_dpp v24, v24, v24 row_half_mirror row_mask:0xf bank_mask:0xf
    s_nop 1
    v_add_f32_dpp v24, v24, v24 row_mirror row_mask:0xf bank_mask:0xf
    v_mov_b32 v25, v24
    s_nop 1
    v_permlane16_swap_b32 v24, v25
    v_add_f32 v24, v24, v25
    v_mov_b32 v25, v24
    s_nop 1
    v_permlane32_swap_b32 v24, v25
    v_add_f32 v24, v24, v25
    v_mul_f32 v24, 0x3b124925, v24
    v_sub_f32 v26, v16, v24
    v_mul_f32 v27, v26, v26
    v_sub_f32 v26, v17, v24
    v_fmac_f32 v27, v26, v26
    v_sub_f32 v26, v18, v24
    v_fmac_f32 v27, v26, v26
    v_sub_f32 v26, v19, v24
    v_fmac_f32 v27, v26, v26
    v_sub_f32 v26, v20, v24
    v_fmac_f32 v27, v26, v26
    v_sub_f32 v26, v21, v24
    v_fmac_f32 v27, v26, v26
    v_sub_f32 v26, v22, v24
    v_fmac_f32 v27, v26, v26
    v_sub_f32 v26, v23, v24
    v_fmac_f32 v27, v26, v26
    v_cndmask_b32 v27, 0, v27, s[30:31]
    s_nop 1
    v_add_f32_dpp v27, v27, v27 quad_perm:[1,0,3,2] row_mask:0xf bank_mask:0xf
    s_nop 1
    v_add_f32_dpp v27, v27, v27 quad_perm:[2,3,0,1] row_mask:0xf bank_mask:0xf
    s_nop 1
    v_add_f32_dpp v27, v27, v27 row_half_mirror row_mask:0xf bank_mask:0xf
    s_nop 1
    v_add_f32_dpp v27, v27, v27 row_mirror row_mask:0xf bank_mask:0xf
    v_mov_b32 v25, v27
    s_nop 1
    v_permlane16_swap_b32 v27, v25
    v_add_f32 v27, v27, v25
    v_mov_b32 v25, v27
    s_nop 1
    v_permlane32_swap_b32 v27, v25
    v_add_f32 v27, v27, v25
    v_mul_f32 v27, 0x3b124925, v27
    v_cvt_pk_bf16_f32 v27, v27, v27
    v_and_b32 v27, 0xffff0000, v27
    v_add_f32 v27, 0x3727c5ac, v27
    v_cvt_pk_bf16_f32 v27, v27, v27
    v_and_b32 v27, 0xffff0000, v27
    v_sqrt_f32 v27, v27
    s_nop 0
    v_cvt_pk_bf16_f32 v27, v27, v27
    v_and_b32 v27, 0xffff0000, v27
    v_rcp_f32 v27, v27
    v_cvt_pk_bf16_f32 v24, v24, v24
    v_and_b32 v24, 0xffff0000, v24
    v_sub_f32 v16, v16, v24
    v_sub_f32 v17, v17, v24
    v_sub_f32 v18, v18, v24
    v_sub_f32 v19, v19, v24
    v_sub_f32 v20, v20, v24
    v_sub_f32 v21, v21, v24
    v_sub_f32 v22, v22, v24
    v_sub_f32 v23, v23, v24
    v_cvt_pk_bf16_f32 v4, v16, v17
    v_cvt_pk_bf16_f32 v5, v18, v19
    v_cvt_pk_bf16_f32 v6, v20, v21
    v_cvt_pk_bf16_f32 v7, v22, v23
    v_lshlrev_b32 v16, 16, v4
    v_and_b32 v17, 0xffff0000, v4
    v_lshlrev_b32 v18, 16, v5
    v_and_b32 v19, 0xffff0000, v5
    v_lshlrev_b32 v20, 16, v6
    v_and_b32 v21, 0xffff0000, v6
    v_lshlrev_b32 v22, 16, v7
    v_and_b32 v23, 0xffff0000, v7
    v_mul_f32 v16, v16, v27
    v_mul_f32 v17, v17, v27
    v_mul_f32 v18, v18, v27
    v_mul_f32 v19, v19, v27
    v_mul_f32 v20, v20, v27
    v_mul_f32 v21, v21, v27
    v_mul_f32 v22, v22, v27
    v_mul_f32 v23, v23, v27
    v_cvt_pk_bf16_f32 v4, v16, v17
    v_cvt_pk_bf16_f32 v5, v18, v19
    v_cvt_pk_bf16_f32 v6, v20, v21
    v_cvt_pk_bf16_f32 v7, v22, v23
    s_mov_b64 exec, s[30:31]
    ds_write_b128 v12, v[4:7] offset:0
    s_mov_b64 exec, s[32:33]
    v_lshlrev_b32 v16, 16, v8
    v_and_b32 v17, 0xffff0000, v8
    v_lshlrev_b32 v18, 16, v9
    v_and_b32 v19, 0xffff0000, v9
    v_lshlrev_b32 v20, 16, v10
    v_and_b32 v21, 0xffff0000, v10
    v_lshlrev_b32 v22, 16, v11
    v_and_b32 v23, 0xffff0000, v11
    v_add_f32 v24, v16, v17
    v_add_f32 v24, v24, v18
    v_add_f32 v24, v24, v19
    v_add_f32 v24, v24, v20
    v_add_f32 v24, v24, v21
    v_add_f32 v24, v24, v22
    v_add_f32 v24, v24, v23
    s_nop 1
    v_add_f32_dpp v24, v24, v24 quad_perm:[1,0,3,2] row_mask:0xf bank_mask:0xf
    s_nop 1
    v_add_f32_dpp v24, v24, v24 quad_perm:[2,3,0,1] row_mask:0xf bank_mask:0xf
    s_nop 1
    v_add_f32_dpp v24, v24, v24 row_half_mirror row_mask:0xf bank_mask:0xf
    s_nop 1
    v_add_f32_dpp v24, v24, v24 row_mirror row_mask:0xf bank_mask:0xf
    v_mov_b32 v25, v24
    s_nop 1
    v_permlane16_swap_b32 v24, v25
    v_add_f32 v24, v24, v25
    v_mov_b32 v25, v24
    s_nop 1
    v_permlane32_swap_b32 v24, v25
    v_add_f32 v24, v24, v25
    v_mul_f32 v24, 0x3b124925, v24
    v_sub_f32 v26, v16, v24
    v_mul_f32 v27, v26, v26
    v_sub_f32 v26, v17, v24
    v_fmac_f32 v27, v26, v26
    v_sub_f32 v26, v18, v24
    v_fmac_f32 v27, v26, v26
    v_sub_f32 v26, v19, v24
    v_fmac_f32 v27, v26, v26
    v_sub_f32 v26, v20, v24
    v_fmac_f32 v27, v26, v26
    v_sub_f32 v26, v21, v24
    v_fmac_f32 v27, v26, v26
    v_sub_f32 v26, v22, v24
    v_fmac_f32 v27, v26, v26
    v_sub_f32 v26, v23, v24
    v_fmac_f32 v27, v26, v26
    v_cndmask_b32 v27, 0, v27, s[30:31]
    s_nop 1
    v_add_f32_dpp v27, v27, v27 quad_perm:[1,0,3,2] row_mask:0xf bank_mask:0xf
    s_nop 1
    v_add_f32_dpp v27, v27, v27 quad_perm:[2,3,0,1] row_mask:0xf bank_mask:0xf
    s_nop 1
    v_add_f32_dpp v27, v27, v27 row_half_mirror row_mask:0xf bank_mask:0xf
    s_nop 1
    v_add_f32_dpp v27, v27, v27 row_mirror row_mask:0xf bank_mask:0xf
    v_mov_b32 v25, v27
    s_nop 1
    v_permlane16_swap_b32 v27, v25
    v_add_f32 v27, v27, v25
    v_mov_b32 v25, v27
    s_nop 1
    v_permlane32_swap_b32 v27, v25
    v_add_f32 v27, v27, v25
    v_mul_f32 v27, 0x3b124925, v27
    v_cvt_pk_bf16_f32 v27, v27, v27
    v_and_b32 v27, 0xffff0000, v27
    v_add_f32 v27, 0x3727c5ac, v27
    v_cvt_pk_bf16_f32 v27, v27, v27
    v_and_b32 v27, 0xffff0000, v27
    v_sqrt_f32 v27, v27
    s_nop 0
    v_cvt_pk_bf16_f32 v27, v27, v27
    v_and_b32 v27, 0xffff0000, v27
    v_rcp_f32 v27, v27
    v_cvt_pk_bf16_f32 v24, v24, v24
    v_and_b32 v24, 0xffff0000, v24
    v_sub_f32 v16, v16, v24
    v_sub_f32 v17, v17, v24
    v_sub_f32 v18, v18, v24
    v_sub_f32 v19, v19, v24
    v_sub_f32 v20, v20, v24
    v_sub_f32 v21, v21, v24
    v_sub_f32 v22, v22, v24
    v_sub_f32 v23, v23, v24
    v_cvt_pk_bf16_f32 v8, v16, v17
    v_cvt_pk_bf16_f32 v9, v18, v19
    v_cvt_pk_bf16_f32 v10, v20, v21
    v_cvt_pk_bf16_f32 v11, v22, v23
    v_lshlrev_b32 v16, 16, v8
    v_and_b32 v17, 0xffff0000, v8
    v_lshlrev_b32 v18, 16, v9
    v_and_b32 v19, 0xffff0000, v9
    v_lshlrev_b32 v20, 16, v10
    v_and_b32 v21, 0xffff0000, v10
    v_lshlrev_b32 v22, 16, v11
    v_and_b32 v23, 0xffff0000, v11
    v_mul_f32 v16, v16, v27
    v_mul_f32 v17, v17, v27
    v_mul_f32 v18, v18, v27
    v_mul_f32 v19, v19, v27
    v_mul_f32 v20, v20, v27
    v_mul_f32 v21, v21, v27
    v_mul_f32 v22, v22, v27
    v_mul_f32 v23, v23, v27
    v_cvt_pk_bf16_f32 v8, v16, v17
    v_cvt_pk_bf16_f32 v9, v18, v19
    v_cvt_pk_bf16_f32 v10, v20, v21
    v_cvt_pk_bf16_f32 v11, v22, v23
    s_mov_b64 exec, s[30:31]
    ds_write_b128 v12, v[8:11] offset:896
    s_mov_b64 exec, s[32:33]
    s_lshr_b32 s34, s2, 2
    s_lshr_b32 s36, s2, 1
    s_and_b32 s36, s36, 1
    s_and_b32 s35, s2, 1
    s_lshl_b32 s35, s35, 7
    s_mul_i32 s37, s34, 28672
    s_lshl_b32 s38, s36, 10
    s_add_u32 s37, s37, s38
    s_add_u32 s37, s37, s35
    s_lshl_b32 s39, s34, 15
    s_lshl_b32 s38, s36, 12
    s_add_u32 s39, s39, s38
    s_add_u32 s39, s39, s35
    v_mov_b32 v39, 0
    s_add_u32 s24, s16, 0x200000
    s_addc_u32 s25, s17, 0
    s_add_u32 s26, s16, 0x1600000
    s_addc_u32 s27, s17, 0
    v_and_b32 v13, 7, v1
    v_lshrrev_b32 v14, 3, v1
    s_mul_i32 s34, s20, 14
    s_waitcnt lgkmcnt(0)
    s_barrier
    v_add_u32 v15, 0, v14
    v_add_u32 v15, s34, v15
    v_mul_u32_u24 v23, 896, v13
    v_lshlrev_b32 v24, 4, v15
    v_add_u32 v23, v23, v24
    v_add_u32 v23, 73728, v23
    ds_read_b128 v[28:31], v23
    v_lshrrev_b32 v24, 2, v15
    v_lshlrev_b32 v24, 11, v24
    v_and_b32 v25, 3, v15
    v_lshlrev_b32 v25, 8, v25
    v_lshlrev_b32 v26, 4, v13
    v_add3_u32 v24, v24, v25, v26
    v_add_u32 v24, s37, v24
    v_lshrrev_b32 v25, 1, v15
    v_lshlrev_b32 v25, 5, v25
    v_and_b32 v27, 1, v15
    v_lshlrev_b32 v27, 2, v27
    v_mul_u32_u24 v23, 896, v13
    v_add3_u32 v23, v23, v25, v27
    v_add_u32 v23, 73728, v23
    ds_read2_b32 v[32:33], v23 offset0:0 offset1:2
    ds_read2_b32 v[34:35], v23 offset0:4 offset1:6
    v_mul_u32_u24 v16, 4682, v15
    v_lshrrev_b32 v16, 16, v16
    v_mul_u32_u24 v17, 14, v16
    v_sub_u32 v17, v15, v17
    v_lshrrev_b32 v18, 2, v17
    v_lshlrev_b32 v18, 10, v18
    v_and_b32 v19, 3, v17
    v_lshlrev_b32 v19, 8, v19
    v_add_u32 v18, v18, v19
    v_and_b32 v19, 1, v17
    v_lshlrev_b32 v19, 9, v19
    v_add_u32 v20, 2048, v19
    v_add_u32 v21, 3072, v19
    v_add_u32 v22, 2304, v19
    v_cmp_le_u32 vcc, 8, v17
    s_nop 1
    v_cndmask_b32 v18, v18, v20, vcc
    v_cmp_le_u32 vcc, 10, v17
    s_nop 1
    v_cndmask_b32 v18, v18, v21, vcc
    v_cmp_le_u32 vcc, 12, v17
    s_nop 1
    v_cndmask_b32 v18, v18, v22, vcc
    v_lshlrev_b32 v16, 13, v16
    v_add_u32 v36, v16, v18
    v_add3_u32 v36, v36, v26, s39
    s_waitcnt lgkmcnt(0)
    global_store_dwordx4 v24, v[28:31], s[24:25] sc1
    global_store_dwordx4 v36, v[32:35], s[26:27] sc1
    v_add_u32 v15, 8, v14
    v_add_u32 v15, s34, v15
    v_min_u32 v15, 55, v15
    v_mul_u32_u24 v23, 896, v13
    v_lshlrev_b32 v24, 4, v15
    v_add_u32 v23, v23, v24
    v_add_u32 v23, 73728, v23
    ds_read_b128 v[28:31], v23
    v_lshrrev_b32 v24, 2, v15
    v_lshlrev_b32 v24, 11, v24
    v_and_b32 v25, 3, v15
    v_lshlrev_b32 v25, 8, v25
    v_lshlrev_b32 v26, 4, v13
    v_add3_u32 v24, v24, v25, v26
    v_add_u32 v24, s37, v24
    v_lshrrev_b32 v25, 1, v15
    v_lshlrev_b32 v25, 5, v25
    v_and_b32 v27, 1, v15
    v_lshlrev_b32 v27, 2, v27
    v_mul_u32_u24 v23, 896, v13
    v_add3_u32 v23, v23, v25, v27
    v_add_u32 v23, 73728, v23
    ds_read2_b32 v[32:33], v23 offset0:0 offset1:2
    ds_read2_b32 v[34:35], v23 offset0:4 offset1:6
    v_mul_u32_u24 v16, 4682, v15
    v_lshrrev_b32 v16, 16, v16
    v_mul_u32_u24 v17, 14, v16
    v_sub_u32 v17, v15, v17
    v_lshrrev_b32 v18, 2, v17
    v_lshlrev_b32 v18, 10, v18
    v_and_b32 v19, 3, v17
    v_lshlrev_b32 v19, 8, v19
    v_add_u32 v18, v18, v19
    v_and_b32 v19, 1, v17
    v_lshlrev_b32 v19, 9, v19
    v_add_u32 v20, 2048, v19
    v_add_u32 v21, 3072, v19
    v_add_u32 v22, 2304, v19
    v_cmp_le_u32 vcc, 8, v17
    s_nop 1
    v_cndmask_b32 v18, v18, v20, vcc
    v_cmp_le_u32 vcc, 10, v17
    s_nop 1
    v_cndmask_b32 v18, v18, v21, vcc
    v_cmp_le_u32 vcc, 12, v17
    s_nop 1
    v_cndmask_b32 v18, v18, v22, vcc
    v_lshlrev_b32 v16, 13, v16
    v_add_u32 v36, v16, v18
    v_add3_u32 v36, v36, v26, s39
    v_cmp_le_u32 vcc, 48, v1
    v_subrev_u32 v37, 6, v14
    v_lshlrev_b32 v37, 9, v37
    s_lshl_b32 s38, s20, 13
    v_add3_u32 v37, v37, v26, s38
    v_add_u32 v37, 3328, v37
    v_add_u32 v37, s39, v37
    v_cndmask_b32 v36, v36, v37, vcc
    s_waitcnt lgkmcnt(0)
    v_cndmask_b32 v32, v32, v39, vcc
    v_cndmask_b32 v33, v33, v39, vcc
    v_cndmask_b32 v34, v34, v39, vcc
    v_cndmask_b32 v35, v35, v39, vcc
    s_mov_b32 exec_hi, 0xffff
    global_store_dwordx4 v24, v[28:31], s[24:25] sc1
    s_mov_b32 exec_hi, -1
    global_store_dwordx4 v36, v[32:35], s[26:27] sc1
    v_mov_b32 v4, -1
    v_mov_b32 v5, -1
    v_mov_b32 v6, -1
    v_mov_b32 v7, -1
    v_lshlrev_b32 v3, 4, v0
    s_lshr_b32 s21, s2, 6
    s_and_b32 s22, s2, 63
    s_cmp_eq_u32 s21, 3
    s_cbranch_scc1 sequential_preLN__memory_aug_recurrent_mem_tr__mixer_gmlp__prompt_kernel_P_flags
    s_cmp_eq_u32 s21, 2
    s_cbranch_scc1 sequential_preLN__memory_aug_recurrent_mem_tr__mixer_gmlp__prompt_kernel_P_pi
    s_mul_i32 s23, s21, 0x100000
    s_lshl_b32 s28, s22, 13
    s_add_u32 s23, s23, s28
    s_add_u32 s23, s23, 0x1200000
    s_add_u32 s28, s16, s23
    s_addc_u32 s29, s17, 0
    s_cmp_eq_u32 s22, 0
    s_cbranch_scc1 sequential_preLN__memory_aug_recurrent_mem_tr__mixer_gmlp__prompt_kernel_P_p2
    global_store_dwordx4 v3, v[4:7], s[28:29] sc1
    s_nop 1
    v_add_u32 v3, 0x1000, v3
    global_store_dwordx4 v3, v[4:7], s[28:29] sc1
    s_nop 0
    s_branch sequential_preLN__memory_aug_recurrent_mem_tr__mixer_gmlp__prompt_kernel_P_p2
sequential_preLN__memory_aug_recurrent_mem_tr__mixer_gmlp__prompt_kernel_P_pi:
    s_mul_i32 s23, s22, 10368
    s_add_u32 s23, s23, 0x1400000
    s_add_u32 s28, s16, s23
    s_addc_u32 s29, s17, 0
    global_store_dwordx4 v3, v[4:7], s[28:29] sc1
    v_add_u32 v8, 0x1000, v3
    global_store_dwordx4 v8, v[4:7], s[28:29] sc1
    s_nop 1
    v_add_u32 v8, 0x2000, v3
    v_cmp_gt_u32 vcc, 128, v0
    s_nop 1
    v_cndmask_b32 v4, 0, v4, vcc
    v_cndmask_b32 v5, 0, v5, vcc
    v_cndmask_b32 v6, 0, v6, vcc
    v_cndmask_b32 v7, 0, v7, vcc
    v_cmp_gt_u32 vcc, 136, v0
    s_nop 0
    s_and_saveexec_b64 s[34:35], vcc
    s_nop 3
    s_cbranch_execz sequential_preLN__memory_aug_recurrent_mem_tr__mixer_gmlp__prompt_kernel_P_pi2
    global_store_dwordx4 v8, v[4:7], s[28:29] sc1
    s_nop 1
sequential_preLN__memory_aug_recurrent_mem_tr__mixer_gmlp__prompt_kernel_P_pi2:
    s_mov_b64 exec, s[34:35]
    s_nop 3
    s_branch sequential_preLN__memory_aug_recurrent_mem_tr__mixer_gmlp__prompt_kernel_P_p2
sequential_preLN__memory_aug_recurrent_mem_tr__mixer_gmlp__prompt_kernel_P_flags:
    s_cmp_lg_u32 s20, 0
    s_cbranch_scc1 sequential_preLN__memory_aug_recurrent_mem_tr__mixer_gmlp__prompt_kernel_P_p2
    s_lshl_b32 s23, s22, 10
    s_add_u32 s23, s23, 0x1500000
    s_add_u32 s28, s16, s23
    s_addc_u32 s29, s17, 0
    v_mov_b64 v[4:5], 0
    v_mov_b64 v[6:7], 0
    global_store_dwordx4 v3, v[4:7], s[28:29] sc1
    s_nop 1
sequential_preLN__memory_aug_recurrent_mem_tr__mixer_gmlp__prompt_kernel_P_p2:
    v_and_b32 v2, 15, v1
    v_lshrrev_b32 v3, 4, v1
    v_lshrrev_b32 v4, 2, v2
    v_sub_u32 v4, 4, v4
    v_and_b32 v4, 3, v4
    v_xor_b32 v4, v4, v3
    v_lshlrev_b32 v5, 2, v2
    v_add_u32 v4, v4, v5
    v_lshlrev_b32 v4, 4, v4
    s_lshl_b32 s28, s20, 12
    s_add_u32 s28, s28, 73728
    v_lshlrev_b32 v5, 4, v1
    v_add_u32 v5, s28, v5
    v_add_u32 v6, s28, v4
    s_waitcnt vmcnt(0)
    s_barrier
    s_cmp_ge_u32 s62, 7
    s_cbranch_scc1 sequential_preLN__memory_aug_recurrent_mem_tr__mixer_gmlp__prompt_kernel_P_p4
    s_cmp_ge_u32 s2, 128
    s_cbranch_scc1 sequential_preLN__memory_aug_recurrent_mem_tr__mixer_gmlp__prompt_kernel_P_btask
    v_add_u32 v7, 16384, v4
    s_lshl_b32 s28, s60, 2
    s_add_u32 s28, s28, s61
    s_mul_i32 s28, s28, 49
    s_add_u32 s28, s28, s62
    s_lshl_b32 s28, s28, 11
    s_add_u32 s28, s28, 0x400000
    s_add_u32 s42, s16, s28
    s_addc_u32 s43, s17, 0
    s_mov_b32 s40, 0x3db8aa3b
    s_mov_b32 s41, 0x3db8aa3b
    ds_read_b128 v[172:175], v7 offset:0
    ds_read_b128 v[176:179], v7 offset:1024
    ds_read_b128 v[180:183], v7 offset:2048
    ds_read_b128 v[184:187], v7 offset:3072
    s_waitcnt lgkmcnt(0)
    ds_read_b128 v[200:203], v7 offset:7168
    ds_read_b128 v[204:207], v7 offset:8192
    ds_read_b128 v[208:211], v7 offset:9216
    ds_read_b128 v[212:215], v7 offset:10240
    v_mfma_f32_16x16x32_bf16 v[44:47], a[0:3], v[172:175], 0
    v_mfma_f32_16x16x32_bf16 v[72:75], a[4:7], v[172:175], 0
    v_mfma_f32_16x16x32_bf16 v[100:103], a[8:11], v[172:175], 0
    v_mfma_f32_16x16x32_bf16 v[128:131], a[12:15], v[172:175], 0
    v_mfma_f32_16x16x32_bf16 v[48:51], a[0:3], v[176:179], 0
    v_mfma_f32_16x16x32_bf16 v[76:79], a[4:7], v[176:179], 0
    v_mfma_f32_16x16x32_bf16 v[104:107], a[8:11], v[176:179], 0
    v_mfma_f32_16x16x32_bf16 v[132:135], a[12:15], v[176:179], 0
    v_mfma_f32_16x16x32_bf16 v[52:55], a[0:3], v[180:183], 0
    v_mfma_f32_16x16x32_bf16 v[80:83], a[4:7], v[180:183], 0
    v_mfma_f32_16x16x32_bf16 v[108:111], a[8:11], v[180:183], 0
    v_mfma_f32_16x16x32_bf16 v[136:139], a[12:15], v[180:183], 0
    v_mfma_f32_16x16x32_bf16 v[56:59], a[0:3], v[184:187], 0
    v_mfma_f32_16x16x32_bf16 v[84:87], a[4:7], v[184:187], 0
    v_mfma_f32_16x16x32_bf16 v[112:115], a[8:11], v[184:187], 0
    v_mfma_f32_16x16x32_bf16 v[140:143], a[12:15], v[184:187], 0
    s_waitcnt lgkmcnt(0)
    ds_read_b128 v[172:175], v7 offset:14336
    ds_read_b128 v[176:179], v7 offset:15360
    ds_read_b128 v[180:183], v7 offset:16384
    ds_read_b128 v[184:187], v7 offset:17408
    v_mfma_f32_16x16x32_bf16 v[44:47], a[16:19], v[200:203], v[44:47]
    v_mfma_f32_16x16x32_bf16 v[72:75], a[20:23], v[200:203], v[72:75]
    v_mfma_f32_16x16x32_bf16 v[100:103], a[24:27], v[200:203], v[100:103]
    v_mfma_f32_16x16x32_bf16 v[128:131], a[28:31], v[200:203], v[128:131]
    v_mfma_f32_16x16x32_bf16 v[48:51], a[16:19], v[204:207], v[48:51]
    v_mfma_f32_16x16x32_bf16 v[76:79], a[20:23], v[204:207], v[76:79]
    v_mfma_f32_16x16x32_bf16 v[104:107], a[24:27], v[204:207], v[104:107]
    v_mfma_f32_16x16x32_bf16 v[132:135], a[28:31], v[204:207], v[132:135]
    v_mfma_f32_16x16x32_bf16 v[52:55], a[16:19], v[208:211], v[52:55]
    v_mfma_f32_16x16x32_bf16 v[80:83], a[20:23], v[208:211], v[80:83]
    v_mfma_f32_16x16x32_bf16 v[108:111], a[24:27], v[208:211], v[108:111]
    v_mfma_f32_16x16x32_bf16 v[136:139], a[28:31], v[208:211], v[136:139]
    v_mfma_f32_16x16x32_bf16 v[56:59], a[16:19], v[212:215], v[56:59]
    v_mfma_f32_16x16x32_bf16 v[84:87], a[20:23], v[212:215], v[84:87]
    v_mfma_f32_16x16x32_bf16 v[112:115], a[24:27], v[212:215], v[112:115]
    v_mfma_f32_16x16x32_bf16 v[140:143], a[28:31], v[212:215], v[140:143]
    s_waitcnt lgkmcnt(0)
    ds_read_b128 v[200:203], v7 offset:21504
    ds_read_b128 v[204:207], v7 offset:22528
    ds_read_b128 v[208:211], v7 offset:23552
    ds_read_b128 v[212:215], v7 offset:24576
    v_mfma_f32_16x16x32_bf16 v[44:47], a[32:35], v[172:175], v[44:47]
    v_mfma_f32_16x16x32_bf16 v[72:75], a[36:39], v[172:175], v[72:75]
    v_mfma_f32_16x16x32_bf16 v[100:103], a[40:43], v[172:175], v[100:103]
    v_mfma_f32_16x16x32_bf16 v[128:131], a[44:47], v[172:175], v[128:131]
    v_mfma_f32_16x16x32_bf16 v[48:51], a[32:35], v[176:179], v[48:51]
    v_mfma_f32_16x16x32_bf16 v[76:79], a[36:39], v[176:179], v[76:79]
    v_mfma_f32_16x16x32_bf16 v[104:107], a[40:43], v[176:179], v[104:107]
    v_mfma_f32_16x16x32_bf16 v[132:135], a[44:47], v[176:179], v[132:135]
    v_mfma_f32_16x16x32_bf16 v[52:55], a[32:35], v[180:183], v[52:55]
    v_mfma_f32_16x16x32_bf16 v[80:83], a[36:39], v[180:183], v[80:83]
    v_mfma_f32_16x16x32_bf16 v[108:111], a[40:43], v[180:183], v[108:111]
    v_mfma_f32_16x16x32_bf16 v[136:139], a[44:47], v[180:183], v[136:139]
    v_mfma_f32_16x16x32_bf16 v[56:59], a[32:35], v[184:187], v[56:59]
    v_mfma_f32_16x16x32_bf16 v[84:87], a[36:39], v[184:187], v[84:87]
    v_mfma_f32_16x16x32_bf16 v[112:115], a[40:43], v[184:187], v[112:115]
    v_mfma_f32_16x16x32_bf16 v[140:143], a[44:47], v[184:187], v[140:143]
    s_waitcnt lgkmcnt(0)
    ds_read_b128 v[172:175], v7 offset:28672
    ds_read_b128 v[176:179], v7 offset:29696
    ds_read_b128 v[180:183], v7 offset:30720
    ds_read_b128 v[184:187], v7 offset:31744
    v_mfma_f32_16x16x32_bf16 v[44:47], a[48:51], v[200:203], v[44:47]
    v_mfma_f32_16x16x32_bf16 v[72:75], a[52:55], v[200:203], v[72:75]
    v_mfma_f32_16x16x32_bf16 v[100:103], a[56:59], v[200:203], v[100:103]
    v_mfma_f32_16x16x32_bf16 v[128:131], a[60:63], v[200:203], v[128:131]
    v_mfma_f32_16x16x32_bf16 v[48:51], a[48:51], v[204:207], v[48:51]
    v_mfma_f32_16x16x32_bf16 v[76:79], a[52:55], v[204:207], v[76:79]
    v_mfma_f32_16x16x32_bf16 v[104:107], a[56:59], v[204:207], v[104:107]
    v_mfma_f32_16x16x32_bf16 v[132:135], a[60:63], v[204:207], v[132:135]
    v_mfma_f32_16x16x32_bf16 v[52:55], a[48:51], v[208:211], v[52:55]
    v_mfma_f32_16x16x32_bf16 v[80:83], a[52:55], v[208:211], v[80:83]
    v_mfma_f32_16x16x32_bf16 v[108:111], a[56:59], v[208:211], v[108:111]
    v_mfma_f32_16x16x32_bf16 v[136:139], a[60:63], v[208:211], v[136:139]
    v_mfma_f32_16x16x32_bf16 v[56:59], a[48:51], v[212:215], v[56:59]
    v_mfma_f32_16x16x32_bf16 v[84:87], a[52:55], v[212:215], v[84:87]
    v_mfma_f32_16x16x32_bf16 v[112:115], a[56:59], v[212:215], v[112:115]
    v_mfma_f32_16x16x32_bf16 v[140:143], a[60:63], v[212:215], v[140:143]
    s_waitcnt lgkmcnt(0)
    ds_read_b128 v[200:203], v7 offset:35840
    ds_read_b128 v[204:207], v7 offset:36864
    ds_read_b128 v[208:211], v7 offset:37888
    ds_read_b128 v[212:215], v7 offset:38912
    v_mfma_f32_16x16x32_bf16 v[44:47], a[64:67], v[172:175], v[44:47]
    v_mfma_f32_16x16x32_bf16 v[72:75], a[68:71], v[172:175], v[72:75]
    v_mfma_f32_16x16x32_bf16 v[100:103], a[72:75], v[172:175], v[100:103]
    v_mfma_f32_16x16x32_bf16 v[128:131], a[76:79], v[172:175], v[128:131]
    v_mfma_f32_16x16x32_bf16 v[48:51], a[64:67], v[176:179], v[48:51]
    v_mfma_f32_16x16x32_bf16 v[76:79], a[68:71], v[176:179], v[76:79]
    v_mfma_f32_16x16x32_bf16 v[104:107], a[72:75], v[176:179], v[104:107]
    v_mfma_f32_16x16x32_bf16 v[132:135], a[76:79], v[176:179], v[132:135]
    v_mfma_f32_16x16x32_bf16 v[52:55], a[64:67], v[180:183], v[52:55]
    v_mfma_f32_16x16x32_bf16 v[80:83], a[68:71], v[180:183], v[80:83]
    v_mfma_f32_16x16x32_bf16 v[108:111], a[72:75], v[180:183], v[108:111]
    v_mfma_f32_16x16x32_bf16 v[136:139], a[76:79], v[180:183], v[136:139]
    v_mfma_f32_16x16x32_bf16 v[56:59], a[64:67], v[184:187], v[56:59]
    v_mfma_f32_16x16x32_bf16 v[84:87], a[68:71], v[184:187], v[84:87]
    v_mfma_f32_16x16x32_bf16 v[112:115], a[72:75], v[184:187], v[112:115]
    v_mfma_f32_16x16x32_bf16 v[140:143], a[76:79], v[184:187], v[140:143]
    s_waitcnt lgkmcnt(0)
    ds_read_b128 v[172:175], v7 offset:43008
    ds_read_b128 v[176:179], v7 offset:44032
    ds_read_b128 v[180:183], v7 offset:45056
    ds_read_b128 v[184:187], v7 offset:46080
    v_mfma_f32_16x16x32_bf16 v[44:47], a[80:83], v[200:203], v[44:47]
    v_mfma_f32_16x16x32_bf16 v[72:75], a[84:87], v[200:203], v[72:75]
    v_mfma_f32_16x16x32_bf16 v[100:103], a[88:91], v[200:203], v[100:103]
    v_mfma_f32_16x16x32_bf16 v[128:131], a[92:95], v[200:203], v[128:131]
    v_mfma_f32_16x16x32_bf16 v[48:51], a[80:83], v[204:207], v[48:51]
    v_mfma_f32_16x16x32_bf16 v[76:79], a[84:87], v[204:207], v[76:79]
    v_mfma_f32_16x16x32_bf16 v[104:107], a[88:91], v[204:207], v[104:107]
    v_mfma_f32_16x16x32_bf16 v[132:135], a[92:95], v[204:207], v[132:135]
    v_mfma_f32_16x16x32_bf16 v[52:55], a[80:83], v[208:211], v[52:55]
    v_mfma_f32_16x16x32_bf16 v[80:83], a[84:87], v[208:211], v[80:83]
    v_mfma_f32_16x16x32_bf16 v[108:111], a[88:91], v[208:211], v[108:111]
    v_mfma_f32_16x16x32_bf16 v[136:139], a[92:95], v[208:211], v[136:139]
    v_mfma_f32_16x16x32_bf16 v[56:59], a[80:83], v[212:215], v[56:59]
    v_mfma_f32_16x16x32_bf16 v[84:87], a[84:87], v[212:215], v[84:87]
    v_mfma_f32_16x16x32_bf16 v[112:115], a[88:91], v[212:215], v[112:115]
    v_mfma_f32_16x16x32_bf16 v[140:143], a[92:95], v[212:215], v[140:143]
    s_waitcnt lgkmcnt(0)
    ds_read_b128 v[200:203], v7 offset:50176
    ds_read_b128 v[204:207], v7 offset:51200
    ds_read_b128 v[208:211], v7 offset:52224
    ds_read_b128 v[212:215], v7 offset:53248
    v_mfma_f32_16x16x32_bf16 v[44:47], a[96:99], v[172:175], v[44:47]
    v_mfma_f32_16x16x32_bf16 v[72:75], a[100:103], v[172:175], v[72:75]
    v_mfma_f32_16x16x32_bf16 v[100:103], a[104:107], v[172:175], v[100:103]
    v_mfma_f32_16x16x32_bf16 v[128:131], a[108:111], v[172:175], v[128:131]
    v_mfma_f32_16x16x32_bf16 v[48:51], a[96:99], v[176:179], v[48:51]
    v_mfma_f32_16x16x32_bf16 v[76:79], a[100:103], v[176:179], v[76:79]
    v_mfma_f32_16x16x32_bf16 v[104:107], a[104:107], v[176:179], v[104:107]
    v_mfma_f32_16x16x32_bf16 v[132:135], a[108:111], v[176:179], v[132:135]
    v_mfma_f32_16x16x32_bf16 v[52:55], a[96:99], v[180:183], v[52:55]
    v_mfma_f32_16x16x32_bf16 v[80:83], a[100:103], v[180:183], v[80:83]
    v_mfma_f32_16x16x32_bf16 v[108:111], a[104:107], v[180:183], v[108:111]
    v_mfma_f32_16x16x32_bf16 v[136:139], a[108:111], v[180:183], v[136:139]
    v_mfma_f32_16x16x32_bf16 v[56:59], a[96:99], v[184:187], v[56:59]
    v_mfma_f32_16x16x32_bf16 v[84:87], a[100:103], v[184:187], v[84:87]
    v_mfma_f32_16x16x32_bf16 v[112:115], a[104:107], v[184:187], v[112:115]
    v_mfma_f32_16x16x32_bf16 v[140:143], a[108:111], v[184:187], v[140:143]
    s_waitcnt lgkmcnt(0)
    v_mfma_f32_16x16x32_bf16 v[44:47], a[112:115], v[200:203], v[44:47]
    v_mfma_f32_16x16x32_bf16 v[72:75], a[116:119], v[200:203], v[72:75]
    v_mfma_f32_16x16x32_bf16 v[100:103], a[120:123], v[200:203], v[100:103]
    v_mfma_f32_16x16x32_bf16 v[128:131], a[124:127], v[200:203], v[128:131]
    v_mfma_f32_16x16x32_bf16 v[48:51], a[112:115], v[204:207], v[48:51]
    v_mfma_f32_16x16x32_bf16 v[76:79], a[116:119], v[204:207], v[76:79]
    v_mfma_f32_16x16x32_bf16 v[104:107], a[120:123], v[204:207], v[104:107]
    v_mfma_f32_16x16x32_bf16 v[132:135], a[124:127], v[204:207], v[132:135]
    v_mfma_f32_16x16x32_bf16 v[52:55], a[112:115], v[208:211], v[52:55]
    v_mfma_f32_16x16x32_bf16 v[80:83], a[116:119], v[208:211], v[80:83]
    v_mfma_f32_16x16x32_bf16 v[108:111], a[120:123], v[208:211], v[108:111]
    v_mfma_f32_16x16x32_bf16 v[136:139], a[124:127], v[208:211], v[136:139]
    v_mfma_f32_16x16x32_bf16 v[56:59], a[112:115], v[212:215], v[56:59]
    v_mfma_f32_16x16x32_bf16 v[84:87], a[116:119], v[212:215], v[84:87]
    v_mfma_f32_16x16x32_bf16 v[112:115], a[120:123], v[212:215], v[112:115]
    v_mfma_f32_16x16x32_bf16 v[140:143], a[124:127], v[212:215], v[140:143]
    v_lshlrev_b32 v3, 4, v1
    v_pk_mul_f32 v[44:45], v[44:45], s[40:41]
    v_pk_mul_f32 v[46:47], v[46:47], s[40:41]
    v_pk_mul_f32 v[72:73], v[72:73], s[40:41]
    v_pk_mul_f32 v[74:75], v[74:75], s[40:41]
    v_cvt_pk_bf16_f32 v20, v44, v45
    v_cvt_pk_bf16_f32 v21, v46, v47
    v_cvt_pk_bf16_f32 v22, v72, v73
    v_cvt_pk_bf16_f32 v23, v74, v75
    global_store_dwordx4 v3, v[20:23], s[42:43] offset:0 sc1
    v_pk_mul_f32 v[100:101], v[100:101], s[40:41]
    v_pk_mul_f32 v[102:103], v[102:103], s[40:41]
    v_pk_mul_f32 v[128:129], v[128:129], s[40:41]
    v_pk_mul_f32 v[130:131], v[130:131], s[40:41]
    v_cvt_pk_bf16_f32 v24, v100, v101
    v_cvt_pk_bf16_f32 v25, v102, v103
    v_cvt_pk_bf16_f32 v26, v128, v129
    v_cvt_pk_bf16_f32 v27, v130, v131
    global_store_dwordx4 v3, v[24:27], s[42:43] offset:1024 sc1
    s_add_u32 s42, s42, 14336
    s_addc_u32 s43, s43, 0
    v_pk_mul_f32 v[48:49], v[48:49], s[40:41]
    v_pk_mul_f32 v[50:51], v[50:51], s[40:41]
    v_pk_mul_f32 v[76:77], v[76:77], s[40:41]
    v_pk_mul_f32 v[78:79], v[78:79], s[40:41]
    v_cvt_pk_bf16_f32 v28, v48, v49
    v_cvt_pk_bf16_f32 v29, v50, v51
    v_cvt_pk_bf16_f32 v30, v76, v77
    v_cvt_pk_bf16_f32 v31, v78, v79
    global_store_dwordx4 v3, v[28:31], s[42:43] offset:0 sc1
    v_pk_mul_f32 v[104:105], v[104:105], s[40:41]
    v_pk_mul_f32 v[106:107], v[106:107], s[40:41]
    v_pk_mul_f32 v[132:133], v[132:133], s[40:41]
    v_pk_mul_f32 v[134:135], v[134:135], s[40:41]
    v_cvt_pk_bf16_f32 v32, v104, v105
    v_cvt_pk_bf16_f32 v33, v106, v107
    v_cvt_pk_bf16_f32 v34, v132, v133
    v_cvt_pk_bf16_f32 v35, v134, v135
    global_store_dwordx4 v3, v[32:35], s[42:43] offset:1024 sc1
    s_add_u32 s42, s42, 14336
    s_addc_u32 s43, s43, 0
    v_pk_mul_f32 v[52:53], v[52:53], s[40:41]
    v_pk_mul_f32 v[54:55], v[54:55], s[40:41]
    v_pk_mul_f32 v[80:81], v[80:81], s[40:41]
    v_pk_mul_f32 v[82:83], v[82:83], s[40:41]
    v_cvt_pk_bf16_f32 v20, v52, v53
    v_cvt_pk_bf16_f32 v21, v54, v55
    v_cvt_pk_bf16_f32 v22, v80, v81
    v_cvt_pk_bf16_f32 v23, v82, v83
    global_store_dwordx4 v3, v[20:23], s[42:43] offset:0 sc1
    v_pk_mul_f32 v[108:109], v[108:109], s[40:41]
    v_pk_mul_f32 v[110:111], v[110:111], s[40:41]
    v_pk_mul_f32 v[136:137], v[136:137], s[40:41]
    v_pk_mul_f32 v[138:139], v[138:139], s[40:41]
    v_cvt_pk_bf16_f32 v24, v108, v109
    v_cvt_pk_bf16_f32 v25, v110, v111
    v_cvt_pk_bf16_f32 v26, v136, v137
    v_cvt_pk_bf16_f32 v27, v138, v139
    global_store_dwordx4 v3, v[24:27], s[42:43] offset:1024 sc1
    s_add_u32 s42, s42, 14336
    s_addc_u32 s43, s43, 0
    v_pk_mul_f32 v[56:57], v[56:57], s[40:41]
    v_pk_mul_f32 v[58:59], v[58:59], s[40:41]
    v_pk_mul_f32 v[84:85], v[84:85], s[40:41]
    v_pk_mul_f32 v[86:87], v[86:87], s[40:41]
    v_cvt_pk_bf16_f32 v28, v56, v57
    v_cvt_pk_bf16_f32 v29, v58, v59
    v_cvt_pk_bf16_f32 v30, v84, v85
    v_cvt_pk_bf16_f32 v31, v86, v87
    global_store_dwordx4 v3, v[28:31], s[42:43] offset:0 sc1
    v_pk_mul_f32 v[112:113], v[112:113], s[40:41]
    v_pk_mul_f32 v[114:115], v[114:115], s[40:41]
    v_pk_mul_f32 v[140:141], v[140:141], s[40:41]
    v_pk_mul_f32 v[142:143], v[142:143], s[40:41]
    v_cvt_pk_bf16_f32 v32, v112, v113
    v_cvt_pk_bf16_f32 v33, v114, v115
    v_cvt_pk_bf16_f32 v34, v140, v141
    v_cvt_pk_bf16_f32 v35, v142, v143
    global_store_dwordx4 v3, v[32:35], s[42:43] offset:1024 sc1
    s_add_u32 s42, s42, 14336
    s_addc_u32 s43, s43, 0
    ds_read_b128 v[188:191], v7 offset:4096
    ds_read_b128 v[192:195], v7 offset:5120
    ds_read_b128 v[196:199], v7 offset:6144
    s_waitcnt lgkmcnt(0)
    ds_read_b128 v[216:219], v7 offset:11264
    ds_read_b128 v[220:223], v7 offset:12288
    ds_read_b128 v[224:227], v7 offset:13312
    v_mfma_f32_16x16x32_bf16 v[60:63], a[0:3], v[188:191], 0
    v_mfma_f32_16x16x32_bf16 v[88:91], a[4:7], v[188:191], 0
    v_mfma_f32_16x16x32_bf16 v[116:119], a[8:11], v[188:191], 0
    v_mfma_f32_16x16x32_bf16 v[144:147], a[12:15], v[188:191], 0
    v_mfma_f32_16x16x32_bf16 v[64:67], a[0:3], v[192:195], 0
    v_mfma_f32_16x16x32_bf16 v[92:95], a[4:7], v[192:195], 0
    v_mfma_f32_16x16x32_bf16 v[120:123], a[8:11], v[192:195], 0
    v_mfma_f32_16x16x32_bf16 v[148:151], a[12:15], v[192:195], 0
    v_mfma_f32_16x16x32_bf16 v[68:71], a[0:3], v[196:199], 0
    v_mfma_f32_16x16x32_bf16 v[96:99], a[4:7], v[196:199], 0
    v_mfma_f32_16x16x32_bf16 v[124:127], a[8:11], v[196:199], 0
    v_mfma_f32_16x16x32_bf16 v[152:155], a[12:15], v[196:199], 0
    s_waitcnt lgkmcnt(0)
    ds_read_b128 v[188:191], v7 offset:18432
    ds_read_b128 v[192:195], v7 offset:19456
    ds_read_b128 v[196:199], v7 offset:20480
    v_mfma_f32_16x16x32_bf16 v[60:63], a[16:19], v[216:219], v[60:63]
    v_mfma_f32_16x16x32_bf16 v[88:91], a[20:23], v[216:219], v[88:91]
    v_mfma_f32_16x16x32_bf16 v[116:119], a[24:27], v[216:219], v[116:119]
    v_mfma_f32_16x16x32_bf16 v[144:147], a[28:31], v[216:219], v[144:147]
    v_mfma_f32_16x16x32_bf16 v[64:67], a[16:19], v[220:223], v[64:67]
    v_mfma_f32_16x16x32_bf16 v[92:95], a[20:23], v[220:223], v[92:95]
    v_mfma_f32_16x16x32_bf16 v[120:123], a[24:27], v[220:223], v[120:123]
    v_mfma_f32_16x16x32_bf16 v[148:151], a[28:31], v[220:223], v[148:151]
    v_mfma_f32_16x16x32_bf16 v[68:71], a[16:19], v[224:227], v[68:71]
    v_mfma_f32_16x16x32_bf16 v[96:99], a[20:23], v[224:227], v[96:99]
    v_mfma_f32_16x16x32_bf16 v[124:127], a[24:27], v[224:227], v[124:127]
    v_mfma_f32_16x16x32_bf16 v[152:155], a[28:31], v[224:227], v[152:155]
    s_waitcnt lgkmcnt(0)
    ds_read_b128 v[216:219], v7 offset:25600
    ds_read_b128 v[220:223], v7 offset:26624
    ds_read_b128 v[224:227], v7 offset:27648
    v_mfma_f32_16x16x32_bf16 v[60:63], a[32:35], v[188:191], v[60:63]
    v_mfma_f32_16x16x32_bf16 v[88:91], a[36:39], v[188:191], v[88:91]
    v_mfma_f32_16x16x32_bf16 v[116:119], a[40:43], v[188:191], v[116:119]
    v_mfma_f32_16x16x32_bf16 v[144:147], a[44:47], v[188:191], v[144:147]
    v_mfma_f32_16x16x32_bf16 v[64:67], a[32:35], v[192:195], v[64:67]
    v_mfma_f32_16x16x32_bf16 v[92:95], a[36:39], v[192:195], v[92:95]
    v_mfma_f32_16x16x32_bf16 v[120:123], a[40:43], v[192:195], v[120:123]
    v_mfma_f32_16x16x32_bf16 v[148:151], a[44:47], v[192:195], v[148:151]
    v_mfma_f32_16x16x32_bf16 v[68:71], a[32:35], v[196:199], v[68:71]
    v_mfma_f32_16x16x32_bf16 v[96:99], a[36:39], v[196:199], v[96:99]
    v_mfma_f32_16x16x32_bf16 v[124:127], a[40:43], v[196:199], v[124:127]
    v_mfma_f32_16x16x32_bf16 v[152:155], a[44:47], v[196:199], v[152:155]
    s_waitcnt lgkmcnt(0)
    ds_read_b128 v[188:191], v7 offset:32768
    ds_read_b128 v[192:195], v7 offset:33792
    ds_read_b128 v[196:199], v7 offset:34816
    v_mfma_f32_16x16x32_bf16 v[60:63], a[48:51], v[216:219], v[60:63]
    v_mfma_f32_16x16x32_bf16 v[88:91], a[52:55], v[216:219], v[88:91]
    v_mfma_f32_16x16x32_bf16 v[116:119], a[56:59], v[216:219], v[116:119]
    v_mfma_f32_16x16x32_bf16 v[144:147], a[60:63], v[216:219], v[144:147]
    v_mfma_f32_16x16x32_bf16 v[64:67], a[48:51], v[220:223], v[64:67]
    v_mfma_f32_16x16x32_bf16 v[92:95], a[52:55], v[220:223], v[92:95]
    v_mfma_f32_16x16x32_bf16 v[120:123], a[56:59], v[220:223], v[120:123]
    v_mfma_f32_16x16x32_bf16 v[148:151], a[60:63], v[220:223], v[148:151]
    v_mfma_f32_16x16x32_bf16 v[68:71], a[48:51], v[224:227], v[68:71]
    v_mfma_f32_16x16x32_bf16 v[96:99], a[52:55], v[224:227], v[96:99]
    v_mfma_f32_16x16x32_bf16 v[124:127], a[56:59], v[224:227], v[124:127]
    v_mfma_f32_16x16x32_bf16 v[152:155], a[60:63], v[224:227], v[152:155]
    s_waitcnt lgkmcnt(0)
    ds_read_b128 v[216:219], v7 offset:39936
    ds_read_b128 v[220:223], v7 offset:40960
    ds_read_b128 v[224:227], v7 offset:41984
    v_mfma_f32_16x16x32_bf16 v[60:63], a[64:67], v[188:191], v[60:63]
    v_mfma_f32_16x16x32_bf16 v[88:91], a[68:71], v[188:191], v[88:91]
    v_mfma_f32_16x16x32_bf16 v[116:119], a[72:75], v[188:191], v[116:119]
    v_mfma_f32_16x16x32_bf16 v[144:147], a[76:79], v[188:191], v[144:147]
    v_mfma_f32_16x16x32_bf16 v[64:67], a[64:67], v[192:195], v[64:67]
    v_mfma_f32_16x16x32_bf16 v[92:95], a[68:71], v[192:195], v[92:95]
    v_mfma_f32_16x16x32_bf16 v[120:123], a[72:75], v[192:195], v[120:123]
    v_mfma_f32_16x16x32_bf16 v[148:151], a[76:79], v[192:195], v[148:151]
    v_mfma_f32_16x16x32_bf16 v[68:71], a[64:67], v[196:199], v[68:71]
    v_mfma_f32_16x16x32_bf16 v[96:99], a[68:71], v[196:199], v[96:99]
    v_mfma_f32_16x16x32_bf16 v[124:127], a[72:75], v[196:199], v[124:127]
    v_mfma_f32_16x16x32_bf16 v[152:155], a[76:79], v[196:199], v[152:155]
    s_waitcnt lgkmcnt(0)
    ds_read_b128 v[188:191], v7 offset:47104
    ds_read_b128 v[192:195], v7 offset:48128
    ds_read_b128 v[196:199], v7 offset:49152
    v_mfma_f32_16x16x32_bf16 v[60:63], a[80:83], v[216:219], v[60:63]
    v_mfma_f32_16x16x32_bf16 v[88:91], a[84:87], v[216:219], v[88:91]
    v_mfma_f32_16x16x32_bf16 v[116:119], a[88:91], v[216:219], v[116:119]
    v_mfma_f32_16x16x32_bf16 v[144:147], a[92:95], v[216:219], v[144:147]
    v_mfma_f32_16x16x32_bf16 v[64:67], a[80:83], v[220:223], v[64:67]
    v_mfma_f32_16x16x32_bf16 v[92:95], a[84:87], v[220:223], v[92:95]
    v_mfma_f32_16x16x32_bf16 v[120:123], a[88:91], v[220:223], v[120:123]
    v_mfma_f32_16x16x32_bf16 v[148:151], a[92:95], v[220:223], v[148:151]
    v_mfma_f32_16x16x32_bf16 v[68:71], a[80:83], v[224:227], v[68:71]
    v_mfma_f32_16x16x32_bf16 v[96:99], a[84:87], v[224:227], v[96:99]
    v_mfma_f32_16x16x32_bf16 v[124:127], a[88:91], v[224:227], v[124:127]
    v_mfma_f32_16x16x32_bf16 v[152:155], a[92:95], v[224:227], v[152:155]
    s_waitcnt lgkmcnt(0)
    ds_read_b128 v[216:219], v7 offset:54272
    ds_read_b128 v[220:223], v7 offset:55296
    ds_read_b128 v[224:227], v7 offset:56320
    v_mfma_f32_16x16x32_bf16 v[60:63], a[96:99], v[188:191], v[60:63]
    v_mfma_f32_16x16x32_bf16 v[88:91], a[100:103], v[188:191], v[88:91]
    v_mfma_f32_16x16x32_bf16 v[116:119], a[104:107], v[188:191], v[116:119]
    v_mfma_f32_16x16x32_bf16 v[144:147], a[108:111], v[188:191], v[144:147]
    v_mfma_f32_16x16x32_bf16 v[64:67], a[96:99], v[192:195], v[64:67]
    v_mfma_f32_16x16x32_bf16 v[92:95], a[100:103], v[192:195], v[92:95]
    v_mfma_f32_16x16x32_bf16 v[120:123], a[104:107], v[192:195], v[120:123]
    v_mfma_f32_16x16x32_bf16 v[148:151], a[108:111], v[192:195], v[148:151]
    v_mfma_f32_16x16x32_bf16 v[68:71], a[96:99], v[196:199], v[68:71]
    v_mfma_f32_16x16x32_bf16 v[96:99], a[100:103], v[196:199], v[96:99]
    v_mfma_f32_16x16x32_bf16 v[124:127], a[104:107], v[196:199], v[124:127]
    v_mfma_f32_16x16x32_bf16 v[152:155], a[108:111], v[196:199], v[152:155]
    s_waitcnt lgkmcnt(0)
    v_mfma_f32_16x16x32_bf16 v[60:63], a[112:115], v[216:219], v[60:63]
    v_mfma_f32_16x16x32_bf16 v[88:91], a[116:119], v[216:219], v[88:91]
    v_mfma_f32_16x16x32_bf16 v[116:119], a[120:123], v[216:219], v[116:119]
    v_mfma_f32_16x16x32_bf16 v[144:147], a[124:127], v[216:219], v[144:147]
    v_mfma_f32_16x16x32_bf16 v[64:67], a[112:115], v[220:223], v[64:67]
    v_mfma_f32_16x16x32_bf16 v[92:95], a[116:119], v[220:223], v[92:95]
    v_mfma_f32_16x16x32_bf16 v[120:123], a[120:123], v[220:223], v[120:123]
    v_mfma_f32_16x16x32_bf16 v[148:151], a[124:127], v[220:223], v[148:151]
    v_mfma_f32_16x16x32_bf16 v[68:71], a[112:115], v[224:227], v[68:71]
    v_mfma_f32_16x16x32_bf16 v[96:99], a[116:119], v[224:227], v[96:99]
    v_mfma_f32_16x16x32_bf16 v[124:127], a[120:123], v[224:227], v[124:127]
    v_mfma_f32_16x16x32_bf16 v[152:155], a[124:127], v[224:227], v[152:155]
    v_lshlrev_b32 v3, 4, v1
    v_pk_mul_f32 v[60:61], v[60:61], s[40:41]
    v_pk_mul_f32 v[62:63], v[62:63], s[40:41]
    v_pk_mul_f32 v[88:89], v[88:89], s[40:41]
    v_pk_mul_f32 v[90:91], v[90:91], s[40:41]
    v_cvt_pk_bf16_f32 v20, v60, v61
    v_cvt_pk_bf16_f32 v21, v62, v63
    v_cvt_pk_bf16_f32 v22, v88, v89
    v_cvt_pk_bf16_f32 v23, v90, v91
    global_store_dwordx4 v3, v[20:23], s[42:43] offset:0 sc1
    v_pk_mul_f32 v[116:117], v[116:117], s[40:41]
    v_pk_mul_f32 v[118:119], v[118:119], s[40:41]
    v_pk_mul_f32 v[144:145], v[144:145], s[40:41]
    v_pk_mul_f32 v[146:147], v[146:147], s[40:41]
    v_cvt_pk_bf16_f32 v24, v116, v117
    v_cvt_pk_bf16_f32 v25, v118, v119
    v_cvt_pk_bf16_f32 v26, v144, v145
    v_cvt_pk_bf16_f32 v27, v146, v147
    global_store_dwordx4 v3, v[24:27], s[42:43] offset:1024 sc1
    s_add_u32 s42, s42, 14336
    s_addc_u32 s43, s43, 0
    v_pk_mul_f32 v[64:65], v[64:65], s[40:41]
    v_pk_mul_f32 v[66:67], v[66:67], s[40:41]
    v_pk_mul_f32 v[92:93], v[92:93], s[40:41]
    v_pk_mul_f32 v[94:95], v[94:95], s[40:41]
    v_cvt_pk_bf16_f32 v28, v64, v65
    v_cvt_pk_bf16_f32 v29, v66, v67
    v_cvt_pk_bf16_f32 v30, v92, v93
    v_cvt_pk_bf16_f32 v31, v94, v95
    global_store_dwordx4 v3, v[28:31], s[42:43] offset:0 sc1
    v_pk_mul_f32 v[120:121], v[120:121], s[40:41]
    v_pk_mul_f32 v[122:123], v[122:123], s[40:41]
    v_pk_mul_f32 v[148:149], v[148:149], s[40:41]
    v_pk_mul_f32 v[150:151], v[150:151], s[40:41]
    v_cvt_pk_bf16_f32 v32, v120, v121
    v_cvt_pk_bf16_f32 v33, v122, v123
    v_cvt_pk_bf16_f32 v34, v148, v149
    v_cvt_pk_bf16_f32 v35, v150, v151
    global_store_dwordx4 v3, v[32:35], s[42:43] offset:1024 sc1
    s_add_u32 s42, s42, 14336
    s_addc_u32 s43, s43, 0
    v_pk_mul_f32 v[68:69], v[68:69], s[40:41]
    v_pk_mul_f32 v[70:71], v[70:71], s[40:41]
    v_pk_mul_f32 v[96:97], v[96:97], s[40:41]
    v_pk_mul_f32 v[98:99], v[98:99], s[40:41]
    v_cvt_pk_bf16_f32 v20, v68, v69
    v_cvt_pk_bf16_f32 v21, v70, v71
    v_cvt_pk_bf16_f32 v22, v96, v97
    v_cvt_pk_bf16_f32 v23, v98, v99
    global_store_dwordx4 v3, v[20:23], s[42:43] offset:0 sc1
    v_pk_mul_f32 v[124:125], v[124:125], s[40:41]
    v_pk_mul_f32 v[126:127], v[126:127], s[40:41]
    v_pk_mul_f32 v[152:153], v[152:153], s[40:41]
    v_pk_mul_f32 v[154:155], v[154:155], s[40:41]
    v_cvt_pk_bf16_f32 v24, v124, v125
    v_cvt_pk_bf16_f32 v25, v126, v127
    v_cvt_pk_bf16_f32 v26, v152, v153
    v_cvt_pk_bf16_f32 v27, v154, v155
    global_store_dwordx4 v3, v[24:27], s[42:43] offset:1024 sc1
    s_nop 0
    s_branch sequential_preLN__memory_aug_recurrent_mem_tr__mixer_gmlp__prompt_kernel_P_done
sequential_preLN__memory_aug_recurrent_mem_tr__mixer_gmlp__prompt_kernel_P_btask:
    v_lshrrev_b32 v40, 2, v2
    v_lshlrev_b32 v41, 3, v3
    v_add_u32 v40, v40, v41
    v_mul_u32_u24 v40, 224, v40
    v_and_b32 v41, 3, v2
    v_lshlrev_b32 v41, 3, v41
    v_add_u32 v7, v40, v41
    v_add_u32 v7, 16384, v7
    s_mul_i32 s28, s60, 28
    s_mul_i32 s29, s61, 7
    s_add_u32 s28, s28, s29
    s_mul_i32 s28, s28, 7
    s_add_u32 s28, s28, s62
    s_lshl_b32 s28, s28, 11
    s_add_u32 s28, s28, 0xb00000
    s_add_u32 s42, s16, s28
    s_addc_u32 s43, s17, 0
    ds_read_b64_tr_b16 v[172:173], v7 offset:0
    ds_read_b64_tr_b16 v[174:175], v7 offset:896
    ds_read_b64_tr_b16 v[176:177], v7 offset:32
    ds_read_b64_tr_b16 v[178:179], v7 offset:928
    ds_read_b64_tr_b16 v[180:181], v7 offset:64
    ds_read_b64_tr_b16 v[182:183], v7 offset:960
    ds_read_b64_tr_b16 v[184:185], v7 offset:96
    ds_read_b64_tr_b16 v[186:187], v7 offset:992
    s_waitcnt lgkmcnt(0)
    ds_read_b64_tr_b16 v[200:201], v7 offset:7168
    ds_read_b64_tr_b16 v[202:203], v7 offset:8064
    ds_read_b64_tr_b16 v[204:205], v7 offset:7200
    ds_read_b64_tr_b16 v[206:207], v7 offset:8096
    ds_read_b64_tr_b16 v[208:209], v7 offset:7232
    ds_read_b64_tr_b16 v[210:211], v7 offset:8128
    ds_read_b64_tr_b16 v[212:213], v7 offset:7264
    ds_read_b64_tr_b16 v[214:215], v7 offset:8160
    v_mfma_f32_16x16x32_bf16 v[44:47], a[0:3], v[172:175], 0
    v_mfma_f32_16x16x32_bf16 v[72:75], a[4:7], v[172:175], 0
    v_mfma_f32_16x16x32_bf16 v[100:103], a[8:11], v[172:175], 0
    v_mfma_f32_16x16x32_bf16 v[128:131], a[12:15], v[172:175], 0
    v_mfma_f32_16x16x32_bf16 v[48:51], a[0:3], v[176:179], 0
    v_mfma_f32_16x16x32_bf16 v[76:79], a[4:7], v[176:179], 0
    v_mfma_f32_16x16x32_bf16 v[104:107], a[8:11], v[176:179], 0
    v_mfma_f32_16x16x32_bf16 v[132:135], a[12:15], v[176:179], 0
    v_mfma_f32_16x16x32_bf16 v[52:55], a[0:3], v[180:183], 0
    v_mfma_f32_16x16x32_bf16 v[80:83], a[4:7], v[180:183], 0
    v_mfma_f32_16x16x32_bf16 v[108:111], a[8:11], v[180:183], 0
    v_mfma_f32_16x16x32_bf16 v[136:139], a[12:15], v[180:183], 0
    v_mfma_f32_16x16x32_bf16 v[56:59], a[0:3], v[184:187], 0
    v_mfma_f32_16x16x32_bf16 v[84:87], a[4:7], v[184:187], 0
    v_mfma_f32_16x16x32_bf16 v[112:115], a[8:11], v[184:187], 0
    v_mfma_f32_16x16x32_bf16 v[140:143], a[12:15], v[184:187], 0
    s_waitcnt lgkmcnt(0)
    ds_read_b64_tr_b16 v[172:173], v7 offset:14336
    ds_read_b64_tr_b16 v[174:175], v7 offset:15232
    ds_read_b64_tr_b16 v[176:177], v7 offset:14368
    ds_read_b64_tr_b16 v[178:179], v7 offset:15264
    ds_read_b64_tr_b16 v[180:181], v7 offset:14400
    ds_read_b64_tr_b16 v[182:183], v7 offset:15296
    ds_read_b64_tr_b16 v[184:185], v7 offset:14432
    ds_read_b64_tr_b16 v[186:187], v7 offset:15328
    v_mfma_f32_16x16x32_bf16 v[44:47], a[16:19], v[200:203], v[44:47]
    v_mfma_f32_16x16x32_bf16 v[72:75], a[20:23], v[200:203], v[72:75]
    v_mfma_f32_16x16x32_bf16 v[100:103], a[24:27], v[200:203], v[100:103]
    v_mfma_f32_16x16x32_bf16 v[128:131], a[28:31], v[200:203], v[128:131]
    v_mfma_f32_16x16x32_bf16 v[48:51], a[16:19], v[204:207], v[48:51]
    v_mfma_f32_16x16x32_bf16 v[76:79], a[20:23], v[204:207], v[76:79]
    v_mfma_f32_16x16x32_bf16 v[104:107], a[24:27], v[204:207], v[104:107]
    v_mfma_f32_16x16x32_bf16 v[132:135], a[28:31], v[204:207], v[132:135]
    v_mfma_f32_16x16x32_bf16 v[52:55], a[16:19], v[208:211], v[52:55]
    v_mfma_f32_16x16x32_bf16 v[80:83], a[20:23], v[208:211], v[80:83]
    v_mfma_f32_16x16x32_bf16 v[108:111], a[24:27], v[208:211], v[108:111]
    v_mfma_f32_16x16x32_bf16 v[136:139], a[28:31], v[208:211], v[136:139]
    v_mfma_f32_16x16x32_bf16 v[56:59], a[16:19], v[212:215], v[56:59]
    v_mfma_f32_16x16x32_bf16 v[84:87], a[20:23], v[212:215], v[84:87]
    v_mfma_f32_16x16x32_bf16 v[112:115], a[24:27], v[212:215], v[112:115]
    v_mfma_f32_16x16x32_bf16 v[140:143], a[28:31], v[212:215], v[140:143]
    s_waitcnt lgkmcnt(0)
    ds_read_b64_tr_b16 v[200:201], v7 offset:21504
    ds_read_b64_tr_b16 v[202:203], v7 offset:22400
    ds_read_b64_tr_b16 v[204:205], v7 offset:21536
    ds_read_b64_tr_b16 v[206:207], v7 offset:22432
    ds_read_b64_tr_b16 v[208:209], v7 offset:21568
    ds_read_b64_tr_b16 v[210:211], v7 offset:22464
    ds_read_b64_tr_b16 v[212:213], v7 offset:21600
    ds_read_b64_tr_b16 v[214:215], v7 offset:22496
    v_mfma_f32_16x16x32_bf16 v[44:47], a[32:35], v[172:175], v[44:47]
    v_mfma_f32_16x16x32_bf16 v[72:75], a[36:39], v[172:175], v[72:75]
    v_mfma_f32_16x16x32_bf16 v[100:103], a[40:43], v[172:175], v[100:103]
    v_mfma_f32_16x16x32_bf16 v[128:131], a[44:47], v[172:175], v[128:131]
    v_mfma_f32_16x16x32_bf16 v[48:51], a[32:35], v[176:179], v[48:51]
    v_mfma_f32_16x16x32_bf16 v[76:79], a[36:39], v[176:179], v[76:79]
    v_mfma_f32_16x16x32_bf16 v[104:107], a[40:43], v[176:179], v[104:107]
    v_mfma_f32_16x16x32_bf16 v[132:135], a[44:47], v[176:179], v[132:135]
    v_mfma_f32_16x16x32_bf16 v[52:55], a[32:35], v[180:183], v[52:55]
    v_mfma_f32_16x16x32_bf16 v[80:83], a[36:39], v[180:183], v[80:83]
    v_mfma_f32_16x16x32_bf16 v[108:111], a[40:43], v[180:183], v[108:111]
    v_mfma_f32_16x16x32_bf16 v[136:139], a[44:47], v[180:183], v[136:139]
    v_mfma_f32_16x16x32_bf16 v[56:59], a[32:35], v[184:187], v[56:59]
    v_mfma_f32_16x16x32_bf16 v[84:87], a[36:39], v[184:187], v[84:87]
    v_mfma_f32_16x16x32_bf16 v[112:115], a[40:43], v[184:187], v[112:115]
    v_mfma_f32_16x16x32_bf16 v[140:143], a[44:47], v[184:187], v[140:143]
    s_waitcnt lgkmcnt(0)
    ds_read_b64_tr_b16 v[172:173], v7 offset:28672
    ds_read_b64_tr_b16 v[174:175], v7 offset:29568
    ds_read_b64_tr_b16 v[176:177], v7 offset:28704
    ds_read_b64_tr_b16 v[178:179], v7 offset:29600
    ds_read_b64_tr_b16 v[180:181], v7 offset:28736
    ds_read_b64_tr_b16 v[182:183], v7 offset:29632
    ds_read_b64_tr_b16 v[184:185], v7 offset:28768
    ds_read_b64_tr_b16 v[186:187], v7 offset:29664
    v_mfma_f32_16x16x32_bf16 v[44:47], a[48:51], v[200:203], v[44:47]
    v_mfma_f32_16x16x32_bf16 v[72:75], a[52:55], v[200:203], v[72:75]
    v_mfma_f32_16x16x32_bf16 v[100:103], a[56:59], v[200:203], v[100:103]
    v_mfma_f32_16x16x32_bf16 v[128:131], a[60:63], v[200:203], v[128:131]
    v_mfma_f32_16x16x32_bf16 v[48:51], a[48:51], v[204:207], v[48:51]
    v_mfma_f32_16x16x32_bf16 v[76:79], a[52:55], v[204:207], v[76:79]
    v_mfma_f32_16x16x32_bf16 v[104:107], a[56:59], v[204:207], v[104:107]
    v_mfma_f32_16x16x32_bf16 v[132:135], a[60:63], v[204:207], v[132:135]
    v_mfma_f32_16x16x32_bf16 v[52:55], a[48:51], v[208:211], v[52:55]
    v_mfma_f32_16x16x32_bf16 v[80:83], a[52:55], v[208:211], v[80:83]
    v_mfma_f32_16x16x32_bf16 v[108:111], a[56:59], v[208:211], v[108:111]
    v_mfma_f32_16x16x32_bf16 v[136:139], a[60:63], v[208:211], v[136:139]
    v_mfma_f32_16x16x32_bf16 v[56:59], a[48:51], v[212:215], v[56:59]
    v_mfma_f32_16x16x32_bf16 v[84:87], a[52:55], v[212:215], v[84:87]
    v_mfma_f32_16x16x32_bf16 v[112:115], a[56:59], v[212:215], v[112:115]
    v_mfma_f32_16x16x32_bf16 v[140:143], a[60:63], v[212:215], v[140:143]
    s_waitcnt lgkmcnt(0)
    ds_read_b64_tr_b16 v[200:201], v7 offset:35840
    ds_read_b64_tr_b16 v[202:203], v7 offset:36736
    ds_read_b64_tr_b16 v[204:205], v7 offset:35872
    ds_read_b64_tr_b16 v[206:207], v7 offset:36768
    ds_read_b64_tr_b16 v[208:209], v7 offset:35904
    ds_read_b64_tr_b16 v[210:211], v7 offset:36800
    ds_read_b64_tr_b16 v[212:213], v7 offset:35936
    ds_read_b64_tr_b16 v[214:215], v7 offset:36832
    v_mfma_f32_16x16x32_bf16 v[44:47], a[64:67], v[172:175], v[44:47]
    v_mfma_f32_16x16x32_bf16 v[72:75], a[68:71], v[172:175], v[72:75]
    v_mfma_f32_16x16x32_bf16 v[100:103], a[72:75], v[172:175], v[100:103]
    v_mfma_f32_16x16x32_bf16 v[128:131], a[76:79], v[172:175], v[128:131]
    v_mfma_f32_16x16x32_bf16 v[48:51], a[64:67], v[176:179], v[48:51]
    v_mfma_f32_16x16x32_bf16 v[76:79], a[68:71], v[176:179], v[76:79]
    v_mfma_f32_16x16x32_bf16 v[104:107], a[72:75], v[176:179], v[104:107]
    v_mfma_f32_16x16x32_bf16 v[132:135], a[76:79], v[176:179], v[132:135]
    v_mfma_f32_16x16x32_bf16 v[52:55], a[64:67], v[180:183], v[52:55]
    v_mfma_f32_16x16x32_bf16 v[80:83], a[68:71], v[180:183], v[80:83]
    v_mfma_f32_16x16x32_bf16 v[108:111], a[72:75], v[180:183], v[108:111]
    v_mfma_f32_16x16x32_bf16 v[136:139], a[76:79], v[180:183], v[136:139]
    v_mfma_f32_16x16x32_bf16 v[56:59], a[64:67], v[184:187], v[56:59]
    v_mfma_f32_16x16x32_bf16 v[84:87], a[68:71], v[184:187], v[84:87]
    v_mfma_f32_16x16x32_bf16 v[112:115], a[72:75], v[184:187], v[112:115]
    v_mfma_f32_16x16x32_bf16 v[140:143], a[76:79], v[184:187], v[140:143]
    s_waitcnt lgkmcnt(0)
    ds_read_b64_tr_b16 v[172:173], v7 offset:43008
    ds_read_b64_tr_b16 v[174:175], v7 offset:43904
    ds_read_b64_tr_b16 v[176:177], v7 offset:43040
    ds_read_b64_tr_b16 v[178:179], v7 offset:43936
    ds_read_b64_tr_b16 v[180:181], v7 offset:43072
    ds_read_b64_tr_b16 v[182:183], v7 offset:43968
    ds_read_b64_tr_b16 v[184:185], v7 offset:43104
    ds_read_b64_tr_b16 v[186:187], v7 offset:44000
    v_mfma_f32_16x16x32_bf16 v[44:47], a[80:83], v[200:203], v[44:47]
    v_mfma_f32_16x16x32_bf16 v[72:75], a[84:87], v[200:203], v[72:75]
    v_mfma_f32_16x16x32_bf16 v[100:103], a[88:91], v[200:203], v[100:103]
    v_mfma_f32_16x16x32_bf16 v[128:131], a[92:95], v[200:203], v[128:131]
    v_mfma_f32_16x16x32_bf16 v[48:51], a[80:83], v[204:207], v[48:51]
    v_mfma_f32_16x16x32_bf16 v[76:79], a[84:87], v[204:207], v[76:79]
    v_mfma_f32_16x16x32_bf16 v[104:107], a[88:91], v[204:207], v[104:107]
    v_mfma_f32_16x16x32_bf16 v[132:135], a[92:95], v[204:207], v[132:135]
    v_mfma_f32_16x16x32_bf16 v[52:55], a[80:83], v[208:211], v[52:55]
    v_mfma_f32_16x16x32_bf16 v[80:83], a[84:87], v[208:211], v[80:83]
    v_mfma_f32_16x16x32_bf16 v[108:111], a[88:91], v[208:211], v[108:111]
    v_mfma_f32_16x16x32_bf16 v[136:139], a[92:95], v[208:211], v[136:139]
    v_mfma_f32_16x16x32_bf16 v[56:59], a[80:83], v[212:215], v[56:59]
    v_mfma_f32_16x16x32_bf16 v[84:87], a[84:87], v[212:215], v[84:87]
    v_mfma_f32_16x16x32_bf16 v[112:115], a[88:91], v[212:215], v[112:115]
    v_mfma_f32_16x16x32_bf16 v[140:143], a[92:95], v[212:215], v[140:143]
    s_waitcnt lgkmcnt(0)
    ds_read_b64_tr_b16 v[200:201], v7 offset:50176
    ds_read_b64_tr_b16 v[202:203], v7 offset:51072
    ds_read_b64_tr_b16 v[204:205], v7 offset:50208
    ds_read_b64_tr_b16 v[206:207], v7 offset:51104
    ds_read_b64_tr_b16 v[208:209], v7 offset:50240
    ds_read_b64_tr_b16 v[210:211], v7 offset:51136
    ds_read_b64_tr_b16 v[212:213], v7 offset:50272
    ds_read_b64_tr_b16 v[214:215], v7 offset:51168
    v_mfma_f32_16x16x32_bf16 v[44:47], a[96:99], v[172:175], v[44:47]
    v_mfma_f32_16x16x32_bf16 v[72:75], a[100:103], v[172:175], v[72:75]
    v_mfma_f32_16x16x32_bf16 v[100:103], a[104:107], v[172:175], v[100:103]
    v_mfma_f32_16x16x32_bf16 v[128:131], a[108:111], v[172:175], v[128:131]
    v_mfma_f32_16x16x32_bf16 v[48:51], a[96:99], v[176:179], v[48:51]
    v_mfma_f32_16x16x32_bf16 v[76:79], a[100:103], v[176:179], v[76:79]
    v_mfma_f32_16x16x32_bf16 v[104:107], a[104:107], v[176:179], v[104:107]
    v_mfma_f32_16x16x32_bf16 v[132:135], a[108:111], v[176:179], v[132:135]
    v_mfma_f32_16x16x32_bf16 v[52:55], a[96:99], v[180:183], v[52:55]
    v_mfma_f32_16x16x32_bf16 v[80:83], a[100:103], v[180:183], v[80:83]
    v_mfma_f32_16x16x32_bf16 v[108:111], a[104:107], v[180:183], v[108:111]
    v_mfma_f32_16x16x32_bf16 v[136:139], a[108:111], v[180:183], v[136:139]
    v_mfma_f32_16x16x32_bf16 v[56:59], a[96:99], v[184:187], v[56:59]
    v_mfma_f32_16x16x32_bf16 v[84:87], a[100:103], v[184:187], v[84:87]
    v_mfma_f32_16x16x32_bf16 v[112:115], a[104:107], v[184:187], v[112:115]
    v_mfma_f32_16x16x32_bf16 v[140:143], a[108:111], v[184:187], v[140:143]
    s_waitcnt lgkmcnt(0)
    v_mfma_f32_16x16x32_bf16 v[44:47], a[112:115], v[200:203], v[44:47]
    v_mfma_f32_16x16x32_bf16 v[72:75], a[116:119], v[200:203], v[72:75]
    v_mfma_f32_16x16x32_bf16 v[100:103], a[120:123], v[200:203], v[100:103]
    v_mfma_f32_16x16x32_bf16 v[128:131], a[124:127], v[200:203], v[128:131]
    v_mfma_f32_16x16x32_bf16 v[48:51], a[112:115], v[204:207], v[48:51]
    v_mfma_f32_16x16x32_bf16 v[76:79], a[116:119], v[204:207], v[76:79]
    v_mfma_f32_16x16x32_bf16 v[104:107], a[120:123], v[204:207], v[104:107]
    v_mfma_f32_16x16x32_bf16 v[132:135], a[124:127], v[204:207], v[132:135]
    v_mfma_f32_16x16x32_bf16 v[52:55], a[112:115], v[208:211], v[52:55]
    v_mfma_f32_16x16x32_bf16 v[80:83], a[116:119], v[208:211], v[80:83]
    v_mfma_f32_16x16x32_bf16 v[108:111], a[120:123], v[208:211], v[108:111]
    v_mfma_f32_16x16x32_bf16 v[136:139], a[124:127], v[208:211], v[136:139]
    v_mfma_f32_16x16x32_bf16 v[56:59], a[112:115], v[212:215], v[56:59]
    v_mfma_f32_16x16x32_bf16 v[84:87], a[116:119], v[212:215], v[84:87]
    v_mfma_f32_16x16x32_bf16 v[112:115], a[120:123], v[212:215], v[112:115]
    v_mfma_f32_16x16x32_bf16 v[140:143], a[124:127], v[212:215], v[140:143]
    v_lshlrev_b32 v3, 4, v1
    v_cvt_pk_bf16_f32 v20, v44, v45
    v_cvt_pk_bf16_f32 v21, v46, v47
    v_cvt_pk_bf16_f32 v22, v72, v73
    v_cvt_pk_bf16_f32 v23, v74, v75
    global_store_dwordx4 v3, v[20:23], s[42:43] offset:0 sc1
    v_cvt_pk_bf16_f32 v24, v100, v101
    v_cvt_pk_bf16_f32 v25, v102, v103
    v_cvt_pk_bf16_f32 v26, v128, v129
    v_cvt_pk_bf16_f32 v27, v130, v131
    global_store_dwordx4 v3, v[24:27], s[42:43] offset:1024 sc1
    s_add_u32 s42, s42, 14336
    s_addc_u32 s43, s43, 0
    v_cvt_pk_bf16_f32 v28, v48, v49
    v_cvt_pk_bf16_f32 v29, v50, v51
    v_cvt_pk_bf16_f32 v30, v76, v77
    v_cvt_pk_bf16_f32 v31, v78, v79
    global_store_dwordx4 v3, v[28:31], s[42:43] offset:0 sc1
    v_cvt_pk_bf16_f32 v32, v104, v105
    v_cvt_pk_bf16_f32 v33, v106, v107
    v_cvt_pk_bf16_f32 v34, v132, v133
    v_cvt_pk_bf16_f32 v35, v134, v135
    global_store_dwordx4 v3, v[32:35], s[42:43] offset:1024 sc1
    s_add_u32 s42, s42, 14336
    s_addc_u32 s43, s43, 0
    v_cvt_pk_bf16_f32 v20, v52, v53
    v_cvt_pk_bf16_f32 v21, v54, v55
    v_cvt_pk_bf16_f32 v22, v80, v81
    v_cvt_pk_bf16_f32 v23, v82, v83
    global_store_dwordx4 v3, v[20:23], s[42:43] offset:0 sc1
    v_cvt_pk_bf16_f32 v24, v108, v109
    v_cvt_pk_bf16_f32 v25, v110, v111
    v_cvt_pk_bf16_f32 v26, v136, v137
    v_cvt_pk_bf16_f32 v27, v138, v139
    global_store_dwordx4 v3, v[24:27], s[42:43] offset:1024 sc1
    s_add_u32 s42, s42, 14336
    s_addc_u32 s43, s43, 0
    v_cvt_pk_bf16_f32 v28, v56, v57
    v_cvt_pk_bf16_f32 v29, v58, v59
    v_cvt_pk_bf16_f32 v30, v84, v85
    v_cvt_pk_bf16_f32 v31, v86, v87
    global_store_dwordx4 v3, v[28:31], s[42:43] offset:0 sc1
    v_cvt_pk_bf16_f32 v32, v112, v113
    v_cvt_pk_bf16_f32 v33, v114, v115
    v_cvt_pk_bf16_f32 v34, v140, v141
    v_cvt_pk_bf16_f32 v35, v142, v143
    global_store_dwordx4 v3, v[32:35], s[42:43] offset:1024 sc1
    s_add_u32 s42, s42, 14336
    s_addc_u32 s43, s43, 0
    ds_read_b64_tr_b16 v[188:189], v7 offset:128
    ds_read_b64_tr_b16 v[190:191], v7 offset:1024
    ds_read_b64_tr_b16 v[192:193], v7 offset:160
    ds_read_b64_tr_b16 v[194:195], v7 offset:1056
    ds_read_b64_tr_b16 v[196:197], v7 offset:192
    ds_read_b64_tr_b16 v[198:199], v7 offset:1088
    s_waitcnt lgkmcnt(0)
    ds_read_b64_tr_b16 v[216:217], v7 offset:7296
    ds_read_b64_tr_b16 v[218:219], v7 offset:8192
    ds_read_b64_tr_b16 v[220:221], v7 offset:7328
    ds_read_b64_tr_b16 v[222:223], v7 offset:8224
    ds_read_b64_tr_b16 v[224:225], v7 offset:7360
    ds_read_b64_tr_b16 v[226:227], v7 offset:8256
    v_mfma_f32_16x16x32_bf16 v[60:63], a[0:3], v[188:191], 0
    v_mfma_f32_16x16x32_bf16 v[88:91], a[4:7], v[188:191], 0
    v_mfma_f32_16x16x32_bf16 v[116:119], a[8:11], v[188:191], 0
    v_mfma_f32_16x16x32_bf16 v[144:147], a[12:15], v[188:191], 0
    v_mfma_f32_16x16x32_bf16 v[64:67], a[0:3], v[192:195], 0
    v_mfma_f32_16x16x32_bf16 v[92:95], a[4:7], v[192:195], 0
    v_mfma_f32_16x16x32_bf16 v[120:123], a[8:11], v[192:195], 0
    v_mfma_f32_16x16x32_bf16 v[148:151], a[12:15], v[192:195], 0
    v_mfma_f32_16x16x32_bf16 v[68:71], a[0:3], v[196:199], 0
    v_mfma_f32_16x16x32_bf16 v[96:99], a[4:7], v[196:199], 0
    v_mfma_f32_16x16x32_bf16 v[124:127], a[8:11], v[196:199], 0
    v_mfma_f32_16x16x32_bf16 v[152:155], a[12:15], v[196:199], 0
    s_waitcnt lgkmcnt(0)
    ds_read_b64_tr_b16 v[188:189], v7 offset:14464
    ds_read_b64_tr_b16 v[190:191], v7 offset:15360
    ds_read_b64_tr_b16 v[192:193], v7 offset:14496
    ds_read_b64_tr_b16 v[194:195], v7 offset:15392
    ds_read_b64_tr_b16 v[196:197], v7 offset:14528
    ds_read_b64_tr_b16 v[198:199], v7 offset:15424
    v_mfma_f32_16x16x32_bf16 v[60:63], a[16:19], v[216:219], v[60:63]
    v_mfma_f32_16x16x32_bf16 v[88:91], a[20:23], v[216:219], v[88:91]
    v_mfma_f32_16x16x32_bf16 v[116:119], a[24:27], v[216:219], v[116:119]
    v_mfma_f32_16x16x32_bf16 v[144:147], a[28:31], v[216:219], v[144:147]
    v_mfma_f32_16x16x32_bf16 v[64:67], a[16:19], v[220:223], v[64:67]
    v_mfma_f32_16x16x32_bf16 v[92:95], a[20:23], v[220:223], v[92:95]
    v_mfma_f32_16x16x32_bf16 v[120:123], a[24:27], v[220:223], v[120:123]
    v_mfma_f32_16x16x32_bf16 v[148:151], a[28:31], v[220:223], v[148:151]
    v_mfma_f32_16x16x32_bf16 v[68:71], a[16:19], v[224:227], v[68:71]
    v_mfma_f32_16x16x32_bf16 v[96:99], a[20:23], v[224:227], v[96:99]
    v_mfma_f32_16x16x32_bf16 v[124:127], a[24:27], v[224:227], v[124:127]
    v_mfma_f32_16x16x32_bf16 v[152:155], a[28:31], v[224:227], v[152:155]
    s_waitcnt lgkmcnt(0)
    ds_read_b64_tr_b16 v[216:217], v7 offset:21632
    ds_read_b64_tr_b16 v[218:219], v7 offset:22528
    ds_read_b64_tr_b16 v[220:221], v7 offset:21664
    ds_read_b64_tr_b16 v[222:223], v7 offset:22560
    ds_read_b64_tr_b16 v[224:225], v7 offset:21696
    ds_read_b64_tr_b16 v[226:227], v7 offset:22592
    v_mfma_f32_16x16x32_bf16 v[60:63], a[32:35], v[188:191], v[60:63]
    v_mfma_f32_16x16x32_bf16 v[88:91], a[36:39], v[188:191], v[88:91]
    v_mfma_f32_16x16x32_bf16 v[116:119], a[40:43], v[188:191], v[116:119]
    v_mfma_f32_16x16x32_bf16 v[144:147], a[44:47], v[188:191], v[144:147]
    v_mfma_f32_16x16x32_bf16 v[64:67], a[32:35], v[192:195], v[64:67]
    v_mfma_f32_16x16x32_bf16 v[92:95], a[36:39], v[192:195], v[92:95]
    v_mfma_f32_16x16x32_bf16 v[120:123], a[40:43], v[192:195], v[120:123]
    v_mfma_f32_16x16x32_bf16 v[148:151], a[44:47], v[192:195], v[148:151]
    v_mfma_f32_16x16x32_bf16 v[68:71], a[32:35], v[196:199], v[68:71]
    v_mfma_f32_16x16x32_bf16 v[96:99], a[36:39], v[196:199], v[96:99]
    v_mfma_f32_16x16x32_bf16 v[124:127], a[40:43], v[196:199], v[124:127]
    v_mfma_f32_16x16x32_bf16 v[152:155], a[44:47], v[196:199], v[152:155]
    s_waitcnt lgkmcnt(0)
    ds_read_b64_tr_b16 v[188:189], v7 offset:28800
    ds_read_b64_tr_b16 v[190:191], v7 offset:29696
    ds_read_b64_tr_b16 v[192:193], v7 offset:28832
    ds_read_b64_tr_b16 v[194:195], v7 offset:29728
    ds_read_b64_tr_b16 v[196:197], v7 offset:28864
    ds_read_b64_tr_b16 v[198:199], v7 offset:29760
    v_mfma_f32_16x16x32_bf16 v[60:63], a[48:51], v[216:219], v[60:63]
    v_mfma_f32_16x16x32_bf16 v[88:91], a[52:55], v[216:219], v[88:91]
    v_mfma_f32_16x16x32_bf16 v[116:119], a[56:59], v[216:219], v[116:119]
    v_mfma_f32_16x16x32_bf16 v[144:147], a[60:63], v[216:219], v[144:147]
    v_mfma_f32_16x16x32_bf16 v[64:67], a[48:51], v[220:223], v[64:67]
    v_mfma_f32_16x16x32_bf16 v[92:95], a[52:55], v[220:223], v[92:95]
    v_mfma_f32_16x16x32_bf16 v[120:123], a[56:59], v[220:223], v[120:123]
    v_mfma_f32_16x16x32_bf16 v[148:151], a[60:63], v[220:223], v[148:151]
    v_mfma_f32_16x16x32_bf16 v[68:71], a[48:51], v[224:227], v[68:71]
    v_mfma_f32_16x16x32_bf16 v[96:99], a[52:55], v[224:227], v[96:99]
    v_mfma_f32_16x16x32_bf16 v[124:127], a[56:59], v[224:227], v[124:127]
    v_mfma_f32_16x16x32_bf16 v[152:155], a[60:63], v[224:227], v[152:155]
    s_waitcnt lgkmcnt(0)
    ds_read_b64_tr_b16 v[216:217], v7 offset:35968
    ds_read_b64_tr_b16 v[218:219], v7 offset:36864
    ds_read_b64_tr_b16 v[220:221], v7 offset:36000
    ds_read_b64_tr_b16 v[222:223], v7 offset:36896
    ds_read_b64_tr_b16 v[224:225], v7 offset:36032
    ds_read_b64_tr_b16 v[226:227], v7 offset:36928
    v_mfma_f32_16x16x32_bf16 v[60:63], a[64:67], v[188:191], v[60:63]
    v_mfma_f32_16x16x32_bf16 v[88:91], a[68:71], v[188:191], v[88:91]
    v_mfma_f32_16x16x32_bf16 v[116:119], a[72:75], v[188:191], v[116:119]
    v_mfma_f32_16x16x32_bf16 v[144:147], a[76:79], v[188:191], v[144:147]
    v_mfma_f32_16x16x32_bf16 v[64:67], a[64:67], v[192:195], v[64:67]
    v_mfma_f32_16x16x32_bf16 v[92:95], a[68:71], v[192:195], v[92:95]
    v_mfma_f32_16x16x32_bf16 v[120:123], a[72:75], v[192:195], v[120:123]
    v_mfma_f32_16x16x32_bf16 v[148:151], a[76:79], v[192:195], v[148:151]
    v_mfma_f32_16x16x32_bf16 v[68:71], a[64:67], v[196:199], v[68:71]
    v_mfma_f32_16x16x32_bf16 v[96:99], a[68:71], v[196:199], v[96:99]
    v_mfma_f32_16x16x32_bf16 v[124:127], a[72:75], v[196:199], v[124:127]
    v_mfma_f32_16x16x32_bf16 v[152:155], a[76:79], v[196:199], v[152:155]
    s_waitcnt lgkmcnt(0)
    ds_read_b64_tr_b16 v[188:189], v7 offset:43136
    ds_read_b64_tr_b16 v[190:191], v7 offset:44032
    ds_read_b64_tr_b16 v[192:193], v7 offset:43168
    ds_read_b64_tr_b16 v[194:195], v7 offset:44064
    ds_read_b64_tr_b16 v[196:197], v7 offset:43200
    ds_read_b64_tr_b16 v[198:199], v7 offset:44096
    v_mfma_f32_16x16x32_bf16 v[60:63], a[80:83], v[216:219], v[60:63]
    v_mfma_f32_16x16x32_bf16 v[88:91], a[84:87], v[216:219], v[88:91]
    v_mfma_f32_16x16x32_bf16 v[116:119], a[88:91], v[216:219], v[116:119]
    v_mfma_f32_16x16x32_bf16 v[144:147], a[92:95], v[216:219], v[144:147]
    v_mfma_f32_16x16x32_bf16 v[64:67], a[80:83], v[220:223], v[64:67]
    v_mfma_f32_16x16x32_bf16 v[92:95], a[84:87], v[220:223], v[92:95]
    v_mfma_f32_16x16x32_bf16 v[120:123], a[88:91], v[220:223], v[120:123]
    v_mfma_f32_16x16x32_bf16 v[148:151], a[92:95], v[220:223], v[148:151]
    v_mfma_f32_16x16x32_bf16 v[68:71], a[80:83], v[224:227], v[68:71]
    v_mfma_f32_16x16x32_bf16 v[96:99], a[84:87], v[224:227], v[96:99]
    v_mfma_f32_16x16x32_bf16 v[124:127], a[88:91], v[224:227], v[124:127]
    v_mfma_f32_16x16x32_bf16 v[152:155], a[92:95], v[224:227], v[152:155]
    s_waitcnt lgkmcnt(0)
    ds_read_b64_tr_b16 v[216:217], v7 offset:50304
    ds_read_b64_tr_b16 v[218:219], v7 offset:51200
    ds_read_b64_tr_b16 v[220:221], v7 offset:50336
    ds_read_b64_tr_b16 v[222:223], v7 offset:51232
    ds_read_b64_tr_b16 v[224:225], v7 offset:50368
    ds_read_b64_tr_b16 v[226:227], v7 offset:51264
    v_mfma_f32_16x16x32_bf16 v[60:63], a[96:99], v[188:191], v[60:63]
    v_mfma_f32_16x16x32_bf16 v[88:91], a[100:103], v[188:191], v[88:91]
    v_mfma_f32_16x16x32_bf16 v[116:119], a[104:107], v[188:191], v[116:119]
    v_mfma_f32_16x16x32_bf16 v[144:147], a[108:111], v[188:191], v[144:147]
    v_mfma_f32_16x16x32_bf16 v[64:67], a[96:99], v[192:195], v[64:67]
    v_mfma_f32_16x16x32_bf16 v[92:95], a[100:103], v[192:195], v[92:95]
    v_mfma_f32_16x16x32_bf16 v[120:123], a[104:107], v[192:195], v[120:123]
    v_mfma_f32_16x16x32_bf16 v[148:151], a[108:111], v[192:195], v[148:151]
    v_mfma_f32_16x16x32_bf16 v[68:71], a[96:99], v[196:199], v[68:71]
    v_mfma_f32_16x16x32_bf16 v[96:99], a[100:103], v[196:199], v[96:99]
    v_mfma_f32_16x16x32_bf16 v[124:127], a[104:107], v[196:199], v[124:127]
    v_mfma_f32_16x16x32_bf16 v[152:155], a[108:111], v[196:199], v[152:155]
    s_waitcnt lgkmcnt(0)
    v_mfma_f32_16x16x32_bf16 v[60:63], a[112:115], v[216:219], v[60:63]
    v_mfma_f32_16x16x32_bf16 v[88:91], a[116:119], v[216:219], v[88:91]
    v_mfma_f32_16x16x32_bf16 v[116:119], a[120:123], v[216:219], v[116:119]
    v_mfma_f32_16x16x32_bf16 v[144:147], a[124:127], v[216:219], v[144:147]
    v_mfma_f32_16x16x32_bf16 v[64:67], a[112:115], v[220:223], v[64:67]
    v_mfma_f32_16x16x32_bf16 v[92:95], a[116:119], v[220:223], v[92:95]
    v_mfma_f32_16x16x32_bf16 v[120:123], a[120:123], v[220:223], v[120:123]
    v_mfma_f32_16x16x32_bf16 v[148:151], a[124:127], v[220:223], v[148:151]
    v_mfma_f32_16x16x32_bf16 v[68:71], a[112:115], v[224:227], v[68:71]
    v_mfma_f32_16x16x32_bf16 v[96:99], a[116:119], v[224:227], v[96:99]
    v_mfma_f32_16x16x32_bf16 v[124:127], a[120:123], v[224:227], v[124:127]
    v_mfma_f32_16x16x32_bf16 v[152:155], a[124:127], v[224:227], v[152:155]
    v_lshlrev_b32 v3, 4, v1
    v_cvt_pk_bf16_f32 v20, v60, v61
    v_cvt_pk_bf16_f32 v21, v62, v63
    v_cvt_pk_bf16_f32 v22, v88, v89
    v_cvt_pk_bf16_f32 v23, v90, v91
    global_store_dwordx4 v3, v[20:23], s[42:43] offset:0 sc1
    v_cvt_pk_bf16_f32 v24, v116, v117
    v_cvt_pk_bf16_f32 v25, v118, v119
    v_cvt_pk_bf16_f32 v26, v144, v145
    v_cvt_pk_bf16_f32 v27, v146, v147
    global_store_dwordx4 v3, v[24:27], s[42:43] offset:1024 sc1
    s_add_u32 s42, s42, 14336
    s_addc_u32 s43, s43, 0
    v_cvt_pk_bf16_f32 v28, v64, v65
    v_cvt_pk_bf16_f32 v29, v66, v67
    v_cvt_pk_bf16_f32 v30, v92, v93
    v_cvt_pk_bf16_f32 v31, v94, v95
    global_store_dwordx4 v3, v[28:31], s[42:43] offset:0 sc1
    v_cvt_pk_bf16_f32 v32, v120, v121
    v_cvt_pk_bf16_f32 v33, v122, v123
    v_cvt_pk_bf16_f32 v34, v148, v149
    v_cvt_pk_bf16_f32 v35, v150, v151
    global_store_dwordx4 v3, v[32:35], s[42:43] offset:1024 sc1
    s_add_u32 s42, s42, 14336
    s_addc_u32 s43, s43, 0
    v_cvt_pk_bf16_f32 v20, v68, v69
    v_cvt_pk_bf16_f32 v21, v70, v71
    v_cvt_pk_bf16_f32 v22, v96, v97
    v_cvt_pk_bf16_f32 v23, v98, v99
    global_store_dwordx4 v3, v[20:23], s[42:43] offset:0 sc1
    v_cvt_pk_bf16_f32 v24, v124, v125
    v_cvt_pk_bf16_f32 v25, v126, v127
    v_cvt_pk_bf16_f32 v26, v152, v153
    v_cvt_pk_bf16_f32 v27, v154, v155
    global_store_dwordx4 v3, v[24:27], s[42:43] offset:1024 sc1
    s_nop 0
    s_branch sequential_preLN__memory_aug_recurrent_mem_tr__mixer_gmlp__prompt_kernel_P_done
sequential_preLN__memory_aug_recurrent_mem_tr__mixer_gmlp__prompt_kernel_P_p4:
    s_cmp_lg_u32 s2, 1
    s_cbranch_scc1 sequential_preLN__memory_aug_recurrent_mem_tr__mixer_gmlp__prompt_kernel_P_nomem0
    v_and_b32 v8, 7, v1
    v_mul_u32_u24 v8, 896, v8
    v_lshrrev_b32 v9, 4, v1
    v_lshlrev_b32 v9, 5, v9
    v_lshrrev_b32 v10, 3, v1
    v_and_b32 v10, 1, v10
    v_lshlrev_b32 v10, 2, v10
    v_add3_u32 v8, v8, v9, v10
    v_lshlrev_b32 v9, 4, v1
    v_add_u32 v10, 0x1000, v9
    global_load_dword v44, v8, s[6:7] offset:0
    global_load_dword v45, v8, s[6:7] offset:8
    global_load_dword v46, v8, s[6:7] offset:16
    global_load_dword v47, v8, s[6:7] offset:24
    global_load_dword v48, v8, s[6:7] offset:128
    global_load_dword v49, v8, s[6:7] offset:136
    global_load_dword v50, v8, s[6:7] offset:144
    global_load_dword v51, v8, s[6:7] offset:152
    global_load_dword v52, v8, s[6:7] offset:256
    global_load_dword v53, v8, s[6:7] offset:264
    global_load_dword v54, v8, s[6:7] offset:272
    global_load_dword v55, v8, s[6:7] offset:280
    global_load_dword v56, v8, s[6:7] offset:384
    global_load_dword v57, v8, s[6:7] offset:392
    global_load_dword v58, v8, s[6:7] offset:400
    global_load_dword v59, v8, s[6:7] offset:408
    global_load_dword v60, v8, s[6:7] offset:512
    global_load_dword v61, v8, s[6:7] offset:520
    global_load_dword v62, v8, s[6:7] offset:528
    global_load_dword v63, v8, s[6:7] offset:536
    global_load_dword v64, v8, s[6:7] offset:640
    global_load_dword v65, v8, s[6:7] offset:648
    global_load_dword v66, v8, s[6:7] offset:656
    global_load_dword v67, v8, s[6:7] offset:664
    global_load_dword v68, v8, s[6:7] offset:768
    global_load_dword v69, v8, s[6:7] offset:776
    global_load_dword v70, v8, s[6:7] offset:784
    global_load_dword v71, v8, s[6:7] offset:792
    s_add_u32 s28, s16, 0x1200000
    s_addc_u32 s29, s17, 0
    s_add_u32 s34, s16, 0x1300000
    s_addc_u32 s35, s17, 0
    s_waitcnt vmcnt(0)
    global_store_dwordx4 v9, v[44:47], s[28:29] offset:0 sc1
    global_store_dwordx4 v9, v[48:51], s[28:29] offset:1024 sc1
    global_store_dwordx4 v9, v[52:55], s[28:29] offset:2048 sc1
    global_store_dwordx4 v9, v[56:59], s[28:29] offset:3072 sc1
    global_store_dwordx4 v10, v[60:63], s[28:29] offset:0 sc1
    global_store_dwordx4 v10, v[64:67], s[28:29] offset:1024 sc1
    global_store_dwordx4 v10, v[68:71], s[28:29] offset:2048 sc1
    global_store_dwordx4 v9, v[44:47], s[34:35] offset:0 sc1
    global_store_dwordx4 v9, v[48:51], s[34:35] offset:1024 sc1
    global_store_dwordx4 v9, v[52:55], s[34:35] offset:2048 sc1
    global_store_dwordx4 v9, v[56:59], s[34:35] offset:3072 sc1
    global_store_dwordx4 v10, v[60:63], s[34:35] offset:0 sc1
    global_store_dwordx4 v10, v[64:67], s[34:35] offset:1024 sc1
    global_store_dwordx4 v10, v[68:71], s[34:35] offset:2048 sc1
    s_nop 1
sequential_preLN__memory_aug_recurrent_mem_tr__mixer_gmlp__prompt_kernel_P_nomem0:
    s_branch sequential_preLN__memory_aug_recurrent_mem_tr__mixer_gmlp__prompt_kernel_P_p4fin
sequential_preLN__memory_aug_recurrent_mem_tr__mixer_gmlp__prompt_kernel_P_p4fin:
    s_lshr_b32 s50, s2, 1
    s_add_u32 s50, s50, 128
    s_cmp_lt_u32 s50, 168
    s_cbranch_scc0 sequential_preLN__memory_aug_recurrent_mem_tr__mixer_gmlp__prompt_kernel_P_p4noB
    v_mul_u32_u24 v26, 4682, v1
    v_lshrrev_b32 v26, 16, v26
    v_mul_u32_u24 v27, 14, v26
    v_sub_u32 v27, v1, v27
    v_lshlrev_b32 v27, 4, v27
    v_lshrrev_b32 v29, 4, v1
    s_cmp_ge_u32 s50, 112
    s_cbranch_scc1 sequential_preLN__memory_aug_recurrent_mem_tr__mixer_gmlp__prompt_kernel_P_p4oB
    s_mul_i32 s70, s50, 2341
    s_lshr_b32 s70, s70, 16
    s_mul_i32 s71, s70, 28
    s_sub_u32 s71, s50, s71
    s_mul_i32 s72, s71, 37
    s_lshr_b32 s72, s72, 8
    s_mul_i32 s73, s72, 7
    s_sub_u32 s73, s71, s73
    s_mul_i32 s74, s73, 229376
    s_mul_i32 s75, s70, 896
    s_add_u32 s74, s74, s75
    s_mul_i32 s75, s72, 224
    s_add_u32 s74, s74, s75
    s_mov_b32 s76, 3584
    s_mul_i32 s75, s70, 28
    s_mul_i32 s77, s72, 7
    s_add_u32 s75, s75, s77
    s_mul_i32 s75, s75, 7
    s_add_u32 s75, s75, s73
    s_lshl_b32 s75, s75, 11
    s_add_u32 s75, s75, 0x1900000
    s_mov_b32 s92, 14336
    v_lshlrev_b32 v241, 3, v29
    s_mov_b32 s93, 896
    s_mov_b32 s82, s44
    s_mov_b32 s83, s45
    s_branch sequential_preLN__memory_aug_recurrent_mem_tr__mixer_gmlp__prompt_kernel_P_p4goB
sequential_preLN__memory_aug_recurrent_mem_tr__mixer_gmlp__prompt_kernel_P_p4oB:
    s_sub_u32 s71, s50, 112
    s_mul_i32 s72, s71, 4682
    s_lshr_b32 s72, s72, 16
    s_mul_i32 s73, s72, 14
    s_sub_u32 s73, s71, s73
    s_mul_i32 s74, s73, 57344
    s_mul_i32 s75, s72, 224
    s_add_u32 s74, s74, s75
    s_mov_b32 s76, 896
    s_mul_i32 s75, s72, 196
    s_lshl_b32 s77, s73, 1
    s_add_u32 s75, s75, s77
    s_lshl_b32 s75, s75, 10
    s_add_u32 s75, s75, 0x1b00000
    s_mov_b32 s92, 28672
    v_lshlrev_b32 v241, 2, v29
    s_mov_b32 s93, 3584
    s_mov_b32 s82, s46
    s_mov_b32 s83, s47
sequential_preLN__memory_aug_recurrent_mem_tr__mixer_gmlp__prompt_kernel_P_p4goB:
    v_mul_lo_u32 v31, s76, v26
    v_add_u32 v31, v31, v27
    s_add_u32 s82, s82, s74
    s_addc_u32 s83, s83, 0
    s_lshl_b32 s77, s76, 2
    s_mov_b64 exec, s[30:31]
    s_mov_b32 m0, 90112
    s_nop 0
    global_load_lds_dwordx4 v31, s[82:83]
    s_add_u32 s82, s82, s77
    s_addc_u32 s83, s83, 0
    s_mov_b32 m0, 91008
    s_nop 0
    global_load_lds_dwordx4 v31, s[82:83]
    s_add_u32 s82, s82, s77
    s_addc_u32 s83, s83, 0
    s_mov_b32 m0, 91904
    s_nop 0
    global_load_lds_dwordx4 v31, s[82:83]
    s_add_u32 s82, s82, s77
    s_addc_u32 s83, s83, 0
    s_mov_b32 m0, 92800
    s_nop 0
    global_load_lds_dwordx4 v31, s[82:83]
    s_add_u32 s82, s82, s77
    s_addc_u32 s83, s83, 0
    s_mov_b32 m0, 93696
    s_nop 0
    global_load_lds_dwordx4 v31, s[82:83]
    s_add_u32 s82, s82, s77
    s_addc_u32 s83, s83, 0
    s_mov_b32 m0, 94592
    s_nop 0
    global_load_lds_dwordx4 v31, s[82:83]
    s_add_u32 s82, s82, s77
    s_addc_u32 s83, s83, 0
    s_mov_b32 m0, 95488
    s_nop 0
    global_load_lds_dwordx4 v31, s[82:83]
    s_add_u32 s82, s82, s77
    s_addc_u32 s83, s83, 0
    s_mov_b32 m0, 96384
    s_nop 0
    global_load_lds_dwordx4 v31, s[82:83]
    s_add_u32 s82, s82, s77
    s_addc_u32 s83, s83, 0
    s_mov_b32 m0, 97280
    s_nop 0
    global_load_lds_dwordx4 v31, s[82:83]
    s_add_u32 s82, s82, s77
    s_addc_u32 s83, s83, 0
    s_mov_b32 m0, 98176
    s_nop 0
    global_load_lds_dwordx4 v31, s[82:83]
    s_add_u32 s82, s82, s77
    s_addc_u32 s83, s83, 0
    s_mov_b32 m0, 99072
    s_nop 0
    global_load_lds_dwordx4 v31, s[82:83]
    s_add_u32 s82, s82, s77
    s_addc_u32 s83, s83, 0
    s_mov_b32 m0, 99968
    s_nop 0
    global_load_lds_dwordx4 v31, s[82:83]
    s_add_u32 s82, s82, s77
    s_addc_u32 s83, s83, 0
    s_mov_b32 m0, 100864
    s_nop 0
    global_load_lds_dwordx4 v31, s[82:83]
    s_add_u32 s82, s82, s77
    s_addc_u32 s83, s83, 0
    s_mov_b32 m0, 101760
    s_nop 0
    global_load_lds_dwordx4 v31, s[82:83]
    s_add_u32 s82, s82, s77
    s_addc_u32 s83, s83, 0
    s_mov_b32 m0, 102656
    s_nop 0
    global_load_lds_dwordx4 v31, s[82:83]
    s_add_u32 s82, s82, s77
    s_addc_u32 s83, s83, 0
    s_mov_b32 m0, 103552
    s_nop 0
    global_load_lds_dwordx4 v31, s[82:83]
    s_mov_b64 exec, s[32:33]
    s_add_u32 s90, s16, s75
    s_addc_u32 s91, s17, 0
    s_nop 2
sequential_preLN__memory_aug_recurrent_mem_tr__mixer_gmlp__prompt_kernel_P_p4noB:
    s_waitcnt vmcnt(16)
    s_cmp_lt_u32 s50, 168
    s_cbranch_scc1 sequential_preLN__memory_aug_recurrent_mem_tr__mixer_gmlp__prompt_kernel_P_p4wa
    s_waitcnt vmcnt(0)
sequential_preLN__memory_aug_recurrent_mem_tr__mixer_gmlp__prompt_kernel_P_p4wa:
    v_and_b32 v28, 15, v1
    v_lshlrev_b32 v9, 4, v1
    v_lshrrev_b32 v10, 2, v28
    v_add_u32 v10, v10, v240
    v_mul_u32_u24 v10, 224, v10
    v_and_b32 v11, 3, v28
    v_lshlrev_b32 v11, 3, v11
    v_add_u32 v10, v10, v11
    v_add_u32 v11, s87, v10
    ds_read_b64_tr_b16 v[12:13], v10 offset:0
    ds_read_b64_tr_b16 v[14:15], v11 offset:0
    ds_read_b64_tr_b16 v[16:17], v10 offset:7168
    ds_read_b64_tr_b16 v[18:19], v11 offset:7168
    s_waitcnt lgkmcnt(0)
    global_store_dwordx4 v9, v[12:15], s[84:85] sc1
    global_store_dwordx4 v9, v[16:19], s[84:85] offset:1024 sc1
    s_add_u32 s84, s84, s86
    s_addc_u32 s85, s85, 0
    s_nop 1
    ds_read_b64_tr_b16 v[12:13], v10 offset:32
    ds_read_b64_tr_b16 v[14:15], v11 offset:32
    ds_read_b64_tr_b16 v[16:17], v10 offset:7200
    ds_read_b64_tr_b16 v[18:19], v11 offset:7200
    s_waitcnt lgkmcnt(0)
    global_store_dwordx4 v9, v[12:15], s[84:85] sc1
    global_store_dwordx4 v9, v[16:19], s[84:85] offset:1024 sc1
    s_add_u32 s84, s84, s86
    s_addc_u32 s85, s85, 0
    s_nop 1
    ds_read_b64_tr_b16 v[12:13], v10 offset:64
    ds_read_b64_tr_b16 v[14:15], v11 offset:64
    ds_read_b64_tr_b16 v[16:17], v10 offset:7232
    ds_read_b64_tr_b16 v[18:19], v11 offset:7232
    s_waitcnt lgkmcnt(0)
    global_store_dwordx4 v9, v[12:15], s[84:85] sc1
    global_store_dwordx4 v9, v[16:19], s[84:85] offset:1024 sc1
    s_add_u32 s84, s84, s86
    s_addc_u32 s85, s85, 0
    s_nop 1
    ds_read_b64_tr_b16 v[12:13], v10 offset:96
    ds_read_b64_tr_b16 v[14:15], v11 offset:96
    ds_read_b64_tr_b16 v[16:17], v10 offset:7264
    ds_read_b64_tr_b16 v[18:19], v11 offset:7264
    s_waitcnt lgkmcnt(0)
    global_store_dwordx4 v9, v[12:15], s[84:85] sc1
    global_store_dwordx4 v9, v[16:19], s[84:85] offset:1024 sc1
    s_add_u32 s84, s84, s86
    s_addc_u32 s85, s85, 0
    s_nop 1
    ds_read_b64_tr_b16 v[12:13], v10 offset:128
    ds_read_b64_tr_b16 v[14:15], v11 offset:128
    ds_read_b64_tr_b16 v[16:17], v10 offset:7296
    ds_read_b64_tr_b16 v[18:19], v11 offset:7296
    s_waitcnt lgkmcnt(0)
    global_store_dwordx4 v9, v[12:15], s[84:85] sc1
    global_store_dwordx4 v9, v[16:19], s[84:85] offset:1024 sc1
    s_add_u32 s84, s84, s86
    s_addc_u32 s85, s85, 0
    s_nop 1
    ds_read_b64_tr_b16 v[12:13], v10 offset:160
    ds_read_b64_tr_b16 v[14:15], v11 offset:160
    ds_read_b64_tr_b16 v[16:17], v10 offset:7328
    ds_read_b64_tr_b16 v[18:19], v11 offset:7328
    s_waitcnt lgkmcnt(0)
    global_store_dwordx4 v9, v[12:15], s[84:85] sc1
    global_store_dwordx4 v9, v[16:19], s[84:85] offset:1024 sc1
    s_add_u32 s84, s84, s86
    s_addc_u32 s85, s85, 0
    s_nop 1
    ds_read_b64_tr_b16 v[12:13], v10 offset:192
    ds_read_b64_tr_b16 v[14:15], v11 offset:192
    ds_read_b64_tr_b16 v[16:17], v10 offset:7360
    ds_read_b64_tr_b16 v[18:19], v11 offset:7360
    s_waitcnt lgkmcnt(0)
    global_store_dwordx4 v9, v[12:15], s[84:85] sc1
    global_store_dwordx4 v9, v[16:19], s[84:85] offset:1024 sc1
    s_cmp_lt_u32 s50, 168
    s_cbranch_scc0 sequential_preLN__memory_aug_recurrent_mem_tr__mixer_gmlp__prompt_kernel_P_done
    s_waitcnt vmcnt(14)
    v_and_b32 v28, 15, v1
    v_lshlrev_b32 v9, 4, v1
    v_lshrrev_b32 v10, 2, v28
    v_add_u32 v10, v10, v241
    v_mul_u32_u24 v10, 224, v10
    v_and_b32 v11, 3, v28
    v_lshlrev_b32 v11, 3, v11
    v_add_u32 v10, v10, v11
    v_add_u32 v11, s93, v10
    v_add_u32 v10, 90112, v10
    v_add_u32 v11, 90112, v11
    ds_read_b64_tr_b16 v[12:13], v10 offset:0
    ds_read_b64_tr_b16 v[14:15], v11 offset:0
    ds_read_b64_tr_b16 v[16:17], v10 offset:7168
    ds_read_b64_tr_b16 v[18:19], v11 offset:7168
    s_waitcnt lgkmcnt(0)
    global_store_dwordx4 v9, v[12:15], s[90:91] sc1
    global_store_dwordx4 v9, v[16:19], s[90:91] offset:1024 sc1
    s_add_u32 s90, s90, s92
    s_addc_u32 s91, s91, 0
    s_nop 1
    ds_read_b64_tr_b16 v[12:13], v10 offset:32
    ds_read_b64_tr_b16 v[14:15], v11 offset:32
    ds_read_b64_tr_b16 v[16:17], v10 offset:7200
    ds_read_b64_tr_b16 v[18:19], v11 offset:7200
    s_waitcnt lgkmcnt(0)
    global_store_dwordx4 v9, v[12:15], s[90:91] sc1
    global_store_dwordx4 v9, v[16:19], s[90:91] offset:1024 sc1
    s_add_u32 s90, s90, s92
    s_addc_u32 s91, s91, 0
    s_nop 1
    ds_read_b64_tr_b16 v[12:13], v10 offset:64
    ds_read_b64_tr_b16 v[14:15], v11 offset:64
    ds_read_b64_tr_b16 v[16:17], v10 offset:7232
    ds_read_b64_tr_b16 v[18:19], v11 offset:7232
    s_waitcnt lgkmcnt(0)
    global_store_dwordx4 v9, v[12:15], s[90:91] sc1
    global_store_dwordx4 v9, v[16:19], s[90:91] offset:1024 sc1
    s_add_u32 s90, s90, s92
    s_addc_u32 s91, s91, 0
    s_nop 1
    ds_read_b64_tr_b16 v[12:13], v10 offset:96
    ds_read_b64_tr_b16 v[14:15], v11 offset:96
    ds_read_b64_tr_b16 v[16:17], v10 offset:7264
    ds_read_b64_tr_b16 v[18:19], v11 offset:7264
    s_waitcnt lgkmcnt(0)
    global_store_dwordx4 v9, v[12:15], s[90:91] sc1
    global_store_dwordx4 v9, v[16:19], s[90:91] offset:1024 sc1
    s_add_u32 s90, s90, s92
    s_addc_u32 s91, s91, 0
    s_nop 1
    ds_read_b64_tr_b16 v[12:13], v10 offset:128
    ds_read_b64_tr_b16 v[14:15], v11 offset:128
    ds_read_b64_tr_b16 v[16:17], v10 offset:7296
    ds_read_b64_tr_b16 v[18:19], v11 offset:7296
    s_waitcnt lgkmcnt(0)
    global_store_dwordx4 v9, v[12:15], s[90:91] sc1
    global_store_dwordx4 v9, v[16:19], s[90:91] offset:1024 sc1
    s_add_u32 s90, s90, s92
    s_addc_u32 s91, s91, 0
    s_nop 1
    ds_read_b64_tr_b16 v[12:13], v10 offset:160
    ds_read_b64_tr_b16 v[14:15], v11 offset:160
    ds_read_b64_tr_b16 v[16:17], v10 offset:7328
    ds_read_b64_tr_b16 v[18:19], v11 offset:7328
    s_waitcnt lgkmcnt(0)
    global_store_dwordx4 v9, v[12:15], s[90:91] sc1
    global_store_dwordx4 v9, v[16:19], s[90:91] offset:1024 sc1
    s_add_u32 s90, s90, s92
    s_addc_u32 s91, s91, 0
    s_nop 1
    ds_read_b64_tr_b16 v[12:13], v10 offset:192
    ds_read_b64_tr_b16 v[14:15], v11 offset:192
    ds_read_b64_tr_b16 v[16:17], v10 offset:7360
    ds_read_b64_tr_b16 v[18:19], v11 offset:7360
    s_waitcnt lgkmcnt(0)
    global_store_dwordx4 v9, v[12:15], s[90:91] sc1
    global_store_dwordx4 v9, v[16:19], s[90:91] offset:1024 sc1
    s_nop 1
sequential_preLN__memory_aug_recurrent_mem_tr__mixer_gmlp__prompt_kernel_P_done:
    s_waitcnt vmcnt(0) lgkmcnt(0)
    s_barrier
    s_cmp_lg_u32 s20, 0
    s_cbranch_scc1 sequential_preLN__memory_aug_recurrent_mem_tr__mixer_gmlp__prompt_kernel_P_nosig
    s_mov_b64 exec, 1
    v_cmp_eq_u32 vcc, 0, v249
    s_nop 1
    v_cndmask_b32 v249, v249, v246, vcc
    s_lshl_b32 s23, s2, 2
    s_add_u32 s23, s23, 0x1580000
    s_add_u32 s24, s16, s23
    s_addc_u32 s25, s17, 0
    v_mov_b32 v252, 0
    global_store_dword v252, v249, s[24:25] sc1
    v_mov_b32 v255, v249
    ds_write_b32 v252, v254
    ds_write_b32 v252, v255 offset:4
    s_mov_b64 exec, -1
    s_waitcnt lgkmcnt(0)
    s_nop 3
sequential_preLN__memory_aug_recurrent_mem_tr__mixer_gmlp__prompt_kernel_P_nosig:
    s_barrier
    v_mov_b32 v4, 0
    ds_read_b32 v5, v4
    ds_read_b32 v6, v4 offset:4
    s_mov_b32 s4, s16
    s_mov_b32 s5, s17
    s_mov_b32 s6, s18
    s_mov_b32 s7, s19
    s_mov_b32 s10, s20
    s_waitcnt lgkmcnt(0)
    v_readfirstlane_b32 s79, v5
    v_readfirstlane_b32 s78, v6
    s_mov_b32 s82, 255
    s_barrier
    s_mov_b32 s8, 0
    s_mov_b32 s9, s79
    s_cmp_lg_u32 s3, 0
    s_cbranch_scc1 sequential_preLN__memory_aug_recurrent_mem_tr__mixer_gmlp__prompt_kernel_notchain
    s_cmp_lt_u32 s79, 31
    s_cbranch_scc1 sequential_preLN__memory_aug_recurrent_mem_tr__mixer_gmlp__prompt_kernel_role_done
sequential_preLN__memory_aug_recurrent_mem_tr__mixer_gmlp__prompt_kernel_notchain:
    s_mov_b32 s13, 131072
    v_mbcnt_lo_u32_b32 v2, -1, 0
    v_mbcnt_hi_u32_b32 v2, -1, v2
    v_and_b32 v2, 7, v2
    v_lshlrev_b32 v2, 5, v2
    s_nop 1
sequential_preLN__memory_aug_recurrent_mem_tr__mixer_gmlp__prompt_kernel_rc:
    global_load_dword v3, v2, s[6:7] sc1
    s_waitcnt vmcnt(0)
    v_readlane_b32 s68, v3, 0
    v_readlane_b32 s69, v3, 1
    v_readlane_b32 s70, v3, 2
    v_readlane_b32 s71, v3, 3
    v_readlane_b32 s72, v3, 4
    v_readlane_b32 s73, v3, 5
    v_readlane_b32 s74, v3, 6
    v_readlane_b32 s75, v3, 7
    s_add_u32 s14, s68, s69
    s_add_u32 s14, s14, s70
    s_add_u32 s14, s14, s71
    s_add_u32 s14, s14, s72
    s_add_u32 s14, s14, s73
    s_add_u32 s14, s14, s74
    s_add_u32 s14, s14, s75
    s_cmp_ge_u32 s14, 256
    s_cbranch_scc1 sequential_preLN__memory_aug_recurrent_mem_tr__mixer_gmlp__prompt_kernel_rcok
    s_sleep 1
    s_sub_u32 s13, s13, 1
    s_cbranch_scc0 sequential_preLN__memory_aug_recurrent_mem_tr__mixer_gmlp__prompt_kernel_rc
    s_endpgm
sequential_preLN__memory_aug_recurrent_mem_tr__mixer_gmlp__prompt_kernel_rcok:
    s_mov_b32 s15, 0
    s_min_u32 s14, s69, s79
    s_add_u32 s15, s15, s14
    s_cmp_gt_u32 s69, s79
    s_cselect_b32 s14, 1, 0
    s_cmp_gt_u32 s3, 1
    s_cselect_b32 s14, s14, 0
    s_add_u32 s15, s15, s14
    s_min_u32 s14, s70, s79
    s_add_u32 s15, s15, s14
    s_cmp_gt_u32 s70, s79
    s_cselect_b32 s14, 1, 0
    s_cmp_gt_u32 s3, 2
    s_cselect_b32 s14, s14, 0
    s_add_u32 s15, s15, s14
    s_min_u32 s14, s71, s79
    s_add_u32 s15, s15, s14
    s_cmp_gt_u32 s71, s79
    s_cselect_b32 s14, 1, 0
    s_cmp_gt_u32 s3, 3
    s_cselect_b32 s14, s14, 0
    s_add_u32 s15, s15, s14
    s_min_u32 s14, s72, s79
    s_add_u32 s15, s15, s14
    s_cmp_gt_u32 s72, s79
    s_cselect_b32 s14, 1, 0
    s_cmp_gt_u32 s3, 4
    s_cselect_b32 s14, s14, 0
    s_add_u32 s15, s15, s14
    s_min_u32 s14, s73, s79
    s_add_u32 s15, s15, s14
    s_cmp_gt_u32 s73, s79
    s_cselect_b32 s14, 1, 0
    s_cmp_gt_u32 s3, 5
    s_cselect_b32 s14, s14, 0
    s_add_u32 s15, s15, s14
    s_min_u32 s14, s74, s79
    s_add_u32 s15, s15, s14
    s_cmp_gt_u32 s74, s79
    s_cselect_b32 s14, 1, 0
    s_cmp_gt_u32 s3, 6
    s_cselect_b32 s14, s14, 0
    s_add_u32 s15, s15, s14
    s_min_u32 s14, s75, s79
    s_add_u32 s15, s15, s14
    s_cmp_gt_u32 s75, s79
    s_cselect_b32 s14, 1, 0
    s_cmp_gt_u32 s3, 7
    s_cselect_b32 s14, s14, 0
    s_add_u32 s15, s15, s14
    s_add_u32 s16, s69, s70
    s_add_u32 s16, s16, s71
    s_add_u32 s16, s16, s72
    s_add_u32 s16, s16, s73
    s_add_u32 s16, s16, s74
    s_add_u32 s16, s16, s75
    s_add_u32 s16, s16, s79
    s_sub_u32 s16, s16, 31
    s_cmp_eq_u32 s3, 0
    s_cselect_b32 s9, s16, s15
    s_mov_b32 s8, 1
    s_cmp_lt_u32 s9, 220
    s_cbranch_scc1 sequential_preLN__memory_aug_recurrent_mem_tr__mixer_gmlp__prompt_kernel_role_done
    s_min_u32 s14, s68, 31
    s_sub_u32 s9, s9, 220
    s_add_u32 s9, s9, s14
    s_mov_b32 s8, 0
    s_cmp_lt_u32 s9, 31
    s_cbranch_scc1 sequential_preLN__memory_aug_recurrent_mem_tr__mixer_gmlp__prompt_kernel_role_done
    s_mov_b32 s8, 2
sequential_preLN__memory_aug_recurrent_mem_tr__mixer_gmlp__prompt_kernel_role_done:
    s_cmp_eq_u32 s8, 2
    s_cbranch_scc1 sequential_preLN__memory_aug_recurrent_mem_tr__mixer_gmlp__prompt_kernel_DLR
    s_cmp_eq_u32 s8, 1
    s_cbranch_scc1 sequential_preLN__memory_aug_recurrent_mem_tr__mixer_gmlp__prompt_kernel_workers
    s_cmp_lt_u32 s9, 16
    s_cbranch_scc1 sequential_preLN__memory_aug_recurrent_mem_tr__mixer_gmlp__prompt_kernel_jA
    s_cmp_lt_u32 s9, 30
    s_cbranch_scc1 sequential_preLN__memory_aug_recurrent_mem_tr__mixer_gmlp__prompt_kernel_jB
    s_branch sequential_preLN__memory_aug_recurrent_mem_tr__mixer_gmlp__prompt_kernel_RL
sequential_preLN__memory_aug_recurrent_mem_tr__mixer_gmlp__prompt_kernel_jA:
    s_branch sequential_preLN__memory_aug_recurrent_mem_tr__mixer_gmlp__prompt_kernel_A
sequential_preLN__memory_aug_recurrent_mem_tr__mixer_gmlp__prompt_kernel_jB:
    s_branch sequential_preLN__memory_aug_recurrent_mem_tr__mixer_gmlp__prompt_kernel_B
sequential_preLN__memory_aug_recurrent_mem_tr__mixer_gmlp__prompt_kernel_done:
    s_endpgm
sequential_preLN__memory_aug_recurrent_mem_tr__mixer_gmlp__prompt_kernel_workers:
    s_cmp_lt_u32 s9, 32
    s_cbranch_scc0 sequential_preLN__memory_aug_recurrent_mem_tr__mixer_gmlp__prompt_kernel_next0
    s_branch sequential_preLN__memory_aug_recurrent_mem_tr__mixer_gmlp__prompt_kernel_VP
sequential_preLN__memory_aug_recurrent_mem_tr__mixer_gmlp__prompt_kernel_next0:
    s_sub_u32 s9, s9, 32
    s_cmp_lt_u32 s9, 64
    s_cbranch_scc0 sequential_preLN__memory_aug_recurrent_mem_tr__mixer_gmlp__prompt_kernel_next1
    s_branch sequential_preLN__memory_aug_recurrent_mem_tr__mixer_gmlp__prompt_kernel_QP
sequential_preLN__memory_aug_recurrent_mem_tr__mixer_gmlp__prompt_kernel_next1:
    s_sub_u32 s9, s9, 64
    s_cmp_lt_u32 s9, 16
    s_cbranch_scc0 sequential_preLN__memory_aug_recurrent_mem_tr__mixer_gmlp__prompt_kernel_next2
    s_branch sequential_preLN__memory_aug_recurrent_mem_tr__mixer_gmlp__prompt_kernel_VB
sequential_preLN__memory_aug_recurrent_mem_tr__mixer_gmlp__prompt_kernel_next2:
    s_sub_u32 s9, s9, 16
    s_cmp_lt_u32 s9, 28
    s_cbranch_scc0 sequential_preLN__memory_aug_recurrent_mem_tr__mixer_gmlp__prompt_kernel_next3
    s_branch sequential_preLN__memory_aug_recurrent_mem_tr__mixer_gmlp__prompt_kernel_AL
sequential_preLN__memory_aug_recurrent_mem_tr__mixer_gmlp__prompt_kernel_next3:
    s_sub_u32 s9, s9, 28
    s_cmp_lt_u32 s9, 16
    s_cbranch_scc0 sequential_preLN__memory_aug_recurrent_mem_tr__mixer_gmlp__prompt_kernel_next4
    s_branch sequential_preLN__memory_aug_recurrent_mem_tr__mixer_gmlp__prompt_kernel_BE
sequential_preLN__memory_aug_recurrent_mem_tr__mixer_gmlp__prompt_kernel_next4:
    s_sub_u32 s9, s9, 16
    s_cmp_lt_u32 s9, 64
    s_cbranch_scc0 sequential_preLN__memory_aug_recurrent_mem_tr__mixer_gmlp__prompt_kernel_next5
    s_branch sequential_preLN__memory_aug_recurrent_mem_tr__mixer_gmlp__prompt_kernel_GA
sequential_preLN__memory_aug_recurrent_mem_tr__mixer_gmlp__prompt_kernel_next5:
    s_sub_u32 s9, s9, 64
    s_endpgm
sequential_preLN__memory_aug_recurrent_mem_tr__mixer_gmlp__prompt_kernel_RL:
    s_cmp_lg_u32 s10, 0
    s_cbranch_scc1 sequential_preLN__memory_aug_recurrent_mem_tr__mixer_gmlp__prompt_kernel_RL_all_pwj
    s_mov_b32 s13, 131072
    s_add_u32 s76, s4, 0x1580000
    s_addc_u32 s77, s5, 0
    v_mbcnt_lo_u32_b32 v20, -1, 0
    v_mbcnt_hi_u32_b32 v20, -1, v20
    v_lshlrev_b32 v20, 4, v20
    s_nop 1
sequential_preLN__memory_aug_recurrent_mem_tr__mixer_gmlp__prompt_kernel_RL_all_pw:
    global_load_dwordx4 v[22:25], v20, s[76:77] sc1
    s_waitcnt vmcnt(0)
    v_xor_b32 v22, s78, v22
    v_xor_b32 v23, s78, v23
    v_xor_b32 v24, s78, v24
    v_xor_b32 v25, s78, v25
    v_or_b32 v22, v22, v23
    v_or_b32 v24, v24, v25
    v_or_b32 v22, v22, v24
    v_cmp_ne_u32 vcc, 0, v22
    s_nop 0
    s_cbranch_vccz sequential_preLN__memory_aug_recurrent_mem_tr__mixer_gmlp__prompt_kernel_RL_all_pwok
    s_sleep 16
    s_sub_u32 s13, s13, 1
    s_cbranch_scc0 sequential_preLN__memory_aug_recurrent_mem_tr__mixer_gmlp__prompt_kernel_RL_all_pw
    s_endpgm
sequential_preLN__memory_aug_recurrent_mem_tr__mixer_gmlp__prompt_kernel_RL_all_pwok:
    buffer_inv sc1
    s_waitcnt vmcnt(0)
sequential_preLN__memory_aug_recurrent_mem_tr__mixer_gmlp__prompt_kernel_RL_all_pwj:
    s_barrier
    v_lshlrev_b32 v1, 4, v1
    s_cmp_lt_u32 s10, 3
    s_cselect_b32 s15, 4096, 0
    s_lshl_b32 s14, s10, 10
    v_add_u32 v2, s14, v1
    v_add_u32 v3, s15, v2
    s_add_u32 s18, s4, 0x1202000
    s_addc_u32 s19, s5, 0
    s_add_u32 s20, s4, 0x1302000
    s_addc_u32 s21, s5, 0
    s_mov_b32 s30, 1
sequential_preLN__memory_aug_recurrent_mem_tr__mixer_gmlp__prompt_kernel_RL_loop:
    s_mov_b32 s13, 131072
sequential_preLN__memory_aug_recurrent_mem_tr__mixer_gmlp__prompt_kernel_RL_poll:
    global_load_dwordx4 v[8:11], v2, s[18:19] sc1
    global_load_dwordx4 v[12:15], v3, s[18:19] sc1
    s_waitcnt vmcnt(0)
    v_max3_u32 v4, v8, v9, v10
    v_max3_u32 v5, v11, v12, v13
    v_max3_u32 v4, v4, v14, v15
    v_max_u32 v4, v4, v5
    v_cmp_eq_u32 vcc, -1, v4
    s_nop 0
    s_cbranch_vccz sequential_preLN__memory_aug_recurrent_mem_tr__mixer_gmlp__prompt_kernel_RL_ok
    s_sleep 6
    s_sub_u32 s13, s13, 1
    s_cbranch_scc0 sequential_preLN__memory_aug_recurrent_mem_tr__mixer_gmlp__prompt_kernel_RL_poll
    s_endpgm
sequential_preLN__memory_aug_recurrent_mem_tr__mixer_gmlp__prompt_kernel_RL_ok:
    global_store_dwordx4 v2, v[8:11], s[20:21] sc1
    global_store_dwordx4 v3, v[12:15], s[20:21] sc1
    s_add_u32 s18, s18, 8192
    s_addc_u32 s19, s19, 0
    s_add_u32 s20, s20, 8192
    s_addc_u32 s21, s21, 0
    s_add_u32 s30, s30, 1
    s_cmp_lt_u32 s30, 64
    s_cbranch_scc1 sequential_preLN__memory_aug_recurrent_mem_tr__mixer_gmlp__prompt_kernel_RL_loop
    s_waitcnt vmcnt(0)
    s_branch sequential_preLN__memory_aug_recurrent_mem_tr__mixer_gmlp__prompt_kernel_DL0
sequential_preLN__memory_aug_recurrent_mem_tr__mixer_gmlp__prompt_kernel_A:
    s_mov_b32 s83, s9
    v_lshlrev_b32 v1, 4, v1
    v_and_b32 v0, 63, v0
    s_lshl_b32 s16, s9, 3
    s_lshl_b32 s17, s10, 1
    s_add_u32 s16, s16, s17
    s_mov_b32 s13, 131072
    s_add_u32 s76, s4, 0x1580000
    s_addc_u32 s77, s5, 0
    v_mbcnt_lo_u32_b32 v24, -1, 0
    v_mbcnt_hi_u32_b32 v24, -1, v24
    v_and_b32 v25, 1, v24
    v_lshrrev_b32 v24, 1, v24
    v_and_b32 v24, 0, v24
    v_mul_u32_u24 v24, 0, v24
    v_add_u32 v24, v24, v25
    v_add_u32 v24, s16, v24
    v_lshlrev_b32 v24, 2, v24
    s_nop 1
sequential_preLN__memory_aug_recurrent_mem_tr__mixer_gmlp__prompt_kernel_A_h_pw:
    global_load_dword v25, v24, s[76:77] sc1
    s_waitcnt vmcnt(0)
    v_cmp_ne_u32 vcc, s78, v25
    s_nop 0
    s_cbranch_vccz sequential_preLN__memory_aug_recurrent_mem_tr__mixer_gmlp__prompt_kernel_A_h_pwok
    s_sleep 6
    s_sub_u32 s13, s13, 1
    s_cbranch_scc0 sequential_preLN__memory_aug_recurrent_mem_tr__mixer_gmlp__prompt_kernel_A_h_pw
    s_endpgm
sequential_preLN__memory_aug_recurrent_mem_tr__mixer_gmlp__prompt_kernel_A_h_pwok:
    s_lshl_b32 s14, s9, 2
    s_add_u32 s14, s14, s10
    s_mul_i32 s14, s14, 100352
    s_add_u32 s14, s14, 0x400000
    s_add_u32 s20, s4, s14
    s_addc_u32 s21, s5, 0
    global_load_dwordx4 v[120:123], v1, s[20:21] offset:0 sc1
    global_load_dwordx4 v[124:127], v1, s[20:21] offset:1024 sc1
    global_load_dwordx4 v[128:131], v1, s[20:21] offset:2048 sc1
    global_load_dwordx4 v[132:135], v1, s[20:21] offset:3072 sc1
    s_add_u32 s20, s20, 4096
    s_addc_u32 s21, s21, 0
    global_load_dwordx4 v[136:139], v1, s[20:21] offset:0 sc1
    global_load_dwordx4 v[140:143], v1, s[20:21] offset:1024 sc1
    global_load_dwordx4 v[144:147], v1, s[20:21] offset:2048 sc1
    global_load_dwordx4 v[148:151], v1, s[20:21] offset:3072 sc1
    s_add_u32 s20, s20, 4096
    s_addc_u32 s21, s21, 0
    global_load_dwordx4 v[152:155], v1, s[20:21] offset:0 sc1
    global_load_dwordx4 v[156:159], v1, s[20:21] offset:1024 sc1
    global_load_dwordx4 v[160:163], v1, s[20:21] offset:2048 sc1
    global_load_dwordx4 v[164:167], v1, s[20:21] offset:3072 sc1
    s_add_u32 s20, s20, 4096
    s_addc_u32 s21, s21, 0
    global_load_dwordx4 v[168:171], v1, s[20:21] offset:0 sc1
    global_load_dwordx4 v[172:175], v1, s[20:21] offset:1024 sc1
    global_load_dwordx4 v[176:179], v1, s[20:21] offset:2048 sc1
    global_load_dwordx4 v[180:183], v1, s[20:21] offset:3072 sc1
    s_add_u32 s20, s20, 4096
    s_addc_u32 s21, s21, 0
    s_waitcnt vmcnt(32)
    global_load_dwordx4 v[184:187], v1, s[20:21] offset:0 sc1
    global_load_dwordx4 v[188:191], v1, s[20:21] offset:1024 sc1
    global_load_dwordx4 v[192:195], v1, s[20:21] offset:2048 sc1
    global_load_dwordx4 v[196:199], v1, s[20:21] offset:3072 sc1
    s_add_u32 s20, s20, 4096
    s_addc_u32 s21, s21, 0
    global_load_dwordx4 v[200:203], v1, s[20:21] offset:0 sc1
    global_load_dwordx4 v[204:207], v1, s[20:21] offset:1024 sc1
    global_load_dwordx4 v[208:211], v1, s[20:21] offset:2048 sc1
    global_load_dwordx4 v[212:215], v1, s[20:21] offset:3072 sc1
    s_add_u32 s20, s20, 4096
    s_addc_u32 s21, s21, 0
    global_load_dwordx4 v[216:219], v1, s[20:21] offset:0 sc1
    global_load_dwordx4 v[220:223], v1, s[20:21] offset:1024 sc1
    global_load_dwordx4 v[224:227], v1, s[20:21] offset:2048 sc1
    global_load_dwordx4 v[228:231], v1, s[20:21] offset:3072 sc1
    s_add_u32 s20, s20, 4096
    s_addc_u32 s21, s21, 0
    global_load_dwordx4 v[232:235], v1, s[20:21] offset:0 sc1
    global_load_dwordx4 v[236:239], v1, s[20:21] offset:1024 sc1
    global_load_dwordx4 v[240:243], v1, s[20:21] offset:2048 sc1
    global_load_dwordx4 v[244:247], v1, s[20:21] offset:3072 sc1
    s_add_u32 s20, s20, 4096
    s_addc_u32 s21, s21, 0
    s_waitcnt vmcnt(32)
    global_load_dwordx4 v[248:251], v1, s[20:21] offset:0 sc1
    global_load_dwordx4 v[252:255], v1, s[20:21] offset:1024 sc1
    global_load_dwordx4 a[0:3], v1, s[20:21] offset:2048 sc1
    global_load_dwordx4 a[4:7], v1, s[20:21] offset:3072 sc1
    s_add_u32 s20, s20, 4096
    s_addc_u32 s21, s21, 0
    global_load_dwordx4 a[8:11], v1, s[20:21] offset:0 sc1
    global_load_dwordx4 a[12:15], v1, s[20:21] offset:1024 sc1
    global_load_dwordx4 a[16:19], v1, s[20:21] offset:2048 sc1
    global_load_dwordx4 a[20:23], v1, s[20:21] offset:3072 sc1
    s_add_u32 s20, s20, 4096
    s_addc_u32 s21, s21, 0
    global_load_dwordx4 a[24:27], v1, s[20:21] offset:0 sc1
    global_load_dwordx4 a[28:31], v1, s[20:21] offset:1024 sc1
    global_load_dwordx4 a[32:35], v1, s[20:21] offset:2048 sc1
    global_load_dwordx4 a[36:39], v1, s[20:21] offset:3072 sc1
    s_add_u32 s20, s20, 4096
    s_addc_u32 s21, s21, 0
    global_load_dwordx4 a[40:43], v1, s[20:21] offset:0 sc1
    global_load_dwordx4 a[44:47], v1, s[20:21] offset:1024 sc1
    global_load_dwordx4 a[48:51], v1, s[20:21] offset:2048 sc1
    global_load_dwordx4 a[52:55], v1, s[20:21] offset:3072 sc1
    s_add_u32 s20, s20, 4096
    s_addc_u32 s21, s21, 0
    s_waitcnt vmcnt(32)
    global_load_dwordx4 a[56:59], v1, s[20:21] offset:0 sc1
    global_load_dwordx4 a[60:63], v1, s[20:21] offset:1024 sc1
    global_load_dwordx4 a[64:67], v1, s[20:21] offset:2048 sc1
    global_load_dwordx4 a[68:71], v1, s[20:21] offset:3072 sc1
    s_add_u32 s20, s20, 4096
    s_addc_u32 s21, s21, 0
    global_load_dwordx4 a[72:75], v1, s[20:21] offset:0 sc1
    global_load_dwordx4 a[76:79], v1, s[20:21] offset:1024 sc1
    global_load_dwordx4 a[80:83], v1, s[20:21] offset:2048 sc1
    global_load_dwordx4 a[84:87], v1, s[20:21] offset:3072 sc1
    s_add_u32 s20, s20, 4096
    s_addc_u32 s21, s21, 0
    global_load_dwordx4 a[88:91], v1, s[20:21] offset:0 sc1
    global_load_dwordx4 a[92:95], v1, s[20:21] offset:1024 sc1
    global_load_dwordx4 a[96:99], v1, s[20:21] offset:2048 sc1
    global_load_dwordx4 a[100:103], v1, s[20:21] offset:3072 sc1
    s_add_u32 s20, s20, 4096
    s_addc_u32 s21, s21, 0
    global_load_dwordx4 a[104:107], v1, s[20:21] offset:0 sc1
    global_load_dwordx4 a[108:111], v1, s[20:21] offset:1024 sc1
    global_load_dwordx4 a[112:115], v1, s[20:21] offset:2048 sc1
    global_load_dwordx4 a[116:119], v1, s[20:21] offset:3072 sc1
    s_add_u32 s20, s20, 4096
    s_addc_u32 s21, s21, 0
    s_waitcnt vmcnt(32)
    global_load_dwordx4 a[120:123], v1, s[20:21] offset:0 sc1
    global_load_dwordx4 a[124:127], v1, s[20:21] offset:1024 sc1
    global_load_dwordx4 a[128:131], v1, s[20:21] offset:2048 sc1
    global_load_dwordx4 a[132:135], v1, s[20:21] offset:3072 sc1
    s_add_u32 s20, s20, 4096
    s_addc_u32 s21, s21, 0
    global_load_dwordx4 a[136:139], v1, s[20:21] offset:0 sc1
    global_load_dwordx4 a[140:143], v1, s[20:21] offset:1024 sc1
    global_load_dwordx4 a[144:147], v1, s[20:21] offset:2048 sc1
    global_load_dwordx4 a[148:151], v1, s[20:21] offset:3072 sc1
    s_add_u32 s20, s20, 4096
    s_addc_u32 s21, s21, 0
    global_load_dwordx4 a[152:155], v1, s[20:21] offset:0 sc1
    global_load_dwordx4 a[156:159], v1, s[20:21] offset:1024 sc1
    global_load_dwordx4 a[160:163], v1, s[20:21] offset:2048 sc1
    global_load_dwordx4 a[164:167], v1, s[20:21] offset:3072 sc1
    s_add_u32 s20, s20, 4096
    s_addc_u32 s21, s21, 0
    global_load_dwordx4 a[168:171], v1, s[20:21] offset:0 sc1
    global_load_dwordx4 a[172:175], v1, s[20:21] offset:1024 sc1
    global_load_dwordx4 a[176:179], v1, s[20:21] offset:2048 sc1
    global_load_dwordx4 a[180:183], v1, s[20:21] offset:3072 sc1
    s_add_u32 s20, s20, 4096
    s_addc_u32 s21, s21, 0
    s_waitcnt vmcnt(32)
    global_load_dwordx4 a[184:187], v1, s[20:21] offset:0 sc1
    global_load_dwordx4 a[188:191], v1, s[20:21] offset:1024 sc1
    global_load_dwordx4 a[192:195], v1, s[20:21] offset:2048 sc1
    global_load_dwordx4 a[196:199], v1, s[20:21] offset:3072 sc1
    s_add_u32 s20, s20, 4096
    s_addc_u32 s21, s21, 0
    global_load_dwordx4 a[200:203], v1, s[20:21] offset:0 sc1
    global_load_dwordx4 a[204:207], v1, s[20:21] offset:1024 sc1
    global_load_dwordx4 a[208:211], v1, s[20:21] offset:2048 sc1
    global_load_dwordx4 a[212:215], v1, s[20:21] offset:3072 sc1
    s_add_u32 s20, s20, 4096
    s_addc_u32 s21, s21, 0
    global_load_dwordx4 a[216:219], v1, s[20:21] offset:0 sc1
    global_load_dwordx4 a[220:223], v1, s[20:21] offset:1024 sc1
    global_load_dwordx4 a[224:227], v1, s[20:21] offset:2048 sc1
    global_load_dwordx4 a[228:231], v1, s[20:21] offset:3072 sc1
    s_add_u32 s20, s20, 4096
    s_addc_u32 s21, s21, 0
    global_load_dwordx4 a[232:235], v1, s[20:21] offset:0 sc1
    global_load_dwordx4 a[236:239], v1, s[20:21] offset:1024 sc1
    global_load_dwordx4 a[240:243], v1, s[20:21] offset:2048 sc1
    global_load_dwordx4 a[244:247], v1, s[20:21] offset:3072 sc1
    s_add_u32 s20, s20, 4096
    s_addc_u32 s21, s21, 0
    s_waitcnt vmcnt(32)
    global_load_dwordx4 a[248:251], v1, s[20:21] offset:0 sc1
    global_load_dwordx4 a[252:255], v1, s[20:21] offset:1024 sc1
    s_cmp_lg_u32 s10, 0
    s_cbranch_scc1 sequential_preLN__memory_aug_recurrent_mem_tr__mixer_gmlp__prompt_kernel_A_all_pwj
    s_mov_b32 s13, 131072
    s_add_u32 s76, s4, 0x1580000
    s_addc_u32 s77, s5, 0
    v_mbcnt_lo_u32_b32 v24, -1, 0
    v_mbcnt_hi_u32_b32 v24, -1, v24
    v_lshlrev_b32 v24, 4, v24
    s_nop 1
sequential_preLN__memory_aug_recurrent_mem_tr__mixer_gmlp__prompt_kernel_A_all_pw:
    global_load_dwordx4 v[26:29], v24, s[76:77] sc1
    s_waitcnt vmcnt(0)
    v_xor_b32 v26, s78, v26
    v_xor_b32 v27, s78, v27
    v_xor_b32 v28, s78, v28
    v_xor_b32 v29, s78, v29
    v_or_b32 v26, v26, v27
    v_or_b32 v28, v28, v29
    v_or_b32 v26, v26, v28
    v_cmp_ne_u32 vcc, 0, v26
    s_nop 0
    s_cbranch_vccz sequential_preLN__memory_aug_recurrent_mem_tr__mixer_gmlp__prompt_kernel_A_all_pwok
    s_sleep 16
    s_sub_u32 s13, s13, 1
    s_cbranch_scc0 sequential_preLN__memory_aug_recurrent_mem_tr__mixer_gmlp__prompt_kernel_A_all_pw
    s_endpgm
sequential_preLN__memory_aug_recurrent_mem_tr__mixer_gmlp__prompt_kernel_A_all_pwok:
    buffer_inv sc1
    s_waitcnt vmcnt(0)
sequential_preLN__memory_aug_recurrent_mem_tr__mixer_gmlp__prompt_kernel_A_all_pwj:
    s_barrier
    v_and_b32 v3, 8, v0
    v_cmp_ne_u32 vcc, 0, v3
    v_mov_b32 v3, 0x44444444
    v_mov_b32 v23, 0xeeeeeeee
    v_cndmask_b32 v3, v3, v23, vcc
    v_lshrrev_b32 v24, 4, v0
    v_and_b32 v24, 1, v24
    v_lshrrev_b32 v25, 2, v0
    v_and_b32 v25, 1, v25
    v_cmp_eq_u32 vcc, v24, v25
    v_and_b32 v24, 1, v0
    v_lshlrev_b32 v24, 4, v24
    v_mov_b32 v25, 0x3f80
    v_lshlrev_b32 v25, v24, v25
    v_cndmask_b32 v25, 0, v25, vcc
    v_lshrrev_b32 v26, 3, v0
    v_and_b32 v26, 1, v26
    v_lshlrev_b32 v26, 1, v26
    v_lshrrev_b32 v27, 1, v0
    v_and_b32 v27, 1, v27
    v_add_u32 v26, v26, v27
    v_cmp_eq_u32 vcc, 0, v26
    s_nop 1
    v_cndmask_b32 v4, 0, v25, vcc
    v_cmp_eq_u32 vcc, 1, v26
    s_nop 1
    v_cndmask_b32 v5, 0, v25, vcc
    v_cmp_eq_u32 vcc, 2, v26
    s_nop 1
    v_cndmask_b32 v6, 0, v25, vcc
    v_cmp_eq_u32 vcc, 3, v26
    s_nop 1
    v_cndmask_b32 v7, 0, v25, vcc
    v_lshrrev_b32 v24, 4, v0
    v_and_b32 v25, 15, v0
    v_lshrrev_b32 v26, 1, v24
    v_and_b32 v27, 1, v24
    v_lshlrev_b32 v28, 2, v27
    v_add3_u32 v28, v28, v26, 8
    v_add_u32 v29, 10, v26
    v_add_u32 v30, 4, v24
    s_mul_i32 s14, s10, 14
    v_and_b32 v32, 7, v25
    v_lshlrev_b32 v32, 4, v32
    v_add_u32 v33, s14, v24
    v_lshlrev_b32 v34, 7, v33
    v_add_u32 v12, v34, v32
    v_add_u32 v12, 8192, v12
    v_add_u32 v33, s14, v30
    v_lshlrev_b32 v34, 7, v33
    v_add_u32 v13, v34, v32
    v_add_u32 v13, 8192, v13
    v_add_u32 v33, s14, v28
    v_lshlrev_b32 v34, 7, v33
    v_add_u32 v14, v34, v32
    v_add_u32 v14, 8192, v14
    v_add_u32 v33, s14, v29
    v_lshlrev_b32 v34, 7, v33
    v_add_u32 v15, v34, v32
    v_add_u32 v15, 8192, v15
    v_cmp_gt_u32 s[26:27], 32, v0
    s_lshl_b32 s14, s10, 14
    s_add_u32 s28, s14, 24576
    v_add_u32 v16, s28, v1
    s_cmp_lt_u32 s10, 3
    s_cselect_b32 s15, 4096, 0
    s_lshl_b32 s14, s10, 10
    v_add_u32 v116, s14, v1
    v_add_u32 v117, s15, v116
    v_add_u32 v9, 8192, v116
    v_add_u32 v10, 8192, v117
    v_add_u32 v22, 8192, v1
    v_add_u32 v8, 0x1000, v1
    v_min_u32 v33, 55, v0
    v_lshrrev_b32 v34, 2, v33
    v_lshlrev_b32 v34, 9, v34
    v_and_b32 v33, 3, v33
    v_lshlrev_b32 v33, 5, v33
    v_add_u32 v2, v33, v34
    v_add_u32 v2, 412, v2
    v_lshrrev_b32 v33, 3, v25
    v_lshrrev_b32 v34, 1, v25
    v_and_b32 v34, 1, v34
    v_lshlrev_b32 v35, 1, v34
    v_add_u32 v35, v35, v33
    v_add_u32 v35, s10, v35
    v_and_b32 v35, 3, v35
    v_lshlrev_b32 v35, 2, v35
    v_lshlrev_b32 v36, 4, v33
    v_lshlrev_b32 v37, 3, v34
    v_add_u32 v36, v36, v37
    v_lshrrev_b32 v37, 2, v25
    v_and_b32 v37, 1, v37
    v_lshlrev_b32 v37, 2, v37
    v_add_u32 v36, v36, v37
    v_lshlrev_b32 v37, 1, v26
    v_add_u32 v36, v36, v37
    v_and_b32 v37, 1, v25
    v_add_u32 v36, v36, v37
    v_lshlrev_b32 v36, 4, v36
    v_mul_u32_u24 v37, 3072, v27
    v_add3_u32 v17, v35, v36, v37
    v_add_u32 v17, 0, v17
    v_lshlrev_b32 v35, 1, v27
    v_add_u32 v35, v35, v33
    v_add_u32 v35, s10, v35
    v_and_b32 v35, 3, v35
    v_lshlrev_b32 v35, 2, v35
    v_mul_u32_u24 v36, 1536, v26
    v_lshlrev_b32 v38, 4, v25
    v_add3_u32 v35, v35, v36, v38
    v_add_u32 v35, v35, v37
    v_add_u32 v21, 512, v35
    s_lshl_b32 s14, s10, 1
    v_lshrrev_b32 v33, 3, v0
    v_and_b32 v33, 1, v33
    v_add_u32 v33, s14, v33
    v_mul_u32_u24 v35, 768, v33
    v_lshlrev_b32 v36, 3, v24
    v_and_b32 v37, 7, v0
    v_add_u32 v36, v36, v37
    v_lshlrev_b32 v36, 4, v36
    v_add_u32 v18, v35, v36
    v_add_u32 v18, 0, v18
    v_lshlrev_b32 v36, 4, v37
    v_add_u32 v19, v35, v36
    v_add_u32 v19, 512, v19
    v_lshlrev_b32 v36, 7, v24
    v_lshlrev_b32 v38, 4, v33
    v_add_u32 v36, v36, v38
    v_lshrrev_b32 v38, 1, v0
    v_and_b32 v38, 3, v38
    v_lshlrev_b32 v38, 2, v38
    v_add_u32 v36, v36, v38
    s_lshl_b32 s14, s9, 9
    v_add_u32 v36, s14, v36
    s_lshl_b32 s14, s9, 7
    s_add_u32 s14, s14, 8192
    v_lshlrev_b32 v38, 4, v33
    v_lshrrev_b32 v39, 1, v37
    v_lshlrev_b32 v39, 2, v39
    v_add3_u32 v38, v38, v39, s14
    v_and_b32 v39, 1, v0
    v_cmp_eq_u32 s[32:33], 1, v39
    s_nop 1
    v_cndmask_b32 v20, v36, v38, s[32:33]
    s_mov_b32 s38, 0x5555ffff
    s_mov_b32 s39, 0x55555555
    s_add_u32 s18, s4, 0x1200000
    s_addc_u32 s19, s5, 0
    s_add_u32 s20, s4, 0x1400000
    s_addc_u32 s21, s5, 0
    s_lshl_b32 s14, s10, 13
    s_add_u32 s14, s14, 0x1600000
    s_add_u32 s22, s4, s14
    s_addc_u32 s23, s5, 0
    s_mov_b32 s29, s28
    s_add_u32 m0, s29, 0
    s_nop 0
    global_load_lds_dwordx4 v1, s[22:23] offset:0
    global_load_lds_dwordx4 v1, s[22:23] offset:1024
    global_load_lds_dwordx4 v1, s[22:23] offset:2048
    global_load_lds_dwordx4 v1, s[22:23] offset:3072
    s_add_u32 m0, s29, 4096
    s_nop 0
    global_load_lds_dwordx4 v8, s[22:23] offset:0
    global_load_lds_dwordx4 v8, s[22:23] offset:1024
    global_load_lds_dwordx4 v8, s[22:23] offset:2048
    global_load_lds_dwordx4 v8, s[22:23] offset:3072
    s_add_u32 s22, s22, 32768
    s_addc_u32 s23, s23, 0
    s_xor_b32 s29, s29, 8192
    s_mov_b32 s13, 131072
    v_mbcnt_lo_u32_b32 v24, -1, 0
    v_mbcnt_hi_u32_b32 v24, -1, v24
    v_and_b32 v24, 7, v24
    v_lshlrev_b32 v24, 5, v24
    s_nop 1
sequential_preLN__memory_aug_recurrent_mem_tr__mixer_gmlp__prompt_kernel_A_cm_rc:
    global_load_dword v25, v24, s[6:7] sc1
    s_waitcnt vmcnt(0)
    v_readlane_b32 s68, v25, 0
    v_readlane_b32 s69, v25, 1
    v_readlane_b32 s70, v25, 2
    v_readlane_b32 s71, v25, 3
    v_readlane_b32 s72, v25, 4
    v_readlane_b32 s73, v25, 5
    v_readlane_b32 s74, v25, 6
    v_readlane_b32 s75, v25, 7
    s_add_u32 s14, s68, s69
    s_add_u32 s14, s14, s70
    s_add_u32 s14, s14, s71
    s_add_u32 s14, s14, s72
    s_add_u32 s14, s14, s73
    s_add_u32 s14, s14, s74
    s_add_u32 s14, s14, s75
    s_cmp_ge_u32 s14, 256
    s_cbranch_scc1 sequential_preLN__memory_aug_recurrent_mem_tr__mixer_gmlp__prompt_kernel_A_cm_rcok
    s_sleep 1
    s_sub_u32 s13, s13, 1
    s_cbranch_scc0 sequential_preLN__memory_aug_recurrent_mem_tr__mixer_gmlp__prompt_kernel_A_cm_rc
    s_endpgm
sequential_preLN__memory_aug_recurrent_mem_tr__mixer_gmlp__prompt_kernel_A_cm_rcok:
    s_cmp_lt_u32 s68, 31
    s_cselect_b32 s11, 1, 0
    s_mov_b32 s36, 0x3e800000
    s_mov_b32 s34, 0x2b800000
    s_mov_b32 s35, 0x28000000
    s_waitcnt vmcnt(0) lgkmcnt(0)
    s_barrier
    s_mov_b32 s12, 0
    v_mov_b64 v[52:53], 0
    v_mov_b64 v[54:55], 0
    v_mov_b64 v[56:57], 0
    v_mov_b64 v[58:59], 0
    v_mov_b64 v[60:61], 0
    v_mov_b64 v[62:63], 0
    v_mov_b64 v[64:65], 0
    v_mov_b64 v[66:67], 0
    v_mov_b64 v[68:69], 0
    v_mov_b64 v[70:71], 0
    v_mov_b64 v[72:73], 0
    v_mov_b64 v[74:75], 0
    v_mov_b64 v[76:77], 0
    v_mov_b64 v[78:79], 0
    s_cmp_eq_u32 s11, 0
    s_cbranch_scc0 sequential_preLN__memory_aug_recurrent_mem_tr__mixer_gmlp__prompt_kernel_A_slow_loop
sequential_preLN__memory_aug_recurrent_mem_tr__mixer_gmlp__prompt_kernel_A_fast_loop:
    s_mov_b32 s13, 131072
sequential_preLN__memory_aug_recurrent_mem_tr__mixer_gmlp__prompt_kernel_A_fast_mpoll:
    global_load_dwordx4 v[92:95], v116, s[18:19] sc1
    global_load_dwordx4 v[96:99], v117, s[18:19] sc1
    s_sub_u32 s13, s13, 1
    s_cbranch_scc1 sequential_preLN__memory_aug_recurrent_mem_tr__mixer_gmlp__prompt_kernel_A_fast_abort
    s_waitcnt vmcnt(1)
    ds_write_b128 v9, v[92:95]
    v_max3_u32 v23, v92, v93, v94
    v_max_u32 v23, v23, v95
    s_waitcnt vmcnt(0)
    ds_write_b128 v10, v[96:99]
    v_max3_u32 v0, v96, v97, v98
    v_max3_u32 v23, v23, v0, v99
    v_cmp_eq_u32 vcc, -1, v23
    s_nop 0
    s_cbranch_vccnz sequential_preLN__memory_aug_recurrent_mem_tr__mixer_gmlp__prompt_kernel_A_fast_mpoll
    s_waitcnt lgkmcnt(0)
    s_barrier
    ds_read_b128 v[24:27], v22 offset:0
    ds_read_b128 v[28:31], v22 offset:1024
    ds_read_b128 v[32:35], v22 offset:2048
    s_waitcnt lgkmcnt(2)
    v_smfmac_f32_16x16x64_bf16 v[68:71], v[24:27], a[88:95], v3
    ds_read_b128 v[36:39], v22 offset:3072
    v_smfmac_f32_16x16x64_bf16 v[72:75], v[24:27], a[144:151], v3
    ds_read_b128 v[40:43], v22 offset:4096
    v_smfmac_f32_16x16x64_bf16 v[76:79], v[24:27], a[200:207], v3
    ds_read_b128 v[44:47], v22 offset:5120
    s_waitcnt lgkmcnt(4)
    v_smfmac_f32_16x16x64_bf16 v[68:71], v[28:31], a[96:103], v3
    ds_read_b128 v[48:51], v22 offset:6144
    v_smfmac_f32_16x16x64_bf16 v[72:75], v[28:31], a[152:159], v3
    ds_read_b128 v[92:95], v14
    v_smfmac_f32_16x16x64_bf16 v[76:79], v[28:31], a[208:215], v3
    ds_read_b128 v[96:99], v15
    s_waitcnt lgkmcnt(6)
    v_smfmac_f32_16x16x64_bf16 v[68:71], v[32:35], a[104:111], v3
    ds_read_b128 v[100:103], v16 offset:2048
    v_smfmac_f32_16x16x64_bf16 v[72:75], v[32:35], a[160:167], v3
    ds_read_b128 v[104:107], v16 offset:3072
    v_smfmac_f32_16x16x64_bf16 v[76:79], v[32:35], a[216:223], v3
    ds_read_b128 v[108:111], v16 offset:6144
    s_waitcnt lgkmcnt(8)
    v_smfmac_f32_16x16x64_bf16 v[68:71], v[36:39], a[112:119], v3
    ds_read_b128 v[112:115], v16 offset:7168
    v_smfmac_f32_16x16x64_bf16 v[72:75], v[36:39], a[168:175], v3
    s_add_u32 m0, s29, 0
    v_smfmac_f32_16x16x64_bf16 v[76:79], v[36:39], a[224:231], v3
    global_load_lds_dwordx4 v1, s[22:23] offset:0
    s_waitcnt lgkmcnt(8)
    v_smfmac_f32_16x16x64_bf16 v[68:71], v[40:43], a[120:127], v3
    v_smfmac_f32_16x16x64_bf16 v[72:75], v[40:43], a[176:183], v3
    global_load_lds_dwordx4 v1, s[22:23] offset:1024
    v_smfmac_f32_16x16x64_bf16 v[76:79], v[40:43], a[232:239], v3
    s_waitcnt lgkmcnt(7)
    v_smfmac_f32_16x16x64_bf16 v[68:71], v[44:47], a[128:135], v3
    global_load_lds_dwordx4 v1, s[22:23] offset:2048
    v_smfmac_f32_16x16x64_bf16 v[72:75], v[44:47], a[184:191], v3
    v_smfmac_f32_16x16x64_bf16 v[76:79], v[44:47], a[240:247], v3
    global_load_lds_dwordx4 v1, s[22:23] offset:3072
    s_waitcnt lgkmcnt(6)
    v_smfmac_f32_16x16x64_bf16 v[68:71], v[48:51], a[136:143], v3
    s_add_u32 m0, s29, 4096
    v_smfmac_f32_16x16x64_bf16 v[72:75], v[48:51], a[192:199], v3
    global_load_lds_dwordx4 v8, s[22:23] offset:0
    v_smfmac_f32_16x16x64_bf16 v[76:79], v[48:51], a[248:255], v3
    v_smfmac_f32_16x16x64_bf16 v[52:55], v[24:27], v[120:127], v3
    global_load_lds_dwordx4 v8, s[22:23] offset:1024
    v_smfmac_f32_16x16x64_bf16 v[56:59], v[24:27], v[176:183], v3
    v_smfmac_f32_16x16x64_bf16 v[52:55], v[28:31], v[128:135], v3
    global_load_lds_dwordx4 v8, s[22:23] offset:2048
    v_smfmac_f32_16x16x64_bf16 v[56:59], v[28:31], v[184:191], v3
    v_smfmac_f32_16x16x64_bf16 v[52:55], v[32:35], v[136:143], v3
    global_load_lds_dwordx4 v8, s[22:23] offset:3072
    v_smfmac_f32_16x16x64_bf16 v[56:59], v[32:35], v[192:199], v3
    v_cvt_pk_bf16_f32 v80, v68, v69
    v_cvt_pk_bf16_f32 v81, v70, v71
    v_smfmac_f32_16x16x64_bf16 v[52:55], v[36:39], v[144:151], v3
    v_cvt_pk_bf16_f32 v82, v72, v73
    v_cvt_pk_bf16_f32 v83, v74, v75
    v_smfmac_f32_16x16x64_bf16 v[56:59], v[36:39], v[200:207], v3
    v_cvt_pk_bf16_f32 v84, v76, v77
    v_cvt_pk_bf16_f32 v85, v78, v79
    v_smfmac_f32_16x16x64_bf16 v[52:55], v[40:43], v[152:159], v3
    v_mfma_f32_16x16x32_bf16 v[68:71], v[80:83], v[4:7], 0
    v_mov_b64 v[76:77], 0
    v_smfmac_f32_16x16x64_bf16 v[56:59], v[40:43], v[208:215], v3
    v_mov_b32_dpp v86, v84 row_ror:8 row_mask:0xf bank_mask:0xf
    v_mov_b32_dpp v87, v85 row_ror:8 row_mask:0xf bank_mask:0xf
    v_smfmac_f32_16x16x64_bf16 v[52:55], v[44:47], v[160:167], v3
    v_mov_b64 v[78:79], 0
    v_smfmac_f32_16x16x64_bf16 v[56:59], v[44:47], v[216:223], v3
    v_mfma_f32_16x16x32_bf16 v[72:75], v[84:87], v[4:7], 0
    v_smfmac_f32_16x16x64_bf16 v[52:55], v[48:51], v[168:175], v3
    v_smfmac_f32_16x16x64_bf16 v[56:59], v[48:51], v[224:231], v3
    v_smfmac_f32_16x16x64_bf16 v[60:63], v[24:27], v[232:239], v3
    v_smfmac_f32_16x16x64_bf16 v[60:63], v[28:31], v[240:247], v3
    v_cvt_pk_bf16_f32 v80, v68, v69
    v_cvt_pk_bf16_f32 v81, v70, v71
    v_smfmac_f32_16x16x64_bf16 v[60:63], v[32:35], v[248:255], v3
    v_mov_b64 v[68:69], 0
    v_mov_b64 v[70:71], 0
    v_smfmac_f32_16x16x64_bf16 v[60:63], v[36:39], a[0:7], v3
    v_smfmac_f32_16x16x64_bf16 v[60:63], v[40:43], a[8:15], v3
    v_cvt_pk_bf16_f32 v82, v72, v73
    v_cvt_pk_bf16_f32 v83, v74, v75
    v_smfmac_f32_16x16x64_bf16 v[60:63], v[44:47], a[16:23], v3
    v_cndmask_b32 v82, 0, v82, s[26:27]
    v_cndmask_b32 v83, 0, v83, s[26:27]
    v_smfmac_f32_16x16x64_bf16 v[60:63], v[48:51], a[24:31], v3
    v_mov_b64 v[72:73], 0
    v_mov_b64 v[74:75], 0
    s_waitcnt lgkmcnt(0)
    v_smfmac_f32_16x16x64_bf16 v[64:67], v[24:27], a[32:39], v3
    v_smfmac_f32_16x16x64_bf16 v[76:79], v[80:83], v[92:99], v3
    v_smfmac_f32_16x16x64_bf16 v[68:71], v[80:83], v[100:107], v3
    v_smfmac_f32_16x16x64_bf16 v[72:75], v[80:83], v[108:115], v3
    v_cvt_pk_bf16_f32 v84, v52, v53
    v_cvt_pk_bf16_f32 v85, v54, v55
    v_smfmac_f32_16x16x64_bf16 v[64:67], v[28:31], a[40:47], v3
    v_cvt_pk_bf16_f32 v86, v56, v57
    v_cvt_pk_bf16_f32 v87, v58, v59
    ds_read_b128 v[92:95], v12
    ds_read_b128 v[96:99], v13
    v_smfmac_f32_16x16x64_bf16 v[64:67], v[32:35], a[48:55], v3
    ds_read_b128 v[100:103], v16 offset:0
    ds_read_b128 v[104:107], v16 offset:1024
    v_smfmac_f32_16x16x64_bf16 v[64:67], v[36:39], a[56:63], v3
    v_mfma_f32_16x16x32_bf16 v[52:55], v[84:87], v[4:7], 0
    ds_read_b128 v[108:111], v16 offset:4096
    ds_read_b128 v[112:115], v16 offset:5120
    v_smfmac_f32_16x16x64_bf16 v[64:67], v[40:43], a[64:71], v3
    v_smfmac_f32_16x16x64_bf16 v[64:67], v[44:47], a[72:79], v3
    v_smfmac_f32_16x16x64_bf16 v[64:67], v[48:51], a[80:87], v3
    v_cvt_pk_bf16_f32 v84, v60, v61
    v_cvt_pk_bf16_f32 v85, v62, v63
    s_nop 0
    v_cvt_pk_bf16_f32 v88, v52, v53
    v_cvt_pk_bf16_f32 v89, v54, v55
    s_nop 2
    v_cvt_pk_bf16_f32 v86, v64, v65
    v_cvt_pk_bf16_f32 v87, v66, v67
    s_nop 1
    v_mfma_f32_16x16x32_bf16 v[56:59], v[84:87], v[4:7], 0
    s_nop 7
    v_cvt_pk_bf16_f32 v90, v56, v57
    v_cvt_pk_bf16_f32 v91, v58, v59
    s_waitcnt lgkmcnt(0)
    s_nop 0
    v_smfmac_f32_16x16x64_bf16 v[76:79], v[88:91], v[92:99], v3
    v_smfmac_f32_16x16x64_bf16 v[68:71], v[88:91], v[100:107], v3
    v_smfmac_f32_16x16x64_bf16 v[72:75], v[88:91], v[108:115], v3
    s_nop 5
    v_permlane32_swap_b32 v76, v78
    v_permlane32_swap_b32 v77, v79
    v_permlane32_swap_b32 v68, v72
    v_permlane32_swap_b32 v69, v73
    v_permlane32_swap_b32 v70, v74
    v_permlane32_swap_b32 v71, v75
    v_add_f32 v76, v76, v78
    ds_write_b32 v21, v76 offset:0
    v_add_f32 v77, v77, v79
    ds_write_b32 v21, v77 offset:768
    v_add_f32 v68, v68, v72
    ds_write_b32 v17, v68 offset:0
    v_add_f32 v69, v69, v73
    ds_write_b32 v17, v69 offset:768
    v_add_f32 v70, v70, v74
    ds_write_b32 v17, v70 offset:1536
    v_add_f32 v71, v71, v75
    ds_write_b32 v17, v71 offset:2304
    s_waitcnt lgkmcnt(0)
    s_barrier
    ds_read_b128 v[100:103], v18
    ds_read_b128 v[104:107], v19
    s_waitcnt lgkmcnt(1)
    v_add_f32 v100, v100, v101
    v_add_f32 v102, v102, v103
    s_waitcnt lgkmcnt(0)
    v_add_f32 v104, v104, v105
    v_add_f32 v106, v106, v107
    v_add_f32 v92, v100, v102
    v_add_f32 v93, v104, v106
    v_exp_f32 v96, v92
    v_exp_f32 v97, v93
    s_nop 0
    v_fma_f32 v94, v97, s36, v96
    s_nop 1
    v_add_f32_dpp v94, v94, v94 quad_perm:[1,0,3,2] row_mask:0xf bank_mask:0xf
    s_nop 1
    v_add_f32_dpp v94, v94, v94 quad_perm:[2,3,0,1] row_mask:0xf bank_mask:0xf
    s_nop 1
    v_add_f32_dpp v94, v94, v94 row_half_mirror row_mask:0xf bank_mask:0xf
    v_mov_b32 v95, v94
    s_nop 1
    v_permlane16_swap_b32 v94, v95
    v_add_f32 v94, v94, v95
    v_mov_b32 v95, v94
    s_nop 1
    v_permlane32_swap_b32 v94, v95
    v_add_f32 v94, v94, v95
    v_subrev_u32 v95, s34, v94
    v_rcp_f32 v94, v94
    v_cmp_le_u32 vcc, s35, v95
    v_mul_f32 v98, v96, v94
    v_mul_f32_dpp v99, v96, v94 quad_perm:[1,0,3,2] row_mask:0xf bank_mask:0xf
    v_mul_f32 v100, v97, v94
    v_mul_f32_dpp v101, v97, v94 quad_perm:[1,0,3,2] row_mask:0xf bank_mask:0xf
    s_cbranch_vccnz sequential_preLN__memory_aug_recurrent_mem_tr__mixer_gmlp__prompt_kernel_A_fast_sm_slow
    v_cvt_pk_bf16_f32 v98, v98, v99
    v_cvt_pk_bf16_f32 v100, v101, v100
    s_mov_b64 exec, s[38:39]
    v_cndmask_b32 v98, v98, v100, s[32:33]
    global_store_dword v20, v98, s[20:21]
    s_nop 2
sequential_preLN__memory_aug_recurrent_mem_tr__mixer_gmlp__prompt_kernel_A_fast_after_store:
    s_mov_b64 exec, -1
    v_mov_b64 v[52:53], 0
    v_mov_b64 v[54:55], 0
    v_mov_b64 v[56:57], 0
    v_mov_b64 v[58:59], 0
    v_mov_b64 v[60:61], 0
    v_mov_b64 v[62:63], 0
    v_mov_b64 v[64:65], 0
    v_mov_b64 v[66:67], 0
    v_mov_b64 v[68:69], 0
    v_mov_b64 v[70:71], 0
    v_mov_b64 v[72:73], 0
    v_mov_b64 v[74:75], 0
    v_mov_b64 v[76:77], 0
    v_mov_b64 v[78:79], 0
    s_add_u32 s22, s22, 32768
    s_addc_u32 s23, s23, 0
    s_xor_b32 s29, s29, 8192
    s_add_u32 s20, s20, 10368
    s_addc_u32 s21, s21, 0
    s_add_u32 s18, s18, 8192
    s_addc_u32 s19, s19, 0
    v_xor_b32 v16, 0x2000, v16
    s_add_u32 s12, s12, 1
    s_cmp_lt_u32 s12, 63
    s_cbranch_scc1 sequential_preLN__memory_aug_recurrent_mem_tr__mixer_gmlp__prompt_kernel_A_fast_loop
    s_waitcnt vmcnt(0) lgkmcnt(0)
    s_barrier
    s_branch sequential_preLN__memory_aug_recurrent_mem_tr__mixer_gmlp__prompt_kernel_DL0
    s_endpgm
sequential_preLN__memory_aug_recurrent_mem_tr__mixer_gmlp__prompt_kernel_A_fast_sm_slow:
    s_nop 7
    v_max_f32 v94, v92, v93
    s_nop 1
    v_max_f32_dpp v94, v94, v94 quad_perm:[1,0,3,2] row_mask:0xf bank_mask:0xf
    s_nop 1
    v_max_f32_dpp v94, v94, v94 quad_perm:[2,3,0,1] row_mask:0xf bank_mask:0xf
    s_nop 1
    v_max_f32_dpp v94, v94, v94 row_half_mirror row_mask:0xf bank_mask:0xf
    v_mov_b32 v95, v94
    s_nop 1
    v_permlane16_swap_b32 v94, v95
    v_max_f32 v94, v94, v95
    v_mov_b32 v95, v94
    s_nop 1
    v_permlane32_swap_b32 v94, v95
    v_max_f32 v94, v94, v95
    v_sub_f32 v102, v92, v94
    v_sub_f32 v103, v93, v94
    v_exp_f32 v96, v102
    v_exp_f32 v97, v103
    s_nop 0
    v_fma_f32 v94, v97, s36, v96
    s_nop 1
    v_add_f32_dpp v94, v94, v94 quad_perm:[1,0,3,2] row_mask:0xf bank_mask:0xf
    s_nop 1
    v_add_f32_dpp v94, v94, v94 quad_perm:[2,3,0,1] row_mask:0xf bank_mask:0xf
    s_nop 1
    v_add_f32_dpp v94, v94, v94 row_half_mirror row_mask:0xf bank_mask:0xf
    v_mov_b32 v95, v94
    s_nop 1
    v_permlane16_swap_b32 v94, v95
    v_add_f32 v94, v94, v95
    v_mov_b32 v95, v94
    s_nop 1
    v_permlane32_swap_b32 v94, v95
    v_add_f32 v94, v94, v95
    v_rcp_f32 v94, v94
    s_nop 0
    v_mul_f32 v98, v96, v94
    v_mul_f32_dpp v99, v96, v94 quad_perm:[1,0,3,2] row_mask:0xf bank_mask:0xf
    v_mul_f32 v100, v97, v94
    v_mul_f32_dpp v101, v97, v94 quad_perm:[1,0,3,2] row_mask:0xf bank_mask:0xf
    v_cvt_pk_bf16_f32 v98, v98, v99
    v_cvt_pk_bf16_f32 v100, v101, v100
    s_mov_b64 exec, s[38:39]
    v_cndmask_b32 v98, v98, v100, s[32:33]
    v_min_u32 v98, -2, v98
    global_store_dword v20, v98, s[20:21]
    s_nop 0
    s_branch sequential_preLN__memory_aug_recurrent_mem_tr__mixer_gmlp__prompt_kernel_A_fast_after_store
sequential_preLN__memory_aug_recurrent_mem_tr__mixer_gmlp__prompt_kernel_A_fast_restart:
    s_nop 15
    s_waitcnt vmcnt(0) lgkmcnt(0)
    s_barrier
    v_mov_b64 v[52:53], 0
    v_mov_b64 v[54:55], 0
    v_mov_b64 v[56:57], 0
    v_mov_b64 v[58:59], 0
    v_mov_b64 v[60:61], 0
    v_mov_b64 v[62:63], 0
    v_mov_b64 v[64:65], 0
    v_mov_b64 v[66:67], 0
    v_mov_b64 v[68:69], 0
    v_mov_b64 v[70:71], 0
    v_mov_b64 v[72:73], 0
    v_mov_b64 v[74:75], 0
    v_mov_b64 v[76:77], 0
    v_mov_b64 v[78:79], 0
    s_nop 0
    s_branch sequential_preLN__memory_aug_recurrent_mem_tr__mixer_gmlp__prompt_kernel_A_fast_loop
sequential_preLN__memory_aug_recurrent_mem_tr__mixer_gmlp__prompt_kernel_A_fast_abort:
    s_endpgm
sequential_preLN__memory_aug_recurrent_mem_tr__mixer_gmlp__prompt_kernel_A_slow_loop:
    s_mov_b32 s13, 131072
sequential_preLN__memory_aug_recurrent_mem_tr__mixer_gmlp__prompt_kernel_A_slow_mpoll:
    global_load_dwordx4 v[92:95], v116, s[18:19] sc1
    global_load_dwordx4 v[96:99], v117, s[18:19] sc1
    s_sub_u32 s13, s13, 1
    s_cbranch_scc1 sequential_preLN__memory_aug_recurrent_mem_tr__mixer_gmlp__prompt_kernel_A_slow_abort
    s_waitcnt vmcnt(1)
    ds_write_b128 v9, v[92:95]
    v_max3_u32 v23, v92, v93, v94
    v_max_u32 v23, v23, v95
    s_waitcnt vmcnt(0)
    ds_write_b128 v10, v[96:99]
    v_max3_u32 v0, v96, v97, v98
    v_max3_u32 v23, v23, v0, v99
    v_cmp_eq_u32 vcc, -1, v23
    s_nop 0
    s_cbranch_vccnz sequential_preLN__memory_aug_recurrent_mem_tr__mixer_gmlp__prompt_kernel_A_slow_mpoll
    s_waitcnt lgkmcnt(0)
    s_barrier
    ds_read_b128 v[24:27], v22 offset:0
    ds_read_b128 v[28:31], v22 offset:1024
    ds_read_b128 v[32:35], v22 offset:2048
    s_waitcnt lgkmcnt(2)
    v_smfmac_f32_16x16x64_bf16 v[68:71], v[24:27], a[88:95], v3
    ds_read_b128 v[36:39], v22 offset:3072
    v_smfmac_f32_16x16x64_bf16 v[72:75], v[24:27], a[144:151], v3
    ds_read_b128 v[40:43], v22 offset:4096
    v_smfmac_f32_16x16x64_bf16 v[76:79], v[24:27], a[200:207], v3
    ds_read_b128 v[44:47], v22 offset:5120
    s_waitcnt lgkmcnt(4)
    v_smfmac_f32_16x16x64_bf16 v[68:71], v[28:31], a[96:103], v3
    ds_read_b128 v[48:51], v22 offset:6144
    v_smfmac_f32_16x16x64_bf16 v[72:75], v[28:31], a[152:159], v3
    ds_read_b128 v[92:95], v14
    v_smfmac_f32_16x16x64_bf16 v[76:79], v[28:31], a[208:215], v3
    ds_read_b128 v[96:99], v15
    s_waitcnt lgkmcnt(6)
    v_smfmac_f32_16x16x64_bf16 v[68:71], v[32:35], a[104:111], v3
    ds_read_b128 v[100:103], v16 offset:2048
    v_smfmac_f32_16x16x64_bf16 v[72:75], v[32:35], a[160:167], v3
    ds_read_b128 v[104:107], v16 offset:3072
    v_smfmac_f32_16x16x64_bf16 v[76:79], v[32:35], a[216:223], v3
    ds_read_b128 v[108:111], v16 offset:6144
    s_waitcnt lgkmcnt(8)
    v_smfmac_f32_16x16x64_bf16 v[68:71], v[36:39], a[112:119], v3
    ds_read_b128 v[112:115], v16 offset:7168
    v_smfmac_f32_16x16x64_bf16 v[72:75], v[36:39], a[168:175], v3
    s_add_u32 m0, s29, 0
    v_smfmac_f32_16x16x64_bf16 v[76:79], v[36:39], a[224:231], v3
    global_load_lds_dwordx4 v1, s[22:23] offset:0
    s_waitcnt lgkmcnt(8)
    v_smfmac_f32_16x16x64_bf16 v[68:71], v[40:43], a[120:127], v3
    v_smfmac_f32_16x16x64_bf16 v[72:75], v[40:43], a[176:183], v3
    global_load_lds_dwordx4 v1, s[22:23] offset:1024
    v_smfmac_f32_16x16x64_bf16 v[76:79], v[40:43], a[232:239], v3
    s_waitcnt lgkmcnt(7)
    v_smfmac_f32_16x16x64_bf16 v[68:71], v[44:47], a[128:135], v3
    global_load_lds_dwordx4 v1, s[22:23] offset:2048
    v_smfmac_f32_16x16x64_bf16 v[72:75], v[44:47], a[184:191], v3
    v_smfmac_f32_16x16x64_bf16 v[76:79], v[44:47], a[240:247], v3
    global_load_lds_dwordx4 v1, s[22:23] offset:3072
    s_waitcnt lgkmcnt(6)
    v_smfmac_f32_16x16x64_bf16 v[68:71], v[48:51], a[136:143], v3
    s_add_u32 m0, s29, 4096
    v_smfmac_f32_16x16x64_bf16 v[72:75], v[48:51], a[192:199], v3
    global_load_lds_dwordx4 v8, s[22:23] offset:0
    v_smfmac_f32_16x16x64_bf16 v[76:79], v[48:51], a[248:255], v3
    v_smfmac_f32_16x16x64_bf16 v[52:55], v[24:27], v[120:127], v3
    global_load_lds_dwordx4 v8, s[22:23] offset:1024
    v_smfmac_f32_16x16x64_bf16 v[56:59], v[24:27], v[176:183], v3
    v_smfmac_f32_16x16x64_bf16 v[52:55], v[28:31], v[128:135], v3
    global_load_lds_dwordx4 v8, s[22:23] offset:2048
    v_smfmac_f32_16x16x64_bf16 v[56:59], v[28:31], v[184:191], v3
    v_smfmac_f32_16x16x64_bf16 v[52:55], v[32:35], v[136:143], v3
    global_load_lds_dwordx4 v8, s[22:23] offset:3072
    v_smfmac_f32_16x16x64_bf16 v[56:59], v[32:35], v[192:199], v3
    v_cvt_pk_bf16_f32 v80, v68, v69
    v_cvt_pk_bf16_f32 v81, v70, v71
    v_smfmac_f32_16x16x64_bf16 v[52:55], v[36:39], v[144:151], v3
    v_cvt_pk_bf16_f32 v82, v72, v73
    v_cvt_pk_bf16_f32 v83, v74, v75
    v_smfmac_f32_16x16x64_bf16 v[56:59], v[36:39], v[200:207], v3
    v_cvt_pk_bf16_f32 v84, v76, v77
    v_cvt_pk_bf16_f32 v85, v78, v79
    v_smfmac_f32_16x16x64_bf16 v[52:55], v[40:43], v[152:159], v3
    v_mfma_f32_16x16x32_bf16 v[68:71], v[80:83], v[4:7], 0
    v_mov_b64 v[76:77], 0
    v_smfmac_f32_16x16x64_bf16 v[56:59], v[40:43], v[208:215], v3
    v_mov_b32_dpp v86, v84 row_ror:8 row_mask:0xf bank_mask:0xf
    v_mov_b32_dpp v87, v85 row_ror:8 row_mask:0xf bank_mask:0xf
    v_smfmac_f32_16x16x64_bf16 v[52:55], v[44:47], v[160:167], v3
    v_mov_b64 v[78:79], 0
    v_smfmac_f32_16x16x64_bf16 v[56:59], v[44:47], v[216:223], v3
    v_mfma_f32_16x16x32_bf16 v[72:75], v[84:87], v[4:7], 0
    v_smfmac_f32_16x16x64_bf16 v[52:55], v[48:51], v[168:175], v3
    v_smfmac_f32_16x16x64_bf16 v[56:59], v[48:51], v[224:231], v3
    v_smfmac_f32_16x16x64_bf16 v[60:63], v[24:27], v[232:239], v3
    v_smfmac_f32_16x16x64_bf16 v[60:63], v[28:31], v[240:247], v3
    v_cvt_pk_bf16_f32 v80, v68, v69
    v_cvt_pk_bf16_f32 v81, v70, v71
    v_smfmac_f32_16x16x64_bf16 v[60:63], v[32:35], v[248:255], v3
    v_mov_b64 v[68:69], 0
    v_mov_b64 v[70:71], 0
    v_smfmac_f32_16x16x64_bf16 v[60:63], v[36:39], a[0:7], v3
    v_smfmac_f32_16x16x64_bf16 v[60:63], v[40:43], a[8:15], v3
    v_cvt_pk_bf16_f32 v82, v72, v73
    v_cvt_pk_bf16_f32 v83, v74, v75
    v_smfmac_f32_16x16x64_bf16 v[60:63], v[44:47], a[16:23], v3
    v_cndmask_b32 v82, 0, v82, s[26:27]
    v_cndmask_b32 v83, 0, v83, s[26:27]
    v_smfmac_f32_16x16x64_bf16 v[60:63], v[48:51], a[24:31], v3
    v_mov_b64 v[72:73], 0
    v_mov_b64 v[74:75], 0
    s_waitcnt lgkmcnt(0)
    v_smfmac_f32_16x16x64_bf16 v[64:67], v[24:27], a[32:39], v3
    v_smfmac_f32_16x16x64_bf16 v[76:79], v[80:83], v[92:99], v3
    v_smfmac_f32_16x16x64_bf16 v[68:71], v[80:83], v[100:107], v3
    v_smfmac_f32_16x16x64_bf16 v[72:75], v[80:83], v[108:115], v3
    v_cvt_pk_bf16_f32 v84, v52, v53
    v_cvt_pk_bf16_f32 v85, v54, v55
    v_smfmac_f32_16x16x64_bf16 v[64:67], v[28:31], a[40:47], v3
    v_cvt_pk_bf16_f32 v86, v56, v57
    v_cvt_pk_bf16_f32 v87, v58, v59
    ds_read_b128 v[92:95], v12
    ds_read_b128 v[96:99], v13
    v_smfmac_f32_16x16x64_bf16 v[64:67], v[32:35], a[48:55], v3
    ds_read_b128 v[100:103], v16 offset:0
    ds_read_b128 v[104:107], v16 offset:1024
    v_smfmac_f32_16x16x64_bf16 v[64:67], v[36:39], a[56:63], v3
    v_mfma_f32_16x16x32_bf16 v[52:55], v[84:87], v[4:7], 0
    ds_read_b128 v[108:111], v16 offset:4096
    ds_read_b128 v[112:115], v16 offset:5120
    v_smfmac_f32_16x16x64_bf16 v[64:67], v[40:43], a[64:71], v3
    v_smfmac_f32_16x16x64_bf16 v[64:67], v[44:47], a[72:79], v3
    v_smfmac_f32_16x16x64_bf16 v[64:67], v[48:51], a[80:87], v3
    v_cvt_pk_bf16_f32 v84, v60, v61
    v_cvt_pk_bf16_f32 v85, v62, v63
    s_nop 0
    v_cvt_pk_bf16_f32 v88, v52, v53
    v_cvt_pk_bf16_f32 v89, v54, v55
    s_nop 2
    v_cvt_pk_bf16_f32 v86, v64, v65
    v_cvt_pk_bf16_f32 v87, v66, v67
    s_nop 1
    v_mfma_f32_16x16x32_bf16 v[56:59], v[84:87], v[4:7], 0
    s_nop 7
    v_cvt_pk_bf16_f32 v90, v56, v57
    v_cvt_pk_bf16_f32 v91, v58, v59
    s_waitcnt lgkmcnt(0)
    s_nop 0
    v_smfmac_f32_16x16x64_bf16 v[76:79], v[88:91], v[92:99], v3
    v_smfmac_f32_16x16x64_bf16 v[68:71], v[88:91], v[100:107], v3
    v_smfmac_f32_16x16x64_bf16 v[72:75], v[88:91], v[108:115], v3
    s_nop 5
    v_permlane32_swap_b32 v76, v78
    v_permlane32_swap_b32 v77, v79
    v_permlane32_swap_b32 v68, v72
    v_permlane32_swap_b32 v69, v73
    v_permlane32_swap_b32 v70, v74
    v_permlane32_swap_b32 v71, v75
    v_add_f32 v76, v76, v78
    ds_write_b32 v21, v76 offset:0
    v_add_f32 v77, v77, v79
    ds_write_b32 v21, v77 offset:768
    v_add_f32 v68, v68, v72
    ds_write_b32 v17, v68 offset:0
    v_add_f32 v69, v69, v73
    ds_write_b32 v17, v69 offset:768
    v_add_f32 v70, v70, v74
    ds_write_b32 v17, v70 offset:1536
    v_add_f32 v71, v71, v75
    ds_write_b32 v17, v71 offset:2304
    s_waitcnt lgkmcnt(0)
    s_barrier
    ds_read_b128 v[100:103], v18
    ds_read_b128 v[104:107], v19
    s_waitcnt lgkmcnt(1)
    v_add_f32 v100, v100, v101
    v_add_f32 v102, v102, v103
    s_waitcnt lgkmcnt(0)
    v_add_f32 v104, v104, v105
    v_add_f32 v106, v106, v107
    v_add_f32 v92, v100, v102
    v_add_f32 v93, v104, v106
    v_exp_f32 v96, v92
    v_exp_f32 v97, v93
    s_nop 0
    v_fma_f32 v94, v97, s36, v96
    s_nop 1
    v_add_f32_dpp v94, v94, v94 quad_perm:[1,0,3,2] row_mask:0xf bank_mask:0xf
    s_nop 1
    v_add_f32_dpp v94, v94, v94 quad_perm:[2,3,0,1] row_mask:0xf bank_mask:0xf
    s_nop 1
    v_add_f32_dpp v94, v94, v94 row_half_mirror row_mask:0xf bank_mask:0xf
    v_mov_b32 v95, v94
    s_nop 1
    v_permlane16_swap_b32 v94, v95
    v_add_f32 v94, v94, v95
    v_mov_b32 v95, v94
    s_nop 1
    v_permlane32_swap_b32 v94, v95
    v_add_f32 v94, v94, v95
    v_subrev_u32 v95, s34, v94
    v_rcp_f32 v94, v94
    v_cmp_le_u32 vcc, s35, v95
    v_mul_f32 v98, v96, v94
    v_mul_f32_dpp v99, v96, v94 quad_perm:[1,0,3,2] row_mask:0xf bank_mask:0xf
    v_mul_f32 v100, v97, v94
    v_mul_f32_dpp v101, v97, v94 quad_perm:[1,0,3,2] row_mask:0xf bank_mask:0xf
    s_cbranch_vccnz sequential_preLN__memory_aug_recurrent_mem_tr__mixer_gmlp__prompt_kernel_A_slow_sm_slow
    v_cvt_pk_bf16_f32 v98, v98, v99
    v_cvt_pk_bf16_f32 v100, v101, v100
    s_mov_b64 exec, s[38:39]
    v_cndmask_b32 v98, v98, v100, s[32:33]
    global_store_dword v20, v98, s[20:21] sc1
    s_nop 2
sequential_preLN__memory_aug_recurrent_mem_tr__mixer_gmlp__prompt_kernel_A_slow_after_store:
    s_mov_b64 exec, -1
    v_mov_b64 v[52:53], 0
    v_mov_b64 v[54:55], 0
    v_mov_b64 v[56:57], 0
    v_mov_b64 v[58:59], 0
    v_mov_b64 v[60:61], 0
    v_mov_b64 v[62:63], 0
    v_mov_b64 v[64:65], 0
    v_mov_b64 v[66:67], 0
    v_mov_b64 v[68:69], 0
    v_mov_b64 v[70:71], 0
    v_mov_b64 v[72:73], 0
    v_mov_b64 v[74:75], 0
    v_mov_b64 v[76:77], 0
    v_mov_b64 v[78:79], 0
    s_add_u32 s22, s22, 32768
    s_addc_u32 s23, s23, 0
    s_xor_b32 s29, s29, 8192
    s_add_u32 s20, s20, 10368
    s_addc_u32 s21, s21, 0
    s_add_u32 s18, s18, 8192
    s_addc_u32 s19, s19, 0
    v_xor_b32 v16, 0x2000, v16
    s_add_u32 s12, s12, 1
    s_cmp_lt_u32 s12, 63
    s_cbranch_scc1 sequential_preLN__memory_aug_recurrent_mem_tr__mixer_gmlp__prompt_kernel_A_slow_loop
    s_waitcnt vmcnt(0) lgkmcnt(0)
    s_barrier
    s_branch sequential_preLN__memory_aug_recurrent_mem_tr__mixer_gmlp__prompt_kernel_DL0
    s_endpgm
sequential_preLN__memory_aug_recurrent_mem_tr__mixer_gmlp__prompt_kernel_A_slow_sm_slow:
    s_nop 7
    v_max_f32 v94, v92, v93
    s_nop 1
    v_max_f32_dpp v94, v94, v94 quad_perm:[1,0,3,2] row_mask:0xf bank_mask:0xf
    s_nop 1
    v_max_f32_dpp v94, v94, v94 quad_perm:[2,3,0,1] row_mask:0xf bank_mask:0xf
    s_nop 1
    v_max_f32_dpp v94, v94, v94 row_half_mirror row_mask:0xf bank_mask:0xf
    v_mov_b32 v95, v94
    s_nop 1
    v_permlane16_swap_b32 v94, v95
    v_max_f32 v94, v94, v95
    v_mov_b32 v95, v94
    s_nop 1
    v_permlane32_swap_b32 v94, v95
    v_max_f32 v94, v94, v95
    v_sub_f32 v102, v92, v94
    v_sub_f32 v103, v93, v94
    v_exp_f32 v96, v102
    v_exp_f32 v97, v103
    s_nop 0
    v_fma_f32 v94, v97, s36, v96
    s_nop 1
    v_add_f32_dpp v94, v94, v94 quad_perm:[1,0,3,2] row_mask:0xf bank_mask:0xf
    s_nop 1
    v_add_f32_dpp v94, v94, v94 quad_perm:[2,3,0,1] row_mask:0xf bank_mask:0xf
    s_nop 1
    v_add_f32_dpp v94, v94, v94 row_half_mirror row_mask:0xf bank_mask:0xf
    v_mov_b32 v95, v94
    s_nop 1
    v_permlane16_swap_b32 v94, v95
    v_add_f32 v94, v94, v95
    v_mov_b32 v95, v94
    s_nop 1
    v_permlane32_swap_b32 v94, v95
    v_add_f32 v94, v94, v95
    v_rcp_f32 v94, v94
    s_nop 0
    v_mul_f32 v98, v96, v94
    v_mul_f32_dpp v99, v96, v94 quad_perm:[1,0,3,2] row_mask:0xf bank_mask:0xf
    v_mul_f32 v100, v97, v94
    v_mul_f32_dpp v101, v97, v94 quad_perm:[1,0,3,2] row_mask:0xf bank_mask:0xf
    v_cvt_pk_bf16_f32 v98, v98, v99
    v_cvt_pk_bf16_f32 v100, v101, v100
    s_mov_b64 exec, s[38:39]
    v_cndmask_b32 v98, v98, v100, s[32:33]
    v_min_u32 v98, -2, v98
    global_store_dword v20, v98, s[20:21] sc1
    s_nop 0
    s_branch sequential_preLN__memory_aug_recurrent_mem_tr__mixer_gmlp__prompt_kernel_A_slow_after_store
sequential_preLN__memory_aug_recurrent_mem_tr__mixer_gmlp__prompt_kernel_A_slow_restart:
    s_nop 15
    s_waitcnt vmcnt(0) lgkmcnt(0)
    s_barrier
    v_mov_b64 v[52:53], 0
    v_mov_b64 v[54:55], 0
    v_mov_b64 v[56:57], 0
    v_mov_b64 v[58:59], 0
    v_mov_b64 v[60:61], 0
    v_mov_b64 v[62:63], 0
    v_mov_b64 v[64:65], 0
    v_mov_b64 v[66:67], 0
    v_mov_b64 v[68:69], 0
    v_mov_b64 v[70:71], 0
    v_mov_b64 v[72:73], 0
    v_mov_b64 v[74:75], 0
    v_mov_b64 v[76:77], 0
    v_mov_b64 v[78:79], 0
    s_nop 0
    s_branch sequential_preLN__memory_aug_recurrent_mem_tr__mixer_gmlp__prompt_kernel_A_slow_loop
sequential_preLN__memory_aug_recurrent_mem_tr__mixer_gmlp__prompt_kernel_A_slow_abort:
    s_endpgm
sequential_preLN__memory_aug_recurrent_mem_tr__mixer_gmlp__prompt_kernel_B:
    v_lshlrev_b32 v1, 4, v1
    v_and_b32 v0, 63, v0
    s_mov_b32 s83, s9
    s_sub_u32 s9, s9, 16
    s_lshl_b32 s16, s9, 1
    s_mul_i32 s16, s16, 37
    s_lshr_b32 s16, s16, 8
    s_min_u32 s16, s16, 2
    s_lshl_b32 s16, s16, 1
    s_lshl_b32 s17, s10, 5
    s_add_u32 s16, s16, s17
    s_add_u32 s16, s16, 128
    s_mov_b32 s13, 131072
    s_add_u32 s76, s4, 0x1580000
    s_addc_u32 s77, s5, 0
    v_mbcnt_lo_u32_b32 v24, -1, 0
    v_mbcnt_hi_u32_b32 v24, -1, v24
    v_and_b32 v25, 3, v24
    v_lshrrev_b32 v24, 2, v24
    v_and_b32 v24, 3, v24
    v_mul_u32_u24 v24, 8, v24
    v_add_u32 v24, v24, v25
    v_add_u32 v24, s16, v24
    v_lshlrev_b32 v24, 2, v24
    s_nop 1
sequential_preLN__memory_aug_recurrent_mem_tr__mixer_gmlp__prompt_kernel_B_b_pw:
    global_load_dword v25, v24, s[76:77] sc1
    s_waitcnt vmcnt(0)
    v_cmp_ne_u32 vcc, s78, v25
    s_nop 0
    s_cbranch_vccz sequential_preLN__memory_aug_recurrent_mem_tr__mixer_gmlp__prompt_kernel_B_b_pwok
    s_sleep 6
    s_sub_u32 s13, s13, 1
    s_cbranch_scc0 sequential_preLN__memory_aug_recurrent_mem_tr__mixer_gmlp__prompt_kernel_B_b_pw
    s_endpgm
sequential_preLN__memory_aug_recurrent_mem_tr__mixer_gmlp__prompt_kernel_B_b_pwok:
    s_lshl_b32 s14, s10, 2
    s_mul_i32 s14, s14, 28
    s_lshl_b32 s15, s9, 1
    s_add_u32 s14, s14, s15
    s_mul_i32 s14, s14, 14336
    s_add_u32 s14, s14, 0xb00000
    s_add_u32 s20, s4, s14
    s_addc_u32 s21, s5, 0
    s_lshl_b32 s28, s10, 15
    v_add_u32 v4, 0x1000, v1
    v_add_u32 v5, 0x2000, v1
    v_add_u32 v6, 0x3000, v1
    s_add_u32 s22, s20, 0
    s_addc_u32 s23, s21, 0
    global_load_dwordx4 a[0:3], v1, s[22:23] offset:0 sc1
    global_load_dwordx4 a[4:7], v1, s[22:23] offset:1024 sc1
    global_load_dwordx4 a[8:11], v1, s[22:23] offset:2048 sc1
    global_load_dwordx4 a[12:15], v1, s[22:23] offset:3072 sc1
    global_load_dwordx4 a[16:19], v4, s[22:23] offset:0 sc1
    global_load_dwordx4 a[20:23], v4, s[22:23] offset:1024 sc1
    global_load_dwordx4 a[24:27], v4, s[22:23] offset:2048 sc1
    global_load_dwordx4 a[28:31], v4, s[22:23] offset:3072 sc1
    global_load_dwordx4 a[32:35], v5, s[22:23] offset:0 sc1
    global_load_dwordx4 a[36:39], v5, s[22:23] offset:1024 sc1
    global_load_dwordx4 v[24:27], v5, s[22:23] offset:2048 sc1
    global_load_dwordx4 v[28:31], v5, s[22:23] offset:3072 sc1
    global_load_dwordx4 v[32:35], v6, s[22:23] offset:0 sc1
    global_load_dwordx4 v[36:39], v6, s[22:23] offset:1024 sc1
    s_waitcnt vmcnt(28)
    s_add_u32 s22, s20, 14336
    s_addc_u32 s23, s21, 0
    global_load_dwordx4 a[40:43], v1, s[22:23] offset:0 sc1
    global_load_dwordx4 a[44:47], v1, s[22:23] offset:1024 sc1
    global_load_dwordx4 a[48:51], v1, s[22:23] offset:2048 sc1
    global_load_dwordx4 a[52:55], v1, s[22:23] offset:3072 sc1
    global_load_dwordx4 a[56:59], v4, s[22:23] offset:0 sc1
    global_load_dwordx4 a[60:63], v4, s[22:23] offset:1024 sc1
    global_load_dwordx4 a[64:67], v4, s[22:23] offset:2048 sc1
    global_load_dwordx4 a[68:71], v4, s[22:23] offset:3072 sc1
    global_load_dwordx4 a[72:75], v5, s[22:23] offset:0 sc1
    global_load_dwordx4 a[76:79], v5, s[22:23] offset:1024 sc1
    global_load_dwordx4 v[40:43], v5, s[22:23] offset:2048 sc1
    global_load_dwordx4 v[44:47], v5, s[22:23] offset:3072 sc1
    global_load_dwordx4 v[48:51], v6, s[22:23] offset:0 sc1
    global_load_dwordx4 v[52:55], v6, s[22:23] offset:1024 sc1
    s_waitcnt vmcnt(28)
    s_add_u32 s22, s20, 401408
    s_addc_u32 s23, s21, 0
    global_load_dwordx4 a[80:83], v1, s[22:23] offset:0 sc1
    global_load_dwordx4 a[84:87], v1, s[22:23] offset:1024 sc1
    global_load_dwordx4 a[88:91], v1, s[22:23] offset:2048 sc1
    global_load_dwordx4 a[92:95], v1, s[22:23] offset:3072 sc1
    global_load_dwordx4 a[96:99], v4, s[22:23] offset:0 sc1
    global_load_dwordx4 a[100:103], v4, s[22:23] offset:1024 sc1
    global_load_dwordx4 a[104:107], v4, s[22:23] offset:2048 sc1
    global_load_dwordx4 a[108:111], v4, s[22:23] offset:3072 sc1
    global_load_dwordx4 a[112:115], v5, s[22:23] offset:0 sc1
    global_load_dwordx4 a[116:119], v5, s[22:23] offset:1024 sc1
    global_load_dwordx4 v[56:59], v5, s[22:23] offset:2048 sc1
    global_load_dwordx4 v[60:63], v5, s[22:23] offset:3072 sc1
    global_load_dwordx4 v[64:67], v6, s[22:23] offset:0 sc1
    global_load_dwordx4 v[68:71], v6, s[22:23] offset:1024 sc1
    s_waitcnt vmcnt(28)
    s_add_u32 s22, s20, 415744
    s_addc_u32 s23, s21, 0
    global_load_dwordx4 a[120:123], v1, s[22:23] offset:0 sc1
    global_load_dwordx4 a[124:127], v1, s[22:23] offset:1024 sc1
    global_load_dwordx4 a[128:131], v1, s[22:23] offset:2048 sc1
    global_load_dwordx4 a[132:135], v1, s[22:23] offset:3072 sc1
    global_load_dwordx4 a[136:139], v4, s[22:23] offset:0 sc1
    global_load_dwordx4 a[140:143], v4, s[22:23] offset:1024 sc1
    global_load_dwordx4 a[144:147], v4, s[22:23] offset:2048 sc1
    global_load_dwordx4 a[148:151], v4, s[22:23] offset:3072 sc1
    global_load_dwordx4 a[152:155], v5, s[22:23] offset:0 sc1
    global_load_dwordx4 a[156:159], v5, s[22:23] offset:1024 sc1
    global_load_dwordx4 v[72:75], v5, s[22:23] offset:2048 sc1
    global_load_dwordx4 v[76:79], v5, s[22:23] offset:3072 sc1
    global_load_dwordx4 v[80:83], v6, s[22:23] offset:0 sc1
    global_load_dwordx4 v[84:87], v6, s[22:23] offset:1024 sc1
    s_waitcnt vmcnt(28)
    s_add_u32 s22, s20, 802816
    s_addc_u32 s23, s21, 0
    global_load_dwordx4 a[160:163], v1, s[22:23] offset:0 sc1
    global_load_dwordx4 a[164:167], v1, s[22:23] offset:1024 sc1
    global_load_dwordx4 a[168:171], v1, s[22:23] offset:2048 sc1
    global_load_dwordx4 a[172:175], v1, s[22:23] offset:3072 sc1
    global_load_dwordx4 a[176:179], v4, s[22:23] offset:0 sc1
    global_load_dwordx4 a[180:183], v4, s[22:23] offset:1024 sc1
    global_load_dwordx4 a[184:187], v4, s[22:23] offset:2048 sc1
    global_load_dwordx4 a[188:191], v4, s[22:23] offset:3072 sc1
    global_load_dwordx4 a[192:195], v5, s[22:23] offset:0 sc1
    global_load_dwordx4 a[196:199], v5, s[22:23] offset:1024 sc1
    global_load_dwordx4 v[88:91], v5, s[22:23] offset:2048 sc1
    global_load_dwordx4 v[92:95], v5, s[22:23] offset:3072 sc1
    global_load_dwordx4 v[96:99], v6, s[22:23] offset:0 sc1
    global_load_dwordx4 v[100:103], v6, s[22:23] offset:1024 sc1
    s_waitcnt vmcnt(28)
    s_add_u32 s22, s20, 817152
    s_addc_u32 s23, s21, 0
    global_load_dwordx4 a[200:203], v1, s[22:23] offset:0 sc1
    global_load_dwordx4 a[204:207], v1, s[22:23] offset:1024 sc1
    global_load_dwordx4 a[208:211], v1, s[22:23] offset:2048 sc1
    global_load_dwordx4 a[212:215], v1, s[22:23] offset:3072 sc1
    global_load_dwordx4 a[216:219], v4, s[22:23] offset:0 sc1
    global_load_dwordx4 a[220:223], v4, s[22:23] offset:1024 sc1
    global_load_dwordx4 a[224:227], v4, s[22:23] offset:2048 sc1
    global_load_dwordx4 a[228:231], v4, s[22:23] offset:3072 sc1
    global_load_dwordx4 a[232:235], v5, s[22:23] offset:0 sc1
    global_load_dwordx4 a[236:239], v5, s[22:23] offset:1024 sc1
    global_load_dwordx4 v[104:107], v5, s[22:23] offset:2048 sc1
    global_load_dwordx4 v[108:111], v5, s[22:23] offset:3072 sc1
    global_load_dwordx4 v[112:115], v6, s[22:23] offset:0 sc1
    global_load_dwordx4 v[116:119], v6, s[22:23] offset:1024 sc1
    s_waitcnt vmcnt(28)
    s_add_u32 s22, s20, 1204224
    s_addc_u32 s23, s21, 0
    global_load_dwordx4 a[240:243], v1, s[22:23] offset:0 sc1
    global_load_dwordx4 a[244:247], v1, s[22:23] offset:1024 sc1
    global_load_dwordx4 a[248:251], v1, s[22:23] offset:2048 sc1
    global_load_dwordx4 a[252:255], v1, s[22:23] offset:3072 sc1
    global_load_dwordx4 v[192:195], v4, s[22:23] offset:0 sc1
    global_load_dwordx4 v[196:199], v4, s[22:23] offset:1024 sc1
    global_load_dwordx4 v[200:203], v4, s[22:23] offset:2048 sc1
    global_load_dwordx4 v[204:207], v4, s[22:23] offset:3072 sc1
    global_load_dwordx4 v[208:211], v5, s[22:23] offset:0 sc1
    global_load_dwordx4 v[212:215], v5, s[22:23] offset:1024 sc1
    global_load_dwordx4 v[120:123], v5, s[22:23] offset:2048 sc1
    global_load_dwordx4 v[124:127], v5, s[22:23] offset:3072 sc1
    global_load_dwordx4 v[128:131], v6, s[22:23] offset:0 sc1
    global_load_dwordx4 v[132:135], v6, s[22:23] offset:1024 sc1
    s_waitcnt vmcnt(28)
    s_add_u32 s22, s20, 1218560
    s_addc_u32 s23, s21, 0
    global_load_dwordx4 v[216:219], v1, s[22:23] offset:0 sc1
    global_load_dwordx4 v[220:223], v1, s[22:23] offset:1024 sc1
    global_load_dwordx4 v[224:227], v1, s[22:23] offset:2048 sc1
    global_load_dwordx4 v[228:231], v1, s[22:23] offset:3072 sc1
    global_load_dwordx4 v[232:235], v4, s[22:23] offset:0 sc1
    global_load_dwordx4 v[236:239], v4, s[22:23] offset:1024 sc1
    global_load_dwordx4 v[240:243], v4, s[22:23] offset:2048 sc1
    global_load_dwordx4 v[244:247], v4, s[22:23] offset:3072 sc1
    global_load_dwordx4 v[248:251], v5, s[22:23] offset:0 sc1
    global_load_dwordx4 v[252:255], v5, s[22:23] offset:1024 sc1
    global_load_dwordx4 v[136:139], v5, s[22:23] offset:2048 sc1
    global_load_dwordx4 v[140:143], v5, s[22:23] offset:3072 sc1
    global_load_dwordx4 v[144:147], v6, s[22:23] offset:0 sc1
    global_load_dwordx4 v[148:151], v6, s[22:23] offset:1024 sc1
    s_waitcnt vmcnt(28)
    s_waitcnt vmcnt(0)
    v_add_u32 v15, s28, v1
    ds_write_b128 v15, v[24:27] offset:0
    ds_write_b128 v15, v[28:31] offset:1024
    ds_write_b128 v15, v[32:35] offset:2048
    ds_write_b128 v15, v[36:39] offset:3072
    ds_write_b128 v15, v[40:43] offset:4096
    ds_write_b128 v15, v[44:47] offset:5120
    ds_write_b128 v15, v[48:51] offset:6144
    ds_write_b128 v15, v[52:55] offset:7168
    ds_write_b128 v15, v[56:59] offset:8192
    ds_write_b128 v15, v[60:63] offset:9216
    ds_write_b128 v15, v[64:67] offset:10240
    ds_write_b128 v15, v[68:71] offset:11264
    ds_write_b128 v15, v[72:75] offset:12288
    ds_write_b128 v15, v[76:79] offset:13312
    ds_write_b128 v15, v[80:83] offset:14336
    ds_write_b128 v15, v[84:87] offset:15360
    ds_write_b128 v15, v[88:91] offset:16384
    ds_write_b128 v15, v[92:95] offset:17408
    ds_write_b128 v15, v[96:99] offset:18432
    ds_write_b128 v15, v[100:103] offset:19456
    ds_write_b128 v15, v[104:107] offset:20480
    ds_write_b128 v15, v[108:111] offset:21504
    ds_write_b128 v15, v[112:115] offset:22528
    ds_write_b128 v15, v[116:119] offset:23552
    ds_write_b128 v15, v[120:123] offset:24576
    ds_write_b128 v15, v[124:127] offset:25600
    ds_write_b128 v15, v[128:131] offset:26624
    ds_write_b128 v15, v[132:135] offset:27648
    ds_write_b128 v15, v[136:139] offset:28672
    ds_write_b128 v15, v[140:143] offset:29696
    ds_write_b128 v15, v[144:147] offset:30720
    ds_write_b128 v15, v[148:151] offset:31744
    s_cmp_lg_u32 s10, 0
    s_cbranch_scc1 sequential_preLN__memory_aug_recurrent_mem_tr__mixer_gmlp__prompt_kernel_B_all_pwj
    s_mov_b32 s13, 131072
    s_add_u32 s76, s4, 0x1580000
    s_addc_u32 s77, s5, 0
    v_mbcnt_lo_u32_b32 v152, -1, 0
    v_mbcnt_hi_u32_b32 v152, -1, v152
    v_lshlrev_b32 v152, 4, v152
    s_nop 1
sequential_preLN__memory_aug_recurrent_mem_tr__mixer_gmlp__prompt_kernel_B_all_pw:
    global_load_dwordx4 v[154:157], v152, s[76:77] sc1
    s_waitcnt vmcnt(0)
    v_xor_b32 v154, s78, v154
    v_xor_b32 v155, s78, v155
    v_xor_b32 v156, s78, v156
    v_xor_b32 v157, s78, v157
    v_or_b32 v154, v154, v155
    v_or_b32 v156, v156, v157
    v_or_b32 v154, v154, v156
    v_cmp_ne_u32 vcc, 0, v154
    s_nop 0
    s_cbranch_vccz sequential_preLN__memory_aug_recurrent_mem_tr__mixer_gmlp__prompt_kernel_B_all_pwok
    s_sleep 16
    s_sub_u32 s13, s13, 1
    s_cbranch_scc0 sequential_preLN__memory_aug_recurrent_mem_tr__mixer_gmlp__prompt_kernel_B_all_pw
    s_endpgm
sequential_preLN__memory_aug_recurrent_mem_tr__mixer_gmlp__prompt_kernel_B_all_pwok:
sequential_preLN__memory_aug_recurrent_mem_tr__mixer_gmlp__prompt_kernel_B_all_pwj:
    s_barrier
    v_and_b32 v3, 8, v0
    v_cmp_ne_u32 vcc, 0, v3
    v_mov_b32 v3, 0x44444444
    v_mov_b32 v23, 0xeeeeeeee
    v_cndmask_b32 v3, v3, v23, vcc
    v_mov_b32 v4, v1
    v_add_u32 v5, 28672, v1
    v_add_u32 v6, 57344, v1
    v_add_u32 v7, 86016, v1
    s_cmp_lt_u32 s10, 3
    s_cselect_b32 s15, 4096, 0
    s_lshl_b32 s14, s10, 10
    v_add_u32 v21, s14, v1
    v_add_u32 v22, s15, v21
    v_add_u32 v18, 135168, v21
    v_add_u32 v19, 135168, v22
    v_add_u32 v16, 135168, v1
    v_min_u32 v33, 55, v0
    v_lshrrev_b32 v34, 2, v33
    v_lshlrev_b32 v34, 9, v34
    v_and_b32 v33, 3, v33
    v_lshlrev_b32 v33, 5, v33
    v_add_u32 v2, v33, v34
    v_add_u32 v2, 412, v2
    v_lshrrev_b32 v24, 4, v0
    v_and_b32 v28, 15, v0
    v_lshlrev_b32 v25, 7, v24
    v_lshlrev_b32 v26, 4, v28
    v_add_u32 v25, v25, v26
    s_lshl_b32 s14, s10, 9
    s_add_u32 s14, s14, 8192
    v_add_u32 v25, s14, v25
    v_mov_b32 v26, 10240
    v_cmp_gt_u32 vcc, 8, v28
    s_nop 1
    v_cndmask_b32 v9, v26, v25, vcc
    s_lshl_b32 s14, s10, 11
    v_add_u32 v8, s14, v1
    s_lshl_b32 s14, s9, 2
    s_add_u32 s14, s14, s10
    s_lshl_b32 s14, s14, 2
    v_mov_b32 v17, s14
    v_and_b32 v26, 1, v24
    v_lshrrev_b32 v27, 3, v28
    v_lshlrev_b32 v29, 1, v26
    v_add_u32 v27, v27, v29
    v_add_u32 v27, s10, v27
    v_and_b32 v27, 3, v27
    v_lshlrev_b32 v27, 2, v27
    v_lshlrev_b32 v29, 11, v26
    v_add_u32 v27, v27, v29
    v_lshrrev_b32 v30, 5, v0
    v_lshlrev_b32 v30, 4, v30
    v_add_u32 v30, v30, v28
    v_lshlrev_b32 v30, 4, v30
    v_add_u32 v10, v27, v30
    v_add_u32 v10, 131072, v10
    s_lshl_b32 s14, s10, 1
    v_lshrrev_b32 v27, 2, v0
    v_and_b32 v27, 1, v27
    v_add_u32 v27, s14, v27
    v_lshrrev_b32 v29, 3, v0
    v_and_b32 v29, 3, v29
    v_and_b32 v30, 3, v0
    v_lshrrev_b32 v31, 1, v29
    v_lshlrev_b32 v31, 3, v31
    v_lshlrev_b32 v32, 1, v30
    v_add_u32 v31, v31, v32
    v_and_b32 v32, 1, v29
    v_add_u32 v31, v31, v32
    v_lshlrev_b32 v32, 9, v27
    v_lshlrev_b32 v31, 5, v31
    v_add_u32 v11, v31, v32
    v_add_u32 v11, 131072, v11
    s_lshl_b32 s14, s9, 2
    v_add_u32 v29, s14, v29
    v_lshlrev_b32 v29, 7, v29
    v_lshlrev_b32 v31, 4, v27
    v_lshlrev_b32 v30, 2, v30
    v_add3_u32 v12, v29, v30, v31
    v_add_u32 v15, s28, v1
    v_mov_b32 v14, 0
    v_mov_b32 v177, 1
    s_mov_b32 s30, -1
    s_mov_b32 s31, 0
    s_mov_b32 s44, 0x00ff00ff
    s_mov_b32 s45, 0x00ff00ff
    v_mov_b32 v164, 0
    v_mov_b32 v165, 0
    v_mov_b32 v166, 0
    v_mov_b32 v167, 0
    s_add_u32 s18, s4, 0x1200000
    s_addc_u32 s19, s5, 0
    s_add_u32 s20, s4, 0x1400000
    s_addc_u32 s21, s5, 0
    s_lshl_b32 s14, s10, 2
    s_mul_i32 s14, s14, 28
    s_lshl_b32 s15, s9, 1
    s_add_u32 s14, s14, s15
    s_lshl_b32 s14, s14, 10
    s_add_u32 s14, s14, 0x2000000
    s_add_u32 s22, s4, s14
    s_addc_u32 s23, s5, 0
    s_add_u32 s24, s4, 0x1202000
    s_addc_u32 s25, s5, 0
    s_add_u32 s36, s4, 0x137e000
    s_addc_u32 s37, s5, 0
    s_mul_i32 s14, s10, 28
    s_lshl_b32 s15, s9, 1
    s_add_u32 s14, s14, s15
    s_lshl_b32 s14, s14, 10
    s_add_u32 s14, s14, 0x4000000
    s_add_u32 s38, s4, s14
    s_addc_u32 s39, s5, 0
    s_add_u32 s40, s4, 0x1500000
    s_addc_u32 s41, s5, 0
    s_add_u32 s42, s4, 0x1502000
    s_addc_u32 s43, s5, 0
    s_mov_b32 s13, 131072
    v_mbcnt_lo_u32_b32 v24, -1, 0
    v_mbcnt_hi_u32_b32 v24, -1, v24
    v_and_b32 v24, 7, v24
    v_lshlrev_b32 v24, 5, v24
    s_nop 1
sequential_preLN__memory_aug_recurrent_mem_tr__mixer_gmlp__prompt_kernel_B_cm_rc:
    global_load_dword v25, v24, s[6:7] sc1
    s_waitcnt vmcnt(0)
    v_readlane_b32 s68, v25, 0
    v_readlane_b32 s69, v25, 1
    v_readlane_b32 s70, v25, 2
    v_readlane_b32 s71, v25, 3
    v_readlane_b32 s72, v25, 4
    v_readlane_b32 s73, v25, 5
    v_readlane_b32 s74, v25, 6
    v_readlane_b32 s75, v25, 7
    s_add_u32 s14, s68, s69
    s_add_u32 s14, s14, s70
    s_add_u32 s14, s14, s71
    s_add_u32 s14, s14, s72
    s_add_u32 s14, s14, s73
    s_add_u32 s14, s14, s74
    s_add_u32 s14, s14, s75
    s_cmp_ge_u32 s14, 256
    s_cbranch_scc1 sequential_preLN__memory_aug_recurrent_mem_tr__mixer_gmlp__prompt_kernel_B_cm_rcok
    s_sleep 1
    s_sub_u32 s13, s13, 1
    s_cbranch_scc0 sequential_preLN__memory_aug_recurrent_mem_tr__mixer_gmlp__prompt_kernel_B_cm_rc
    s_endpgm
sequential_preLN__memory_aug_recurrent_mem_tr__mixer_gmlp__prompt_kernel_B_cm_rcok:
    s_cmp_lt_u32 s68, 31
    s_cselect_b32 s11, 1, 0
    s_mov_b32 s13, 131072
sequential_preLN__memory_aug_recurrent_mem_tr__mixer_gmlp__prompt_kernel_B_vp0:
    global_load_dword v24, v14, s[40:41] offset:0 sc1
    s_waitcnt vmcnt(0)
    v_readfirstlane_b32 s14, v24
    s_nop 0
    s_cmp_ge_u32 s14, 16
    s_nop 1
    s_cbranch_scc1 sequential_preLN__memory_aug_recurrent_mem_tr__mixer_gmlp__prompt_kernel_B_vp0_ok
    s_sleep 2
    s_sub_u32 s13, s13, 1
    s_cbranch_scc0 sequential_preLN__memory_aug_recurrent_mem_tr__mixer_gmlp__prompt_kernel_B_vp0
    s_endpgm
sequential_preLN__memory_aug_recurrent_mem_tr__mixer_gmlp__prompt_kernel_B_vp0_ok:
    s_waitcnt vmcnt(0) lgkmcnt(0)
    s_barrier
    s_mov_b32 s12, 0
    v_mov_b64 v[52:53], 0
    v_mov_b64 v[54:55], 0
    v_mov_b64 v[56:57], 0
    v_mov_b64 v[58:59], 0
    v_mov_b64 v[60:61], 0
    v_mov_b64 v[62:63], 0
    v_mov_b64 v[64:65], 0
    v_mov_b64 v[66:67], 0
    v_mov_b64 v[68:69], 0
    v_mov_b64 v[70:71], 0
    v_mov_b64 v[72:73], 0
    v_mov_b64 v[74:75], 0
    v_mov_b64 v[76:77], 0
    v_mov_b64 v[78:79], 0
    v_mov_b64 v[80:81], 0
    v_mov_b64 v[82:83], 0
    s_cmp_eq_u32 s11, 0
    s_cbranch_scc0 sequential_preLN__memory_aug_recurrent_mem_tr__mixer_gmlp__prompt_kernel_B_slow_loop
sequential_preLN__memory_aug_recurrent_mem_tr__mixer_gmlp__prompt_kernel_B_fast_loop:
    s_mov_b32 s13, 131072
sequential_preLN__memory_aug_recurrent_mem_tr__mixer_gmlp__prompt_kernel_B_fast_mpoll:
    global_load_dwordx4 v[116:119], v21, s[18:19] sc1
    global_load_dwordx4 v[120:123], v22, s[18:19] sc1
    s_sub_u32 s13, s13, 1
    s_cbranch_scc1 sequential_preLN__memory_aug_recurrent_mem_tr__mixer_gmlp__prompt_kernel_B_fast_abort
    s_waitcnt vmcnt(1)
    ds_write_b128 v18, v[116:119]
    v_max3_u32 v23, v116, v117, v118
    v_max_u32 v23, v23, v119
    s_waitcnt vmcnt(0)
    ds_write_b128 v19, v[120:123]
    v_max3_u32 v0, v120, v121, v122
    v_max3_u32 v23, v23, v0, v123
    v_cmp_eq_u32 vcc, -1, v23
    s_nop 0
    s_cbranch_vccnz sequential_preLN__memory_aug_recurrent_mem_tr__mixer_gmlp__prompt_kernel_B_fast_mpoll
    s_waitcnt lgkmcnt(0)
    s_barrier
    ds_read_b128 v[24:27], v16 offset:0
    ds_read_b128 v[28:31], v16 offset:1024
    ds_read_b128 v[32:35], v16 offset:2048
    ds_read_b128 v[36:39], v16 offset:3072
    ds_read_b128 v[40:43], v16 offset:4096
    ds_read_b128 v[44:47], v16 offset:5120
    ds_read_b128 v[48:51], v16 offset:6144
    ds_read_b128 v[116:119], v15 offset:0
    ds_read_b128 v[120:123], v15 offset:1024
    ds_read_b128 v[124:127], v15 offset:4096
    ds_read_b128 v[128:131], v15 offset:5120
    ds_read_b128 v[132:135], v15 offset:8192
    ds_read_b128 v[136:139], v15 offset:9216
    ds_read_b128 v[140:143], v15 offset:12288
    ds_read_b128 v[144:147], v15 offset:13312
    s_waitcnt lgkmcnt(14)
    v_smfmac_f32_16x16x64_bf16 v[52:55], v[24:27], a[0:7], v3
    v_smfmac_f32_16x16x64_bf16 v[56:59], v[24:27], a[40:47], v3
    v_smfmac_f32_16x16x64_bf16 v[60:63], v[24:27], a[80:87], v3
    v_smfmac_f32_16x16x64_bf16 v[64:67], v[24:27], a[120:127], v3
    v_smfmac_f32_16x16x64_bf16 v[68:71], v[24:27], a[160:167], v3
    v_smfmac_f32_16x16x64_bf16 v[72:75], v[24:27], a[200:207], v3
    v_smfmac_f32_16x16x64_bf16 v[76:79], v[24:27], a[240:247], v3
    v_smfmac_f32_16x16x64_bf16 v[80:83], v[24:27], v[216:223], v3
    global_load_dwordx4 v[84:87], v4, s[22:23] offset:0 sc1
    s_waitcnt lgkmcnt(13)
    v_smfmac_f32_16x16x64_bf16 v[52:55], v[28:31], a[8:15], v3
    v_smfmac_f32_16x16x64_bf16 v[56:59], v[28:31], a[48:55], v3
    v_smfmac_f32_16x16x64_bf16 v[60:63], v[28:31], a[88:95], v3
    v_smfmac_f32_16x16x64_bf16 v[64:67], v[28:31], a[128:135], v3
    global_load_dwordx4 v[92:95], v4, s[22:23] offset:1024 sc1
    v_smfmac_f32_16x16x64_bf16 v[68:71], v[28:31], a[168:175], v3
    v_smfmac_f32_16x16x64_bf16 v[72:75], v[28:31], a[208:215], v3
    v_smfmac_f32_16x16x64_bf16 v[76:79], v[28:31], a[248:255], v3
    v_smfmac_f32_16x16x64_bf16 v[80:83], v[28:31], v[224:231], v3
    global_load_dwordx4 v[88:91], v5, s[22:23] offset:0 sc1
    s_waitcnt lgkmcnt(12)
    v_smfmac_f32_16x16x64_bf16 v[52:55], v[32:35], a[16:23], v3
    s_waitcnt lgkmcnt(9)
    s_waitcnt lgkmcnt(6)
    v_smfmac_f32_16x16x64_bf16 v[52:55], v[44:47], v[116:123], v3
    ds_read_b128 v[116:119], v15 offset:16384
    ds_read_b128 v[120:123], v15 offset:17408
    v_smfmac_f32_16x16x64_bf16 v[56:59], v[32:35], a[56:63], v3
    v_smfmac_f32_16x16x64_bf16 v[60:63], v[32:35], a[96:103], v3
    global_load_dwordx4 v[96:99], v5, s[22:23] offset:1024 sc1
    s_waitcnt lgkmcnt(6)
    v_smfmac_f32_16x16x64_bf16 v[56:59], v[44:47], v[124:131], v3
    ds_read_b128 v[124:127], v15 offset:20480
    ds_read_b128 v[128:131], v15 offset:21504
    v_smfmac_f32_16x16x64_bf16 v[64:67], v[32:35], a[136:143], v3
    s_waitcnt lgkmcnt(6)
    v_smfmac_f32_16x16x64_bf16 v[60:63], v[44:47], v[132:139], v3
    ds_read_b128 v[132:135], v15 offset:24576
    ds_read_b128 v[136:139], v15 offset:25600
    v_smfmac_f32_16x16x64_bf16 v[68:71], v[32:35], a[176:183], v3
    global_load_dwordx4 v[100:103], v6, s[22:23] offset:0 sc1
    v_smfmac_f32_16x16x64_bf16 v[72:75], v[32:35], a[216:223], v3
    s_waitcnt lgkmcnt(6)
    v_smfmac_f32_16x16x64_bf16 v[64:67], v[44:47], v[140:147], v3
    ds_read_b128 v[140:143], v15 offset:28672
    ds_read_b128 v[144:147], v15 offset:29696
    v_smfmac_f32_16x16x64_bf16 v[76:79], v[32:35], v[192:199], v3
    s_waitcnt lgkmcnt(6)
    v_smfmac_f32_16x16x64_bf16 v[68:71], v[44:47], v[116:123], v3
    ds_read_b128 v[116:119], v15 offset:2048
    ds_read_b128 v[120:123], v15 offset:3072
    global_load_dwordx4 v[108:111], v6, s[22:23] offset:1024 sc1
    v_smfmac_f32_16x16x64_bf16 v[80:83], v[32:35], v[232:239], v3
    v_smfmac_f32_16x16x64_bf16 v[52:55], v[36:39], a[24:31], v3
    s_waitcnt lgkmcnt(6)
    v_smfmac_f32_16x16x64_bf16 v[72:75], v[44:47], v[124:131], v3
    ds_read_b128 v[124:127], v15 offset:6144
    ds_read_b128 v[128:131], v15 offset:7168
    v_smfmac_f32_16x16x64_bf16 v[56:59], v[36:39], a[64:71], v3
    global_load_dwordx4 v[104:107], v7, s[22:23] offset:0 sc1
    s_waitcnt lgkmcnt(6)
    v_smfmac_f32_16x16x64_bf16 v[76:79], v[44:47], v[132:139], v3
    ds_read_b128 v[132:135], v15 offset:10240
    ds_read_b128 v[136:139], v15 offset:11264
    v_smfmac_f32_16x16x64_bf16 v[60:63], v[36:39], a[104:111], v3
    v_smfmac_f32_16x16x64_bf16 v[64:67], v[36:39], a[144:151], v3
    s_waitcnt lgkmcnt(6)
    v_smfmac_f32_16x16x64_bf16 v[80:83], v[44:47], v[140:147], v3
    ds_read_b128 v[140:143], v15 offset:14336
    ds_read_b128 v[144:147], v15 offset:15360
    global_load_dwordx4 v[112:115], v7, s[22:23] offset:1024 sc1
    v_smfmac_f32_16x16x64_bf16 v[68:71], v[36:39], a[184:191], v3
    s_waitcnt lgkmcnt(6)
    v_smfmac_f32_16x16x64_bf16 v[52:55], v[48:51], v[116:123], v3
    ds_read_b128 v[116:119], v15 offset:18432
    ds_read_b128 v[120:123], v15 offset:19456
    v_smfmac_f32_16x16x64_bf16 v[72:75], v[36:39], a[224:231], v3
    v_smfmac_f32_16x16x64_bf16 v[76:79], v[36:39], v[200:207], v3
    global_load_dword v176, v14, s[40:41] offset:128 sc1
    s_waitcnt lgkmcnt(6)
    v_smfmac_f32_16x16x64_bf16 v[56:59], v[48:51], v[124:131], v3
    ds_read_b128 v[124:127], v15 offset:22528
    ds_read_b128 v[128:131], v15 offset:23552
    v_smfmac_f32_16x16x64_bf16 v[80:83], v[36:39], v[240:247], v3
    s_waitcnt lgkmcnt(6)
    v_smfmac_f32_16x16x64_bf16 v[60:63], v[48:51], v[132:139], v3
    ds_read_b128 v[132:135], v15 offset:26624
    ds_read_b128 v[136:139], v15 offset:27648
    v_smfmac_f32_16x16x64_bf16 v[52:55], v[40:43], a[32:39], v3
    v_smfmac_f32_16x16x64_bf16 v[56:59], v[40:43], a[72:79], v3
    s_waitcnt lgkmcnt(6)
    v_smfmac_f32_16x16x64_bf16 v[64:67], v[48:51], v[140:147], v3
    ds_read_b128 v[140:143], v15 offset:30720
    ds_read_b128 v[144:147], v15 offset:31744
    v_smfmac_f32_16x16x64_bf16 v[60:63], v[40:43], a[112:119], v3
    s_waitcnt lgkmcnt(6)
    v_smfmac_f32_16x16x64_bf16 v[68:71], v[48:51], v[116:123], v3
    v_smfmac_f32_16x16x64_bf16 v[64:67], v[40:43], a[152:159], v3
    v_smfmac_f32_16x16x64_bf16 v[68:71], v[40:43], a[192:199], v3
    s_waitcnt lgkmcnt(4)
    v_smfmac_f32_16x16x64_bf16 v[72:75], v[48:51], v[124:131], v3
    v_smfmac_f32_16x16x64_bf16 v[72:75], v[40:43], a[232:239], v3
    s_waitcnt lgkmcnt(2)
    v_smfmac_f32_16x16x64_bf16 v[76:79], v[48:51], v[132:139], v3
    v_smfmac_f32_16x16x64_bf16 v[76:79], v[40:43], v[208:215], v3
    v_smfmac_f32_16x16x64_bf16 v[80:83], v[40:43], v[248:255], v3
    s_waitcnt lgkmcnt(0)
    v_smfmac_f32_16x16x64_bf16 v[80:83], v[48:51], v[140:147], v3
    v_permlane32_swap_b32 v52, v60
    v_permlane32_swap_b32 v53, v61
    v_permlane32_swap_b32 v54, v62
    v_permlane32_swap_b32 v55, v63
    v_add_f32 v52, v52, v60
    v_add_f32 v53, v53, v61
    v_add_f32 v54, v54, v62
    v_add_f32 v55, v55, v63
    v_permlane32_swap_b32 v68, v76
    v_permlane32_swap_b32 v69, v77
    v_permlane32_swap_b32 v70, v78
    v_permlane32_swap_b32 v71, v79
    v_add_f32 v68, v68, v76
    v_add_f32 v69, v69, v77
    v_add_f32 v70, v70, v78
    v_add_f32 v71, v71, v79
    v_cvt_pk_bf16_f32 v148, v52, v53
    v_cvt_pk_bf16_f32 v149, v54, v55
    v_cvt_pk_bf16_f32 v150, v68, v69
    v_cvt_pk_bf16_f32 v151, v70, v71
    s_nop 0
    v_permlane32_swap_b32 v148, v150
    v_permlane32_swap_b32 v149, v151
    s_nop 0
    v_permlane16_swap_b32 v148, v150
    v_permlane16_swap_b32 v149, v151
    v_permlane32_swap_b32 v56, v64
    v_permlane32_swap_b32 v57, v65
    v_permlane32_swap_b32 v58, v66
    v_permlane32_swap_b32 v59, v67
    v_add_f32 v56, v56, v64
    v_add_f32 v57, v57, v65
    v_add_f32 v58, v58, v66
    v_add_f32 v59, v59, v67
    v_permlane32_swap_b32 v72, v80
    v_permlane32_swap_b32 v73, v81
    v_permlane32_swap_b32 v74, v82
    v_permlane32_swap_b32 v75, v83
    v_add_f32 v72, v72, v80
    v_add_f32 v73, v73, v81
    v_add_f32 v74, v74, v82
    v_add_f32 v75, v75, v83
    v_cvt_pk_bf16_f32 v152, v56, v57
    v_cvt_pk_bf16_f32 v153, v58, v59
    v_cvt_pk_bf16_f32 v154, v72, v73
    v_cvt_pk_bf16_f32 v155, v74, v75
    s_nop 0
    v_permlane32_swap_b32 v152, v154
    v_permlane32_swap_b32 v153, v155
    s_nop 0
    v_permlane16_swap_b32 v152, v154
    v_permlane16_swap_b32 v153, v155
    v_mov_b64 v[52:53], 0
    v_mov_b64 v[54:55], 0
    v_mov_b64 v[56:57], 0
    v_mov_b64 v[58:59], 0
    v_mov_b64 v[60:61], 0
    v_mov_b64 v[62:63], 0
    v_mov_b64 v[64:65], 0
    v_mov_b64 v[66:67], 0
    v_mov_b64 v[68:69], 0
    v_mov_b64 v[70:71], 0
    v_mov_b64 v[72:73], 0
    v_mov_b64 v[74:75], 0
    v_mov_b64 v[76:77], 0
    v_mov_b64 v[78:79], 0
    v_mov_b64 v[80:81], 0
    v_mov_b64 v[82:83], 0
    s_mov_b32 s13, 131072
    s_nop 0
sequential_preLN__memory_aug_recurrent_mem_tr__mixer_gmlp__prompt_kernel_B_fast_ppoll:
    global_load_dwordx4 v[164:167], v9, s[20:21] sc1
    global_load_dwordx4 v[156:159], v8, s[20:21] sc1
    global_load_dwordx4 v[160:163], v8, s[20:21] offset:1024 sc1
    s_sub_u32 s13, s13, 1
    s_cbranch_scc1 sequential_preLN__memory_aug_recurrent_mem_tr__mixer_gmlp__prompt_kernel_B_fast_p_abort
    s_waitcnt vmcnt(0)
    v_max3_u32 v23, v156, v157, v158
    v_max3_u32 v0, v159, v160, v161
    v_max3_u32 v178, v162, v163, v164
    v_max3_u32 v179, v165, v166, v167
    v_max3_u32 v23, v23, v0, v178
    v_max_u32 v23, v23, v179
    v_cmp_eq_u32 vcc, -1, v23
    s_nop 0
    s_cbranch_vccnz sequential_preLN__memory_aug_recurrent_mem_tr__mixer_gmlp__prompt_kernel_B_fast_ppoll
    v_mfma_f32_16x16x32_bf16 v[168:171], v[164:167], v[148:151], 0
    v_mfma_f32_16x16x32_bf16 v[172:175], v[164:167], v[152:155], 0
    v_smfmac_f32_16x16x64_bf16 v[168:171], v[156:159], v[84:91], v3
    v_smfmac_f32_16x16x64_bf16 v[172:175], v[156:159], v[92:99], v3
    v_smfmac_f32_16x16x64_bf16 v[168:171], v[160:163], v[100:107], v3
    v_smfmac_f32_16x16x64_bf16 v[172:175], v[160:163], v[108:115], v3
    s_nop 7
    v_permlane32_swap_b32 v168, v172
    v_permlane32_swap_b32 v169, v173
    v_permlane32_swap_b32 v170, v174
    v_permlane32_swap_b32 v171, v175
    v_add_f32 v168, v168, v172
    ds_write_b32 v10, v168 offset:0
    v_add_f32 v169, v169, v173
    ds_write_b32 v10, v169 offset:512
    v_add_f32 v170, v170, v174
    ds_write_b32 v10, v170 offset:1024
    v_add_f32 v171, v171, v175
    ds_write_b32 v10, v171 offset:1536
    s_waitcnt lgkmcnt(0)
    s_barrier
    ds_read_b128 v[180:183], v11
    ds_read_b128 v[184:187], v11 offset:16
    s_mov_b64 exec, s[30:31]
    s_waitcnt lgkmcnt(1)
    v_add_f32 v180, v180, v181
    v_add_f32 v182, v182, v183
    s_waitcnt lgkmcnt(0)
    v_add_f32 v184, v184, v185
    v_add_f32 v186, v186, v187
    v_add_f32 v180, v180, v182
    v_add_f32 v184, v184, v186
    v_cvt_pk_bf16_f32 v13, v180, v184
    v_min_u32 v13, -2, v13
    global_store_dword v12, v13, s[24:25]
    s_cmp_eq_u32 s12, 62
    s_cbranch_scc0 sequential_preLN__memory_aug_recurrent_mem_tr__mixer_gmlp__prompt_kernel_B_fast_nolast
    global_store_dword v12, v13, s[36:37] sc1
sequential_preLN__memory_aug_recurrent_mem_tr__mixer_gmlp__prompt_kernel_B_fast_nolast:
    s_mov_b64 exec, -1
    v_readfirstlane_b32 s14, v176
    s_add_u32 s15, s12, 1
    s_cmp_ge_u32 s15, 63
    s_nop 1
    s_cbranch_scc1 sequential_preLN__memory_aug_recurrent_mem_tr__mixer_gmlp__prompt_kernel_B_fast_vpok
    s_cmp_ge_u32 s14, 16
    s_cbranch_scc1 sequential_preLN__memory_aug_recurrent_mem_tr__mixer_gmlp__prompt_kernel_B_fast_vpok
    s_mov_b32 s13, 131072
sequential_preLN__memory_aug_recurrent_mem_tr__mixer_gmlp__prompt_kernel_B_fast_vpw:
    global_load_dword v24, v14, s[40:41] offset:128 sc1
    s_waitcnt vmcnt(0)
    v_readfirstlane_b32 s14, v24
    s_nop 0
    s_cmp_ge_u32 s14, 16
    s_nop 1
    s_cbranch_scc1 sequential_preLN__memory_aug_recurrent_mem_tr__mixer_gmlp__prompt_kernel_B_fast_vpw_ok
    s_sleep 2
    s_sub_u32 s13, s13, 1
    s_cbranch_scc0 sequential_preLN__memory_aug_recurrent_mem_tr__mixer_gmlp__prompt_kernel_B_fast_vpw
    s_endpgm
sequential_preLN__memory_aug_recurrent_mem_tr__mixer_gmlp__prompt_kernel_B_fast_vpw_ok:
sequential_preLN__memory_aug_recurrent_mem_tr__mixer_gmlp__prompt_kernel_B_fast_vpok:
    s_add_u32 s18, s18, 8192
    s_addc_u32 s19, s19, 0
    s_add_u32 s24, s24, 8192
    s_addc_u32 s25, s25, 0
    s_add_u32 s20, s20, 10368
    s_addc_u32 s21, s21, 0
    s_add_u32 s22, s22, 458752
    s_addc_u32 s23, s23, 0
    s_add_u32 s40, s40, 128
    s_addc_u32 s41, s41, 0
    s_add_u32 s12, s12, 1
    s_cmp_lt_u32 s12, 63
    s_cbranch_scc1 sequential_preLN__memory_aug_recurrent_mem_tr__mixer_gmlp__prompt_kernel_B_fast_loop
    s_cmp_lg_u32 s10, 0
    s_cbranch_scc1 sequential_preLN__memory_aug_recurrent_mem_tr__mixer_gmlp__prompt_kernel_B_fast_noinv
    buffer_inv sc1
sequential_preLN__memory_aug_recurrent_mem_tr__mixer_gmlp__prompt_kernel_B_fast_noinv:
    s_waitcnt vmcnt(0) lgkmcnt(0)
    s_barrier
    s_branch sequential_preLN__memory_aug_recurrent_mem_tr__mixer_gmlp__prompt_kernel_DL0
    s_endpgm
sequential_preLN__memory_aug_recurrent_mem_tr__mixer_gmlp__prompt_kernel_B_fast_restart:
    s_nop 15
    s_waitcnt vmcnt(0) lgkmcnt(0)
    s_barrier
    v_mov_b64 v[52:53], 0
    v_mov_b64 v[54:55], 0
    v_mov_b64 v[56:57], 0
    v_mov_b64 v[58:59], 0
    v_mov_b64 v[60:61], 0
    v_mov_b64 v[62:63], 0
    v_mov_b64 v[64:65], 0
    v_mov_b64 v[66:67], 0
    v_mov_b64 v[68:69], 0
    v_mov_b64 v[70:71], 0
    v_mov_b64 v[72:73], 0
    v_mov_b64 v[74:75], 0
    v_mov_b64 v[76:77], 0
    v_mov_b64 v[78:79], 0
    v_mov_b64 v[80:81], 0
    v_mov_b64 v[82:83], 0
    s_nop 0
    s_branch sequential_preLN__memory_aug_recurrent_mem_tr__mixer_gmlp__prompt_kernel_B_fast_loop
sequential_preLN__memory_aug_recurrent_mem_tr__mixer_gmlp__prompt_kernel_B_fast_abort:
sequential_preLN__memory_aug_recurrent_mem_tr__mixer_gmlp__prompt_kernel_B_fast_p_abort:
    s_endpgm
sequential_preLN__memory_aug_recurrent_mem_tr__mixer_gmlp__prompt_kernel_B_slow_loop:
    s_mov_b32 s13, 131072
sequential_preLN__memory_aug_recurrent_mem_tr__mixer_gmlp__prompt_kernel_B_slow_mpoll:
    global_load_dwordx4 v[116:119], v21, s[18:19] sc1
    global_load_dwordx4 v[120:123], v22, s[18:19] sc1
    s_sub_u32 s13, s13, 1
    s_cbranch_scc1 sequential_preLN__memory_aug_recurrent_mem_tr__mixer_gmlp__prompt_kernel_B_slow_abort
    s_waitcnt vmcnt(1)
    ds_write_b128 v18, v[116:119]
    v_max3_u32 v23, v116, v117, v118
    v_max_u32 v23, v23, v119
    s_waitcnt vmcnt(0)
    ds_write_b128 v19, v[120:123]
    v_max3_u32 v0, v120, v121, v122
    v_max3_u32 v23, v23, v0, v123
    v_cmp_eq_u32 vcc, -1, v23
    s_nop 0
    s_cbranch_vccnz sequential_preLN__memory_aug_recurrent_mem_tr__mixer_gmlp__prompt_kernel_B_slow_mpoll
    s_waitcnt lgkmcnt(0)
    s_barrier
    ds_read_b128 v[24:27], v16 offset:0
    ds_read_b128 v[28:31], v16 offset:1024
    ds_read_b128 v[32:35], v16 offset:2048
    ds_read_b128 v[36:39], v16 offset:3072
    ds_read_b128 v[40:43], v16 offset:4096
    ds_read_b128 v[44:47], v16 offset:5120
    ds_read_b128 v[48:51], v16 offset:6144
    ds_read_b128 v[116:119], v15 offset:0
    ds_read_b128 v[120:123], v15 offset:1024
    ds_read_b128 v[124:127], v15 offset:4096
    ds_read_b128 v[128:131], v15 offset:5120
    ds_read_b128 v[132:135], v15 offset:8192
    ds_read_b128 v[136:139], v15 offset:9216
    ds_read_b128 v[140:143], v15 offset:12288
    ds_read_b128 v[144:147], v15 offset:13312
    s_waitcnt lgkmcnt(14)
    v_smfmac_f32_16x16x64_bf16 v[52:55], v[24:27], a[0:7], v3
    v_smfmac_f32_16x16x64_bf16 v[56:59], v[24:27], a[40:47], v3
    v_smfmac_f32_16x16x64_bf16 v[60:63], v[24:27], a[80:87], v3
    v_smfmac_f32_16x16x64_bf16 v[64:67], v[24:27], a[120:127], v3
    v_smfmac_f32_16x16x64_bf16 v[68:71], v[24:27], a[160:167], v3
    v_smfmac_f32_16x16x64_bf16 v[72:75], v[24:27], a[200:207], v3
    v_smfmac_f32_16x16x64_bf16 v[76:79], v[24:27], a[240:247], v3
    v_smfmac_f32_16x16x64_bf16 v[80:83], v[24:27], v[216:223], v3
    global_load_dwordx4 v[84:87], v4, s[22:23] offset:0 sc1
    s_waitcnt lgkmcnt(13)
    v_smfmac_f32_16x16x64_bf16 v[52:55], v[28:31], a[8:15], v3
    v_smfmac_f32_16x16x64_bf16 v[56:59], v[28:31], a[48:55], v3
    v_smfmac_f32_16x16x64_bf16 v[60:63], v[28:31], a[88:95], v3
    v_smfmac_f32_16x16x64_bf16 v[64:67], v[28:31], a[128:135], v3
    global_load_dwordx4 v[92:95], v4, s[22:23] offset:1024 sc1
    v_smfmac_f32_16x16x64_bf16 v[68:71], v[28:31], a[168:175], v3
    v_smfmac_f32_16x16x64_bf16 v[72:75], v[28:31], a[208:215], v3
    v_smfmac_f32_16x16x64_bf16 v[76:79], v[28:31], a[248:255], v3
    v_smfmac_f32_16x16x64_bf16 v[80:83], v[28:31], v[224:231], v3
    global_load_dwordx4 v[88:91], v5, s[22:23] offset:0 sc1
    s_waitcnt lgkmcnt(12)
    v_smfmac_f32_16x16x64_bf16 v[52:55], v[32:35], a[16:23], v3
    s_waitcnt lgkmcnt(9)
    s_waitcnt lgkmcnt(6)
    v_smfmac_f32_16x16x64_bf16 v[52:55], v[44:47], v[116:123], v3
    ds_read_b128 v[116:119], v15 offset:16384
    ds_read_b128 v[120:123], v15 offset:17408
    v_smfmac_f32_16x16x64_bf16 v[56:59], v[32:35], a[56:63], v3
    v_smfmac_f32_16x16x64_bf16 v[60:63], v[32:35], a[96:103], v3
    global_load_dwordx4 v[96:99], v5, s[22:23] offset:1024 sc1
    s_waitcnt lgkmcnt(6)
    v_smfmac_f32_16x16x64_bf16 v[56:59], v[44:47], v[124:131], v3
    ds_read_b128 v[124:127], v15 offset:20480
    ds_read_b128 v[128:131], v15 offset:21504
    v_smfmac_f32_16x16x64_bf16 v[64:67], v[32:35], a[136:143], v3
    s_waitcnt lgkmcnt(6)
    v_smfmac_f32_16x16x64_bf16 v[60:63], v[44:47], v[132:139], v3
    ds_read_b128 v[132:135], v15 offset:24576
    ds_read_b128 v[136:139], v15 offset:25600
    v_smfmac_f32_16x16x64_bf16 v[68:71], v[32:35], a[176:183], v3
    global_load_dwordx4 v[100:103], v6, s[22:23] offset:0 sc1
    v_smfmac_f32_16x16x64_bf16 v[72:75], v[32:35], a[216:223], v3
    s_waitcnt lgkmcnt(6)
    v_smfmac_f32_16x16x64_bf16 v[64:67], v[44:47], v[140:147], v3
    ds_read_b128 v[140:143], v15 offset:28672
    ds_read_b128 v[144:147], v15 offset:29696
    v_smfmac_f32_16x16x64_bf16 v[76:79], v[32:35], v[192:199], v3
    s_waitcnt lgkmcnt(6)
    v_smfmac_f32_16x16x64_bf16 v[68:71], v[44:47], v[116:123], v3
    ds_read_b128 v[116:119], v15 offset:2048
    ds_read_b128 v[120:123], v15 offset:3072
    global_load_dwordx4 v[108:111], v6, s[22:23] offset:1024 sc1
    v_smfmac_f32_16x16x64_bf16 v[80:83], v[32:35], v[232:239], v3
    v_smfmac_f32_16x16x64_bf16 v[52:55], v[36:39], a[24:31], v3
    s_waitcnt lgkmcnt(6)
    v_smfmac_f32_16x16x64_bf16 v[72:75], v[44:47], v[124:131], v3
    ds_read_b128 v[124:127], v15 offset:6144
    ds_read_b128 v[128:131], v15 offset:7168
    v_smfmac_f32_16x16x64_bf16 v[56:59], v[36:39], a[64:71], v3
    global_load_dwordx4 v[104:107], v7, s[22:23] offset:0 sc1
    s_waitcnt lgkmcnt(6)
    v_smfmac_f32_16x16x64_bf16 v[76:79], v[44:47], v[132:139], v3
    ds_read_b128 v[132:135], v15 offset:10240
    ds_read_b128 v[136:139], v15 offset:11264
    v_smfmac_f32_16x16x64_bf16 v[60:63], v[36:39], a[104:111], v3
    v_smfmac_f32_16x16x64_bf16 v[64:67], v[36:39], a[144:151], v3
    s_waitcnt lgkmcnt(6)
    v_smfmac_f32_16x16x64_bf16 v[80:83], v[44:47], v[140:147], v3
    ds_read_b128 v[140:143], v15 offset:14336
    ds_read_b128 v[144:147], v15 offset:15360
    global_load_dwordx4 v[112:115], v7, s[22:23] offset:1024 sc1
    v_smfmac_f32_16x16x64_bf16 v[68:71], v[36:39], a[184:191], v3
    s_waitcnt lgkmcnt(6)
    v_smfmac_f32_16x16x64_bf16 v[52:55], v[48:51], v[116:123], v3
    ds_read_b128 v[116:119], v15 offset:18432
    ds_read_b128 v[120:123], v15 offset:19456
    v_smfmac_f32_16x16x64_bf16 v[72:75], v[36:39], a[224:231], v3
    v_smfmac_f32_16x16x64_bf16 v[76:79], v[36:39], v[200:207], v3
    global_load_dword v176, v14, s[40:41] offset:128 sc1
    s_waitcnt lgkmcnt(6)
    v_smfmac_f32_16x16x64_bf16 v[56:59], v[48:51], v[124:131], v3
    ds_read_b128 v[124:127], v15 offset:22528
    ds_read_b128 v[128:131], v15 offset:23552
    v_smfmac_f32_16x16x64_bf16 v[80:83], v[36:39], v[240:247], v3
    s_waitcnt lgkmcnt(6)
    v_smfmac_f32_16x16x64_bf16 v[60:63], v[48:51], v[132:139], v3
    ds_read_b128 v[132:135], v15 offset:26624
    ds_read_b128 v[136:139], v15 offset:27648
    v_smfmac_f32_16x16x64_bf16 v[52:55], v[40:43], a[32:39], v3
    v_smfmac_f32_16x16x64_bf16 v[56:59], v[40:43], a[72:79], v3
    s_waitcnt lgkmcnt(6)
    v_smfmac_f32_16x16x64_bf16 v[64:67], v[48:51], v[140:147], v3
    ds_read_b128 v[140:143], v15 offset:30720
    ds_read_b128 v[144:147], v15 offset:31744
    v_smfmac_f32_16x16x64_bf16 v[60:63], v[40:43], a[112:119], v3
    s_waitcnt lgkmcnt(6)
    v_smfmac_f32_16x16x64_bf16 v[68:71], v[48:51], v[116:123], v3
    v_smfmac_f32_16x16x64_bf16 v[64:67], v[40:43], a[152:159], v3
    v_smfmac_f32_16x16x64_bf16 v[68:71], v[40:43], a[192:199], v3
    s_waitcnt lgkmcnt(4)
    v_smfmac_f32_16x16x64_bf16 v[72:75], v[48:51], v[124:131], v3
    v_smfmac_f32_16x16x64_bf16 v[72:75], v[40:43], a[232:239], v3
    s_waitcnt lgkmcnt(2)
    v_smfmac_f32_16x16x64_bf16 v[76:79], v[48:51], v[132:139], v3
    v_smfmac_f32_16x16x64_bf16 v[76:79], v[40:43], v[208:215], v3
    v_smfmac_f32_16x16x64_bf16 v[80:83], v[40:43], v[248:255], v3
    s_waitcnt lgkmcnt(0)
    v_smfmac_f32_16x16x64_bf16 v[80:83], v[48:51], v[140:147], v3
    v_permlane32_swap_b32 v52, v60
    v_permlane32_swap_b32 v53, v61
    v_permlane32_swap_b32 v54, v62
    v_permlane32_swap_b32 v55, v63
    v_add_f32 v52, v52, v60
    v_add_f32 v53, v53, v61
    v_add_f32 v54, v54, v62
    v_add_f32 v55, v55, v63
    v_permlane32_swap_b32 v68, v76
    v_permlane32_swap_b32 v69, v77
    v_permlane32_swap_b32 v70, v78
    v_permlane32_swap_b32 v71, v79
    v_add_f32 v68, v68, v76
    v_add_f32 v69, v69, v77
    v_add_f32 v70, v70, v78
    v_add_f32 v71, v71, v79
    v_cvt_pk_bf16_f32 v148, v52, v53
    v_cvt_pk_bf16_f32 v149, v54, v55
    v_cvt_pk_bf16_f32 v150, v68, v69
    v_cvt_pk_bf16_f32 v151, v70, v71
    s_nop 0
    v_permlane32_swap_b32 v148, v150
    v_permlane32_swap_b32 v149, v151
    s_nop 0
    v_permlane16_swap_b32 v148, v150
    v_permlane16_swap_b32 v149, v151
    v_permlane32_swap_b32 v56, v64
    v_permlane32_swap_b32 v57, v65
    v_permlane32_swap_b32 v58, v66
    v_permlane32_swap_b32 v59, v67
    v_add_f32 v56, v56, v64
    v_add_f32 v57, v57, v65
    v_add_f32 v58, v58, v66
    v_add_f32 v59, v59, v67
    v_permlane32_swap_b32 v72, v80
    v_permlane32_swap_b32 v73, v81
    v_permlane32_swap_b32 v74, v82
    v_permlane32_swap_b32 v75, v83
    v_add_f32 v72, v72, v80
    v_add_f32 v73, v73, v81
    v_add_f32 v74, v74, v82
    v_add_f32 v75, v75, v83
    v_cvt_pk_bf16_f32 v152, v56, v57
    v_cvt_pk_bf16_f32 v153, v58, v59
    v_cvt_pk_bf16_f32 v154, v72, v73
    v_cvt_pk_bf16_f32 v155, v74, v75
    s_nop 0
    v_permlane32_swap_b32 v152, v154
    v_permlane32_swap_b32 v153, v155
    s_nop 0
    v_permlane16_swap_b32 v152, v154
    v_permlane16_swap_b32 v153, v155
    v_mov_b64 v[52:53], 0
    v_mov_b64 v[54:55], 0
    v_mov_b64 v[56:57], 0
    v_mov_b64 v[58:59], 0
    v_mov_b64 v[60:61], 0
    v_mov_b64 v[62:63], 0
    v_mov_b64 v[64:65], 0
    v_mov_b64 v[66:67], 0
    v_mov_b64 v[68:69], 0
    v_mov_b64 v[70:71], 0
    v_mov_b64 v[72:73], 0
    v_mov_b64 v[74:75], 0
    v_mov_b64 v[76:77], 0
    v_mov_b64 v[78:79], 0
    v_mov_b64 v[80:81], 0
    v_mov_b64 v[82:83], 0
    s_mov_b32 s13, 131072
    s_nop 0
sequential_preLN__memory_aug_recurrent_mem_tr__mixer_gmlp__prompt_kernel_B_slow_ppoll:
    global_load_dwordx4 v[164:167], v9, s[20:21] sc1
    global_load_dwordx4 v[156:159], v8, s[20:21] sc1
    global_load_dwordx4 v[160:163], v8, s[20:21] offset:1024 sc1
    s_sub_u32 s13, s13, 1
    s_cbranch_scc1 sequential_preLN__memory_aug_recurrent_mem_tr__mixer_gmlp__prompt_kernel_B_slow_p_abort
    s_waitcnt vmcnt(0)
    v_max3_u32 v23, v156, v157, v158
    v_max3_u32 v0, v159, v160, v161
    v_max3_u32 v178, v162, v163, v164
    v_max3_u32 v179, v165, v166, v167
    v_max3_u32 v23, v23, v0, v178
    v_max_u32 v23, v23, v179
    v_cmp_eq_u32 vcc, -1, v23
    s_nop 0
    s_cbranch_vccnz sequential_preLN__memory_aug_recurrent_mem_tr__mixer_gmlp__prompt_kernel_B_slow_ppoll
    v_mfma_f32_16x16x32_bf16 v[168:171], v[164:167], v[148:151], 0
    v_mfma_f32_16x16x32_bf16 v[172:175], v[164:167], v[152:155], 0
    v_smfmac_f32_16x16x64_bf16 v[168:171], v[156:159], v[84:91], v3
    v_smfmac_f32_16x16x64_bf16 v[172:175], v[156:159], v[92:99], v3
    v_smfmac_f32_16x16x64_bf16 v[168:171], v[160:163], v[100:107], v3
    v_smfmac_f32_16x16x64_bf16 v[172:175], v[160:163], v[108:115], v3
    s_nop 7
    v_permlane32_swap_b32 v168, v172
    v_permlane32_swap_b32 v169, v173
    v_permlane32_swap_b32 v170, v174
    v_permlane32_swap_b32 v171, v175
    v_add_f32 v168, v168, v172
    ds_write_b32 v10, v168 offset:0
    v_add_f32 v169, v169, v173
    ds_write_b32 v10, v169 offset:512
    v_add_f32 v170, v170, v174
    ds_write_b32 v10, v170 offset:1024
    v_add_f32 v171, v171, v175
    ds_write_b32 v10, v171 offset:1536
    s_waitcnt lgkmcnt(0)
    s_barrier
    ds_read_b128 v[180:183], v11
    ds_read_b128 v[184:187], v11 offset:16
    s_mov_b64 exec, s[30:31]
    s_waitcnt lgkmcnt(1)
    v_add_f32 v180, v180, v181
    v_add_f32 v182, v182, v183
    s_waitcnt lgkmcnt(0)
    v_add_f32 v184, v184, v185
    v_add_f32 v186, v186, v187
    v_add_f32 v180, v180, v182
    v_add_f32 v184, v184, v186
    v_cvt_pk_bf16_f32 v13, v180, v184
    v_min_u32 v13, -2, v13
    global_store_dword v12, v13, s[24:25] sc1
    s_cmp_eq_u32 s12, 62
    s_cbranch_scc0 sequential_preLN__memory_aug_recurrent_mem_tr__mixer_gmlp__prompt_kernel_B_slow_nolast
    global_store_dword v12, v13, s[36:37] sc1
sequential_preLN__memory_aug_recurrent_mem_tr__mixer_gmlp__prompt_kernel_B_slow_nolast:
    s_mov_b64 exec, -1
    v_readfirstlane_b32 s14, v176
    s_add_u32 s15, s12, 1
    s_cmp_ge_u32 s15, 63
    s_nop 1
    s_cbranch_scc1 sequential_preLN__memory_aug_recurrent_mem_tr__mixer_gmlp__prompt_kernel_B_slow_vpok
    s_cmp_ge_u32 s14, 16
    s_cbranch_scc1 sequential_preLN__memory_aug_recurrent_mem_tr__mixer_gmlp__prompt_kernel_B_slow_vpok
    s_mov_b32 s13, 131072
sequential_preLN__memory_aug_recurrent_mem_tr__mixer_gmlp__prompt_kernel_B_slow_vpw:
    global_load_dword v24, v14, s[40:41] offset:128 sc1
    s_waitcnt vmcnt(0)
    v_readfirstlane_b32 s14, v24
    s_nop 0
    s_cmp_ge_u32 s14, 16
    s_nop 1
    s_cbranch_scc1 sequential_preLN__memory_aug_recurrent_mem_tr__mixer_gmlp__prompt_kernel_B_slow_vpw_ok
    s_sleep 2
    s_sub_u32 s13, s13, 1
    s_cbranch_scc0 sequential_preLN__memory_aug_recurrent_mem_tr__mixer_gmlp__prompt_kernel_B_slow_vpw
    s_endpgm
sequential_preLN__memory_aug_recurrent_mem_tr__mixer_gmlp__prompt_kernel_B_slow_vpw_ok:
sequential_preLN__memory_aug_recurrent_mem_tr__mixer_gmlp__prompt_kernel_B_slow_vpok:
    s_add_u32 s18, s18, 8192
    s_addc_u32 s19, s19, 0
    s_add_u32 s24, s24, 8192
    s_addc_u32 s25, s25, 0
    s_add_u32 s20, s20, 10368
    s_addc_u32 s21, s21, 0
    s_add_u32 s22, s22, 458752
    s_addc_u32 s23, s23, 0
    s_add_u32 s40, s40, 128
    s_addc_u32 s41, s41, 0
    s_add_u32 s12, s12, 1
    s_cmp_lt_u32 s12, 63
    s_cbranch_scc1 sequential_preLN__memory_aug_recurrent_mem_tr__mixer_gmlp__prompt_kernel_B_slow_loop
    s_cmp_lg_u32 s10, 0
    s_cbranch_scc1 sequential_preLN__memory_aug_recurrent_mem_tr__mixer_gmlp__prompt_kernel_B_slow_noinv
    buffer_inv sc1
sequential_preLN__memory_aug_recurrent_mem_tr__mixer_gmlp__prompt_kernel_B_slow_noinv:
    s_waitcnt vmcnt(0) lgkmcnt(0)
    s_barrier
    s_branch sequential_preLN__memory_aug_recurrent_mem_tr__mixer_gmlp__prompt_kernel_DL0
    s_endpgm
sequential_preLN__memory_aug_recurrent_mem_tr__mixer_gmlp__prompt_kernel_B_slow_restart:
    s_nop 15
    s_waitcnt vmcnt(0) lgkmcnt(0)
    s_barrier
    v_mov_b64 v[52:53], 0
    v_mov_b64 v[54:55], 0
    v_mov_b64 v[56:57], 0
    v_mov_b64 v[58:59], 0
    v_mov_b64 v[60:61], 0
    v_mov_b64 v[62:63], 0
    v_mov_b64 v[64:65], 0
    v_mov_b64 v[66:67], 0
    v_mov_b64 v[68:69], 0
    v_mov_b64 v[70:71], 0
    v_mov_b64 v[72:73], 0
    v_mov_b64 v[74:75], 0
    v_mov_b64 v[76:77], 0
    v_mov_b64 v[78:79], 0
    v_mov_b64 v[80:81], 0
    v_mov_b64 v[82:83], 0
    s_nop 0
    s_branch sequential_preLN__memory_aug_recurrent_mem_tr__mixer_gmlp__prompt_kernel_B_slow_loop
sequential_preLN__memory_aug_recurrent_mem_tr__mixer_gmlp__prompt_kernel_B_slow_abort:
sequential_preLN__memory_aug_recurrent_mem_tr__mixer_gmlp__prompt_kernel_B_slow_p_abort:
    s_endpgm
sequential_preLN__memory_aug_recurrent_mem_tr__mixer_gmlp__prompt_kernel_VP:
    v_lshlrev_b32 v1, 4, v1
    s_lshr_b32 s16, s9, 1
    s_and_b32 s17, s9, 1
    s_mul_i32 s14, s16, 28
    s_mul_i32 s15, s10, 7
    s_add_u32 s14, s14, s15
    s_mul_i32 s14, s14, 14336
    s_add_u32 s14, s14, 0xb00000
    s_add_u32 s20, s4, s14
    s_addc_u32 s21, s5, 0
    s_lshl_b32 s18, s16, 3
    s_lshl_b32 s19, s10, 1
    s_add_u32 s18, s18, s19
    s_add_u32 s18, s18, 128
    s_mov_b32 s13, 131072
    s_add_u32 s76, s4, 0x1580000
    s_addc_u32 s77, s5, 0
    v_mbcnt_lo_u32_b32 v24, -1, 0
    v_mbcnt_hi_u32_b32 v24, -1, v24
    v_and_b32 v25, 1, v24
    v_lshrrev_b32 v24, 1, v24
    v_and_b32 v24, 0, v24
    v_mul_u32_u24 v24, 0, v24
    v_add_u32 v24, v24, v25
    v_add_u32 v24, s18, v24
    v_lshlrev_b32 v24, 2, v24
    s_nop 1
sequential_preLN__memory_aug_recurrent_mem_tr__mixer_gmlp__prompt_kernel_VP_h_pw:
    global_load_dword v25, v24, s[76:77] sc1
    s_waitcnt vmcnt(0)
    v_cmp_ne_u32 vcc, s78, v25
    s_nop 0
    s_cbranch_vccz sequential_preLN__memory_aug_recurrent_mem_tr__mixer_gmlp__prompt_kernel_VP_h_pwok
    s_sleep 6
    s_sub_u32 s13, s13, 1
    s_cbranch_scc0 sequential_preLN__memory_aug_recurrent_mem_tr__mixer_gmlp__prompt_kernel_VP_h_pw
    s_endpgm
sequential_preLN__memory_aug_recurrent_mem_tr__mixer_gmlp__prompt_kernel_VP_h_pwok:
    s_mul_i32 s15, s10, 7168
    v_add_u32 v2, s15, v1
    v_add_u32 v3, 0x1000, v2
    s_mul_i32 s14, s17, 28672
    s_add_u32 s14, s14, 0x200000
    s_add_u32 s22, s4, s14
    s_addc_u32 s23, s5, 0
    s_add_u32 s24, s15, 0
    s_lshl_b32 s18, s17, 2
    s_mov_b32 s13, 131072
    s_add_u32 s76, s4, 0x1580000
    s_addc_u32 s77, s5, 0
    v_mbcnt_lo_u32_b32 v24, -1, 0
    v_mbcnt_hi_u32_b32 v24, -1, v24
    v_and_b32 v25, 3, v24
    v_lshrrev_b32 v24, 2, v24
    v_and_b32 v24, 0, v24
    v_mul_u32_u24 v24, 0, v24
    v_add_u32 v24, v24, v25
    v_add_u32 v24, s18, v24
    v_lshlrev_b32 v24, 2, v24
    s_nop 1
sequential_preLN__memory_aug_recurrent_mem_tr__mixer_gmlp__prompt_kernel_VP_x_pw:
    global_load_dword v25, v24, s[76:77] sc1
    s_waitcnt vmcnt(0)
    v_cmp_ne_u32 vcc, s78, v25
    s_nop 0
    s_cbranch_vccz sequential_preLN__memory_aug_recurrent_mem_tr__mixer_gmlp__prompt_kernel_VP_x_pwok
    s_sleep 6
    s_sub_u32 s13, s13, 1
    s_cbranch_scc0 sequential_preLN__memory_aug_recurrent_mem_tr__mixer_gmlp__prompt_kernel_VP_x_pw
    s_endpgm
sequential_preLN__memory_aug_recurrent_mem_tr__mixer_gmlp__prompt_kernel_VP_x_pwok:
    global_load_dwordx4 v[24:27], v2, s[22:23] offset:0 sc1
    global_load_dwordx4 v[28:31], v2, s[22:23] offset:1024 sc1
    global_load_dwordx4 v[32:35], v2, s[22:23] offset:2048 sc1
    global_load_dwordx4 v[36:39], v2, s[22:23] offset:3072 sc1
    global_load_dwordx4 v[40:43], v3, s[22:23] offset:0 sc1
    global_load_dwordx4 v[44:47], v3, s[22:23] offset:1024 sc1
    global_load_dwordx4 v[48:51], v3, s[22:23] offset:2048 sc1
    s_add_u32 s60, s20, 0
    s_addc_u32 s61, s21, 0
    global_load_dwordx4 v[120:123], v1, s[60:61] offset:0 sc1
    global_load_dwordx4 v[124:127], v1, s[60:61] offset:1024 sc1
    s_add_u32 s60, s20, 14336
    s_addc_u32 s61, s21, 0
    global_load_dwordx4 v[176:179], v1, s[60:61] offset:0 sc1
    global_load_dwordx4 v[180:183], v1, s[60:61] offset:1024 sc1
    s_add_u32 s60, s20, 28672
    s_addc_u32 s61, s21, 0
    global_load_dwordx4 v[232:235], v1, s[60:61] offset:0 sc1
    global_load_dwordx4 v[236:239], v1, s[60:61] offset:1024 sc1
    s_add_u32 s60, s20, 43008
    s_addc_u32 s61, s21, 0
    global_load_dwordx4 a[32:35], v1, s[60:61] offset:0 sc1
    global_load_dwordx4 a[36:39], v1, s[60:61] offset:1024 sc1
    s_add_u32 s60, s20, 57344
    s_addc_u32 s61, s21, 0
    global_load_dwordx4 a[88:91], v1, s[60:61] offset:0 sc1
    global_load_dwordx4 a[92:95], v1, s[60:61] offset:1024 sc1
    s_add_u32 s60, s20, 71680
    s_addc_u32 s61, s21, 0
    global_load_dwordx4 a[144:147], v1, s[60:61] offset:0 sc1
    global_load_dwordx4 a[148:151], v1, s[60:61] offset:1024 sc1
    s_add_u32 s60, s20, 86016
    s_addc_u32 s61, s21, 0
    global_load_dwordx4 a[200:203], v1, s[60:61] offset:0 sc1
    global_load_dwordx4 a[204:207], v1, s[60:61] offset:1024 sc1
    s_add_u32 s60, s20, 2048
    s_addc_u32 s61, s21, 0
    global_load_dwordx4 v[128:131], v1, s[60:61] offset:0 sc1
    global_load_dwordx4 v[132:135], v1, s[60:61] offset:1024 sc1
    s_add_u32 s60, s20, 16384
    s_addc_u32 s61, s21, 0
    global_load_dwordx4 v[184:187], v1, s[60:61] offset:0 sc1
    global_load_dwordx4 v[188:191], v1, s[60:61] offset:1024 sc1
    s_add_u32 s60, s20, 30720
    s_addc_u32 s61, s21, 0
    global_load_dwordx4 v[240:243], v1, s[60:61] offset:0 sc1
    global_load_dwordx4 v[244:247], v1, s[60:61] offset:1024 sc1
    s_add_u32 s60, s20, 45056
    s_addc_u32 s61, s21, 0
    global_load_dwordx4 a[40:43], v1, s[60:61] offset:0 sc1
    global_load_dwordx4 a[44:47], v1, s[60:61] offset:1024 sc1
    s_add_u32 s60, s20, 59392
    s_addc_u32 s61, s21, 0
    global_load_dwordx4 a[96:99], v1, s[60:61] offset:0 sc1
    global_load_dwordx4 a[100:103], v1, s[60:61] offset:1024 sc1
    s_add_u32 s60, s20, 73728
    s_addc_u32 s61, s21, 0
    global_load_dwordx4 a[152:155], v1, s[60:61] offset:0 sc1
    global_load_dwordx4 a[156:159], v1, s[60:61] offset:1024 sc1
    s_add_u32 s60, s20, 88064
    s_addc_u32 s61, s21, 0
    global_load_dwordx4 a[208:211], v1, s[60:61] offset:0 sc1
    global_load_dwordx4 a[212:215], v1, s[60:61] offset:1024 sc1
    s_add_u32 s60, s20, 4096
    s_addc_u32 s61, s21, 0
    global_load_dwordx4 v[136:139], v1, s[60:61] offset:0 sc1
    global_load_dwordx4 v[140:143], v1, s[60:61] offset:1024 sc1
    s_add_u32 s60, s20, 18432
    s_addc_u32 s61, s21, 0
    global_load_dwordx4 v[192:195], v1, s[60:61] offset:0 sc1
    global_load_dwordx4 v[196:199], v1, s[60:61] offset:1024 sc1
    s_add_u32 s60, s20, 32768
    s_addc_u32 s61, s21, 0
    global_load_dwordx4 v[248:251], v1, s[60:61] offset:0 sc1
    global_load_dwordx4 v[252:255], v1, s[60:61] offset:1024 sc1
    s_add_u32 s60, s20, 47104
    s_addc_u32 s61, s21, 0
    global_load_dwordx4 a[48:51], v1, s[60:61] offset:0 sc1
    global_load_dwordx4 a[52:55], v1, s[60:61] offset:1024 sc1
    s_add_u32 s60, s20, 61440
    s_addc_u32 s61, s21, 0
    global_load_dwordx4 a[104:107], v1, s[60:61] offset:0 sc1
    global_load_dwordx4 a[108:111], v1, s[60:61] offset:1024 sc1
    s_add_u32 s60, s20, 75776
    s_addc_u32 s61, s21, 0
    global_load_dwordx4 a[160:163], v1, s[60:61] offset:0 sc1
    global_load_dwordx4 a[164:167], v1, s[60:61] offset:1024 sc1
    s_add_u32 s60, s20, 90112
    s_addc_u32 s61, s21, 0
    global_load_dwordx4 a[216:219], v1, s[60:61] offset:0 sc1
    global_load_dwordx4 a[220:223], v1, s[60:61] offset:1024 sc1
    s_waitcnt vmcnt(28)
    s_add_u32 s60, s20, 6144
    s_addc_u32 s61, s21, 0
    global_load_dwordx4 v[144:147], v1, s[60:61] offset:0 sc1
    global_load_dwordx4 v[148:151], v1, s[60:61] offset:1024 sc1
    s_add_u32 s60, s20, 20480
    s_addc_u32 s61, s21, 0
    global_load_dwordx4 v[200:203], v1, s[60:61] offset:0 sc1
    global_load_dwordx4 v[204:207], v1, s[60:61] offset:1024 sc1
    s_add_u32 s60, s20, 34816
    s_addc_u32 s61, s21, 0
    global_load_dwordx4 a[0:3], v1, s[60:61] offset:0 sc1
    global_load_dwordx4 a[4:7], v1, s[60:61] offset:1024 sc1
    s_add_u32 s60, s20, 49152
    s_addc_u32 s61, s21, 0
    global_load_dwordx4 a[56:59], v1, s[60:61] offset:0 sc1
    global_load_dwordx4 a[60:63], v1, s[60:61] offset:1024 sc1
    s_add_u32 s60, s20, 63488
    s_addc_u32 s61, s21, 0
    global_load_dwordx4 a[112:115], v1, s[60:61] offset:0 sc1
    global_load_dwordx4 a[116:119], v1, s[60:61] offset:1024 sc1
    s_add_u32 s60, s20, 77824
    s_addc_u32 s61, s21, 0
    global_load_dwordx4 a[168:171], v1, s[60:61] offset:0 sc1
    global_load_dwordx4 a[172:175], v1, s[60:61] offset:1024 sc1
    s_add_u32 s60, s20, 92160
    s_addc_u32 s61, s21, 0
    global_load_dwordx4 a[224:227], v1, s[60:61] offset:0 sc1
    global_load_dwordx4 a[228:231], v1, s[60:61] offset:1024 sc1
    s_add_u32 s60, s20, 8192
    s_addc_u32 s61, s21, 0
    global_load_dwordx4 v[152:155], v1, s[60:61] offset:0 sc1
    global_load_dwordx4 v[156:159], v1, s[60:61] offset:1024 sc1
    s_add_u32 s60, s20, 22528
    s_addc_u32 s61, s21, 0
    global_load_dwordx4 v[208:211], v1, s[60:61] offset:0 sc1
    global_load_dwordx4 v[212:215], v1, s[60:61] offset:1024 sc1
    s_add_u32 s60, s20, 36864
    s_addc_u32 s61, s21, 0
    global_load_dwordx4 a[8:11], v1, s[60:61] offset:0 sc1
    global_load_dwordx4 a[12:15], v1, s[60:61] offset:1024 sc1
    s_add_u32 s60, s20, 51200
    s_addc_u32 s61, s21, 0
    global_load_dwordx4 a[64:67], v1, s[60:61] offset:0 sc1
    global_load_dwordx4 a[68:71], v1, s[60:61] offset:1024 sc1
    s_add_u32 s60, s20, 65536
    s_addc_u32 s61, s21, 0
    global_load_dwordx4 a[120:123], v1, s[60:61] offset:0 sc1
    global_load_dwordx4 a[124:127], v1, s[60:61] offset:1024 sc1
    s_add_u32 s60, s20, 79872
    s_addc_u32 s61, s21, 0
    global_load_dwordx4 a[176:179], v1, s[60:61] offset:0 sc1
    global_load_dwordx4 a[180:183], v1, s[60:61] offset:1024 sc1
    s_add_u32 s60, s20, 94208
    s_addc_u32 s61, s21, 0
    global_load_dwordx4 a[232:235], v1, s[60:61] offset:0 sc1
    global_load_dwordx4 a[236:239], v1, s[60:61] offset:1024 sc1
    s_waitcnt vmcnt(28)
    s_add_u32 s60, s20, 10240
    s_addc_u32 s61, s21, 0
    global_load_dwordx4 v[160:163], v1, s[60:61] offset:0 sc1
    global_load_dwordx4 v[164:167], v1, s[60:61] offset:1024 sc1
    s_add_u32 s60, s20, 24576
    s_addc_u32 s61, s21, 0
    global_load_dwordx4 v[216:219], v1, s[60:61] offset:0 sc1
    global_load_dwordx4 v[220:223], v1, s[60:61] offset:1024 sc1
    s_add_u32 s60, s20, 38912
    s_addc_u32 s61, s21, 0
    global_load_dwordx4 a[16:19], v1, s[60:61] offset:0 sc1
    global_load_dwordx4 a[20:23], v1, s[60:61] offset:1024 sc1
    s_add_u32 s60, s20, 53248
    s_addc_u32 s61, s21, 0
    global_load_dwordx4 a[72:75], v1, s[60:61] offset:0 sc1
    global_load_dwordx4 a[76:79], v1, s[60:61] offset:1024 sc1
    s_add_u32 s60, s20, 67584
    s_addc_u32 s61, s21, 0
    global_load_dwordx4 a[128:131], v1, s[60:61] offset:0 sc1
    global_load_dwordx4 a[132:135], v1, s[60:61] offset:1024 sc1
    s_add_u32 s60, s20, 81920
    s_addc_u32 s61, s21, 0
    global_load_dwordx4 a[184:187], v1, s[60:61] offset:0 sc1
    global_load_dwordx4 a[188:191], v1, s[60:61] offset:1024 sc1
    s_add_u32 s60, s20, 96256
    s_addc_u32 s61, s21, 0
    global_load_dwordx4 a[240:243], v1, s[60:61] offset:0 sc1
    global_load_dwordx4 a[244:247], v1, s[60:61] offset:1024 sc1
    s_add_u32 s60, s20, 12288
    s_addc_u32 s61, s21, 0
    global_load_dwordx4 v[168:171], v1, s[60:61] offset:0 sc1
    global_load_dwordx4 v[172:175], v1, s[60:61] offset:1024 sc1
    s_add_u32 s60, s20, 26624
    s_addc_u32 s61, s21, 0
    global_load_dwordx4 v[224:227], v1, s[60:61] offset:0 sc1
    global_load_dwordx4 v[228:231], v1, s[60:61] offset:1024 sc1
    s_add_u32 s60, s20, 40960
    s_addc_u32 s61, s21, 0
    global_load_dwordx4 a[24:27], v1, s[60:61] offset:0 sc1
    global_load_dwordx4 a[28:31], v1, s[60:61] offset:1024 sc1
    s_add_u32 s60, s20, 55296
    s_addc_u32 s61, s21, 0
    global_load_dwordx4 a[80:83], v1, s[60:61] offset:0 sc1
    global_load_dwordx4 a[84:87], v1, s[60:61] offset:1024 sc1
    s_add_u32 s60, s20, 69632
    s_addc_u32 s61, s21, 0
    global_load_dwordx4 a[136:139], v1, s[60:61] offset:0 sc1
    global_load_dwordx4 a[140:143], v1, s[60:61] offset:1024 sc1
    s_add_u32 s60, s20, 83968
    s_addc_u32 s61, s21, 0
    global_load_dwordx4 a[192:195], v1, s[60:61] offset:0 sc1
    global_load_dwordx4 a[196:199], v1, s[60:61] offset:1024 sc1
    s_add_u32 s60, s20, 98304
    s_addc_u32 s61, s21, 0
    global_load_dwordx4 a[248:251], v1, s[60:61] offset:0 sc1
    global_load_dwordx4 a[252:255], v1, s[60:61] offset:1024 sc1
    ds_write_b128 v2, v[24:27] offset:0
    ds_write_b128 v2, v[28:31] offset:1024
    ds_write_b128 v2, v[32:35] offset:2048
    ds_write_b128 v2, v[36:39] offset:3072
    ds_write_b128 v3, v[40:43] offset:0
    ds_write_b128 v3, v[44:47] offset:1024
    ds_write_b128 v3, v[48:51] offset:2048
    s_waitcnt lgkmcnt(0)
    v_add_u32 v4, 0, v1
    s_lshl_b32 s14, s17, 4
    s_add_u32 s14, s14, s16
    s_mul_i32 s14, s14, 28
    s_mul_i32 s15, s10, 7
    s_add_u32 s14, s14, s15
    s_lshl_b32 s14, s14, 10
    s_add_u32 s14, s14, 0x2000000
    s_add_u32 s26, s4, s14
    s_addc_u32 s27, s5, 0
    s_lshl_b32 s14, s17, 7
    s_add_u32 s14, s14, 0x1500000
    s_add_u32 s28, s4, s14
    s_addc_u32 s29, s5, 0
    v_mov_b32 v5, 0
    v_mov_b32 v6, 1
    v_add_u32 v7, 0x1000, v1
    s_mov_b32 s30, 0
    s_waitcnt vmcnt(56)
    s_barrier
    s_add_u32 s22, s22, 57344
    s_addc_u32 s23, s23, 0
    ds_read_b128 v[80:83], v4 offset:0
    ds_read_b128 v[84:87], v4 offset:1024
    ds_read_b128 v[88:91], v4 offset:2048
    ds_read_b128 v[92:95], v4 offset:3072
    s_waitcnt lgkmcnt(2)
    v_mfma_f32_16x16x32_bf16 v[24:27], v[80:83], v[120:123], 0
    v_mfma_f32_16x16x32_bf16 v[52:55], v[84:87], v[120:123], 0
    ds_read_b128 v[96:99], v4 offset:4096
    ds_read_b128 v[100:103], v4 offset:5120
    v_mfma_f32_16x16x32_bf16 v[28:31], v[80:83], v[176:179], 0
    v_mfma_f32_16x16x32_bf16 v[56:59], v[84:87], v[176:179], 0
    v_mfma_f32_16x16x32_bf16 v[32:35], v[80:83], v[232:235], 0
    v_mfma_f32_16x16x32_bf16 v[60:63], v[84:87], v[232:235], 0
    v_mfma_f32_16x16x32_bf16 v[36:39], v[80:83], a[32:35], 0
    v_mfma_f32_16x16x32_bf16 v[64:67], v[84:87], a[32:35], 0
    v_mfma_f32_16x16x32_bf16 v[40:43], v[80:83], a[88:91], 0
    v_mfma_f32_16x16x32_bf16 v[68:71], v[84:87], a[88:91], 0
    v_mfma_f32_16x16x32_bf16 v[44:47], v[80:83], a[144:147], 0
    v_mfma_f32_16x16x32_bf16 v[72:75], v[84:87], a[144:147], 0
    v_mfma_f32_16x16x32_bf16 v[48:51], v[80:83], a[200:203], 0
    v_mfma_f32_16x16x32_bf16 v[76:79], v[84:87], a[200:203], 0
    s_waitcnt lgkmcnt(2)
    v_mfma_f32_16x16x32_bf16 v[24:27], v[88:91], v[124:127], v[24:27]
    v_mfma_f32_16x16x32_bf16 v[52:55], v[92:95], v[124:127], v[52:55]
    ds_read_b128 v[80:83], v4 offset:6144
    ds_read_b128 v[84:87], v4 offset:7168
    v_mfma_f32_16x16x32_bf16 v[28:31], v[88:91], v[180:183], v[28:31]
    v_mfma_f32_16x16x32_bf16 v[56:59], v[92:95], v[180:183], v[56:59]
    v_mfma_f32_16x16x32_bf16 v[32:35], v[88:91], v[236:239], v[32:35]
    v_mfma_f32_16x16x32_bf16 v[60:63], v[92:95], v[236:239], v[60:63]
    v_mfma_f32_16x16x32_bf16 v[36:39], v[88:91], a[36:39], v[36:39]
    v_mfma_f32_16x16x32_bf16 v[64:67], v[92:95], a[36:39], v[64:67]
    v_mfma_f32_16x16x32_bf16 v[40:43], v[88:91], a[92:95], v[40:43]
    v_mfma_f32_16x16x32_bf16 v[68:71], v[92:95], a[92:95], v[68:71]
    v_mfma_f32_16x16x32_bf16 v[44:47], v[88:91], a[148:151], v[44:47]
    v_mfma_f32_16x16x32_bf16 v[72:75], v[92:95], a[148:151], v[72:75]
    v_mfma_f32_16x16x32_bf16 v[48:51], v[88:91], a[204:207], v[48:51]
    v_mfma_f32_16x16x32_bf16 v[76:79], v[92:95], a[204:207], v[76:79]
    s_waitcnt lgkmcnt(2)
    v_mfma_f32_16x16x32_bf16 v[24:27], v[96:99], v[128:131], v[24:27]
    v_mfma_f32_16x16x32_bf16 v[52:55], v[100:103], v[128:131], v[52:55]
    ds_read_b128 v[88:91], v4 offset:8192
    ds_read_b128 v[92:95], v4 offset:9216
    v_mfma_f32_16x16x32_bf16 v[28:31], v[96:99], v[184:187], v[28:31]
    v_mfma_f32_16x16x32_bf16 v[56:59], v[100:103], v[184:187], v[56:59]
    v_mfma_f32_16x16x32_bf16 v[32:35], v[96:99], v[240:243], v[32:35]
    v_mfma_f32_16x16x32_bf16 v[60:63], v[100:103], v[240:243], v[60:63]
    v_mfma_f32_16x16x32_bf16 v[36:39], v[96:99], a[40:43], v[36:39]
    v_mfma_f32_16x16x32_bf16 v[64:67], v[100:103], a[40:43], v[64:67]
    v_mfma_f32_16x16x32_bf16 v[40:43], v[96:99], a[96:99], v[40:43]
    v_mfma_f32_16x16x32_bf16 v[68:71], v[100:103], a[96:99], v[68:71]
    v_mfma_f32_16x16x32_bf16 v[44:47], v[96:99], a[152:155], v[44:47]
    v_mfma_f32_16x16x32_bf16 v[72:75], v[100:103], a[152:155], v[72:75]
    v_mfma_f32_16x16x32_bf16 v[48:51], v[96:99], a[208:211], v[48:51]
    v_mfma_f32_16x16x32_bf16 v[76:79], v[100:103], a[208:211], v[76:79]
    s_waitcnt lgkmcnt(2)
    v_mfma_f32_16x16x32_bf16 v[24:27], v[80:83], v[132:135], v[24:27]
    v_mfma_f32_16x16x32_bf16 v[52:55], v[84:87], v[132:135], v[52:55]
    ds_read_b128 v[96:99], v4 offset:10240
    ds_read_b128 v[100:103], v4 offset:11264
    v_mfma_f32_16x16x32_bf16 v[28:31], v[80:83], v[188:191], v[28:31]
    v_mfma_f32_16x16x32_bf16 v[56:59], v[84:87], v[188:191], v[56:59]
    v_mfma_f32_16x16x32_bf16 v[32:35], v[80:83], v[244:247], v[32:35]
    v_mfma_f32_16x16x32_bf16 v[60:63], v[84:87], v[244:247], v[60:63]
    v_mfma_f32_16x16x32_bf16 v[36:39], v[80:83], a[44:47], v[36:39]
    v_mfma_f32_16x16x32_bf16 v[64:67], v[84:87], a[44:47], v[64:67]
    v_mfma_f32_16x16x32_bf16 v[40:43], v[80:83], a[100:103], v[40:43]
    v_mfma_f32_16x16x32_bf16 v[68:71], v[84:87], a[100:103], v[68:71]
    v_mfma_f32_16x16x32_bf16 v[44:47], v[80:83], a[156:159], v[44:47]
    v_mfma_f32_16x16x32_bf16 v[72:75], v[84:87], a[156:159], v[72:75]
    v_mfma_f32_16x16x32_bf16 v[48:51], v[80:83], a[212:215], v[48:51]
    v_mfma_f32_16x16x32_bf16 v[76:79], v[84:87], a[212:215], v[76:79]
    s_waitcnt lgkmcnt(2)
    v_mfma_f32_16x16x32_bf16 v[24:27], v[88:91], v[136:139], v[24:27]
    v_mfma_f32_16x16x32_bf16 v[52:55], v[92:95], v[136:139], v[52:55]
    ds_read_b128 v[80:83], v4 offset:12288
    ds_read_b128 v[84:87], v4 offset:13312
    v_mfma_f32_16x16x32_bf16 v[28:31], v[88:91], v[192:195], v[28:31]
    v_mfma_f32_16x16x32_bf16 v[56:59], v[92:95], v[192:195], v[56:59]
    v_mfma_f32_16x16x32_bf16 v[32:35], v[88:91], v[248:251], v[32:35]
    v_mfma_f32_16x16x32_bf16 v[60:63], v[92:95], v[248:251], v[60:63]
    v_mfma_f32_16x16x32_bf16 v[36:39], v[88:91], a[48:51], v[36:39]
    v_mfma_f32_16x16x32_bf16 v[64:67], v[92:95], a[48:51], v[64:67]
    v_mfma_f32_16x16x32_bf16 v[40:43], v[88:91], a[104:107], v[40:43]
    v_mfma_f32_16x16x32_bf16 v[68:71], v[92:95], a[104:107], v[68:71]
    v_mfma_f32_16x16x32_bf16 v[44:47], v[88:91], a[160:163], v[44:47]
    v_mfma_f32_16x16x32_bf16 v[72:75], v[92:95], a[160:163], v[72:75]
    v_mfma_f32_16x16x32_bf16 v[48:51], v[88:91], a[216:219], v[48:51]
    v_mfma_f32_16x16x32_bf16 v[76:79], v[92:95], a[216:219], v[76:79]
    s_waitcnt lgkmcnt(2)
    v_mfma_f32_16x16x32_bf16 v[24:27], v[96:99], v[140:143], v[24:27]
    v_mfma_f32_16x16x32_bf16 v[52:55], v[100:103], v[140:143], v[52:55]
    ds_read_b128 v[88:91], v4 offset:14336
    ds_read_b128 v[92:95], v4 offset:15360
    v_mfma_f32_16x16x32_bf16 v[28:31], v[96:99], v[196:199], v[28:31]
    v_mfma_f32_16x16x32_bf16 v[56:59], v[100:103], v[196:199], v[56:59]
    v_mfma_f32_16x16x32_bf16 v[32:35], v[96:99], v[252:255], v[32:35]
    v_mfma_f32_16x16x32_bf16 v[60:63], v[100:103], v[252:255], v[60:63]
    v_mfma_f32_16x16x32_bf16 v[36:39], v[96:99], a[52:55], v[36:39]
    v_mfma_f32_16x16x32_bf16 v[64:67], v[100:103], a[52:55], v[64:67]
    v_mfma_f32_16x16x32_bf16 v[40:43], v[96:99], a[108:111], v[40:43]
    v_mfma_f32_16x16x32_bf16 v[68:71], v[100:103], a[108:111], v[68:71]
    v_mfma_f32_16x16x32_bf16 v[44:47], v[96:99], a[164:167], v[44:47]
    v_mfma_f32_16x16x32_bf16 v[72:75], v[100:103], a[164:167], v[72:75]
    v_mfma_f32_16x16x32_bf16 v[48:51], v[96:99], a[220:223], v[48:51]
    v_mfma_f32_16x16x32_bf16 v[76:79], v[100:103], a[220:223], v[76:79]
    s_waitcnt lgkmcnt(2)
    s_waitcnt vmcnt(42)
    v_mfma_f32_16x16x32_bf16 v[24:27], v[80:83], v[144:147], v[24:27]
    v_mfma_f32_16x16x32_bf16 v[52:55], v[84:87], v[144:147], v[52:55]
    ds_read_b128 v[96:99], v4 offset:16384
    ds_read_b128 v[100:103], v4 offset:17408
    v_mfma_f32_16x16x32_bf16 v[28:31], v[80:83], v[200:203], v[28:31]
    v_mfma_f32_16x16x32_bf16 v[56:59], v[84:87], v[200:203], v[56:59]
    v_mfma_f32_16x16x32_bf16 v[32:35], v[80:83], a[0:3], v[32:35]
    v_mfma_f32_16x16x32_bf16 v[60:63], v[84:87], a[0:3], v[60:63]
    v_mfma_f32_16x16x32_bf16 v[36:39], v[80:83], a[56:59], v[36:39]
    v_mfma_f32_16x16x32_bf16 v[64:67], v[84:87], a[56:59], v[64:67]
    v_mfma_f32_16x16x32_bf16 v[40:43], v[80:83], a[112:115], v[40:43]
    v_mfma_f32_16x16x32_bf16 v[68:71], v[84:87], a[112:115], v[68:71]
    v_mfma_f32_16x16x32_bf16 v[44:47], v[80:83], a[168:171], v[44:47]
    v_mfma_f32_16x16x32_bf16 v[72:75], v[84:87], a[168:171], v[72:75]
    v_mfma_f32_16x16x32_bf16 v[48:51], v[80:83], a[224:227], v[48:51]
    v_mfma_f32_16x16x32_bf16 v[76:79], v[84:87], a[224:227], v[76:79]
    s_waitcnt lgkmcnt(2)
    v_mfma_f32_16x16x32_bf16 v[24:27], v[88:91], v[148:151], v[24:27]
    v_mfma_f32_16x16x32_bf16 v[52:55], v[92:95], v[148:151], v[52:55]
    ds_read_b128 v[80:83], v4 offset:18432
    ds_read_b128 v[84:87], v4 offset:19456
    v_mfma_f32_16x16x32_bf16 v[28:31], v[88:91], v[204:207], v[28:31]
    v_mfma_f32_16x16x32_bf16 v[56:59], v[92:95], v[204:207], v[56:59]
    v_mfma_f32_16x16x32_bf16 v[32:35], v[88:91], a[4:7], v[32:35]
    v_mfma_f32_16x16x32_bf16 v[60:63], v[92:95], a[4:7], v[60:63]
    v_mfma_f32_16x16x32_bf16 v[36:39], v[88:91], a[60:63], v[36:39]
    v_mfma_f32_16x16x32_bf16 v[64:67], v[92:95], a[60:63], v[64:67]
    v_mfma_f32_16x16x32_bf16 v[40:43], v[88:91], a[116:119], v[40:43]
    v_mfma_f32_16x16x32_bf16 v[68:71], v[92:95], a[116:119], v[68:71]
    v_mfma_f32_16x16x32_bf16 v[44:47], v[88:91], a[172:175], v[44:47]
    v_mfma_f32_16x16x32_bf16 v[72:75], v[92:95], a[172:175], v[72:75]
    v_mfma_f32_16x16x32_bf16 v[48:51], v[88:91], a[228:231], v[48:51]
    v_mfma_f32_16x16x32_bf16 v[76:79], v[92:95], a[228:231], v[76:79]
    s_waitcnt lgkmcnt(2)
    s_waitcnt vmcnt(28)
    v_mfma_f32_16x16x32_bf16 v[24:27], v[96:99], v[152:155], v[24:27]
    v_mfma_f32_16x16x32_bf16 v[52:55], v[100:103], v[152:155], v[52:55]
    ds_read_b128 v[88:91], v4 offset:20480
    ds_read_b128 v[92:95], v4 offset:21504
    v_mfma_f32_16x16x32_bf16 v[28:31], v[96:99], v[208:211], v[28:31]
    v_mfma_f32_16x16x32_bf16 v[56:59], v[100:103], v[208:211], v[56:59]
    v_mfma_f32_16x16x32_bf16 v[32:35], v[96:99], a[8:11], v[32:35]
    v_mfma_f32_16x16x32_bf16 v[60:63], v[100:103], a[8:11], v[60:63]
    v_mfma_f32_16x16x32_bf16 v[36:39], v[96:99], a[64:67], v[36:39]
    v_mfma_f32_16x16x32_bf16 v[64:67], v[100:103], a[64:67], v[64:67]
    v_mfma_f32_16x16x32_bf16 v[40:43], v[96:99], a[120:123], v[40:43]
    v_mfma_f32_16x16x32_bf16 v[68:71], v[100:103], a[120:123], v[68:71]
    v_mfma_f32_16x16x32_bf16 v[44:47], v[96:99], a[176:179], v[44:47]
    v_mfma_f32_16x16x32_bf16 v[72:75], v[100:103], a[176:179], v[72:75]
    v_mfma_f32_16x16x32_bf16 v[48:51], v[96:99], a[232:235], v[48:51]
    v_mfma_f32_16x16x32_bf16 v[76:79], v[100:103], a[232:235], v[76:79]
    s_waitcnt lgkmcnt(2)
    v_mfma_f32_16x16x32_bf16 v[24:27], v[80:83], v[156:159], v[24:27]
    v_mfma_f32_16x16x32_bf16 v[52:55], v[84:87], v[156:159], v[52:55]
    ds_read_b128 v[96:99], v4 offset:22528
    ds_read_b128 v[100:103], v4 offset:23552
    v_mfma_f32_16x16x32_bf16 v[28:31], v[80:83], v[212:215], v[28:31]
    v_mfma_f32_16x16x32_bf16 v[56:59], v[84:87], v[212:215], v[56:59]
    v_mfma_f32_16x16x32_bf16 v[32:35], v[80:83], a[12:15], v[32:35]
    v_mfma_f32_16x16x32_bf16 v[60:63], v[84:87], a[12:15], v[60:63]
    v_mfma_f32_16x16x32_bf16 v[36:39], v[80:83], a[68:71], v[36:39]
    v_mfma_f32_16x16x32_bf16 v[64:67], v[84:87], a[68:71], v[64:67]
    v_mfma_f32_16x16x32_bf16 v[40:43], v[80:83], a[124:127], v[40:43]
    v_mfma_f32_16x16x32_bf16 v[68:71], v[84:87], a[124:127], v[68:71]
    v_mfma_f32_16x16x32_bf16 v[44:47], v[80:83], a[180:183], v[44:47]
    v_mfma_f32_16x16x32_bf16 v[72:75], v[84:87], a[180:183], v[72:75]
    v_mfma_f32_16x16x32_bf16 v[48:51], v[80:83], a[236:239], v[48:51]
    v_mfma_f32_16x16x32_bf16 v[76:79], v[84:87], a[236:239], v[76:79]
    s_waitcnt lgkmcnt(2)
    s_waitcnt vmcnt(14)
    v_mfma_f32_16x16x32_bf16 v[24:27], v[88:91], v[160:163], v[24:27]
    v_mfma_f32_16x16x32_bf16 v[52:55], v[92:95], v[160:163], v[52:55]
    ds_read_b128 v[80:83], v4 offset:24576
    ds_read_b128 v[84:87], v4 offset:25600
    v_mfma_f32_16x16x32_bf16 v[28:31], v[88:91], v[216:219], v[28:31]
    v_mfma_f32_16x16x32_bf16 v[56:59], v[92:95], v[216:219], v[56:59]
    v_mfma_f32_16x16x32_bf16 v[32:35], v[88:91], a[16:19], v[32:35]
    v_mfma_f32_16x16x32_bf16 v[60:63], v[92:95], a[16:19], v[60:63]
    v_mfma_f32_16x16x32_bf16 v[36:39], v[88:91], a[72:75], v[36:39]
    v_mfma_f32_16x16x32_bf16 v[64:67], v[92:95], a[72:75], v[64:67]
    v_mfma_f32_16x16x32_bf16 v[40:43], v[88:91], a[128:131], v[40:43]
    v_mfma_f32_16x16x32_bf16 v[68:71], v[92:95], a[128:131], v[68:71]
    v_mfma_f32_16x16x32_bf16 v[44:47], v[88:91], a[184:187], v[44:47]
    v_mfma_f32_16x16x32_bf16 v[72:75], v[92:95], a[184:187], v[72:75]
    v_mfma_f32_16x16x32_bf16 v[48:51], v[88:91], a[240:243], v[48:51]
    v_mfma_f32_16x16x32_bf16 v[76:79], v[92:95], a[240:243], v[76:79]
    s_waitcnt lgkmcnt(2)
    v_mfma_f32_16x16x32_bf16 v[24:27], v[96:99], v[164:167], v[24:27]
    v_mfma_f32_16x16x32_bf16 v[52:55], v[100:103], v[164:167], v[52:55]
    ds_read_b128 v[88:91], v4 offset:26624
    ds_read_b128 v[92:95], v4 offset:27648
    v_mfma_f32_16x16x32_bf16 v[28:31], v[96:99], v[220:223], v[28:31]
    v_mfma_f32_16x16x32_bf16 v[56:59], v[100:103], v[220:223], v[56:59]
    v_mfma_f32_16x16x32_bf16 v[32:35], v[96:99], a[20:23], v[32:35]
    v_mfma_f32_16x16x32_bf16 v[60:63], v[100:103], a[20:23], v[60:63]
    v_mfma_f32_16x16x32_bf16 v[36:39], v[96:99], a[76:79], v[36:39]
    v_mfma_f32_16x16x32_bf16 v[64:67], v[100:103], a[76:79], v[64:67]
    v_mfma_f32_16x16x32_bf16 v[40:43], v[96:99], a[132:135], v[40:43]
    v_mfma_f32_16x16x32_bf16 v[68:71], v[100:103], a[132:135], v[68:71]
    v_mfma_f32_16x16x32_bf16 v[44:47], v[96:99], a[188:191], v[44:47]
    v_mfma_f32_16x16x32_bf16 v[72:75], v[100:103], a[188:191], v[72:75]
    v_mfma_f32_16x16x32_bf16 v[48:51], v[96:99], a[244:247], v[48:51]
    v_mfma_f32_16x16x32_bf16 v[76:79], v[100:103], a[244:247], v[76:79]
    s_waitcnt lgkmcnt(2)
    s_waitcnt vmcnt(0)
    v_mfma_f32_16x16x32_bf16 v[24:27], v[80:83], v[168:171], v[24:27]
    v_mfma_f32_16x16x32_bf16 v[52:55], v[84:87], v[168:171], v[52:55]
    v_mfma_f32_16x16x32_bf16 v[28:31], v[80:83], v[224:227], v[28:31]
    v_mfma_f32_16x16x32_bf16 v[56:59], v[84:87], v[224:227], v[56:59]
    v_mfma_f32_16x16x32_bf16 v[32:35], v[80:83], a[24:27], v[32:35]
    v_mfma_f32_16x16x32_bf16 v[60:63], v[84:87], a[24:27], v[60:63]
    v_mfma_f32_16x16x32_bf16 v[36:39], v[80:83], a[80:83], v[36:39]
    v_mfma_f32_16x16x32_bf16 v[64:67], v[84:87], a[80:83], v[64:67]
    v_mfma_f32_16x16x32_bf16 v[40:43], v[80:83], a[136:139], v[40:43]
    v_mfma_f32_16x16x32_bf16 v[68:71], v[84:87], a[136:139], v[68:71]
    v_mfma_f32_16x16x32_bf16 v[44:47], v[80:83], a[192:195], v[44:47]
    v_mfma_f32_16x16x32_bf16 v[72:75], v[84:87], a[192:195], v[72:75]
    v_mfma_f32_16x16x32_bf16 v[48:51], v[80:83], a[248:251], v[48:51]
    v_mfma_f32_16x16x32_bf16 v[76:79], v[84:87], a[248:251], v[76:79]
    s_waitcnt lgkmcnt(0)
    v_mfma_f32_16x16x32_bf16 v[24:27], v[88:91], v[172:175], v[24:27]
    v_mfma_f32_16x16x32_bf16 v[52:55], v[92:95], v[172:175], v[52:55]
    v_mfma_f32_16x16x32_bf16 v[28:31], v[88:91], v[228:231], v[28:31]
    v_mfma_f32_16x16x32_bf16 v[56:59], v[92:95], v[228:231], v[56:59]
    v_mfma_f32_16x16x32_bf16 v[32:35], v[88:91], a[28:31], v[32:35]
    v_mfma_f32_16x16x32_bf16 v[60:63], v[92:95], a[28:31], v[60:63]
    v_mfma_f32_16x16x32_bf16 v[36:39], v[88:91], a[84:87], v[36:39]
    v_mfma_f32_16x16x32_bf16 v[64:67], v[92:95], a[84:87], v[64:67]
    v_mfma_f32_16x16x32_bf16 v[40:43], v[88:91], a[140:143], v[40:43]
    v_mfma_f32_16x16x32_bf16 v[68:71], v[92:95], a[140:143], v[68:71]
    v_mfma_f32_16x16x32_bf16 v[44:47], v[88:91], a[196:199], v[44:47]
    v_mfma_f32_16x16x32_bf16 v[72:75], v[92:95], a[196:199], v[72:75]
    v_mfma_f32_16x16x32_bf16 v[48:51], v[88:91], a[252:255], v[48:51]
    v_mfma_f32_16x16x32_bf16 v[76:79], v[92:95], a[252:255], v[76:79]
    v_cvt_pk_bf16_f32 v80, v24, v25
    v_cvt_pk_bf16_f32 v81, v26, v27
    v_cvt_pk_bf16_f32 v82, v52, v53
    v_cvt_pk_bf16_f32 v83, v54, v55
    global_store_dwordx4 v1, v[80:83], s[26:27] offset:0 sc1
    v_cvt_pk_bf16_f32 v88, v28, v29
    v_cvt_pk_bf16_f32 v89, v30, v31
    v_cvt_pk_bf16_f32 v90, v56, v57
    v_cvt_pk_bf16_f32 v91, v58, v59
    global_store_dwordx4 v1, v[88:91], s[26:27] offset:1024 sc1
    v_cvt_pk_bf16_f32 v96, v32, v33
    v_cvt_pk_bf16_f32 v97, v34, v35
    v_cvt_pk_bf16_f32 v98, v60, v61
    v_cvt_pk_bf16_f32 v99, v62, v63
    global_store_dwordx4 v1, v[96:99], s[26:27] offset:2048 sc1
    v_cvt_pk_bf16_f32 v80, v36, v37
    v_cvt_pk_bf16_f32 v81, v38, v39
    v_cvt_pk_bf16_f32 v82, v64, v65
    v_cvt_pk_bf16_f32 v83, v66, v67
    global_store_dwordx4 v1, v[80:83], s[26:27] offset:3072 sc1
    v_cvt_pk_bf16_f32 v88, v40, v41
    v_cvt_pk_bf16_f32 v89, v42, v43
    v_cvt_pk_bf16_f32 v90, v68, v69
    v_cvt_pk_bf16_f32 v91, v70, v71
    global_store_dwordx4 v7, v[88:91], s[26:27] offset:0 sc1
    v_cvt_pk_bf16_f32 v96, v44, v45
    v_cvt_pk_bf16_f32 v97, v46, v47
    v_cvt_pk_bf16_f32 v98, v72, v73
    v_cvt_pk_bf16_f32 v99, v74, v75
    global_store_dwordx4 v7, v[96:99], s[26:27] offset:1024 sc1
    v_cvt_pk_bf16_f32 v80, v48, v49
    v_cvt_pk_bf16_f32 v81, v50, v51
    v_cvt_pk_bf16_f32 v82, v76, v77
    v_cvt_pk_bf16_f32 v83, v78, v79
    global_store_dwordx4 v7, v[80:83], s[26:27] offset:2048 sc1
    s_cmp_lg_u32 s10, 0
    s_cbranch_scc1 sequential_preLN__memory_aug_recurrent_mem_tr__mixer_gmlp__prompt_kernel_VP_all_pwj
    s_mov_b32 s13, 131072
    s_add_u32 s76, s4, 0x1580000
    s_addc_u32 s77, s5, 0
    v_mbcnt_lo_u32_b32 v104, -1, 0
    v_mbcnt_hi_u32_b32 v104, -1, v104
    v_lshlrev_b32 v104, 4, v104
    s_nop 1
sequential_preLN__memory_aug_recurrent_mem_tr__mixer_gmlp__prompt_kernel_VP_all_pw:
    global_load_dwordx4 v[106:109], v104, s[76:77] sc1
    s_waitcnt vmcnt(0)
    v_xor_b32 v106, s78, v106
    v_xor_b32 v107, s78, v107
    v_xor_b32 v108, s78, v108
    v_xor_b32 v109, s78, v109
    v_or_b32 v106, v106, v107
    v_or_b32 v108, v108, v109
    v_or_b32 v106, v106, v108
    v_cmp_ne_u32 vcc, 0, v106
    s_nop 0
    s_cbranch_vccz sequential_preLN__memory_aug_recurrent_mem_tr__mixer_gmlp__prompt_kernel_VP_all_pwok
    s_sleep 16
    s_sub_u32 s13, s13, 1
    s_cbranch_scc0 sequential_preLN__memory_aug_recurrent_mem_tr__mixer_gmlp__prompt_kernel_VP_all_pw
    s_endpgm
sequential_preLN__memory_aug_recurrent_mem_tr__mixer_gmlp__prompt_kernel_VP_all_pwok:
    buffer_inv sc1
    s_waitcnt vmcnt(0)
sequential_preLN__memory_aug_recurrent_mem_tr__mixer_gmlp__prompt_kernel_VP_all_pwj:
    s_barrier
    s_waitcnt vmcnt(0)
    s_barrier
    s_cmp_lg_u32 s10, 0
    s_cbranch_scc1 sequential_preLN__memory_aug_recurrent_mem_tr__mixer_gmlp__prompt_kernel_VP_f0
    s_mov_b64 exec, 1
    global_atomic_add v5, v6, s[28:29] offset:0
    s_mov_b64 exec, -1
    s_nop 4
sequential_preLN__memory_aug_recurrent_mem_tr__mixer_gmlp__prompt_kernel_VP_f0:
    s_mul_i32 s15, s10, 7168
    s_add_u32 s24, s15, 28672
    s_mov_b32 m0, s24
    s_nop 0
    global_load_lds_dwordx4 v2, s[22:23] offset:0
    global_load_lds_dwordx4 v2, s[22:23] offset:1024
    global_load_lds_dwordx4 v2, s[22:23] offset:2048
    global_load_lds_dwordx4 v2, s[22:23] offset:3072
    s_add_u32 m0, s24, 4096
    s_nop 0
    global_load_lds_dwordx4 v3, s[22:23] offset:0
    global_load_lds_dwordx4 v3, s[22:23] offset:1024
    global_load_lds_dwordx4 v3, s[22:23] offset:2048
    s_add_u32 s26, s26, 917504
    s_addc_u32 s27, s27, 0
    s_add_u32 s28, s28, 256
    s_addc_u32 s29, s29, 0
    s_and_b32 s14, s30, 1
    s_cmp_eq_u32 s14, 0
    s_cselect_b32 s14, 28672, 0
    v_add_u32 v4, s14, v1
    s_mov_b32 s30, 1
    s_nop 0
sequential_preLN__memory_aug_recurrent_mem_tr__mixer_gmlp__prompt_kernel_VP_loop:
    s_waitcnt vmcnt(0)
    s_barrier
    s_cmp_lt_u32 s30, 4
    s_cbranch_scc1 sequential_preLN__memory_aug_recurrent_mem_tr__mixer_gmlp__prompt_kernel_VP_noflag
    s_cmp_lg_u32 s10, 0
    s_cbranch_scc1 sequential_preLN__memory_aug_recurrent_mem_tr__mixer_gmlp__prompt_kernel_VP_noflag
    s_mov_b64 exec, 1
    global_atomic_add v5, v6, s[28:29] offset:-256
    s_mov_b64 exec, -1
    s_nop 4
sequential_preLN__memory_aug_recurrent_mem_tr__mixer_gmlp__prompt_kernel_VP_noflag:
    s_cmp_eq_u32 s30, 31
    s_cbranch_scc1 sequential_preLN__memory_aug_recurrent_mem_tr__mixer_gmlp__prompt_kernel_VP_nopf
    s_add_u32 s22, s22, 57344
    s_addc_u32 s23, s23, 0
    s_nop 0
    s_and_b32 s14, s30, 1
    s_cmp_eq_u32 s14, 0
    s_cselect_b32 s14, 28672, 0
    s_mul_i32 s15, s10, 7168
    s_add_u32 s24, s15, s14
    s_mov_b32 m0, s24
    s_nop 0
    global_load_lds_dwordx4 v2, s[22:23] offset:0
    global_load_lds_dwordx4 v2, s[22:23] offset:1024
    global_load_lds_dwordx4 v2, s[22:23] offset:2048
    global_load_lds_dwordx4 v2, s[22:23] offset:3072
    s_add_u32 m0, s24, 4096
    s_nop 0
    global_load_lds_dwordx4 v3, s[22:23] offset:0
    global_load_lds_dwordx4 v3, s[22:23] offset:1024
    global_load_lds_dwordx4 v3, s[22:23] offset:2048
sequential_preLN__memory_aug_recurrent_mem_tr__mixer_gmlp__prompt_kernel_VP_nopf:
    ds_read_b128 v[80:83], v4 offset:0
    ds_read_b128 v[84:87], v4 offset:1024
    ds_read_b128 v[88:91], v4 offset:2048
    ds_read_b128 v[92:95], v4 offset:3072
    s_waitcnt lgkmcnt(2)
    v_mfma_f32_16x16x32_bf16 v[24:27], v[80:83], v[120:123], 0
    v_mfma_f32_16x16x32_bf16 v[52:55], v[84:87], v[120:123], 0
    ds_read_b128 v[96:99], v4 offset:4096
    ds_read_b128 v[100:103], v4 offset:5120
    v_mfma_f32_16x16x32_bf16 v[28:31], v[80:83], v[176:179], 0
    v_mfma_f32_16x16x32_bf16 v[56:59], v[84:87], v[176:179], 0
    v_mfma_f32_16x16x32_bf16 v[32:35], v[80:83], v[232:235], 0
    v_mfma_f32_16x16x32_bf16 v[60:63], v[84:87], v[232:235], 0
    v_mfma_f32_16x16x32_bf16 v[36:39], v[80:83], a[32:35], 0
    v_mfma_f32_16x16x32_bf16 v[64:67], v[84:87], a[32:35], 0
    v_mfma_f32_16x16x32_bf16 v[40:43], v[80:83], a[88:91], 0
    v_mfma_f32_16x16x32_bf16 v[68:71], v[84:87], a[88:91], 0
    v_mfma_f32_16x16x32_bf16 v[44:47], v[80:83], a[144:147], 0
    v_mfma_f32_16x16x32_bf16 v[72:75], v[84:87], a[144:147], 0
    v_mfma_f32_16x16x32_bf16 v[48:51], v[80:83], a[200:203], 0
    v_mfma_f32_16x16x32_bf16 v[76:79], v[84:87], a[200:203], 0
    s_waitcnt lgkmcnt(2)
    v_mfma_f32_16x16x32_bf16 v[24:27], v[88:91], v[124:127], v[24:27]
    v_mfma_f32_16x16x32_bf16 v[52:55], v[92:95], v[124:127], v[52:55]
    ds_read_b128 v[80:83], v4 offset:6144
    ds_read_b128 v[84:87], v4 offset:7168
    v_mfma_f32_16x16x32_bf16 v[28:31], v[88:91], v[180:183], v[28:31]
    v_mfma_f32_16x16x32_bf16 v[56:59], v[92:95], v[180:183], v[56:59]
    v_mfma_f32_16x16x32_bf16 v[32:35], v[88:91], v[236:239], v[32:35]
    v_mfma_f32_16x16x32_bf16 v[60:63], v[92:95], v[236:239], v[60:63]
    v_mfma_f32_16x16x32_bf16 v[36:39], v[88:91], a[36:39], v[36:39]
    v_mfma_f32_16x16x32_bf16 v[64:67], v[92:95], a[36:39], v[64:67]
    v_mfma_f32_16x16x32_bf16 v[40:43], v[88:91], a[92:95], v[40:43]
    v_mfma_f32_16x16x32_bf16 v[68:71], v[92:95], a[92:95], v[68:71]
    v_mfma_f32_16x16x32_bf16 v[44:47], v[88:91], a[148:151], v[44:47]
    v_mfma_f32_16x16x32_bf16 v[72:75], v[92:95], a[148:151], v[72:75]
    v_mfma_f32_16x16x32_bf16 v[48:51], v[88:91], a[204:207], v[48:51]
    v_mfma_f32_16x16x32_bf16 v[76:79], v[92:95], a[204:207], v[76:79]
    s_waitcnt lgkmcnt(2)
    v_mfma_f32_16x16x32_bf16 v[24:27], v[96:99], v[128:131], v[24:27]
    v_mfma_f32_16x16x32_bf16 v[52:55], v[100:103], v[128:131], v[52:55]
    ds_read_b128 v[88:91], v4 offset:8192
    ds_read_b128 v[92:95], v4 offset:9216
    v_mfma_f32_16x16x32_bf16 v[28:31], v[96:99], v[184:187], v[28:31]
    v_mfma_f32_16x16x32_bf16 v[56:59], v[100:103], v[184:187], v[56:59]
    v_mfma_f32_16x16x32_bf16 v[32:35], v[96:99], v[240:243], v[32:35]
    v_mfma_f32_16x16x32_bf16 v[60:63], v[100:103], v[240:243], v[60:63]
    v_mfma_f32_16x16x32_bf16 v[36:39], v[96:99], a[40:43], v[36:39]
    v_mfma_f32_16x16x32_bf16 v[64:67], v[100:103], a[40:43], v[64:67]
    v_mfma_f32_16x16x32_bf16 v[40:43], v[96:99], a[96:99], v[40:43]
    v_mfma_f32_16x16x32_bf16 v[68:71], v[100:103], a[96:99], v[68:71]
    v_mfma_f32_16x16x32_bf16 v[44:47], v[96:99], a[152:155], v[44:47]
    v_mfma_f32_16x16x32_bf16 v[72:75], v[100:103], a[152:155], v[72:75]
    v_mfma_f32_16x16x32_bf16 v[48:51], v[96:99], a[208:211], v[48:51]
    v_mfma_f32_16x16x32_bf16 v[76:79], v[100:103], a[208:211], v[76:79]
    s_waitcnt lgkmcnt(2)
    v_mfma_f32_16x16x32_bf16 v[24:27], v[80:83], v[132:135], v[24:27]
    v_mfma_f32_16x16x32_bf16 v[52:55], v[84:87], v[132:135], v[52:55]
    ds_read_b128 v[96:99], v4 offset:10240
    ds_read_b128 v[100:103], v4 offset:11264
    v_mfma_f32_16x16x32_bf16 v[28:31], v[80:83], v[188:191], v[28:31]
    v_mfma_f32_16x16x32_bf16 v[56:59], v[84:87], v[188:191], v[56:59]
    v_mfma_f32_16x16x32_bf16 v[32:35], v[80:83], v[244:247], v[32:35]
    v_mfma_f32_16x16x32_bf16 v[60:63], v[84:87], v[244:247], v[60:63]
    v_mfma_f32_16x16x32_bf16 v[36:39], v[80:83], a[44:47], v[36:39]
    v_mfma_f32_16x16x32_bf16 v[64:67], v[84:87], a[44:47], v[64:67]
    v_mfma_f32_16x16x32_bf16 v[40:43], v[80:83], a[100:103], v[40:43]
    v_mfma_f32_16x16x32_bf16 v[68:71], v[84:87], a[100:103], v[68:71]
    v_mfma_f32_16x16x32_bf16 v[44:47], v[80:83], a[156:159], v[44:47]
    v_mfma_f32_16x16x32_bf16 v[72:75], v[84:87], a[156:159], v[72:75]
    v_mfma_f32_16x16x32_bf16 v[48:51], v[80:83], a[212:215], v[48:51]
    v_mfma_f32_16x16x32_bf16 v[76:79], v[84:87], a[212:215], v[76:79]
    s_waitcnt lgkmcnt(2)
    v_mfma_f32_16x16x32_bf16 v[24:27], v[88:91], v[136:139], v[24:27]
    v_mfma_f32_16x16x32_bf16 v[52:55], v[92:95], v[136:139], v[52:55]
    ds_read_b128 v[80:83], v4 offset:12288
    ds_read_b128 v[84:87], v4 offset:13312
    v_mfma_f32_16x16x32_bf16 v[28:31], v[88:91], v[192:195], v[28:31]
    v_mfma_f32_16x16x32_bf16 v[56:59], v[92:95], v[192:195], v[56:59]
    v_mfma_f32_16x16x32_bf16 v[32:35], v[88:91], v[248:251], v[32:35]
    v_mfma_f32_16x16x32_bf16 v[60:63], v[92:95], v[248:251], v[60:63]
    v_mfma_f32_16x16x32_bf16 v[36:39], v[88:91], a[48:51], v[36:39]
    v_mfma_f32_16x16x32_bf16 v[64:67], v[92:95], a[48:51], v[64:67]
    v_mfma_f32_16x16x32_bf16 v[40:43], v[88:91], a[104:107], v[40:43]
    v_mfma_f32_16x16x32_bf16 v[68:71], v[92:95], a[104:107], v[68:71]
    v_mfma_f32_16x16x32_bf16 v[44:47], v[88:91], a[160:163], v[44:47]
    v_mfma_f32_16x16x32_bf16 v[72:75], v[92:95], a[160:163], v[72:75]
    v_mfma_f32_16x16x32_bf16 v[48:51], v[88:91], a[216:219], v[48:51]
    v_mfma_f32_16x16x32_bf16 v[76:79], v[92:95], a[216:219], v[76:79]
    s_waitcnt lgkmcnt(2)
    v_mfma_f32_16x16x32_bf16 v[24:27], v[96:99], v[140:143], v[24:27]
    v_mfma_f32_16x16x32_bf16 v[52:55], v[100:103], v[140:143], v[52:55]
    ds_read_b128 v[88:91], v4 offset:14336
    ds_read_b128 v[92:95], v4 offset:15360
    v_mfma_f32_16x16x32_bf16 v[28:31], v[96:99], v[196:199], v[28:31]
    v_mfma_f32_16x16x32_bf16 v[56:59], v[100:103], v[196:199], v[56:59]
    v_mfma_f32_16x16x32_bf16 v[32:35], v[96:99], v[252:255], v[32:35]
    v_mfma_f32_16x16x32_bf16 v[60:63], v[100:103], v[252:255], v[60:63]
    v_mfma_f32_16x16x32_bf16 v[36:39], v[96:99], a[52:55], v[36:39]
    v_mfma_f32_16x16x32_bf16 v[64:67], v[100:103], a[52:55], v[64:67]
    v_mfma_f32_16x16x32_bf16 v[40:43], v[96:99], a[108:111], v[40:43]
    v_mfma_f32_16x16x32_bf16 v[68:71], v[100:103], a[108:111], v[68:71]
    v_mfma_f32_16x16x32_bf16 v[44:47], v[96:99], a[164:167], v[44:47]
    v_mfma_f32_16x16x32_bf16 v[72:75], v[100:103], a[164:167], v[72:75]
    v_mfma_f32_16x16x32_bf16 v[48:51], v[96:99], a[220:223], v[48:51]
    v_mfma_f32_16x16x32_bf16 v[76:79], v[100:103], a[220:223], v[76:79]
    s_waitcnt lgkmcnt(2)
    v_mfma_f32_16x16x32_bf16 v[24:27], v[80:83], v[144:147], v[24:27]
    v_mfma_f32_16x16x32_bf16 v[52:55], v[84:87], v[144:147], v[52:55]
    ds_read_b128 v[96:99], v4 offset:16384
    ds_read_b128 v[100:103], v4 offset:17408
    v_mfma_f32_16x16x32_bf16 v[28:31], v[80:83], v[200:203], v[28:31]
    v_mfma_f32_16x16x32_bf16 v[56:59], v[84:87], v[200:203], v[56:59]
    v_mfma_f32_16x16x32_bf16 v[32:35], v[80:83], a[0:3], v[32:35]
    v_mfma_f32_16x16x32_bf16 v[60:63], v[84:87], a[0:3], v[60:63]
    v_mfma_f32_16x16x32_bf16 v[36:39], v[80:83], a[56:59], v[36:39]
    v_mfma_f32_16x16x32_bf16 v[64:67], v[84:87], a[56:59], v[64:67]
    v_mfma_f32_16x16x32_bf16 v[40:43], v[80:83], a[112:115], v[40:43]
    v_mfma_f32_16x16x32_bf16 v[68:71], v[84:87], a[112:115], v[68:71]
    v_mfma_f32_16x16x32_bf16 v[44:47], v[80:83], a[168:171], v[44:47]
    v_mfma_f32_16x16x32_bf16 v[72:75], v[84:87], a[168:171], v[72:75]
    v_mfma_f32_16x16x32_bf16 v[48:51], v[80:83], a[224:227], v[48:51]
    v_mfma_f32_16x16x32_bf16 v[76:79], v[84:87], a[224:227], v[76:79]
    s_waitcnt lgkmcnt(2)
    v_mfma_f32_16x16x32_bf16 v[24:27], v[88:91], v[148:151], v[24:27]
    v_mfma_f32_16x16x32_bf16 v[52:55], v[92:95], v[148:151], v[52:55]
    ds_read_b128 v[80:83], v4 offset:18432
    ds_read_b128 v[84:87], v4 offset:19456
    v_mfma_f32_16x16x32_bf16 v[28:31], v[88:91], v[204:207], v[28:31]
    v_mfma_f32_16x16x32_bf16 v[56:59], v[92:95], v[204:207], v[56:59]
    v_mfma_f32_16x16x32_bf16 v[32:35], v[88:91], a[4:7], v[32:35]
    v_mfma_f32_16x16x32_bf16 v[60:63], v[92:95], a[4:7], v[60:63]
    v_mfma_f32_16x16x32_bf16 v[36:39], v[88:91], a[60:63], v[36:39]
    v_mfma_f32_16x16x32_bf16 v[64:67], v[92:95], a[60:63], v[64:67]
    v_mfma_f32_16x16x32_bf16 v[40:43], v[88:91], a[116:119], v[40:43]
    v_mfma_f32_16x16x32_bf16 v[68:71], v[92:95], a[116:119], v[68:71]
    v_mfma_f32_16x16x32_bf16 v[44:47], v[88:91], a[172:175], v[44:47]
    v_mfma_f32_16x16x32_bf16 v[72:75], v[92:95], a[172:175], v[72:75]
    v_mfma_f32_16x16x32_bf16 v[48:51], v[88:91], a[228:231], v[48:51]
    v_mfma_f32_16x16x32_bf16 v[76:79], v[92:95], a[228:231], v[76:79]
    s_waitcnt lgkmcnt(2)
    v_mfma_f32_16x16x32_bf16 v[24:27], v[96:99], v[152:155], v[24:27]
    v_mfma_f32_16x16x32_bf16 v[52:55], v[100:103], v[152:155], v[52:55]
    ds_read_b128 v[88:91], v4 offset:20480
    ds_read_b128 v[92:95], v4 offset:21504
    v_mfma_f32_16x16x32_bf16 v[28:31], v[96:99], v[208:211], v[28:31]
    v_mfma_f32_16x16x32_bf16 v[56:59], v[100:103], v[208:211], v[56:59]
    v_mfma_f32_16x16x32_bf16 v[32:35], v[96:99], a[8:11], v[32:35]
    v_mfma_f32_16x16x32_bf16 v[60:63], v[100:103], a[8:11], v[60:63]
    v_mfma_f32_16x16x32_bf16 v[36:39], v[96:99], a[64:67], v[36:39]
    v_mfma_f32_16x16x32_bf16 v[64:67], v[100:103], a[64:67], v[64:67]
    v_mfma_f32_16x16x32_bf16 v[40:43], v[96:99], a[120:123], v[40:43]
    v_mfma_f32_16x16x32_bf16 v[68:71], v[100:103], a[120:123], v[68:71]
    v_mfma_f32_16x16x32_bf16 v[44:47], v[96:99], a[176:179], v[44:47]
    v_mfma_f32_16x16x32_bf16 v[72:75], v[100:103], a[176:179], v[72:75]
    v_mfma_f32_16x16x32_bf16 v[48:51], v[96:99], a[232:235], v[48:51]
    v_mfma_f32_16x16x32_bf16 v[76:79], v[100:103], a[232:235], v[76:79]
    s_waitcnt lgkmcnt(2)
    v_mfma_f32_16x16x32_bf16 v[24:27], v[80:83], v[156:159], v[24:27]
    v_mfma_f32_16x16x32_bf16 v[52:55], v[84:87], v[156:159], v[52:55]
    ds_read_b128 v[96:99], v4 offset:22528
    ds_read_b128 v[100:103], v4 offset:23552
    v_mfma_f32_16x16x32_bf16 v[28:31], v[80:83], v[212:215], v[28:31]
    v_mfma_f32_16x16x32_bf16 v[56:59], v[84:87], v[212:215], v[56:59]
    v_mfma_f32_16x16x32_bf16 v[32:35], v[80:83], a[12:15], v[32:35]
    v_mfma_f32_16x16x32_bf16 v[60:63], v[84:87], a[12:15], v[60:63]
    v_mfma_f32_16x16x32_bf16 v[36:39], v[80:83], a[68:71], v[36:39]
    v_mfma_f32_16x16x32_bf16 v[64:67], v[84:87], a[68:71], v[64:67]
    v_mfma_f32_16x16x32_bf16 v[40:43], v[80:83], a[124:127], v[40:43]
    v_mfma_f32_16x16x32_bf16 v[68:71], v[84:87], a[124:127], v[68:71]
    v_mfma_f32_16x16x32_bf16 v[44:47], v[80:83], a[180:183], v[44:47]
    v_mfma_f32_16x16x32_bf16 v[72:75], v[84:87], a[180:183], v[72:75]
    v_mfma_f32_16x16x32_bf16 v[48:51], v[80:83], a[236:239], v[48:51]
    v_mfma_f32_16x16x32_bf16 v[76:79], v[84:87], a[236:239], v[76:79]
    s_waitcnt lgkmcnt(2)
    v_mfma_f32_16x16x32_bf16 v[24:27], v[88:91], v[160:163], v[24:27]
    v_mfma_f32_16x16x32_bf16 v[52:55], v[92:95], v[160:163], v[52:55]
    ds_read_b128 v[80:83], v4 offset:24576
    ds_read_b128 v[84:87], v4 offset:25600
    v_mfma_f32_16x16x32_bf16 v[28:31], v[88:91], v[216:219], v[28:31]
    v_mfma_f32_16x16x32_bf16 v[56:59], v[92:95], v[216:219], v[56:59]
    v_mfma_f32_16x16x32_bf16 v[32:35], v[88:91], a[16:19], v[32:35]
    v_mfma_f32_16x16x32_bf16 v[60:63], v[92:95], a[16:19], v[60:63]
    v_mfma_f32_16x16x32_bf16 v[36:39], v[88:91], a[72:75], v[36:39]
    v_mfma_f32_16x16x32_bf16 v[64:67], v[92:95], a[72:75], v[64:67]
    v_mfma_f32_16x16x32_bf16 v[40:43], v[88:91], a[128:131], v[40:43]
    v_mfma_f32_16x16x32_bf16 v[68:71], v[92:95], a[128:131], v[68:71]
    v_mfma_f32_16x16x32_bf16 v[44:47], v[88:91], a[184:187], v[44:47]
    v_mfma_f32_16x16x32_bf16 v[72:75], v[92:95], a[184:187], v[72:75]
    v_mfma_f32_16x16x32_bf16 v[48:51], v[88:91], a[240:243], v[48:51]
    v_mfma_f32_16x16x32_bf16 v[76:79], v[92:95], a[240:243], v[76:79]
    s_waitcnt lgkmcnt(2)
    v_mfma_f32_16x16x32_bf16 v[24:27], v[96:99], v[164:167], v[24:27]
    v_mfma_f32_16x16x32_bf16 v[52:55], v[100:103], v[164:167], v[52:55]
    ds_read_b128 v[88:91], v4 offset:26624
    ds_read_b128 v[92:95], v4 offset:27648
    v_mfma_f32_16x16x32_bf16 v[28:31], v[96:99], v[220:223], v[28:31]
    v_mfma_f32_16x16x32_bf16 v[56:59], v[100:103], v[220:223], v[56:59]
    v_mfma_f32_16x16x32_bf16 v[32:35], v[96:99], a[20:23], v[32:35]
    v_mfma_f32_16x16x32_bf16 v[60:63], v[100:103], a[20:23], v[60:63]
    v_mfma_f32_16x16x32_bf16 v[36:39], v[96:99], a[76:79], v[36:39]
    v_mfma_f32_16x16x32_bf16 v[64:67], v[100:103], a[76:79], v[64:67]
    v_mfma_f32_16x16x32_bf16 v[40:43], v[96:99], a[132:135], v[40:43]
    v_mfma_f32_16x16x32_bf16 v[68:71], v[100:103], a[132:135], v[68:71]
    v_mfma_f32_16x16x32_bf16 v[44:47], v[96:99], a[188:191], v[44:47]
    v_mfma_f32_16x16x32_bf16 v[72:75], v[100:103], a[188:191], v[72:75]
    v_mfma_f32_16x16x32_bf16 v[48:51], v[96:99], a[244:247], v[48:51]
    v_mfma_f32_16x16x32_bf16 v[76:79], v[100:103], a[244:247], v[76:79]
    s_waitcnt lgkmcnt(2)
    v_mfma_f32_16x16x32_bf16 v[24:27], v[80:83], v[168:171], v[24:27]
    v_mfma_f32_16x16x32_bf16 v[52:55], v[84:87], v[168:171], v[52:55]
    v_mfma_f32_16x16x32_bf16 v[28:31], v[80:83], v[224:227], v[28:31]
    v_mfma_f32_16x16x32_bf16 v[56:59], v[84:87], v[224:227], v[56:59]
    v_mfma_f32_16x16x32_bf16 v[32:35], v[80:83], a[24:27], v[32:35]
    v_mfma_f32_16x16x32_bf16 v[60:63], v[84:87], a[24:27], v[60:63]
    v_mfma_f32_16x16x32_bf16 v[36:39], v[80:83], a[80:83], v[36:39]
    v_mfma_f32_16x16x32_bf16 v[64:67], v[84:87], a[80:83], v[64:67]
    v_mfma_f32_16x16x32_bf16 v[40:43], v[80:83], a[136:139], v[40:43]
    v_mfma_f32_16x16x32_bf16 v[68:71], v[84:87], a[136:139], v[68:71]
    v_mfma_f32_16x16x32_bf16 v[44:47], v[80:83], a[192:195], v[44:47]
    v_mfma_f32_16x16x32_bf16 v[72:75], v[84:87], a[192:195], v[72:75]
    v_mfma_f32_16x16x32_bf16 v[48:51], v[80:83], a[248:251], v[48:51]
    v_mfma_f32_16x16x32_bf16 v[76:79], v[84:87], a[248:251], v[76:79]
    s_waitcnt lgkmcnt(0)
    v_mfma_f32_16x16x32_bf16 v[24:27], v[88:91], v[172:175], v[24:27]
    v_mfma_f32_16x16x32_bf16 v[52:55], v[92:95], v[172:175], v[52:55]
    v_mfma_f32_16x16x32_bf16 v[28:31], v[88:91], v[228:231], v[28:31]
    v_mfma_f32_16x16x32_bf16 v[56:59], v[92:95], v[228:231], v[56:59]
    v_mfma_f32_16x16x32_bf16 v[32:35], v[88:91], a[28:31], v[32:35]
    v_mfma_f32_16x16x32_bf16 v[60:63], v[92:95], a[28:31], v[60:63]
    v_mfma_f32_16x16x32_bf16 v[36:39], v[88:91], a[84:87], v[36:39]
    v_mfma_f32_16x16x32_bf16 v[64:67], v[92:95], a[84:87], v[64:67]
    v_mfma_f32_16x16x32_bf16 v[40:43], v[88:91], a[140:143], v[40:43]
    v_mfma_f32_16x16x32_bf16 v[68:71], v[92:95], a[140:143], v[68:71]
    v_mfma_f32_16x16x32_bf16 v[44:47], v[88:91], a[196:199], v[44:47]
    v_mfma_f32_16x16x32_bf16 v[72:75], v[92:95], a[196:199], v[72:75]
    v_mfma_f32_16x16x32_bf16 v[48:51], v[88:91], a[252:255], v[48:51]
    v_mfma_f32_16x16x32_bf16 v[76:79], v[92:95], a[252:255], v[76:79]
    v_cvt_pk_bf16_f32 v80, v24, v25
    v_cvt_pk_bf16_f32 v81, v26, v27
    v_cvt_pk_bf16_f32 v82, v52, v53
    v_cvt_pk_bf16_f32 v83, v54, v55
    global_store_dwordx4 v1, v[80:83], s[26:27] offset:0 sc1
    v_cvt_pk_bf16_f32 v88, v28, v29
    v_cvt_pk_bf16_f32 v89, v30, v31
    v_cvt_pk_bf16_f32 v90, v56, v57
    v_cvt_pk_bf16_f32 v91, v58, v59
    global_store_dwordx4 v1, v[88:91], s[26:27] offset:1024 sc1
    v_cvt_pk_bf16_f32 v96, v32, v33
    v_cvt_pk_bf16_f32 v97, v34, v35
    v_cvt_pk_bf16_f32 v98, v60, v61
    v_cvt_pk_bf16_f32 v99, v62, v63
    global_store_dwordx4 v1, v[96:99], s[26:27] offset:2048 sc1
    v_cvt_pk_bf16_f32 v80, v36, v37
    v_cvt_pk_bf16_f32 v81, v38, v39
    v_cvt_pk_bf16_f32 v82, v64, v65
    v_cvt_pk_bf16_f32 v83, v66, v67
    global_store_dwordx4 v1, v[80:83], s[26:27] offset:3072 sc1
    v_cvt_pk_bf16_f32 v88, v40, v41
    v_cvt_pk_bf16_f32 v89, v42, v43
    v_cvt_pk_bf16_f32 v90, v68, v69
    v_cvt_pk_bf16_f32 v91, v70, v71
    global_store_dwordx4 v7, v[88:91], s[26:27] offset:0 sc1
    v_cvt_pk_bf16_f32 v96, v44, v45
    v_cvt_pk_bf16_f32 v97, v46, v47
    v_cvt_pk_bf16_f32 v98, v72, v73
    v_cvt_pk_bf16_f32 v99, v74, v75
    global_store_dwordx4 v7, v[96:99], s[26:27] offset:1024 sc1
    v_cvt_pk_bf16_f32 v80, v48, v49
    v_cvt_pk_bf16_f32 v81, v50, v51
    v_cvt_pk_bf16_f32 v82, v76, v77
    v_cvt_pk_bf16_f32 v83, v78, v79
    global_store_dwordx4 v7, v[80:83], s[26:27] offset:2048 sc1
    s_cmp_lt_u32 s30, 3
    s_cbranch_scc0 sequential_preLN__memory_aug_recurrent_mem_tr__mixer_gmlp__prompt_kernel_VP_nofirst
    s_waitcnt vmcnt(7)
    s_waitcnt vmcnt(0)
    s_barrier
    s_cmp_lg_u32 s10, 0
    s_cbranch_scc1 sequential_preLN__memory_aug_recurrent_mem_tr__mixer_gmlp__prompt_kernel_VP_f1
    s_mov_b64 exec, 1
    global_atomic_add v5, v6, s[28:29] offset:0
    s_mov_b64 exec, -1
    s_nop 4
sequential_preLN__memory_aug_recurrent_mem_tr__mixer_gmlp__prompt_kernel_VP_f1:
sequential_preLN__memory_aug_recurrent_mem_tr__mixer_gmlp__prompt_kernel_VP_nofirst:
    s_add_u32 s26, s26, 917504
    s_addc_u32 s27, s27, 0
    s_add_u32 s28, s28, 256
    s_addc_u32 s29, s29, 0
    s_and_b32 s14, s30, 1
    s_cmp_eq_u32 s14, 0
    s_cselect_b32 s14, 28672, 0
    v_add_u32 v4, s14, v1
    s_add_u32 s30, s30, 1
    s_cmp_lt_u32 s30, 32
    s_cbranch_scc1 sequential_preLN__memory_aug_recurrent_mem_tr__mixer_gmlp__prompt_kernel_VP_loop
    s_waitcnt vmcnt(0)
    s_barrier
    s_cmp_lg_u32 s10, 0
    s_cbranch_scc1 sequential_preLN__memory_aug_recurrent_mem_tr__mixer_gmlp__prompt_kernel_VP_end
    s_mov_b64 exec, 1
    global_atomic_add v5, v6, s[28:29] offset:-256
    s_mov_b64 exec, -1
    s_nop 4
sequential_preLN__memory_aug_recurrent_mem_tr__mixer_gmlp__prompt_kernel_VP_end:
    s_waitcnt vmcnt(0) lgkmcnt(0)
    s_barrier
    s_branch sequential_preLN__memory_aug_recurrent_mem_tr__mixer_gmlp__prompt_kernel_DL0
sequential_preLN__memory_aug_recurrent_mem_tr__mixer_gmlp__prompt_kernel_QP:
    s_cmp_lg_u32 s10, 0
    s_cbranch_scc1 sequential_preLN__memory_aug_recurrent_mem_tr__mixer_gmlp__prompt_kernel_QP_all_pwj
    s_mov_b32 s13, 131072
    s_add_u32 s76, s4, 0x1580000
    s_addc_u32 s77, s5, 0
    v_mbcnt_lo_u32_b32 v20, -1, 0
    v_mbcnt_hi_u32_b32 v20, -1, v20
    v_lshlrev_b32 v20, 4, v20
    s_nop 1
sequential_preLN__memory_aug_recurrent_mem_tr__mixer_gmlp__prompt_kernel_QP_all_pw:
    global_load_dwordx4 v[22:25], v20, s[76:77] sc1
    s_waitcnt vmcnt(0)
    v_xor_b32 v22, s78, v22
    v_xor_b32 v23, s78, v23
    v_xor_b32 v24, s78, v24
    v_xor_b32 v25, s78, v25
    v_or_b32 v22, v22, v23
    v_or_b32 v24, v24, v25
    v_or_b32 v22, v22, v24
    v_cmp_ne_u32 vcc, 0, v22
    s_nop 0
    s_cbranch_vccz sequential_preLN__memory_aug_recurrent_mem_tr__mixer_gmlp__prompt_kernel_QP_all_pwok
    s_sleep 16
    s_sub_u32 s13, s13, 1
    s_cbranch_scc0 sequential_preLN__memory_aug_recurrent_mem_tr__mixer_gmlp__prompt_kernel_QP_all_pw
    s_endpgm
sequential_preLN__memory_aug_recurrent_mem_tr__mixer_gmlp__prompt_kernel_QP_all_pwok:
    buffer_inv sc1
    s_waitcnt vmcnt(0)
sequential_preLN__memory_aug_recurrent_mem_tr__mixer_gmlp__prompt_kernel_QP_all_pwj:
    s_barrier
    v_lshlrev_b32 v1, 4, v1
    v_and_b32 v0, 63, v0
    s_lshr_b32 s16, s9, 2
    s_and_b32 s17, s9, 3
    s_lshl_b32 s14, s16, 2
    s_add_u32 s14, s14, s10
    s_mul_i32 s14, s14, 100352
    s_add_u32 s14, s14, 0x400000
    s_add_u32 s20, s4, s14
    s_addc_u32 s21, s5, 0
    s_mul_i32 s15, s10, 7168
    v_add_u32 v2, s15, v1
    v_add_u32 v3, 0x1000, v2
    s_mul_i32 s14, s17, 28672
    s_add_u32 s14, s14, 0x200000
    s_add_u32 s22, s4, s14
    s_addc_u32 s23, s5, 0
    s_add_u32 s24, s15, 0
    s_mov_b32 m0, s24
    s_nop 0
    global_load_lds_dwordx4 v2, s[22:23] offset:0
    global_load_lds_dwordx4 v2, s[22:23] offset:1024
    global_load_lds_dwordx4 v2, s[22:23] offset:2048
    global_load_lds_dwordx4 v2, s[22:23] offset:3072
    s_add_u32 m0, s24, 4096
    s_nop 0
    global_load_lds_dwordx4 v3, s[22:23] offset:0
    global_load_lds_dwordx4 v3, s[22:23] offset:1024
    global_load_lds_dwordx4 v3, s[22:23] offset:2048
    s_add_u32 s60, s4, 0x1500000
    s_addc_u32 s61, s5, 0
    v_mov_b32 v5, 0
    s_mov_b32 s13, 131072
    s_nop 0
sequential_preLN__memory_aug_recurrent_mem_tr__mixer_gmlp__prompt_kernel_QP_dly:
    global_load_dword v6, v5, s[60:61] offset:0 sc1
    s_waitcnt vmcnt(0)
    v_readfirstlane_b32 s14, v6
    s_nop 0
    s_cmp_ge_u32 s14, 16
    s_nop 1
    s_cbranch_scc1 sequential_preLN__memory_aug_recurrent_mem_tr__mixer_gmlp__prompt_kernel_QP_dly_ok
    s_sleep 8
    s_sub_u32 s13, s13, 1
    s_cbranch_scc0 sequential_preLN__memory_aug_recurrent_mem_tr__mixer_gmlp__prompt_kernel_QP_dly
    s_endpgm
sequential_preLN__memory_aug_recurrent_mem_tr__mixer_gmlp__prompt_kernel_QP_dly_ok:
    global_load_dwordx4 v[120:123], v1, s[20:21] offset:0
    global_load_dwordx4 v[124:127], v1, s[20:21] offset:1024
    global_load_dwordx4 v[128:131], v1, s[20:21] offset:2048
    global_load_dwordx4 v[132:135], v1, s[20:21] offset:3072
    s_add_u32 s20, s20, 4096
    s_addc_u32 s21, s21, 0
    global_load_dwordx4 v[136:139], v1, s[20:21] offset:0
    global_load_dwordx4 v[140:143], v1, s[20:21] offset:1024
    global_load_dwordx4 v[144:147], v1, s[20:21] offset:2048
    global_load_dwordx4 v[148:151], v1, s[20:21] offset:3072
    s_add_u32 s20, s20, 4096
    s_addc_u32 s21, s21, 0
    global_load_dwordx4 v[152:155], v1, s[20:21] offset:0
    global_load_dwordx4 v[156:159], v1, s[20:21] offset:1024
    global_load_dwordx4 v[160:163], v1, s[20:21] offset:2048
    global_load_dwordx4 v[164:167], v1, s[20:21] offset:3072
    s_add_u32 s20, s20, 4096
    s_addc_u32 s21, s21, 0
    global_load_dwordx4 v[168:171], v1, s[20:21] offset:0
    global_load_dwordx4 v[172:175], v1, s[20:21] offset:1024
    global_load_dwordx4 v[176:179], v1, s[20:21] offset:2048
    global_load_dwordx4 v[180:183], v1, s[20:21] offset:3072
    s_add_u32 s20, s20, 4096
    s_addc_u32 s21, s21, 0
    s_waitcnt vmcnt(32)
    global_load_dwordx4 v[184:187], v1, s[20:21] offset:0
    global_load_dwordx4 v[188:191], v1, s[20:21] offset:1024
    global_load_dwordx4 v[192:195], v1, s[20:21] offset:2048
    global_load_dwordx4 v[196:199], v1, s[20:21] offset:3072
    s_add_u32 s20, s20, 4096
    s_addc_u32 s21, s21, 0
    global_load_dwordx4 v[200:203], v1, s[20:21] offset:0
    global_load_dwordx4 v[204:207], v1, s[20:21] offset:1024
    global_load_dwordx4 v[208:211], v1, s[20:21] offset:2048
    global_load_dwordx4 v[212:215], v1, s[20:21] offset:3072
    s_add_u32 s20, s20, 4096
    s_addc_u32 s21, s21, 0
    global_load_dwordx4 v[216:219], v1, s[20:21] offset:0
    global_load_dwordx4 v[220:223], v1, s[20:21] offset:1024
    global_load_dwordx4 v[224:227], v1, s[20:21] offset:2048
    global_load_dwordx4 v[228:231], v1, s[20:21] offset:3072
    s_add_u32 s20, s20, 4096
    s_addc_u32 s21, s21, 0
    global_load_dwordx4 v[232:235], v1, s[20:21] offset:0
    global_load_dwordx4 v[236:239], v1, s[20:21] offset:1024
    global_load_dwordx4 v[240:243], v1, s[20:21] offset:2048
    global_load_dwordx4 v[244:247], v1, s[20:21] offset:3072
    s_add_u32 s20, s20, 4096
    s_addc_u32 s21, s21, 0
    s_waitcnt vmcnt(32)
    global_load_dwordx4 v[248:251], v1, s[20:21] offset:0
    global_load_dwordx4 v[252:255], v1, s[20:21] offset:1024
    global_load_dwordx4 a[0:3], v1, s[20:21] offset:2048
    global_load_dwordx4 a[4:7], v1, s[20:21] offset:3072
    s_add_u32 s20, s20, 4096
    s_addc_u32 s21, s21, 0
    global_load_dwordx4 a[8:11], v1, s[20:21] offset:0
    global_load_dwordx4 a[12:15], v1, s[20:21] offset:1024
    global_load_dwordx4 a[16:19], v1, s[20:21] offset:2048
    global_load_dwordx4 a[20:23], v1, s[20:21] offset:3072
    s_add_u32 s20, s20, 4096
    s_addc_u32 s21, s21, 0
    global_load_dwordx4 a[24:27], v1, s[20:21] offset:0
    global_load_dwordx4 a[28:31], v1, s[20:21] offset:1024
    global_load_dwordx4 a[32:35], v1, s[20:21] offset:2048
    global_load_dwordx4 a[36:39], v1, s[20:21] offset:3072
    s_add_u32 s20, s20, 4096
    s_addc_u32 s21, s21, 0
    global_load_dwordx4 a[40:43], v1, s[20:21] offset:0
    global_load_dwordx4 a[44:47], v1, s[20:21] offset:1024
    global_load_dwordx4 a[48:51], v1, s[20:21] offset:2048
    global_load_dwordx4 a[52:55], v1, s[20:21] offset:3072
    s_add_u32 s20, s20, 4096
    s_addc_u32 s21, s21, 0
    s_waitcnt vmcnt(32)
    global_load_dwordx4 a[56:59], v1, s[20:21] offset:0
    global_load_dwordx4 a[60:63], v1, s[20:21] offset:1024
    global_load_dwordx4 a[64:67], v1, s[20:21] offset:2048
    global_load_dwordx4 a[68:71], v1, s[20:21] offset:3072
    s_add_u32 s20, s20, 4096
    s_addc_u32 s21, s21, 0
    global_load_dwordx4 a[72:75], v1, s[20:21] offset:0
    global_load_dwordx4 a[76:79], v1, s[20:21] offset:1024
    global_load_dwordx4 a[80:83], v1, s[20:21] offset:2048
    global_load_dwordx4 a[84:87], v1, s[20:21] offset:3072
    s_add_u32 s20, s20, 4096
    s_addc_u32 s21, s21, 0
    global_load_dwordx4 a[88:91], v1, s[20:21] offset:0
    global_load_dwordx4 a[92:95], v1, s[20:21] offset:1024
    global_load_dwordx4 a[96:99], v1, s[20:21] offset:2048
    global_load_dwordx4 a[100:103], v1, s[20:21] offset:3072
    s_add_u32 s20, s20, 4096
    s_addc_u32 s21, s21, 0
    global_load_dwordx4 a[104:107], v1, s[20:21] offset:0
    global_load_dwordx4 a[108:111], v1, s[20:21] offset:1024
    global_load_dwordx4 a[112:115], v1, s[20:21] offset:2048
    global_load_dwordx4 a[116:119], v1, s[20:21] offset:3072
    s_add_u32 s20, s20, 4096
    s_addc_u32 s21, s21, 0
    s_waitcnt vmcnt(32)
    global_load_dwordx4 a[120:123], v1, s[20:21] offset:0
    global_load_dwordx4 a[124:127], v1, s[20:21] offset:1024
    global_load_dwordx4 a[128:131], v1, s[20:21] offset:2048
    global_load_dwordx4 a[132:135], v1, s[20:21] offset:3072
    s_add_u32 s20, s20, 4096
    s_addc_u32 s21, s21, 0
    global_load_dwordx4 a[136:139], v1, s[20:21] offset:0
    global_load_dwordx4 a[140:143], v1, s[20:21] offset:1024
    global_load_dwordx4 a[144:147], v1, s[20:21] offset:2048
    global_load_dwordx4 a[148:151], v1, s[20:21] offset:3072
    s_add_u32 s20, s20, 4096
    s_addc_u32 s21, s21, 0
    global_load_dwordx4 a[152:155], v1, s[20:21] offset:0
    global_load_dwordx4 a[156:159], v1, s[20:21] offset:1024
    global_load_dwordx4 a[160:163], v1, s[20:21] offset:2048
    global_load_dwordx4 a[164:167], v1, s[20:21] offset:3072
    s_add_u32 s20, s20, 4096
    s_addc_u32 s21, s21, 0
    global_load_dwordx4 a[168:171], v1, s[20:21] offset:0
    global_load_dwordx4 a[172:175], v1, s[20:21] offset:1024
    global_load_dwordx4 a[176:179], v1, s[20:21] offset:2048
    global_load_dwordx4 a[180:183], v1, s[20:21] offset:3072
    s_add_u32 s20, s20, 4096
    s_addc_u32 s21, s21, 0
    s_waitcnt vmcnt(32)
    global_load_dwordx4 a[184:187], v1, s[20:21] offset:0
    global_load_dwordx4 a[188:191], v1, s[20:21] offset:1024
    global_load_dwordx4 a[192:195], v1, s[20:21] offset:2048
    global_load_dwordx4 a[196:199], v1, s[20:21] offset:3072
    s_add_u32 s20, s20, 4096
    s_addc_u32 s21, s21, 0
    global_load_dwordx4 a[200:203], v1, s[20:21] offset:0
    global_load_dwordx4 a[204:207], v1, s[20:21] offset:1024
    global_load_dwordx4 a[208:211], v1, s[20:21] offset:2048
    global_load_dwordx4 a[212:215], v1, s[20:21] offset:3072
    s_add_u32 s20, s20, 4096
    s_addc_u32 s21, s21, 0
    global_load_dwordx4 a[216:219], v1, s[20:21] offset:0
    global_load_dwordx4 a[220:223], v1, s[20:21] offset:1024
    global_load_dwordx4 a[224:227], v1, s[20:21] offset:2048
    global_load_dwordx4 a[228:231], v1, s[20:21] offset:3072
    s_add_u32 s20, s20, 4096
    s_addc_u32 s21, s21, 0
    global_load_dwordx4 a[232:235], v1, s[20:21] offset:0
    global_load_dwordx4 a[236:239], v1, s[20:21] offset:1024
    global_load_dwordx4 a[240:243], v1, s[20:21] offset:2048
    global_load_dwordx4 a[244:247], v1, s[20:21] offset:3072
    s_add_u32 s20, s20, 4096
    s_addc_u32 s21, s21, 0
    s_waitcnt vmcnt(32)
    global_load_dwordx4 a[248:251], v1, s[20:21] offset:0
    global_load_dwordx4 a[252:255], v1, s[20:21] offset:1024
    v_add_u32 v4, 0, v1
    s_lshl_b32 s14, s17, 15
    s_lshl_b32 s15, s10, 13
    s_add_u32 s14, s14, s15
    s_add_u32 s14, s14, 0x1600000
    s_add_u32 s32, s4, s14
    s_addc_u32 s33, s5, 0
    s_add_u32 s34, s15, 57344
    v_add_u32 v7, 0x1000, v1
    v_lshrrev_b32 v8, 4, v0
    v_and_b32 v9, 15, v0
    v_lshrrev_b32 v10, 1, v8
    v_and_b32 v11, 1, v8
    v_lshlrev_b32 v12, 10, v10
    v_lshlrev_b32 v13, 9, v11
    v_lshlrev_b32 v14, 4, v9
    v_add3_u32 v12, v12, v13, v14
    v_add_u32 v12, s34, v12
    v_lshlrev_b32 v15, 2, v10
    v_add3_u32 v13, v13, v14, v15
    v_add_u32 v13, s34, v13
    v_add_u32 v13, 2304, v13
    s_mul_i32 s14, s10, 14
    v_and_b32 v15, 7, v9
    v_lshlrev_b32 v15, 4, v15
    v_lshlrev_b32 v16, 1, v8
    v_add_u32 v16, s14, v16
    v_lshlrev_b32 v16, 7, v16
    v_add_u32 v16, v16, v15
    v_add_u32 v17, s14, v8
    v_lshlrev_b32 v17, 7, v17
    v_add_u32 v17, v17, v15
    v_add_u32 v17, 1024, v17
    v_add_u32 v18, s14, v11
    v_lshlrev_b32 v18, 7, v18
    v_lshlrev_b32 v19, 2, v10
    v_add3_u32 v18, v18, v15, v19
    v_add_u32 v18, 1536, v18
    s_mul_i32 s14, s10, 5120
    s_add_u32 s14, s14, 90112
    v_add_u32 v19, s14, v1
    v_add_u32 v20, 90112, v1
    v_lshlrev_b32 v21, 2, v8
    v_add_u32 v22, 0, v21
    v_cmp_le_u32 s[40:41], v22, v9
    v_add_u32 v22, 1, v21
    v_cmp_le_u32 s[42:43], v22, v9
    v_add_u32 v22, 2, v21
    v_cmp_le_u32 s[44:45], v22, v9
    v_add_u32 v22, 3, v21
    v_cmp_le_u32 s[46:47], v22, v9
    v_cmp_gt_u32 s[48:49], 2, v8
    s_mul_i32 s14, s17, 40960
    s_add_u32 s14, s14, 0x4800000
    s_add_u32 s26, s4, s14
    s_addc_u32 s27, s5, 0
    s_lshl_b32 s14, s16, 11
    s_lshl_b32 s15, s10, 10
    s_add_u32 s14, s14, s15
    v_add_u32 v21, s14, v1
    s_lshr_b32 s14, s16, 2
    s_lshl_b32 s14, s14, 11
    s_add_u32 s14, s14, s15
    s_and_b32 s15, s16, 3
    s_lshl_b32 s15, s15, 8
    s_add_u32 s14, s14, s15
    s_add_u32 s14, s14, 32768
    v_lshlrev_b32 v22, 4, v9
    v_lshlrev_b32 v23, 3, v8
    v_add3_u32 v22, v22, v23, s14
    s_lshl_b32 s14, s17, 13
    s_add_u32 s14, s14, 0x1300000
    s_add_u32 s36, s4, s14
    s_addc_u32 s37, s5, 0
    s_lshl_b32 s14, s17, 7
    s_add_u32 s14, s14, 0x1508000
    s_add_u32 s28, s4, s14
    s_addc_u32 s29, s5, 0
    v_mov_b32 v5, 0
    v_mov_b32 v6, 1
    s_mov_b32 s30, 0
    s_nop 0
sequential_preLN__memory_aug_recurrent_mem_tr__mixer_gmlp__prompt_kernel_QP_loop:
    s_waitcnt vmcnt(0)
    s_barrier
    s_mov_b32 m0, s34
    s_nop 0
    global_load_lds_dwordx4 v1, s[32:33] offset:0
    global_load_lds_dwordx4 v1, s[32:33] offset:1024
    global_load_lds_dwordx4 v1, s[32:33] offset:2048
    global_load_lds_dwordx4 v1, s[32:33] offset:3072
    s_add_u32 m0, s34, 4096
    s_nop 0
    global_load_lds_dwordx4 v7, s[32:33] offset:0
    global_load_lds_dwordx4 v7, s[32:33] offset:1024
    global_load_lds_dwordx4 v7, s[32:33] offset:2048
    global_load_lds_dwordx4 v7, s[32:33] offset:3072
    s_cmp_eq_u32 s30, 15
    s_cbranch_scc1 sequential_preLN__memory_aug_recurrent_mem_tr__mixer_gmlp__prompt_kernel_QP_nopf
    s_add_u32 s22, s22, 114688
    s_addc_u32 s23, s23, 0
    s_and_b32 s14, s30, 1
    s_cmp_eq_u32 s14, 0
    s_cselect_b32 s14, 28672, 0
    s_mul_i32 s15, s10, 7168
    s_add_u32 s24, s15, s14
    s_mov_b32 m0, s24
    s_nop 0
    global_load_lds_dwordx4 v2, s[22:23] offset:0
    global_load_lds_dwordx4 v2, s[22:23] offset:1024
    global_load_lds_dwordx4 v2, s[22:23] offset:2048
    global_load_lds_dwordx4 v2, s[22:23] offset:3072
    s_add_u32 m0, s24, 4096
    s_nop 0
    global_load_lds_dwordx4 v3, s[22:23] offset:0
    global_load_lds_dwordx4 v3, s[22:23] offset:1024
    global_load_lds_dwordx4 v3, s[22:23] offset:2048
sequential_preLN__memory_aug_recurrent_mem_tr__mixer_gmlp__prompt_kernel_QP_nopf:
    ds_read_b128 v[80:83], v4 offset:0
    ds_read_b128 v[84:87], v4 offset:1024
    ds_read_b128 v[88:91], v4 offset:2048
    ds_read_b128 v[92:95], v4 offset:3072
    s_waitcnt lgkmcnt(2)
    v_mfma_f32_16x16x32_bf16 v[24:27], v[120:123], v[80:83], 0
    v_mfma_f32_16x16x32_bf16 v[52:55], v[120:123], v[84:87], 0
    ds_read_b128 v[96:99], v4 offset:4096
    ds_read_b128 v[100:103], v4 offset:5120
    v_mfma_f32_16x16x32_bf16 v[28:31], v[176:179], v[80:83], 0
    v_mfma_f32_16x16x32_bf16 v[56:59], v[176:179], v[84:87], 0
    v_mfma_f32_16x16x32_bf16 v[32:35], v[232:235], v[80:83], 0
    v_mfma_f32_16x16x32_bf16 v[60:63], v[232:235], v[84:87], 0
    v_mfma_f32_16x16x32_bf16 v[36:39], a[32:35], v[80:83], 0
    v_mfma_f32_16x16x32_bf16 v[64:67], a[32:35], v[84:87], 0
    v_mfma_f32_16x16x32_bf16 v[40:43], a[88:91], v[80:83], 0
    v_mfma_f32_16x16x32_bf16 v[68:71], a[88:91], v[84:87], 0
    v_mfma_f32_16x16x32_bf16 v[44:47], a[144:147], v[80:83], 0
    v_mfma_f32_16x16x32_bf16 v[72:75], a[144:147], v[84:87], 0
    v_mfma_f32_16x16x32_bf16 v[48:51], a[200:203], v[80:83], 0
    v_mfma_f32_16x16x32_bf16 v[76:79], a[200:203], v[84:87], 0
    s_waitcnt lgkmcnt(2)
    v_mfma_f32_16x16x32_bf16 v[24:27], v[124:127], v[88:91], v[24:27]
    v_mfma_f32_16x16x32_bf16 v[52:55], v[124:127], v[92:95], v[52:55]
    ds_read_b128 v[80:83], v4 offset:6144
    ds_read_b128 v[84:87], v4 offset:7168
    v_mfma_f32_16x16x32_bf16 v[28:31], v[180:183], v[88:91], v[28:31]
    v_mfma_f32_16x16x32_bf16 v[56:59], v[180:183], v[92:95], v[56:59]
    v_mfma_f32_16x16x32_bf16 v[32:35], v[236:239], v[88:91], v[32:35]
    v_mfma_f32_16x16x32_bf16 v[60:63], v[236:239], v[92:95], v[60:63]
    v_mfma_f32_16x16x32_bf16 v[36:39], a[36:39], v[88:91], v[36:39]
    v_mfma_f32_16x16x32_bf16 v[64:67], a[36:39], v[92:95], v[64:67]
    v_mfma_f32_16x16x32_bf16 v[40:43], a[92:95], v[88:91], v[40:43]
    v_mfma_f32_16x16x32_bf16 v[68:71], a[92:95], v[92:95], v[68:71]
    v_mfma_f32_16x16x32_bf16 v[44:47], a[148:151], v[88:91], v[44:47]
    v_mfma_f32_16x16x32_bf16 v[72:75], a[148:151], v[92:95], v[72:75]
    v_mfma_f32_16x16x32_bf16 v[48:51], a[204:207], v[88:91], v[48:51]
    v_mfma_f32_16x16x32_bf16 v[76:79], a[204:207], v[92:95], v[76:79]
    s_waitcnt lgkmcnt(2)
    v_mfma_f32_16x16x32_bf16 v[24:27], v[128:131], v[96:99], v[24:27]
    v_mfma_f32_16x16x32_bf16 v[52:55], v[128:131], v[100:103], v[52:55]
    ds_read_b128 v[88:91], v4 offset:8192
    ds_read_b128 v[92:95], v4 offset:9216
    v_mfma_f32_16x16x32_bf16 v[28:31], v[184:187], v[96:99], v[28:31]
    v_mfma_f32_16x16x32_bf16 v[56:59], v[184:187], v[100:103], v[56:59]
    v_mfma_f32_16x16x32_bf16 v[32:35], v[240:243], v[96:99], v[32:35]
    v_mfma_f32_16x16x32_bf16 v[60:63], v[240:243], v[100:103], v[60:63]
    v_mfma_f32_16x16x32_bf16 v[36:39], a[40:43], v[96:99], v[36:39]
    v_mfma_f32_16x16x32_bf16 v[64:67], a[40:43], v[100:103], v[64:67]
    v_mfma_f32_16x16x32_bf16 v[40:43], a[96:99], v[96:99], v[40:43]
    v_mfma_f32_16x16x32_bf16 v[68:71], a[96:99], v[100:103], v[68:71]
    v_mfma_f32_16x16x32_bf16 v[44:47], a[152:155], v[96:99], v[44:47]
    v_mfma_f32_16x16x32_bf16 v[72:75], a[152:155], v[100:103], v[72:75]
    v_mfma_f32_16x16x32_bf16 v[48:51], a[208:211], v[96:99], v[48:51]
    v_mfma_f32_16x16x32_bf16 v[76:79], a[208:211], v[100:103], v[76:79]
    s_waitcnt lgkmcnt(2)
    v_mfma_f32_16x16x32_bf16 v[24:27], v[132:135], v[80:83], v[24:27]
    v_mfma_f32_16x16x32_bf16 v[52:55], v[132:135], v[84:87], v[52:55]
    ds_read_b128 v[96:99], v4 offset:10240
    ds_read_b128 v[100:103], v4 offset:11264
    v_mfma_f32_16x16x32_bf16 v[28:31], v[188:191], v[80:83], v[28:31]
    v_mfma_f32_16x16x32_bf16 v[56:59], v[188:191], v[84:87], v[56:59]
    v_mfma_f32_16x16x32_bf16 v[32:35], v[244:247], v[80:83], v[32:35]
    v_mfma_f32_16x16x32_bf16 v[60:63], v[244:247], v[84:87], v[60:63]
    v_mfma_f32_16x16x32_bf16 v[36:39], a[44:47], v[80:83], v[36:39]
    v_mfma_f32_16x16x32_bf16 v[64:67], a[44:47], v[84:87], v[64:67]
    v_mfma_f32_16x16x32_bf16 v[40:43], a[100:103], v[80:83], v[40:43]
    v_mfma_f32_16x16x32_bf16 v[68:71], a[100:103], v[84:87], v[68:71]
    v_mfma_f32_16x16x32_bf16 v[44:47], a[156:159], v[80:83], v[44:47]
    v_mfma_f32_16x16x32_bf16 v[72:75], a[156:159], v[84:87], v[72:75]
    v_mfma_f32_16x16x32_bf16 v[48:51], a[212:215], v[80:83], v[48:51]
    v_mfma_f32_16x16x32_bf16 v[76:79], a[212:215], v[84:87], v[76:79]
    s_waitcnt lgkmcnt(2)
    v_mfma_f32_16x16x32_bf16 v[24:27], v[136:139], v[88:91], v[24:27]
    v_mfma_f32_16x16x32_bf16 v[52:55], v[136:139], v[92:95], v[52:55]
    ds_read_b128 v[80:83], v4 offset:12288
    ds_read_b128 v[84:87], v4 offset:13312
    v_mfma_f32_16x16x32_bf16 v[28:31], v[192:195], v[88:91], v[28:31]
    v_mfma_f32_16x16x32_bf16 v[56:59], v[192:195], v[92:95], v[56:59]
    v_mfma_f32_16x16x32_bf16 v[32:35], v[248:251], v[88:91], v[32:35]
    v_mfma_f32_16x16x32_bf16 v[60:63], v[248:251], v[92:95], v[60:63]
    v_mfma_f32_16x16x32_bf16 v[36:39], a[48:51], v[88:91], v[36:39]
    v_mfma_f32_16x16x32_bf16 v[64:67], a[48:51], v[92:95], v[64:67]
    v_mfma_f32_16x16x32_bf16 v[40:43], a[104:107], v[88:91], v[40:43]
    v_mfma_f32_16x16x32_bf16 v[68:71], a[104:107], v[92:95], v[68:71]
    v_mfma_f32_16x16x32_bf16 v[44:47], a[160:163], v[88:91], v[44:47]
    v_mfma_f32_16x16x32_bf16 v[72:75], a[160:163], v[92:95], v[72:75]
    v_mfma_f32_16x16x32_bf16 v[48:51], a[216:219], v[88:91], v[48:51]
    v_mfma_f32_16x16x32_bf16 v[76:79], a[216:219], v[92:95], v[76:79]
    s_waitcnt lgkmcnt(2)
    v_mfma_f32_16x16x32_bf16 v[24:27], v[140:143], v[96:99], v[24:27]
    v_mfma_f32_16x16x32_bf16 v[52:55], v[140:143], v[100:103], v[52:55]
    ds_read_b128 v[88:91], v4 offset:14336
    ds_read_b128 v[92:95], v4 offset:15360
    v_mfma_f32_16x16x32_bf16 v[28:31], v[196:199], v[96:99], v[28:31]
    v_mfma_f32_16x16x32_bf16 v[56:59], v[196:199], v[100:103], v[56:59]
    v_mfma_f32_16x16x32_bf16 v[32:35], v[252:255], v[96:99], v[32:35]
    v_mfma_f32_16x16x32_bf16 v[60:63], v[252:255], v[100:103], v[60:63]
    v_mfma_f32_16x16x32_bf16 v[36:39], a[52:55], v[96:99], v[36:39]
    v_mfma_f32_16x16x32_bf16 v[64:67], a[52:55], v[100:103], v[64:67]
    v_mfma_f32_16x16x32_bf16 v[40:43], a[108:111], v[96:99], v[40:43]
    v_mfma_f32_16x16x32_bf16 v[68:71], a[108:111], v[100:103], v[68:71]
    v_mfma_f32_16x16x32_bf16 v[44:47], a[164:167], v[96:99], v[44:47]
    v_mfma_f32_16x16x32_bf16 v[72:75], a[164:167], v[100:103], v[72:75]
    v_mfma_f32_16x16x32_bf16 v[48:51], a[220:223], v[96:99], v[48:51]
    v_mfma_f32_16x16x32_bf16 v[76:79], a[220:223], v[100:103], v[76:79]
    s_waitcnt lgkmcnt(2)
    v_mfma_f32_16x16x32_bf16 v[24:27], v[144:147], v[80:83], v[24:27]
    v_mfma_f32_16x16x32_bf16 v[52:55], v[144:147], v[84:87], v[52:55]
    ds_read_b128 v[96:99], v4 offset:16384
    ds_read_b128 v[100:103], v4 offset:17408
    v_mfma_f32_16x16x32_bf16 v[28:31], v[200:203], v[80:83], v[28:31]
    v_mfma_f32_16x16x32_bf16 v[56:59], v[200:203], v[84:87], v[56:59]
    v_mfma_f32_16x16x32_bf16 v[32:35], a[0:3], v[80:83], v[32:35]
    v_mfma_f32_16x16x32_bf16 v[60:63], a[0:3], v[84:87], v[60:63]
    v_mfma_f32_16x16x32_bf16 v[36:39], a[56:59], v[80:83], v[36:39]
    v_mfma_f32_16x16x32_bf16 v[64:67], a[56:59], v[84:87], v[64:67]
    v_mfma_f32_16x16x32_bf16 v[40:43], a[112:115], v[80:83], v[40:43]
    v_mfma_f32_16x16x32_bf16 v[68:71], a[112:115], v[84:87], v[68:71]
    v_mfma_f32_16x16x32_bf16 v[44:47], a[168:171], v[80:83], v[44:47]
    v_mfma_f32_16x16x32_bf16 v[72:75], a[168:171], v[84:87], v[72:75]
    v_mfma_f32_16x16x32_bf16 v[48:51], a[224:227], v[80:83], v[48:51]
    v_mfma_f32_16x16x32_bf16 v[76:79], a[224:227], v[84:87], v[76:79]
    s_waitcnt lgkmcnt(2)
    v_mfma_f32_16x16x32_bf16 v[24:27], v[148:151], v[88:91], v[24:27]
    v_mfma_f32_16x16x32_bf16 v[52:55], v[148:151], v[92:95], v[52:55]
    ds_read_b128 v[80:83], v4 offset:18432
    ds_read_b128 v[84:87], v4 offset:19456
    v_mfma_f32_16x16x32_bf16 v[28:31], v[204:207], v[88:91], v[28:31]
    v_mfma_f32_16x16x32_bf16 v[56:59], v[204:207], v[92:95], v[56:59]
    v_mfma_f32_16x16x32_bf16 v[32:35], a[4:7], v[88:91], v[32:35]
    v_mfma_f32_16x16x32_bf16 v[60:63], a[4:7], v[92:95], v[60:63]
    v_mfma_f32_16x16x32_bf16 v[36:39], a[60:63], v[88:91], v[36:39]
    v_mfma_f32_16x16x32_bf16 v[64:67], a[60:63], v[92:95], v[64:67]
    v_mfma_f32_16x16x32_bf16 v[40:43], a[116:119], v[88:91], v[40:43]
    v_mfma_f32_16x16x32_bf16 v[68:71], a[116:119], v[92:95], v[68:71]
    v_mfma_f32_16x16x32_bf16 v[44:47], a[172:175], v[88:91], v[44:47]
    v_mfma_f32_16x16x32_bf16 v[72:75], a[172:175], v[92:95], v[72:75]
    v_mfma_f32_16x16x32_bf16 v[48:51], a[228:231], v[88:91], v[48:51]
    v_mfma_f32_16x16x32_bf16 v[76:79], a[228:231], v[92:95], v[76:79]
    s_waitcnt lgkmcnt(2)
    v_mfma_f32_16x16x32_bf16 v[24:27], v[152:155], v[96:99], v[24:27]
    v_mfma_f32_16x16x32_bf16 v[52:55], v[152:155], v[100:103], v[52:55]
    ds_read_b128 v[88:91], v4 offset:20480
    ds_read_b128 v[92:95], v4 offset:21504
    v_mfma_f32_16x16x32_bf16 v[28:31], v[208:211], v[96:99], v[28:31]
    v_mfma_f32_16x16x32_bf16 v[56:59], v[208:211], v[100:103], v[56:59]
    v_mfma_f32_16x16x32_bf16 v[32:35], a[8:11], v[96:99], v[32:35]
    v_mfma_f32_16x16x32_bf16 v[60:63], a[8:11], v[100:103], v[60:63]
    v_mfma_f32_16x16x32_bf16 v[36:39], a[64:67], v[96:99], v[36:39]
    v_mfma_f32_16x16x32_bf16 v[64:67], a[64:67], v[100:103], v[64:67]
    v_mfma_f32_16x16x32_bf16 v[40:43], a[120:123], v[96:99], v[40:43]
    v_mfma_f32_16x16x32_bf16 v[68:71], a[120:123], v[100:103], v[68:71]
    v_mfma_f32_16x16x32_bf16 v[44:47], a[176:179], v[96:99], v[44:47]
    v_mfma_f32_16x16x32_bf16 v[72:75], a[176:179], v[100:103], v[72:75]
    v_mfma_f32_16x16x32_bf16 v[48:51], a[232:235], v[96:99], v[48:51]
    v_mfma_f32_16x16x32_bf16 v[76:79], a[232:235], v[100:103], v[76:79]
    s_waitcnt lgkmcnt(2)
    v_mfma_f32_16x16x32_bf16 v[24:27], v[156:159], v[80:83], v[24:27]
    v_mfma_f32_16x16x32_bf16 v[52:55], v[156:159], v[84:87], v[52:55]
    ds_read_b128 v[96:99], v4 offset:22528
    ds_read_b128 v[100:103], v4 offset:23552
    v_mfma_f32_16x16x32_bf16 v[28:31], v[212:215], v[80:83], v[28:31]
    v_mfma_f32_16x16x32_bf16 v[56:59], v[212:215], v[84:87], v[56:59]
    v_mfma_f32_16x16x32_bf16 v[32:35], a[12:15], v[80:83], v[32:35]
    v_mfma_f32_16x16x32_bf16 v[60:63], a[12:15], v[84:87], v[60:63]
    v_mfma_f32_16x16x32_bf16 v[36:39], a[68:71], v[80:83], v[36:39]
    v_mfma_f32_16x16x32_bf16 v[64:67], a[68:71], v[84:87], v[64:67]
    v_mfma_f32_16x16x32_bf16 v[40:43], a[124:127], v[80:83], v[40:43]
    v_mfma_f32_16x16x32_bf16 v[68:71], a[124:127], v[84:87], v[68:71]
    v_mfma_f32_16x16x32_bf16 v[44:47], a[180:183], v[80:83], v[44:47]
    v_mfma_f32_16x16x32_bf16 v[72:75], a[180:183], v[84:87], v[72:75]
    v_mfma_f32_16x16x32_bf16 v[48:51], a[236:239], v[80:83], v[48:51]
    v_mfma_f32_16x16x32_bf16 v[76:79], a[236:239], v[84:87], v[76:79]
    s_waitcnt lgkmcnt(2)
    v_mfma_f32_16x16x32_bf16 v[24:27], v[160:163], v[88:91], v[24:27]
    v_mfma_f32_16x16x32_bf16 v[52:55], v[160:163], v[92:95], v[52:55]
    ds_read_b128 v[80:83], v4 offset:24576
    ds_read_b128 v[84:87], v4 offset:25600
    v_mfma_f32_16x16x32_bf16 v[28:31], v[216:219], v[88:91], v[28:31]
    v_mfma_f32_16x16x32_bf16 v[56:59], v[216:219], v[92:95], v[56:59]
    v_mfma_f32_16x16x32_bf16 v[32:35], a[16:19], v[88:91], v[32:35]
    v_mfma_f32_16x16x32_bf16 v[60:63], a[16:19], v[92:95], v[60:63]
    v_mfma_f32_16x16x32_bf16 v[36:39], a[72:75], v[88:91], v[36:39]
    v_mfma_f32_16x16x32_bf16 v[64:67], a[72:75], v[92:95], v[64:67]
    v_mfma_f32_16x16x32_bf16 v[40:43], a[128:131], v[88:91], v[40:43]
    v_mfma_f32_16x16x32_bf16 v[68:71], a[128:131], v[92:95], v[68:71]
    v_mfma_f32_16x16x32_bf16 v[44:47], a[184:187], v[88:91], v[44:47]
    v_mfma_f32_16x16x32_bf16 v[72:75], a[184:187], v[92:95], v[72:75]
    v_mfma_f32_16x16x32_bf16 v[48:51], a[240:243], v[88:91], v[48:51]
    v_mfma_f32_16x16x32_bf16 v[76:79], a[240:243], v[92:95], v[76:79]
    s_waitcnt lgkmcnt(2)
    v_mfma_f32_16x16x32_bf16 v[24:27], v[164:167], v[96:99], v[24:27]
    v_mfma_f32_16x16x32_bf16 v[52:55], v[164:167], v[100:103], v[52:55]
    ds_read_b128 v[88:91], v4 offset:26624
    ds_read_b128 v[92:95], v4 offset:27648
    v_mfma_f32_16x16x32_bf16 v[28:31], v[220:223], v[96:99], v[28:31]
    v_mfma_f32_16x16x32_bf16 v[56:59], v[220:223], v[100:103], v[56:59]
    v_mfma_f32_16x16x32_bf16 v[32:35], a[20:23], v[96:99], v[32:35]
    v_mfma_f32_16x16x32_bf16 v[60:63], a[20:23], v[100:103], v[60:63]
    v_mfma_f32_16x16x32_bf16 v[36:39], a[76:79], v[96:99], v[36:39]
    v_mfma_f32_16x16x32_bf16 v[64:67], a[76:79], v[100:103], v[64:67]
    v_mfma_f32_16x16x32_bf16 v[40:43], a[132:135], v[96:99], v[40:43]
    v_mfma_f32_16x16x32_bf16 v[68:71], a[132:135], v[100:103], v[68:71]
    v_mfma_f32_16x16x32_bf16 v[44:47], a[188:191], v[96:99], v[44:47]
    v_mfma_f32_16x16x32_bf16 v[72:75], a[188:191], v[100:103], v[72:75]
    v_mfma_f32_16x16x32_bf16 v[48:51], a[244:247], v[96:99], v[48:51]
    v_mfma_f32_16x16x32_bf16 v[76:79], a[244:247], v[100:103], v[76:79]
    s_waitcnt lgkmcnt(2)
    v_mfma_f32_16x16x32_bf16 v[24:27], v[168:171], v[80:83], v[24:27]
    v_mfma_f32_16x16x32_bf16 v[52:55], v[168:171], v[84:87], v[52:55]
    v_mfma_f32_16x16x32_bf16 v[28:31], v[224:227], v[80:83], v[28:31]
    v_mfma_f32_16x16x32_bf16 v[56:59], v[224:227], v[84:87], v[56:59]
    v_mfma_f32_16x16x32_bf16 v[32:35], a[24:27], v[80:83], v[32:35]
    v_mfma_f32_16x16x32_bf16 v[60:63], a[24:27], v[84:87], v[60:63]
    v_mfma_f32_16x16x32_bf16 v[36:39], a[80:83], v[80:83], v[36:39]
    v_mfma_f32_16x16x32_bf16 v[64:67], a[80:83], v[84:87], v[64:67]
    v_mfma_f32_16x16x32_bf16 v[40:43], a[136:139], v[80:83], v[40:43]
    v_mfma_f32_16x16x32_bf16 v[68:71], a[136:139], v[84:87], v[68:71]
    v_mfma_f32_16x16x32_bf16 v[44:47], a[192:195], v[80:83], v[44:47]
    v_mfma_f32_16x16x32_bf16 v[72:75], a[192:195], v[84:87], v[72:75]
    v_mfma_f32_16x16x32_bf16 v[48:51], a[248:251], v[80:83], v[48:51]
    v_mfma_f32_16x16x32_bf16 v[76:79], a[248:251], v[84:87], v[76:79]
    s_waitcnt lgkmcnt(0)
    v_mfma_f32_16x16x32_bf16 v[24:27], v[172:175], v[88:91], v[24:27]
    v_mfma_f32_16x16x32_bf16 v[52:55], v[172:175], v[92:95], v[52:55]
    v_mfma_f32_16x16x32_bf16 v[28:31], v[228:231], v[88:91], v[28:31]
    v_mfma_f32_16x16x32_bf16 v[56:59], v[228:231], v[92:95], v[56:59]
    v_mfma_f32_16x16x32_bf16 v[32:35], a[28:31], v[88:91], v[32:35]
    v_mfma_f32_16x16x32_bf16 v[60:63], a[28:31], v[92:95], v[60:63]
    v_mfma_f32_16x16x32_bf16 v[36:39], a[84:87], v[88:91], v[36:39]
    v_mfma_f32_16x16x32_bf16 v[64:67], a[84:87], v[92:95], v[64:67]
    v_mfma_f32_16x16x32_bf16 v[40:43], a[140:143], v[88:91], v[40:43]
    v_mfma_f32_16x16x32_bf16 v[68:71], a[140:143], v[92:95], v[68:71]
    v_mfma_f32_16x16x32_bf16 v[44:47], a[196:199], v[88:91], v[44:47]
    v_mfma_f32_16x16x32_bf16 v[72:75], a[196:199], v[92:95], v[72:75]
    v_mfma_f32_16x16x32_bf16 v[48:51], a[252:255], v[88:91], v[48:51]
    v_mfma_f32_16x16x32_bf16 v[76:79], a[252:255], v[92:95], v[76:79]
    v_cvt_pk_bf16_f32 v80, v24, v25
    v_cvt_pk_bf16_f32 v81, v28, v29
    v_cvt_pk_bf16_f32 v82, v26, v27
    v_cvt_pk_bf16_f32 v83, v30, v31
    v_cvt_pk_bf16_f32 v84, v32, v33
    v_cvt_pk_bf16_f32 v85, v36, v37
    v_cvt_pk_bf16_f32 v86, v34, v35
    v_cvt_pk_bf16_f32 v87, v38, v39
    v_cvt_pk_bf16_f32 v88, v40, v41
    v_cvt_pk_bf16_f32 v89, v44, v45
    v_cvt_pk_bf16_f32 v90, v42, v43
    v_cvt_pk_bf16_f32 v91, v46, v47
    v_cvt_pk_bf16_f32 v92, v48, v49
    v_cvt_pk_bf16_f32 v93, v50, v51
    v_cvt_pk_bf16_f32 v94, v52, v53
    v_cvt_pk_bf16_f32 v95, v56, v57
    v_cvt_pk_bf16_f32 v96, v54, v55
    v_cvt_pk_bf16_f32 v97, v58, v59
    v_cvt_pk_bf16_f32 v98, v60, v61
    v_cvt_pk_bf16_f32 v99, v64, v65
    v_cvt_pk_bf16_f32 v100, v62, v63
    v_cvt_pk_bf16_f32 v101, v66, v67
    v_cvt_pk_bf16_f32 v102, v68, v69
    v_cvt_pk_bf16_f32 v103, v72, v73
    v_cvt_pk_bf16_f32 v104, v70, v71
    v_cvt_pk_bf16_f32 v105, v74, v75
    v_cvt_pk_bf16_f32 v106, v76, v77
    v_cvt_pk_bf16_f32 v107, v78, v79
    s_waitcnt vmcnt(7)
    s_cmp_eq_u32 s30, 15
    s_cbranch_scc0 sequential_preLN__memory_aug_recurrent_mem_tr__mixer_gmlp__prompt_kernel_QP_kw
    s_waitcnt vmcnt(0)
sequential_preLN__memory_aug_recurrent_mem_tr__mixer_gmlp__prompt_kernel_QP_kw:
    ds_read_b128 v[44:47], v12 offset:0
    ds_read_b128 v[48:51], v12 offset:256
    ds_read_b128 v[52:55], v12 offset:2048
    ds_read2_b32 v[56:57], v13 offset0:0 offset1:2
    v_add_u32 v23, 0x1000, v13
    s_waitcnt lgkmcnt(0)
    v_mfma_f32_16x16x32_bf16 v[28:31], v[44:47], v[80:83], 0
    v_mfma_f32_16x16x32_bf16 v[36:39], v[44:47], v[94:97], 0
    v_mfma_f32_16x16x32_bf16 v[28:31], v[48:51], v[84:87], v[28:31]
    v_mfma_f32_16x16x32_bf16 v[36:39], v[48:51], v[98:101], v[36:39]
    v_mfma_f32_16x16x32_bf16 v[28:31], v[52:55], v[88:91], v[28:31]
    v_mfma_f32_16x16x32_bf16 v[36:39], v[52:55], v[102:105], v[36:39]
    s_nop 4
    v_mfma_f32_16x16x16_bf16 v[28:31], v[56:57], v[92:93], v[28:31]
    v_mfma_f32_16x16x16_bf16 v[36:39], v[56:57], v[106:107], v[36:39]
    ds_read_b128 v[44:47], v12 offset:4096
    ds_read_b128 v[48:51], v12 offset:4352
    ds_read_b128 v[52:55], v12 offset:6144
    ds_read2_b32 v[56:57], v23 offset0:0 offset1:2
    s_waitcnt lgkmcnt(0)
    v_mfma_f32_16x16x32_bf16 v[40:43], v[44:47], v[94:97], 0
    v_mfma_f32_16x16x32_bf16 v[40:43], v[48:51], v[98:101], v[40:43]
    v_mfma_f32_16x16x32_bf16 v[40:43], v[52:55], v[102:105], v[40:43]
    s_nop 5
    v_mfma_f32_16x16x16_bf16 v[40:43], v[56:57], v[106:107], v[40:43]
    s_mov_b32 s13, 131072
    s_nop 6
sequential_preLN__memory_aug_recurrent_mem_tr__mixer_gmlp__prompt_kernel_QP_mpoll:
    global_load_dwordx4 v[44:47], v16, s[36:37] sc1
    global_load_dwordx4 v[48:51], v16, s[36:37] offset:128 sc1
    global_load_dwordx4 v[52:55], v17, s[36:37] sc1
    global_load_dword v56, v18, s[36:37] sc1
    global_load_dword v57, v18, s[36:37] offset:8 sc1
    s_waitcnt vmcnt(0)
    v_max3_u32 v60, v44, v45, v46
    v_max3_u32 v60, v60, v47, v48
    v_max3_u32 v60, v60, v49, v50
    v_max3_u32 v60, v60, v51, v52
    v_max3_u32 v60, v60, v53, v54
    v_max3_u32 v60, v60, v55, v56
    v_max_u32 v60, v60, v57
    v_cmp_eq_u32 vcc, -1, v60
    s_nop 0
    s_cbranch_vccz sequential_preLN__memory_aug_recurrent_mem_tr__mixer_gmlp__prompt_kernel_QP_mok
    s_cmp_lt_u32 s30, 15
    s_cbranch_scc0 sequential_preLN__memory_aug_recurrent_mem_tr__mixer_gmlp__prompt_kernel_QP_mp_as
    s_sleep 8
sequential_preLN__memory_aug_recurrent_mem_tr__mixer_gmlp__prompt_kernel_QP_mp_as:
    s_sleep 2
    s_sub_u32 s13, s13, 1
    s_cbranch_scc0 sequential_preLN__memory_aug_recurrent_mem_tr__mixer_gmlp__prompt_kernel_QP_mpoll
    s_endpgm
sequential_preLN__memory_aug_recurrent_mem_tr__mixer_gmlp__prompt_kernel_QP_mok:
    v_mfma_f32_16x16x32_bf16 v[24:27], v[44:47], v[80:83], 0
    v_mfma_f32_16x16x32_bf16 v[32:35], v[44:47], v[94:97], 0
    v_mfma_f32_16x16x32_bf16 v[24:27], v[48:51], v[84:87], v[24:27]
    v_mfma_f32_16x16x32_bf16 v[32:35], v[48:51], v[98:101], v[32:35]
    v_mfma_f32_16x16x32_bf16 v[24:27], v[52:55], v[88:91], v[24:27]
    v_mfma_f32_16x16x32_bf16 v[32:35], v[52:55], v[102:105], v[32:35]
    s_nop 4
    v_mfma_f32_16x16x16_bf16 v[24:27], v[56:57], v[92:93], v[24:27]
    v_mfma_f32_16x16x16_bf16 v[32:35], v[56:57], v[106:107], v[32:35]
    s_nop 6
    ds_write_b128 v19, v[24:27] offset:0
    ds_write_b128 v19, v[28:31] offset:1024
    ds_write_b128 v19, v[32:35] offset:2048
    ds_write_b128 v19, v[36:39] offset:3072
    ds_write_b128 v19, v[40:43] offset:4096
    s_waitcnt lgkmcnt(0)
    s_barrier
    s_cmp_ge_u32 s10, 2
    s_cbranch_scc1 sequential_preLN__memory_aug_recurrent_mem_tr__mixer_gmlp__prompt_kernel_QP_skip
    s_lshl_b32 s14, s10, 11
    v_add_u32 v23, s14, v20
    ds_read_b128 v[60:63], v23 offset:0
    ds_read_b128 v[64:67], v23 offset:5120
    ds_read_b128 v[68:71], v23 offset:10240
    ds_read_b128 v[72:75], v23 offset:15360
    s_waitcnt lgkmcnt(0)
    v_add_f32 v60, v60, v64
    v_add_f32 v68, v68, v72
    v_add_f32 v44, v60, v68
    v_add_f32 v61, v61, v65
    v_add_f32 v69, v69, v73
    v_add_f32 v45, v61, v69
    v_add_f32 v62, v62, v66
    v_add_f32 v70, v70, v74
    v_add_f32 v46, v62, v70
    v_add_f32 v63, v63, v67
    v_add_f32 v71, v71, v75
    v_add_f32 v47, v63, v71
    ds_read_b128 v[60:63], v23 offset:1024
    ds_read_b128 v[64:67], v23 offset:6144
    ds_read_b128 v[68:71], v23 offset:11264
    ds_read_b128 v[72:75], v23 offset:16384
    s_waitcnt lgkmcnt(0)
    v_add_f32 v60, v60, v64
    v_add_f32 v68, v68, v72
    v_add_f32 v48, v60, v68
    v_add_f32 v61, v61, v65
    v_add_f32 v69, v69, v73
    v_add_f32 v49, v61, v69
    v_add_f32 v62, v62, v66
    v_add_f32 v70, v70, v74
    v_add_f32 v50, v62, v70
    v_add_f32 v63, v63, v67
    v_add_f32 v71, v71, v75
    v_add_f32 v51, v63, v71
    ds_read_b128 v[60:63], v20 offset:4096
    ds_read_b128 v[64:67], v20 offset:9216
    ds_read_b128 v[68:71], v20 offset:14336
    ds_read_b128 v[72:75], v20 offset:19456
    s_waitcnt lgkmcnt(0)
    v_add_f32 v60, v60, v64
    v_add_f32 v68, v68, v72
    v_add_f32 v52, v60, v68
    v_add_f32 v61, v61, v65
    v_add_f32 v69, v69, v73
    v_add_f32 v53, v61, v69
    v_add_f32 v62, v62, v66
    v_add_f32 v70, v70, v74
    v_add_f32 v54, v62, v70
    v_add_f32 v63, v63, v67
    v_add_f32 v71, v71, v75
    v_add_f32 v55, v63, v71
    v_mov_b32 v60, 0xff800000
    v_cndmask_b32 v44, v60, v44, s[48:49]
    v_cndmask_b32 v45, v60, v45, s[48:49]
    v_cndmask_b32 v46, v60, v46, s[48:49]
    v_cndmask_b32 v47, v60, v47, s[48:49]
    s_cmp_eq_u32 s10, 0
    s_cbranch_scc0 sequential_preLN__memory_aug_recurrent_mem_tr__mixer_gmlp__prompt_kernel_QP_tt1
    v_cndmask_b32 v48, v60, v48, s[40:41]
    v_mov_b32 v52, v60
    v_cndmask_b32 v49, v60, v49, s[42:43]
    v_mov_b32 v53, v60
    v_cndmask_b32 v50, v60, v50, s[44:45]
    v_mov_b32 v54, v60
    v_cndmask_b32 v51, v60, v51, s[46:47]
    v_mov_b32 v55, v60
    s_nop 0
    s_branch sequential_preLN__memory_aug_recurrent_mem_tr__mixer_gmlp__prompt_kernel_QP_ttj
sequential_preLN__memory_aug_recurrent_mem_tr__mixer_gmlp__prompt_kernel_QP_tt1:
    v_cndmask_b32 v52, v60, v52, s[40:41]
    v_cndmask_b32 v53, v60, v53, s[42:43]
    v_cndmask_b32 v54, v60, v54, s[44:45]
    v_cndmask_b32 v55, v60, v55, s[46:47]
    s_nop 1
sequential_preLN__memory_aug_recurrent_mem_tr__mixer_gmlp__prompt_kernel_QP_ttj:
    v_max3_f32 v61, v44, v45, v46
    v_max3_f32 v61, v61, v47, v48
    v_max3_f32 v61, v61, v49, v50
    v_max3_f32 v61, v61, v51, v52
    v_max3_f32 v61, v61, v53, v54
    v_max_f32 v61, v61, v55
    v_mov_b32 v62, v61
    s_nop 1
    v_permlane16_swap_b32 v61, v62
    v_max_f32 v61, v61, v62
    v_mov_b32 v62, v61
    s_nop 1
    v_permlane32_swap_b32 v61, v62
    v_max_f32 v61, v61, v62
    v_sub_f32 v44, v44, v61
    v_sub_f32 v45, v45, v61
    v_sub_f32 v46, v46, v61
    v_sub_f32 v47, v47, v61
    v_sub_f32 v48, v48, v61
    v_sub_f32 v49, v49, v61
    v_sub_f32 v50, v50, v61
    v_sub_f32 v51, v51, v61
    v_sub_f32 v52, v52, v61
    v_sub_f32 v53, v53, v61
    v_sub_f32 v54, v54, v61
    v_sub_f32 v55, v55, v61
    v_exp_f32 v44, v44
    v_exp_f32 v45, v45
    v_exp_f32 v46, v46
    v_exp_f32 v47, v47
    v_exp_f32 v48, v48
    v_exp_f32 v49, v49
    v_exp_f32 v50, v50
    v_exp_f32 v51, v51
    v_exp_f32 v52, v52
    v_exp_f32 v53, v53
    v_exp_f32 v54, v54
    v_exp_f32 v55, v55
    v_add_f32 v61, v44, v45
    v_add_f32 v61, v61, v46
    v_add_f32 v61, v61, v47
    v_add_f32 v61, v61, v48
    v_add_f32 v61, v61, v49
    v_add_f32 v61, v61, v50
    v_add_f32 v61, v61, v51
    v_add_f32 v61, v61, v52
    v_add_f32 v61, v61, v53
    v_add_f32 v61, v61, v54
    v_add_f32 v61, v61, v55
    v_mov_b32 v62, v61
    s_nop 1
    v_permlane16_swap_b32 v61, v62
    v_add_f32 v61, v61, v62
    v_mov_b32 v62, v61
    s_nop 1
    v_permlane32_swap_b32 v61, v62
    v_add_f32 v61, v61, v62
    v_rcp_f32 v61, v61
    s_nop 0
    v_mul_f32 v44, v44, v61
    v_mul_f32 v45, v45, v61
    v_mul_f32 v46, v46, v61
    v_mul_f32 v47, v47, v61
    v_mul_f32 v48, v48, v61
    v_mul_f32 v49, v49, v61
    v_mul_f32 v50, v50, v61
    v_mul_f32 v51, v51, v61
    v_mul_f32 v52, v52, v61
    v_mul_f32 v53, v53, v61
    v_mul_f32 v54, v54, v61
    v_mul_f32 v55, v55, v61
    v_cvt_pk_bf16_f32 v64, v48, v49
    v_cvt_pk_bf16_f32 v65, v50, v51
    v_cvt_pk_bf16_f32 v66, v52, v53
    v_cvt_pk_bf16_f32 v67, v54, v55
    v_cvt_pk_bf16_f32 v68, v44, v45
    v_cvt_pk_bf16_f32 v69, v46, v47
    global_store_dwordx4 v21, v[64:67], s[26:27] sc1
    s_mov_b32 exec_hi, 0
    global_store_dwordx2 v22, v[68:69], s[26:27] sc1
    s_mov_b32 exec_hi, -1
sequential_preLN__memory_aug_recurrent_mem_tr__mixer_gmlp__prompt_kernel_QP_skip:
    s_waitcnt vmcnt(0)
    s_barrier
    s_cmp_lg_u32 s10, 0
    s_cbranch_scc1 sequential_preLN__memory_aug_recurrent_mem_tr__mixer_gmlp__prompt_kernel_QP_flag
    s_mov_b64 exec, 1
    global_atomic_add v5, v6, s[28:29] offset:0
    s_mov_b64 exec, -1
    s_nop 4
sequential_preLN__memory_aug_recurrent_mem_tr__mixer_gmlp__prompt_kernel_QP_flag:
    s_add_u32 s26, s26, 163840
    s_addc_u32 s27, s27, 0
    s_add_u32 s28, s28, 512
    s_addc_u32 s29, s29, 0
    s_add_u32 s32, s32, 131072
    s_addc_u32 s33, s33, 0
    s_add_u32 s36, s36, 32768
    s_addc_u32 s37, s37, 0
    s_and_b32 s14, s30, 1
    s_cmp_eq_u32 s14, 0
    s_cselect_b32 s14, 28672, 0
    v_add_u32 v4, s14, v1
    s_add_u32 s30, s30, 1
    s_cmp_lt_u32 s30, 16
    s_cbranch_scc1 sequential_preLN__memory_aug_recurrent_mem_tr__mixer_gmlp__prompt_kernel_QP_loop
    s_waitcnt vmcnt(0) lgkmcnt(0)
    s_barrier
    s_branch sequential_preLN__memory_aug_recurrent_mem_tr__mixer_gmlp__prompt_kernel_DL0
sequential_preLN__memory_aug_recurrent_mem_tr__mixer_gmlp__prompt_kernel_VB:
    s_cmp_lg_u32 s10, 0
    s_cbranch_scc1 sequential_preLN__memory_aug_recurrent_mem_tr__mixer_gmlp__prompt_kernel_VB_all_pwj
    s_mov_b32 s13, 131072
    s_add_u32 s76, s4, 0x1580000
    s_addc_u32 s77, s5, 0
    v_mbcnt_lo_u32_b32 v20, -1, 0
    v_mbcnt_hi_u32_b32 v20, -1, v20
    v_lshlrev_b32 v20, 4, v20
    s_nop 1
sequential_preLN__memory_aug_recurrent_mem_tr__mixer_gmlp__prompt_kernel_VB_all_pw:
    global_load_dwordx4 v[22:25], v20, s[76:77] sc1
    s_waitcnt vmcnt(0)
    v_xor_b32 v22, s78, v22
    v_xor_b32 v23, s78, v23
    v_xor_b32 v24, s78, v24
    v_xor_b32 v25, s78, v25
    v_or_b32 v22, v22, v23
    v_or_b32 v24, v24, v25
    v_or_b32 v22, v22, v24
    v_cmp_ne_u32 vcc, 0, v22
    s_nop 0
    s_cbranch_vccz sequential_preLN__memory_aug_recurrent_mem_tr__mixer_gmlp__prompt_kernel_VB_all_pwok
    s_sleep 16
    s_sub_u32 s13, s13, 1
    s_cbranch_scc0 sequential_preLN__memory_aug_recurrent_mem_tr__mixer_gmlp__prompt_kernel_VB_all_pw
    s_endpgm
sequential_preLN__memory_aug_recurrent_mem_tr__mixer_gmlp__prompt_kernel_VB_all_pwok:
    buffer_inv sc1
    s_waitcnt vmcnt(0)
sequential_preLN__memory_aug_recurrent_mem_tr__mixer_gmlp__prompt_kernel_VB_all_pwj:
    s_barrier
    v_lshlrev_b32 v1, 4, v1
    v_and_b32 v0, 63, v0
    s_mul_i32 s14, s9, 28
    s_mul_i32 s15, s10, 7
    s_add_u32 s14, s14, s15
    s_mul_i32 s14, s14, 14336
    s_add_u32 s14, s14, 0xb00000
    s_add_u32 s20, s4, s14
    s_addc_u32 s21, s5, 0
    global_load_dwordx4 v[120:123], v1, s[20:21] offset:0
    global_load_dwordx4 v[124:127], v1, s[20:21] offset:1024
    global_load_dwordx4 v[128:131], v1, s[20:21] offset:2048
    global_load_dwordx4 v[132:135], v1, s[20:21] offset:3072
    s_add_u32 s20, s20, 4096
    s_addc_u32 s21, s21, 0
    global_load_dwordx4 v[136:139], v1, s[20:21] offset:0
    global_load_dwordx4 v[140:143], v1, s[20:21] offset:1024
    global_load_dwordx4 v[144:147], v1, s[20:21] offset:2048
    global_load_dwordx4 v[148:151], v1, s[20:21] offset:3072
    s_add_u32 s20, s20, 4096
    s_addc_u32 s21, s21, 0
    global_load_dwordx4 v[152:155], v1, s[20:21] offset:0
    global_load_dwordx4 v[156:159], v1, s[20:21] offset:1024
    global_load_dwordx4 v[160:163], v1, s[20:21] offset:2048
    global_load_dwordx4 v[164:167], v1, s[20:21] offset:3072
    s_add_u32 s20, s20, 4096
    s_addc_u32 s21, s21, 0
    global_load_dwordx4 v[168:171], v1, s[20:21] offset:0
    global_load_dwordx4 v[172:175], v1, s[20:21] offset:1024
    global_load_dwordx4 v[176:179], v1, s[20:21] offset:2048
    global_load_dwordx4 v[180:183], v1, s[20:21] offset:3072
    s_add_u32 s20, s20, 4096
    s_addc_u32 s21, s21, 0
    s_waitcnt vmcnt(32)
    global_load_dwordx4 v[184:187], v1, s[20:21] offset:0
    global_load_dwordx4 v[188:191], v1, s[20:21] offset:1024
    global_load_dwordx4 v[192:195], v1, s[20:21] offset:2048
    global_load_dwordx4 v[196:199], v1, s[20:21] offset:3072
    s_add_u32 s20, s20, 4096
    s_addc_u32 s21, s21, 0
    global_load_dwordx4 v[200:203], v1, s[20:21] offset:0
    global_load_dwordx4 v[204:207], v1, s[20:21] offset:1024
    global_load_dwordx4 v[208:211], v1, s[20:21] offset:2048
    global_load_dwordx4 v[212:215], v1, s[20:21] offset:3072
    s_add_u32 s20, s20, 4096
    s_addc_u32 s21, s21, 0
    global_load_dwordx4 v[216:219], v1, s[20:21] offset:0
    global_load_dwordx4 v[220:223], v1, s[20:21] offset:1024
    global_load_dwordx4 v[224:227], v1, s[20:21] offset:2048
    global_load_dwordx4 v[228:231], v1, s[20:21] offset:3072
    s_add_u32 s20, s20, 4096
    s_addc_u32 s21, s21, 0
    global_load_dwordx4 v[232:235], v1, s[20:21] offset:0
    global_load_dwordx4 v[236:239], v1, s[20:21] offset:1024
    global_load_dwordx4 v[240:243], v1, s[20:21] offset:2048
    global_load_dwordx4 v[244:247], v1, s[20:21] offset:3072
    s_add_u32 s20, s20, 4096
    s_addc_u32 s21, s21, 0
    s_waitcnt vmcnt(32)
    global_load_dwordx4 v[248:251], v1, s[20:21] offset:0
    global_load_dwordx4 v[252:255], v1, s[20:21] offset:1024
    global_load_dwordx4 a[0:3], v1, s[20:21] offset:2048
    global_load_dwordx4 a[4:7], v1, s[20:21] offset:3072
    s_add_u32 s20, s20, 4096
    s_addc_u32 s21, s21, 0
    global_load_dwordx4 a[8:11], v1, s[20:21] offset:0
    global_load_dwordx4 a[12:15], v1, s[20:21] offset:1024
    global_load_dwordx4 a[16:19], v1, s[20:21] offset:2048
    global_load_dwordx4 a[20:23], v1, s[20:21] offset:3072
    s_add_u32 s20, s20, 4096
    s_addc_u32 s21, s21, 0
    global_load_dwordx4 a[24:27], v1, s[20:21] offset:0
    global_load_dwordx4 a[28:31], v1, s[20:21] offset:1024
    global_load_dwordx4 a[32:35], v1, s[20:21] offset:2048
    global_load_dwordx4 a[36:39], v1, s[20:21] offset:3072
    s_add_u32 s20, s20, 4096
    s_addc_u32 s21, s21, 0
    global_load_dwordx4 a[40:43], v1, s[20:21] offset:0
    global_load_dwordx4 a[44:47], v1, s[20:21] offset:1024
    global_load_dwordx4 a[48:51], v1, s[20:21] offset:2048
    global_load_dwordx4 a[52:55], v1, s[20:21] offset:3072
    s_add_u32 s20, s20, 4096
    s_addc_u32 s21, s21, 0
    s_waitcnt vmcnt(32)
    global_load_dwordx4 a[56:59], v1, s[20:21] offset:0
    global_load_dwordx4 a[60:63], v1, s[20:21] offset:1024
    global_load_dwordx4 a[64:67], v1, s[20:21] offset:2048
    global_load_dwordx4 a[68:71], v1, s[20:21] offset:3072
    s_add_u32 s20, s20, 4096
    s_addc_u32 s21, s21, 0
    global_load_dwordx4 a[72:75], v1, s[20:21] offset:0
    global_load_dwordx4 a[76:79], v1, s[20:21] offset:1024
    global_load_dwordx4 a[80:83], v1, s[20:21] offset:2048
    global_load_dwordx4 a[84:87], v1, s[20:21] offset:3072
    s_add_u32 s20, s20, 4096
    s_addc_u32 s21, s21, 0
    global_load_dwordx4 a[88:91], v1, s[20:21] offset:0
    global_load_dwordx4 a[92:95], v1, s[20:21] offset:1024
    global_load_dwordx4 a[96:99], v1, s[20:21] offset:2048
    global_load_dwordx4 a[100:103], v1, s[20:21] offset:3072
    s_add_u32 s20, s20, 4096
    s_addc_u32 s21, s21, 0
    global_load_dwordx4 a[104:107], v1, s[20:21] offset:0
    global_load_dwordx4 a[108:111], v1, s[20:21] offset:1024
    global_load_dwordx4 a[112:115], v1, s[20:21] offset:2048
    global_load_dwordx4 a[116:119], v1, s[20:21] offset:3072
    s_add_u32 s20, s20, 4096
    s_addc_u32 s21, s21, 0
    s_waitcnt vmcnt(32)
    global_load_dwordx4 a[120:123], v1, s[20:21] offset:0
    global_load_dwordx4 a[124:127], v1, s[20:21] offset:1024
    global_load_dwordx4 a[128:131], v1, s[20:21] offset:2048
    global_load_dwordx4 a[132:135], v1, s[20:21] offset:3072
    s_add_u32 s20, s20, 4096
    s_addc_u32 s21, s21, 0
    global_load_dwordx4 a[136:139], v1, s[20:21] offset:0
    global_load_dwordx4 a[140:143], v1, s[20:21] offset:1024
    global_load_dwordx4 a[144:147], v1, s[20:21] offset:2048
    global_load_dwordx4 a[148:151], v1, s[20:21] offset:3072
    s_add_u32 s20, s20, 4096
    s_addc_u32 s21, s21, 0
    global_load_dwordx4 a[152:155], v1, s[20:21] offset:0
    global_load_dwordx4 a[156:159], v1, s[20:21] offset:1024
    global_load_dwordx4 a[160:163], v1, s[20:21] offset:2048
    global_load_dwordx4 a[164:167], v1, s[20:21] offset:3072
    s_add_u32 s20, s20, 4096
    s_addc_u32 s21, s21, 0
    global_load_dwordx4 a[168:171], v1, s[20:21] offset:0
    global_load_dwordx4 a[172:175], v1, s[20:21] offset:1024
    global_load_dwordx4 a[176:179], v1, s[20:21] offset:2048
    global_load_dwordx4 a[180:183], v1, s[20:21] offset:3072
    s_add_u32 s20, s20, 4096
    s_addc_u32 s21, s21, 0
    s_waitcnt vmcnt(32)
    global_load_dwordx4 a[184:187], v1, s[20:21] offset:0
    global_load_dwordx4 a[188:191], v1, s[20:21] offset:1024
    global_load_dwordx4 a[192:195], v1, s[20:21] offset:2048
    global_load_dwordx4 a[196:199], v1, s[20:21] offset:3072
    s_add_u32 s20, s20, 4096
    s_addc_u32 s21, s21, 0
    global_load_dwordx4 a[200:203], v1, s[20:21] offset:0
    global_load_dwordx4 a[204:207], v1, s[20:21] offset:1024
    global_load_dwordx4 a[208:211], v1, s[20:21] offset:2048
    global_load_dwordx4 a[212:215], v1, s[20:21] offset:3072
    s_add_u32 s20, s20, 4096
    s_addc_u32 s21, s21, 0
    global_load_dwordx4 a[216:219], v1, s[20:21] offset:0
    global_load_dwordx4 a[220:223], v1, s[20:21] offset:1024
    global_load_dwordx4 a[224:227], v1, s[20:21] offset:2048
    global_load_dwordx4 a[228:231], v1, s[20:21] offset:3072
    s_add_u32 s20, s20, 4096
    s_addc_u32 s21, s21, 0
    global_load_dwordx4 a[232:235], v1, s[20:21] offset:0
    global_load_dwordx4 a[236:239], v1, s[20:21] offset:1024
    global_load_dwordx4 a[240:243], v1, s[20:21] offset:2048
    global_load_dwordx4 a[244:247], v1, s[20:21] offset:3072
    s_add_u32 s20, s20, 4096
    s_addc_u32 s21, s21, 0
    s_waitcnt vmcnt(32)
    global_load_dwordx4 a[248:251], v1, s[20:21] offset:0
    global_load_dwordx4 a[252:255], v1, s[20:21] offset:1024
    v_and_b32 v3, 8, v0
    v_cmp_ne_u32 vcc, 0, v3
    v_mov_b32 v3, 0x44444444
    v_mov_b32 v4, 0xeeeeeeee
    v_cndmask_b32 v3, v3, v4, vcc
    v_add_u32 v7, 0x1000, v1
    v_and_b32 v8, 15, v0
    v_lshlrev_b32 v8, 4, v8
    v_lshrrev_b32 v9, 4, v0
    v_and_b32 v9, 1, v9
    v_lshlrev_b32 v9, 3, v9
    v_lshrrev_b32 v10, 5, v0
    v_lshlrev_b32 v10, 10, v10
    s_lshr_b32 s14, s9, 2
    s_mul_i32 s14, s14, 28
    s_mul_i32 s15, s10, 7
    s_add_u32 s14, s14, s15
    s_lshl_b32 s14, s14, 10
    s_and_b32 s15, s9, 3
    s_lshl_b32 s15, s15, 8
    s_add_u32 s14, s14, s15
    v_add3_u32 v11, v8, v9, s14
    v_add_u32 v8, v11, v10
    s_add_u32 s26, s4, 0x4000000
    s_addc_u32 s27, s5, 0
    s_add_u32 s36, s4, 0x1300000
    s_addc_u32 s37, s5, 0
    s_add_u32 s28, s4, 0x1502000
    s_addc_u32 s29, s5, 0
    v_mov_b32 v5, 0
    v_mov_b32 v6, 1
    s_mov_b32 s30, 0
    s_nop 0
sequential_preLN__memory_aug_recurrent_mem_tr__mixer_gmlp__prompt_kernel_VB_loop:
    v_mov_b64 v[52:53], 0
    v_mov_b64 v[54:55], 0
    v_mov_b64 v[56:57], 0
    v_mov_b64 v[58:59], 0
    v_mov_b64 v[60:61], 0
    v_mov_b64 v[62:63], 0
    v_mov_b64 v[64:65], 0
    v_mov_b64 v[66:67], 0
    v_mov_b64 v[68:69], 0
    v_mov_b64 v[70:71], 0
    v_mov_b64 v[72:73], 0
    v_mov_b64 v[74:75], 0
    v_mov_b64 v[76:77], 0
    v_mov_b64 v[78:79], 0
    s_mov_b32 s13, 131072
    global_load_dwordx4 v[24:27], v1, s[36:37] offset:0 sc1
    global_load_dwordx4 v[28:31], v1, s[36:37] offset:1024 sc1
    global_load_dwordx4 v[32:35], v1, s[36:37] offset:2048 sc1
    global_load_dwordx4 v[36:39], v1, s[36:37] offset:3072 sc1
    global_load_dwordx4 v[40:43], v7, s[36:37] offset:0 sc1
    global_load_dwordx4 v[44:47], v7, s[36:37] offset:1024 sc1
    global_load_dwordx4 v[48:51], v7, s[36:37] offset:2048 sc1
    s_waitcnt vmcnt(0)
    s_cmp_eq_u32 s30, 0
    s_cbranch_scc1 sequential_preLN__memory_aug_recurrent_mem_tr__mixer_gmlp__prompt_kernel_VB_chk
    s_barrier
    s_cmp_lg_u32 s10, 0
    s_cbranch_scc1 sequential_preLN__memory_aug_recurrent_mem_tr__mixer_gmlp__prompt_kernel_VB_flagp
    s_mov_b64 exec, 1
    global_atomic_add v5, v6, s[28:29] offset:-128
    s_mov_b64 exec, -1
    s_nop 4
sequential_preLN__memory_aug_recurrent_mem_tr__mixer_gmlp__prompt_kernel_VB_flagp:
    s_branch sequential_preLN__memory_aug_recurrent_mem_tr__mixer_gmlp__prompt_kernel_VB_chk
sequential_preLN__memory_aug_recurrent_mem_tr__mixer_gmlp__prompt_kernel_VB_mpoll:
    global_load_dwordx4 v[24:27], v1, s[36:37] offset:0 sc1
    global_load_dwordx4 v[28:31], v1, s[36:37] offset:1024 sc1
    global_load_dwordx4 v[32:35], v1, s[36:37] offset:2048 sc1
    global_load_dwordx4 v[36:39], v1, s[36:37] offset:3072 sc1
    global_load_dwordx4 v[40:43], v7, s[36:37] offset:0 sc1
    global_load_dwordx4 v[44:47], v7, s[36:37] offset:1024 sc1
    global_load_dwordx4 v[48:51], v7, s[36:37] offset:2048 sc1
    s_waitcnt vmcnt(0)
sequential_preLN__memory_aug_recurrent_mem_tr__mixer_gmlp__prompt_kernel_VB_chk:
    v_max3_u32 v12, v24, v25, v26
    v_max3_u32 v12, v12, v27, v28
    v_max3_u32 v12, v12, v29, v30
    v_max3_u32 v12, v12, v31, v32
    v_max3_u32 v12, v12, v33, v34
    v_max3_u32 v12, v12, v35, v36
    v_max3_u32 v12, v12, v37, v38
    v_max3_u32 v12, v12, v39, v40
    v_max3_u32 v12, v12, v41, v42
    v_max3_u32 v12, v12, v43, v44
    v_max3_u32 v12, v12, v45, v46
    v_max3_u32 v12, v12, v47, v48
    v_max3_u32 v12, v12, v49, v50
    v_max_u32 v12, v12, v51
    v_cmp_eq_u32 vcc, -1, v12
    s_nop 0
    s_cbranch_vccz sequential_preLN__memory_aug_recurrent_mem_tr__mixer_gmlp__prompt_kernel_VB_mok
    s_cmp_lt_u32 s30, 60
    s_cbranch_scc0 sequential_preLN__memory_aug_recurrent_mem_tr__mixer_gmlp__prompt_kernel_VB_mp_as
    s_sleep 8
sequential_preLN__memory_aug_recurrent_mem_tr__mixer_gmlp__prompt_kernel_VB_mp_as:
    s_sleep 2
    s_sub_u32 s13, s13, 1
    s_cbranch_scc0 sequential_preLN__memory_aug_recurrent_mem_tr__mixer_gmlp__prompt_kernel_VB_mpoll
    s_endpgm
sequential_preLN__memory_aug_recurrent_mem_tr__mixer_gmlp__prompt_kernel_VB_mok:
    v_smfmac_f32_16x16x64_bf16 v[52:55], v[24:27], v[120:127], v3
    v_smfmac_f32_16x16x64_bf16 v[52:55], v[28:31], v[128:135], v3
    v_smfmac_f32_16x16x64_bf16 v[52:55], v[32:35], v[136:143], v3
    v_smfmac_f32_16x16x64_bf16 v[52:55], v[36:39], v[144:151], v3
    v_smfmac_f32_16x16x64_bf16 v[52:55], v[40:43], v[152:159], v3
    v_smfmac_f32_16x16x64_bf16 v[52:55], v[44:47], v[160:167], v3
    v_smfmac_f32_16x16x64_bf16 v[52:55], v[48:51], v[168:175], v3
    v_smfmac_f32_16x16x64_bf16 v[56:59], v[24:27], v[176:183], v3
    v_smfmac_f32_16x16x64_bf16 v[56:59], v[28:31], v[184:191], v3
    v_smfmac_f32_16x16x64_bf16 v[56:59], v[32:35], v[192:199], v3
    v_smfmac_f32_16x16x64_bf16 v[56:59], v[36:39], v[200:207], v3
    v_smfmac_f32_16x16x64_bf16 v[56:59], v[40:43], v[208:215], v3
    v_smfmac_f32_16x16x64_bf16 v[56:59], v[44:47], v[216:223], v3
    v_smfmac_f32_16x16x64_bf16 v[56:59], v[48:51], v[224:231], v3
    v_smfmac_f32_16x16x64_bf16 v[60:63], v[24:27], v[232:239], v3
    v_smfmac_f32_16x16x64_bf16 v[60:63], v[28:31], v[240:247], v3
    v_smfmac_f32_16x16x64_bf16 v[60:63], v[32:35], v[248:255], v3
    v_smfmac_f32_16x16x64_bf16 v[60:63], v[36:39], a[0:7], v3
    v_smfmac_f32_16x16x64_bf16 v[60:63], v[40:43], a[8:15], v3
    v_smfmac_f32_16x16x64_bf16 v[60:63], v[44:47], a[16:23], v3
    v_smfmac_f32_16x16x64_bf16 v[60:63], v[48:51], a[24:31], v3
    v_smfmac_f32_16x16x64_bf16 v[64:67], v[24:27], a[32:39], v3
    v_smfmac_f32_16x16x64_bf16 v[64:67], v[28:31], a[40:47], v3
    v_smfmac_f32_16x16x64_bf16 v[64:67], v[32:35], a[48:55], v3
    v_smfmac_f32_16x16x64_bf16 v[64:67], v[36:39], a[56:63], v3
    v_smfmac_f32_16x16x64_bf16 v[64:67], v[40:43], a[64:71], v3
    v_smfmac_f32_16x16x64_bf16 v[64:67], v[44:47], a[72:79], v3
    v_smfmac_f32_16x16x64_bf16 v[64:67], v[48:51], a[80:87], v3
    v_smfmac_f32_16x16x64_bf16 v[68:71], v[24:27], a[88:95], v3
    v_smfmac_f32_16x16x64_bf16 v[68:71], v[28:31], a[96:103], v3
    v_smfmac_f32_16x16x64_bf16 v[68:71], v[32:35], a[104:111], v3
    v_smfmac_f32_16x16x64_bf16 v[68:71], v[36:39], a[112:119], v3
    v_smfmac_f32_16x16x64_bf16 v[68:71], v[40:43], a[120:127], v3
    v_smfmac_f32_16x16x64_bf16 v[68:71], v[44:47], a[128:135], v3
    v_smfmac_f32_16x16x64_bf16 v[68:71], v[48:51], a[136:143], v3
    v_smfmac_f32_16x16x64_bf16 v[72:75], v[24:27], a[144:151], v3
    v_smfmac_f32_16x16x64_bf16 v[72:75], v[28:31], a[152:159], v3
    v_smfmac_f32_16x16x64_bf16 v[72:75], v[32:35], a[160:167], v3
    v_smfmac_f32_16x16x64_bf16 v[72:75], v[36:39], a[168:175], v3
    v_smfmac_f32_16x16x64_bf16 v[72:75], v[40:43], a[176:183], v3
    v_smfmac_f32_16x16x64_bf16 v[72:75], v[44:47], a[184:191], v3
    v_smfmac_f32_16x16x64_bf16 v[72:75], v[48:51], a[192:199], v3
    v_smfmac_f32_16x16x64_bf16 v[76:79], v[24:27], a[200:207], v3
    v_smfmac_f32_16x16x64_bf16 v[76:79], v[28:31], a[208:215], v3
    v_smfmac_f32_16x16x64_bf16 v[76:79], v[32:35], a[216:223], v3
    v_smfmac_f32_16x16x64_bf16 v[76:79], v[36:39], a[224:231], v3
    v_smfmac_f32_16x16x64_bf16 v[76:79], v[40:43], a[232:239], v3
    v_smfmac_f32_16x16x64_bf16 v[76:79], v[44:47], a[240:247], v3
    v_smfmac_f32_16x16x64_bf16 v[76:79], v[48:51], a[248:255], v3
    v_permlane32_swap_b32 v52, v56
    v_permlane32_swap_b32 v53, v57
    v_permlane32_swap_b32 v54, v58
    v_permlane32_swap_b32 v55, v59
    v_add_f32 v52, v52, v56
    v_add_f32 v53, v53, v57
    v_add_f32 v54, v54, v58
    v_add_f32 v55, v55, v59
    v_cvt_pk_bf16_f32 v80, v52, v53
    v_cvt_pk_bf16_f32 v81, v54, v55
    global_store_dwordx2 v8, v[80:81], s[26:27] offset:0 sc1
    v_permlane32_swap_b32 v60, v64
    v_permlane32_swap_b32 v61, v65
    v_permlane32_swap_b32 v62, v66
    v_permlane32_swap_b32 v63, v67
    v_add_f32 v60, v60, v64
    v_add_f32 v61, v61, v65
    v_add_f32 v62, v62, v66
    v_add_f32 v63, v63, v67
    v_cvt_pk_bf16_f32 v82, v60, v61
    v_cvt_pk_bf16_f32 v83, v62, v63
    global_store_dwordx2 v8, v[82:83], s[26:27] offset:2048 sc1
    v_permlane32_swap_b32 v68, v72
    v_permlane32_swap_b32 v69, v73
    v_permlane32_swap_b32 v70, v74
    v_permlane32_swap_b32 v71, v75
    v_add_f32 v68, v68, v72
    v_add_f32 v69, v69, v73
    v_add_f32 v70, v70, v74
    v_add_f32 v71, v71, v75
    v_cvt_pk_bf16_f32 v84, v68, v69
    v_cvt_pk_bf16_f32 v85, v70, v71
    v_add_u32 v13, 0x1000, v8
    global_store_dwordx2 v13, v[84:85], s[26:27] sc1
    v_mov_b32 v88, v76
    v_mov_b32 v89, v77
    v_mov_b32 v90, v78
    v_mov_b32 v91, v79
    v_permlane32_swap_b32 v76, v88
    v_permlane32_swap_b32 v77, v89
    v_permlane32_swap_b32 v78, v90
    v_permlane32_swap_b32 v79, v91
    v_add_f32 v76, v76, v88
    v_add_f32 v77, v77, v89
    v_add_f32 v78, v78, v90
    v_add_f32 v79, v79, v91
    v_cvt_pk_bf16_f32 v86, v76, v77
    v_cvt_pk_bf16_f32 v87, v78, v79
    v_add_u32 v13, 6144, v11
    s_mov_b32 exec_hi, 0
    global_store_dwordx2 v13, v[86:87], s[26:27] sc1
    s_mov_b32 exec_hi, -1
    s_add_u32 s26, s26, 114688
    s_addc_u32 s27, s27, 0
    s_add_u32 s28, s28, 128
    s_addc_u32 s29, s29, 0
    s_add_u32 s36, s36, 8192
    s_addc_u32 s37, s37, 0
    s_add_u32 s30, s30, 1
    s_cmp_lt_u32 s30, 64
    s_cbranch_scc1 sequential_preLN__memory_aug_recurrent_mem_tr__mixer_gmlp__prompt_kernel_VB_loop
    s_waitcnt vmcnt(0) lgkmcnt(0)
    s_barrier
    s_cmp_lg_u32 s10, 0
    s_cbranch_scc1 sequential_preLN__memory_aug_recurrent_mem_tr__mixer_gmlp__prompt_kernel_VB_flag
    s_mov_b64 exec, 1
    global_atomic_add v5, v6, s[28:29] offset:-128
    s_mov_b64 exec, -1
    s_nop 4
sequential_preLN__memory_aug_recurrent_mem_tr__mixer_gmlp__prompt_kernel_VB_flag:
    s_branch sequential_preLN__memory_aug_recurrent_mem_tr__mixer_gmlp__prompt_kernel_DL0
sequential_preLN__memory_aug_recurrent_mem_tr__mixer_gmlp__prompt_kernel_AL:
    s_cmp_lg_u32 s10, 0
    s_cbranch_scc1 sequential_preLN__memory_aug_recurrent_mem_tr__mixer_gmlp__prompt_kernel_AL_all_pwj
    s_mov_b32 s13, 131072
    s_add_u32 s76, s4, 0x1580000
    s_addc_u32 s77, s5, 0
    v_mbcnt_lo_u32_b32 v20, -1, 0
    v_mbcnt_hi_u32_b32 v20, -1, v20
    v_lshlrev_b32 v20, 4, v20
    s_nop 1
sequential_preLN__memory_aug_recurrent_mem_tr__mixer_gmlp__prompt_kernel_AL_all_pw:
    global_load_dwordx4 v[22:25], v20, s[76:77] sc1
    s_waitcnt vmcnt(0)
    v_xor_b32 v22, s78, v22
    v_xor_b32 v23, s78, v23
    v_xor_b32 v24, s78, v24
    v_xor_b32 v25, s78, v25
    v_or_b32 v22, v22, v23
    v_or_b32 v24, v24, v25
    v_or_b32 v22, v22, v24
    v_cmp_ne_u32 vcc, 0, v22
    s_nop 0
    s_cbranch_vccz sequential_preLN__memory_aug_recurrent_mem_tr__mixer_gmlp__prompt_kernel_AL_all_pwok
    s_sleep 16
    s_sub_u32 s13, s13, 1
    s_cbranch_scc0 sequential_preLN__memory_aug_recurrent_mem_tr__mixer_gmlp__prompt_kernel_AL_all_pw
    s_endpgm
sequential_preLN__memory_aug_recurrent_mem_tr__mixer_gmlp__prompt_kernel_AL_all_pwok:
    buffer_inv sc1
    s_waitcnt vmcnt(0)
sequential_preLN__memory_aug_recurrent_mem_tr__mixer_gmlp__prompt_kernel_AL_all_pwj:
    s_barrier
    v_lshlrev_b32 v1, 4, v1
    v_and_b32 v0, 63, v0
    s_load_dwordx2 s[38:39], s[0:1], 0
    s_mul_i32 s16, s9, 37
    s_lshr_b32 s16, s16, 8
    s_mul_i32 s17, s16, 7
    s_sub_u32 s17, s9, s17
    s_lshl_b32 s17, s17, 2
    s_add_u32 s17, s17, s10
    s_mul_i32 s14, s16, 458752
    s_lshl_b32 s15, s17, 10
    s_add_u32 s14, s14, s15
    s_add_u32 s14, s14, 0x2000000
    s_add_u32 s20, s4, s14
    s_addc_u32 s21, s5, 0
    s_mul_i32 s14, s16, 114688
    s_add_u32 s14, s14, s15
    s_add_u32 s14, s14, 0x4000000
    s_add_u32 s22, s4, s14
    s_addc_u32 s23, s5, 0
    s_mul_i32 s14, s16, 40960
    s_mul_i32 s15, s10, 10240
    s_add_u32 s14, s14, s15
    s_add_u32 s14, s14, 0x4800000
    s_add_u32 s24, s4, s14
    s_addc_u32 s25, s5, 0
    s_mul_i32 s15, s10, 10240
    v_add_u32 v2, s15, v1
    v_add_u32 v7, 0x1000, v1
    v_add_u32 v8, 0x2000, v1
    v_and_b32 v9, 15, v0
    v_mul_u32_u24 v9, 896, v9
    v_lshrrev_b32 v10, 4, v0
    v_lshlrev_b32 v10, 3, v10
    s_lshl_b32 s15, s17, 5
    v_add3_u32 v9, v9, v10, s15
    v_add_u32 v10, 14336, v9
    s_mul_i32 s14, s16, 28672
    s_waitcnt lgkmcnt(0)
    s_add_u32 s38, s38, s14
    s_addc_u32 s39, s39, 0
    s_add_u32 s14, s14, 0x4c00000
    s_add_u32 s26, s4, s14
    s_addc_u32 s27, s5, 0
    s_lshl_b32 s14, s16, 7
    s_add_u32 s14, s14, 0x1500000
    s_add_u32 s28, s4, s14
    s_addc_u32 s29, s5, 0
    s_add_u32 s32, s28, 0x8000
    s_addc_u32 s33, s29, 0
    s_add_u32 s34, s28, 0x2000
    s_addc_u32 s35, s29, 0
    s_add_u32 s36, s28, 0xa000
    s_addc_u32 s37, s29, 0
    v_mov_b32 v5, 0
    v_mov_b32 v6, 1
    v_and_b32 v12, 1, v0
    v_mul_u32_u24 v12, 24576, v12
    v_sub_u32 v12, 32768, v12
    v_mov_b32 v13, 16
    s_mov_b32 s30, 0
    s_nop 0
sequential_preLN__memory_aug_recurrent_mem_tr__mixer_gmlp__prompt_kernel_AL_loop:
    s_mov_b32 s13, 131072
sequential_preLN__memory_aug_recurrent_mem_tr__mixer_gmlp__prompt_kernel_AL_wvp:
    global_load_dword v11, v5, s[28:29] offset:0 sc1
    s_waitcnt vmcnt(0)
    v_readfirstlane_b32 s14, v11
    s_nop 0
    s_cmp_ge_u32 s14, 16
    s_nop 1
    s_cbranch_scc1 sequential_preLN__memory_aug_recurrent_mem_tr__mixer_gmlp__prompt_kernel_AL_wvp_ok
    s_sleep 4
    s_sub_u32 s13, s13, 1
    s_cbranch_scc0 sequential_preLN__memory_aug_recurrent_mem_tr__mixer_gmlp__prompt_kernel_AL_wvp
    s_endpgm
sequential_preLN__memory_aug_recurrent_mem_tr__mixer_gmlp__prompt_kernel_AL_wvp_ok:
    s_mov_b32 s40, s20
    s_mov_b32 s41, s21
    global_load_dwordx4 v[24:27], v1, s[40:41] sc1
    s_add_u32 s40, s40, 28672
    s_addc_u32 s41, s41, 0
    global_load_dwordx4 v[28:31], v1, s[40:41] sc1
    s_add_u32 s40, s40, 28672
    s_addc_u32 s41, s41, 0
    global_load_dwordx4 v[32:35], v1, s[40:41] sc1
    s_add_u32 s40, s40, 28672
    s_addc_u32 s41, s41, 0
    global_load_dwordx4 v[36:39], v1, s[40:41] sc1
    s_add_u32 s40, s40, 28672
    s_addc_u32 s41, s41, 0
    global_load_dwordx4 v[40:43], v1, s[40:41] sc1
    s_add_u32 s40, s40, 28672
    s_addc_u32 s41, s41, 0
    global_load_dwordx4 v[44:47], v1, s[40:41] sc1
    s_add_u32 s40, s40, 28672
    s_addc_u32 s41, s41, 0
    global_load_dwordx4 v[48:51], v1, s[40:41] sc1
    s_add_u32 s40, s40, 28672
    s_addc_u32 s41, s41, 0
    global_load_dwordx4 v[52:55], v1, s[40:41] sc1
    s_add_u32 s40, s40, 28672
    s_addc_u32 s41, s41, 0
    global_load_dwordx4 v[56:59], v1, s[40:41] sc1
    s_add_u32 s40, s40, 28672
    s_addc_u32 s41, s41, 0
    global_load_dwordx4 v[60:63], v1, s[40:41] sc1
    s_add_u32 s40, s40, 28672
    s_addc_u32 s41, s41, 0
    global_load_dwordx4 v[64:67], v1, s[40:41] sc1
    s_add_u32 s40, s40, 28672
    s_addc_u32 s41, s41, 0
    global_load_dwordx4 v[68:71], v1, s[40:41] sc1
    s_add_u32 s40, s40, 28672
    s_addc_u32 s41, s41, 0
    global_load_dwordx4 v[72:75], v1, s[40:41] sc1
    s_add_u32 s40, s40, 28672
    s_addc_u32 s41, s41, 0
    global_load_dwordx4 v[76:79], v1, s[40:41] sc1
    s_add_u32 s40, s40, 28672
    s_addc_u32 s41, s41, 0
    global_load_dwordx4 v[80:83], v1, s[40:41] sc1
    s_add_u32 s40, s40, 28672
    s_addc_u32 s41, s41, 0
    global_load_dwordx4 v[84:87], v1, s[40:41] sc1
    global_load_dwordx2 v[120:121], v9, s[38:39]
    global_load_dwordx2 v[122:123], v10, s[38:39]
    s_mov_b32 s13, 131072
sequential_preLN__memory_aug_recurrent_mem_tr__mixer_gmlp__prompt_kernel_AL_wpv:
    global_load_dword v11, v12, s[28:29] sc1
    s_waitcnt vmcnt(0)
    v_cmp_lt_u32 vcc, v11, v13
    s_nop 0
    s_cbranch_vccz sequential_preLN__memory_aug_recurrent_mem_tr__mixer_gmlp__prompt_kernel_AL_wpv_ok
    s_cmp_lt_u32 s30, 15
    s_cbranch_scc0 sequential_preLN__memory_aug_recurrent_mem_tr__mixer_gmlp__prompt_kernel_AL_wpv_as
    s_sleep 8
sequential_preLN__memory_aug_recurrent_mem_tr__mixer_gmlp__prompt_kernel_AL_wpv_as:
    s_sleep 1
    s_sub_u32 s13, s13, 1
    s_cbranch_scc0 sequential_preLN__memory_aug_recurrent_mem_tr__mixer_gmlp__prompt_kernel_AL_wpv
    s_endpgm
sequential_preLN__memory_aug_recurrent_mem_tr__mixer_gmlp__prompt_kernel_AL_wpv_ok:
    global_load_dwordx4 v[128:131], v1, s[24:25] offset:0 sc1
    global_load_dwordx4 v[132:135], v1, s[24:25] offset:1024 sc1
    global_load_dwordx4 v[136:139], v1, s[24:25] offset:2048 sc1
    global_load_dwordx4 v[140:143], v1, s[24:25] offset:3072 sc1
    global_load_dwordx4 v[144:147], v7, s[24:25] offset:0 sc1
    global_load_dwordx4 v[148:151], v7, s[24:25] offset:1024 sc1
    global_load_dwordx4 v[152:155], v7, s[24:25] offset:2048 sc1
    global_load_dwordx4 v[156:159], v7, s[24:25] offset:3072 sc1
    global_load_dwordx4 v[160:163], v8, s[24:25] offset:0 sc1
    global_load_dwordx4 v[164:167], v8, s[24:25] offset:1024 sc1
    global_load_dwordx4 v[88:91], v1, s[22:23] sc1
    s_add_u32 s40, s22, 28672
    s_addc_u32 s41, s23, 0
    global_load_dwordx4 v[92:95], v1, s[40:41] sc1
    s_add_u32 s40, s22, 57344
    s_addc_u32 s41, s23, 0
    global_load_dwordx4 v[96:99], v1, s[40:41] sc1
    s_add_u32 s40, s22, 86016
    s_addc_u32 s41, s23, 0
    global_load_dwordx4 v[100:103], v1, s[40:41] sc1
    s_waitcnt vmcnt(4)
    ds_write_b128 v2, v[128:131] offset:0
    ds_write_b128 v2, v[132:135] offset:1024
    ds_write_b128 v2, v[136:139] offset:2048
    ds_write_b128 v2, v[140:143] offset:3072
    ds_write_b128 v2, v[144:147] offset:4096
    ds_write_b128 v2, v[148:151] offset:5120
    ds_write_b128 v2, v[152:155] offset:6144
    ds_write_b128 v2, v[156:159] offset:7168
    ds_write_b128 v2, v[160:163] offset:8192
    ds_write_b128 v2, v[164:167] offset:9216
    s_waitcnt vmcnt(0) lgkmcnt(0)
    s_barrier
    ds_read_b128 v[128:131], v1 offset:0
    ds_read_b128 v[132:135], v1 offset:1024
    ds_read_b128 v[136:139], v1 offset:2048
    ds_read_b128 v[140:143], v1 offset:3072
    s_waitcnt lgkmcnt(3)
    v_mfma_f32_16x16x32_bf16 v[104:107], v[24:27], v[128:131], 0
    ds_read_b128 v[144:147], v1 offset:4096
    s_waitcnt lgkmcnt(3)
    v_mfma_f32_16x16x32_bf16 v[108:111], v[24:27], v[132:135], 0
    ds_read_b128 v[148:151], v1 offset:5120
    s_waitcnt lgkmcnt(3)
    v_mfma_f32_16x16x32_bf16 v[104:107], v[28:31], v[136:139], v[104:107]
    ds_read_b128 v[128:131], v1 offset:6144
    s_waitcnt lgkmcnt(3)
    v_mfma_f32_16x16x32_bf16 v[108:111], v[28:31], v[140:143], v[108:111]
    ds_read_b128 v[132:135], v1 offset:7168
    s_waitcnt lgkmcnt(3)
    v_mfma_f32_16x16x32_bf16 v[104:107], v[32:35], v[144:147], v[104:107]
    ds_read_b128 v[136:139], v1 offset:8192
    s_waitcnt lgkmcnt(3)
    v_mfma_f32_16x16x32_bf16 v[108:111], v[32:35], v[148:151], v[108:111]
    ds_read_b128 v[140:143], v1 offset:9216
    s_waitcnt lgkmcnt(3)
    v_mfma_f32_16x16x32_bf16 v[104:107], v[36:39], v[128:131], v[104:107]
    ds_read_b128 v[144:147], v1 offset:10240
    s_waitcnt lgkmcnt(3)
    v_mfma_f32_16x16x32_bf16 v[108:111], v[36:39], v[132:135], v[108:111]
    ds_read_b128 v[148:151], v1 offset:11264
    s_waitcnt lgkmcnt(3)
    v_mfma_f32_16x16x32_bf16 v[104:107], v[40:43], v[136:139], v[104:107]
    ds_read_b128 v[128:131], v1 offset:12288
    s_waitcnt lgkmcnt(3)
    v_mfma_f32_16x16x32_bf16 v[108:111], v[40:43], v[140:143], v[108:111]
    ds_read_b128 v[132:135], v1 offset:13312
    s_waitcnt lgkmcnt(3)
    v_mfma_f32_16x16x32_bf16 v[104:107], v[44:47], v[144:147], v[104:107]
    ds_read_b128 v[136:139], v1 offset:14336
    s_waitcnt lgkmcnt(3)
    v_mfma_f32_16x16x32_bf16 v[108:111], v[44:47], v[148:151], v[108:111]
    ds_read_b128 v[140:143], v1 offset:15360
    s_waitcnt lgkmcnt(3)
    v_mfma_f32_16x16x32_bf16 v[104:107], v[48:51], v[128:131], v[104:107]
    ds_read_b128 v[144:147], v1 offset:16384
    s_waitcnt lgkmcnt(3)
    v_mfma_f32_16x16x32_bf16 v[108:111], v[48:51], v[132:135], v[108:111]
    ds_read_b128 v[148:151], v1 offset:17408
    s_waitcnt lgkmcnt(3)
    v_mfma_f32_16x16x32_bf16 v[104:107], v[52:55], v[136:139], v[104:107]
    ds_read_b128 v[128:131], v1 offset:18432
    s_waitcnt lgkmcnt(3)
    v_mfma_f32_16x16x32_bf16 v[108:111], v[52:55], v[140:143], v[108:111]
    ds_read_b128 v[132:135], v1 offset:19456
    s_waitcnt lgkmcnt(3)
    v_mfma_f32_16x16x32_bf16 v[104:107], v[56:59], v[144:147], v[104:107]
    ds_read_b128 v[136:139], v1 offset:20480
    s_waitcnt lgkmcnt(3)
    v_mfma_f32_16x16x32_bf16 v[108:111], v[56:59], v[148:151], v[108:111]
    ds_read_b128 v[140:143], v1 offset:21504
    s_waitcnt lgkmcnt(3)
    v_mfma_f32_16x16x32_bf16 v[104:107], v[60:63], v[128:131], v[104:107]
    ds_read_b128 v[144:147], v1 offset:22528
    s_waitcnt lgkmcnt(3)
    v_mfma_f32_16x16x32_bf16 v[108:111], v[60:63], v[132:135], v[108:111]
    ds_read_b128 v[148:151], v1 offset:23552
    s_waitcnt lgkmcnt(3)
    v_mfma_f32_16x16x32_bf16 v[104:107], v[64:67], v[136:139], v[104:107]
    ds_read_b128 v[128:131], v1 offset:24576
    s_waitcnt lgkmcnt(3)
    v_mfma_f32_16x16x32_bf16 v[108:111], v[64:67], v[140:143], v[108:111]
    ds_read_b128 v[132:135], v1 offset:25600
    s_waitcnt lgkmcnt(3)
    v_mfma_f32_16x16x32_bf16 v[104:107], v[68:71], v[144:147], v[104:107]
    ds_read_b128 v[136:139], v1 offset:26624
    s_waitcnt lgkmcnt(3)
    v_mfma_f32_16x16x32_bf16 v[108:111], v[68:71], v[148:151], v[108:111]
    ds_read_b128 v[140:143], v1 offset:27648
    s_waitcnt lgkmcnt(3)
    v_mfma_f32_16x16x32_bf16 v[104:107], v[72:75], v[128:131], v[104:107]
    ds_read_b128 v[144:147], v1 offset:28672
    s_waitcnt lgkmcnt(3)
    v_mfma_f32_16x16x32_bf16 v[108:111], v[72:75], v[132:135], v[108:111]
    ds_read_b128 v[148:151], v1 offset:29696
    s_waitcnt lgkmcnt(3)
    v_mfma_f32_16x16x32_bf16 v[104:107], v[76:79], v[136:139], v[104:107]
    ds_read_b128 v[128:131], v1 offset:30720
    s_waitcnt lgkmcnt(3)
    v_mfma_f32_16x16x32_bf16 v[108:111], v[76:79], v[140:143], v[108:111]
    ds_read_b128 v[132:135], v1 offset:31744
    s_waitcnt lgkmcnt(3)
    v_mfma_f32_16x16x32_bf16 v[104:107], v[80:83], v[144:147], v[104:107]
    ds_read_b128 v[136:139], v1 offset:32768
    s_waitcnt lgkmcnt(3)
    v_mfma_f32_16x16x32_bf16 v[108:111], v[80:83], v[148:151], v[108:111]
    ds_read_b128 v[140:143], v1 offset:33792
    s_waitcnt lgkmcnt(3)
    v_mfma_f32_16x16x32_bf16 v[104:107], v[84:87], v[128:131], v[104:107]
    ds_read_b128 v[144:147], v1 offset:34816
    s_waitcnt lgkmcnt(3)
    v_mfma_f32_16x16x32_bf16 v[108:111], v[84:87], v[132:135], v[108:111]
    ds_read_b128 v[148:151], v1 offset:35840
    s_waitcnt lgkmcnt(3)
    v_mfma_f32_16x16x32_bf16 v[104:107], v[88:91], v[136:139], v[104:107]
    ds_read_b128 v[128:131], v1 offset:36864
    s_waitcnt lgkmcnt(3)
    v_mfma_f32_16x16x32_bf16 v[108:111], v[88:91], v[140:143], v[108:111]
    ds_read_b128 v[132:135], v1 offset:37888
    s_waitcnt lgkmcnt(3)
    v_mfma_f32_16x16x32_bf16 v[104:107], v[92:95], v[144:147], v[104:107]
    ds_read_b128 v[136:139], v1 offset:38912
    s_waitcnt lgkmcnt(3)
    v_mfma_f32_16x16x32_bf16 v[108:111], v[92:95], v[148:151], v[108:111]
    ds_read_b128 v[140:143], v1 offset:39936
    s_waitcnt lgkmcnt(3)
    v_mfma_f32_16x16x32_bf16 v[104:107], v[96:99], v[128:131], v[104:107]
    s_waitcnt lgkmcnt(2)
    v_mfma_f32_16x16x32_bf16 v[108:111], v[96:99], v[132:135], v[108:111]
    s_waitcnt lgkmcnt(1)
    v_mfma_f32_16x16x32_bf16 v[104:107], v[100:103], v[136:139], v[104:107]
    s_waitcnt lgkmcnt(0)
    v_mfma_f32_16x16x32_bf16 v[108:111], v[100:103], v[140:143], v[108:111]
    s_nop 5
    v_cvt_pk_bf16_f32 v112, v104, v105
    v_cvt_pk_bf16_f32 v113, v106, v107
    v_lshlrev_b32 v114, 16, v112
    v_and_b32 v115, 0xffff0000, v112
    v_lshlrev_b32 v116, 16, v113
    v_and_b32 v117, 0xffff0000, v113
    v_lshlrev_b32 v118, 16, v120
    v_add_f32 v114, v114, v118
    v_and_b32 v118, 0xffff0000, v120
    v_add_f32 v115, v115, v118
    v_lshlrev_b32 v118, 16, v121
    v_add_f32 v116, v116, v118
    v_and_b32 v118, 0xffff0000, v121
    v_add_f32 v117, v117, v118
    v_cvt_pk_bf16_f32 v124, v114, v115
    v_cvt_pk_bf16_f32 v125, v116, v117
    global_store_dwordx2 v9, v[124:125], s[26:27] sc1
    v_cvt_pk_bf16_f32 v112, v108, v109
    v_cvt_pk_bf16_f32 v113, v110, v111
    v_lshlrev_b32 v114, 16, v112
    v_and_b32 v115, 0xffff0000, v112
    v_lshlrev_b32 v116, 16, v113
    v_and_b32 v117, 0xffff0000, v113
    v_lshlrev_b32 v118, 16, v122
    v_add_f32 v114, v114, v118
    v_and_b32 v118, 0xffff0000, v122
    v_add_f32 v115, v115, v118
    v_lshlrev_b32 v118, 16, v123
    v_add_f32 v116, v116, v118
    v_and_b32 v118, 0xffff0000, v123
    v_add_f32 v117, v117, v118
    v_cvt_pk_bf16_f32 v126, v114, v115
    v_cvt_pk_bf16_f32 v127, v116, v117
    global_store_dwordx2 v10, v[126:127], s[26:27] sc1
    s_waitcnt vmcnt(0)
    s_barrier
    s_cmp_lg_u32 s10, 0
    s_cbranch_scc1 sequential_preLN__memory_aug_recurrent_mem_tr__mixer_gmlp__prompt_kernel_AL_flag
    s_mov_b64 exec, 1
    global_atomic_add v5, v6, s[36:37] offset:0
    s_mov_b64 exec, -1
    s_nop 4
sequential_preLN__memory_aug_recurrent_mem_tr__mixer_gmlp__prompt_kernel_AL_flag:
    s_add_u32 s20, s20, 1835008
    s_addc_u32 s21, s21, 0
    s_add_u32 s22, s22, 458752
    s_addc_u32 s23, s23, 0
    s_add_u32 s24, s24, 163840
    s_addc_u32 s25, s25, 0
    s_add_u32 s26, s26, 114688
    s_addc_u32 s27, s27, 0
    s_add_u32 s38, s38, 114688
    s_addc_u32 s39, s39, 0
    s_add_u32 s28, s28, 512
    s_addc_u32 s29, s29, 0
    s_add_u32 s32, s32, 512
    s_addc_u32 s33, s33, 0
    s_add_u32 s34, s34, 512
    s_addc_u32 s35, s35, 0
    s_add_u32 s36, s36, 512
    s_addc_u32 s37, s37, 0
    s_add_u32 s30, s30, 1
    s_cmp_lt_u32 s30, 16
    s_cbranch_scc1 sequential_preLN__memory_aug_recurrent_mem_tr__mixer_gmlp__prompt_kernel_AL_loop
    s_waitcnt vmcnt(0) lgkmcnt(0)
    s_barrier
    s_branch sequential_preLN__memory_aug_recurrent_mem_tr__mixer_gmlp__prompt_kernel_DL0
sequential_preLN__memory_aug_recurrent_mem_tr__mixer_gmlp__prompt_kernel_BE:
    s_cmp_lg_u32 s10, 0
    s_cbranch_scc1 sequential_preLN__memory_aug_recurrent_mem_tr__mixer_gmlp__prompt_kernel_BE_all_pwj
    s_mov_b32 s13, 131072
    s_add_u32 s76, s4, 0x1580000
    s_addc_u32 s77, s5, 0
    v_mbcnt_lo_u32_b32 v20, -1, 0
    v_mbcnt_hi_u32_b32 v20, -1, v20
    v_lshlrev_b32 v20, 4, v20
    s_nop 1
sequential_preLN__memory_aug_recurrent_mem_tr__mixer_gmlp__prompt_kernel_BE_all_pw:
    global_load_dwordx4 v[22:25], v20, s[76:77] sc1
    s_waitcnt vmcnt(0)
    v_xor_b32 v22, s78, v22
    v_xor_b32 v23, s78, v23
    v_xor_b32 v24, s78, v24
    v_xor_b32 v25, s78, v25
    v_or_b32 v22, v22, v23
    v_or_b32 v24, v24, v25
    v_or_b32 v22, v22, v24
    v_cmp_ne_u32 vcc, 0, v22
    s_nop 0
    s_cbranch_vccz sequential_preLN__memory_aug_recurrent_mem_tr__mixer_gmlp__prompt_kernel_BE_all_pwok
    s_sleep 16
    s_sub_u32 s13, s13, 1
    s_cbranch_scc0 sequential_preLN__memory_aug_recurrent_mem_tr__mixer_gmlp__prompt_kernel_BE_all_pw
    s_endpgm
sequential_preLN__memory_aug_recurrent_mem_tr__mixer_gmlp__prompt_kernel_BE_all_pwok:
    buffer_inv sc1
    s_waitcnt vmcnt(0)
sequential_preLN__memory_aug_recurrent_mem_tr__mixer_gmlp__prompt_kernel_BE_all_pwj:
    s_barrier
    v_lshlrev_b32 v1, 4, v1
    v_and_b32 v0, 63, v0
    s_lshr_b32 s16, s9, 2
    s_and_b32 s17, s9, 3
    s_mul_i32 s14, s17, 28
    s_mul_i32 s15, s10, 7
    s_add_u32 s14, s14, s15
    s_mul_i32 s14, s14, 14336
    s_add_u32 s14, s14, 0x1900000
    s_add_u32 s20, s4, s14
    s_addc_u32 s21, s5, 0
    s_add_u32 s60, s4, 0x1500000
    s_addc_u32 s61, s5, 0
    v_mov_b32 v5, 0
    s_mov_b32 s13, 131072
    s_nop 0
sequential_preLN__memory_aug_recurrent_mem_tr__mixer_gmlp__prompt_kernel_BE_dly:
    global_load_dword v6, v5, s[60:61] offset:0 sc1
    s_waitcnt vmcnt(0)
    v_readfirstlane_b32 s14, v6
    s_nop 0
    s_cmp_ge_u32 s14, 16
    s_nop 1
    s_cbranch_scc1 sequential_preLN__memory_aug_recurrent_mem_tr__mixer_gmlp__prompt_kernel_BE_dly_ok
    s_sleep 8
    s_sub_u32 s13, s13, 1
    s_cbranch_scc0 sequential_preLN__memory_aug_recurrent_mem_tr__mixer_gmlp__prompt_kernel_BE_dly
    s_endpgm
sequential_preLN__memory_aug_recurrent_mem_tr__mixer_gmlp__prompt_kernel_BE_dly_ok:
    global_load_dwordx4 v[120:123], v1, s[20:21] offset:0
    global_load_dwordx4 v[124:127], v1, s[20:21] offset:1024
    global_load_dwordx4 v[128:131], v1, s[20:21] offset:2048
    global_load_dwordx4 v[132:135], v1, s[20:21] offset:3072
    s_add_u32 s20, s20, 4096
    s_addc_u32 s21, s21, 0
    global_load_dwordx4 v[136:139], v1, s[20:21] offset:0
    global_load_dwordx4 v[140:143], v1, s[20:21] offset:1024
    global_load_dwordx4 v[144:147], v1, s[20:21] offset:2048
    global_load_dwordx4 v[148:151], v1, s[20:21] offset:3072
    s_add_u32 s20, s20, 4096
    s_addc_u32 s21, s21, 0
    global_load_dwordx4 v[152:155], v1, s[20:21] offset:0
    global_load_dwordx4 v[156:159], v1, s[20:21] offset:1024
    global_load_dwordx4 v[160:163], v1, s[20:21] offset:2048
    global_load_dwordx4 v[164:167], v1, s[20:21] offset:3072
    s_add_u32 s20, s20, 4096
    s_addc_u32 s21, s21, 0
    global_load_dwordx4 v[168:171], v1, s[20:21] offset:0
    global_load_dwordx4 v[172:175], v1, s[20:21] offset:1024
    global_load_dwordx4 v[176:179], v1, s[20:21] offset:2048
    global_load_dwordx4 v[180:183], v1, s[20:21] offset:3072
    s_add_u32 s20, s20, 4096
    s_addc_u32 s21, s21, 0
    s_waitcnt vmcnt(32)
    global_load_dwordx4 v[184:187], v1, s[20:21] offset:0
    global_load_dwordx4 v[188:191], v1, s[20:21] offset:1024
    global_load_dwordx4 v[192:195], v1, s[20:21] offset:2048
    global_load_dwordx4 v[196:199], v1, s[20:21] offset:3072
    s_add_u32 s20, s20, 4096
    s_addc_u32 s21, s21, 0
    global_load_dwordx4 v[200:203], v1, s[20:21] offset:0
    global_load_dwordx4 v[204:207], v1, s[20:21] offset:1024
    global_load_dwordx4 v[208:211], v1, s[20:21] offset:2048
    global_load_dwordx4 v[212:215], v1, s[20:21] offset:3072
    s_add_u32 s20, s20, 4096
    s_addc_u32 s21, s21, 0
    global_load_dwordx4 v[216:219], v1, s[20:21] offset:0
    global_load_dwordx4 v[220:223], v1, s[20:21] offset:1024
    global_load_dwordx4 v[224:227], v1, s[20:21] offset:2048
    global_load_dwordx4 v[228:231], v1, s[20:21] offset:3072
    s_add_u32 s20, s20, 4096
    s_addc_u32 s21, s21, 0
    global_load_dwordx4 v[232:235], v1, s[20:21] offset:0
    global_load_dwordx4 v[236:239], v1, s[20:21] offset:1024
    global_load_dwordx4 v[240:243], v1, s[20:21] offset:2048
    global_load_dwordx4 v[244:247], v1, s[20:21] offset:3072
    s_add_u32 s20, s20, 4096
    s_addc_u32 s21, s21, 0
    s_waitcnt vmcnt(32)
    global_load_dwordx4 v[248:251], v1, s[20:21] offset:0
    global_load_dwordx4 v[252:255], v1, s[20:21] offset:1024
    global_load_dwordx4 a[0:3], v1, s[20:21] offset:2048
    global_load_dwordx4 a[4:7], v1, s[20:21] offset:3072
    s_add_u32 s20, s20, 4096
    s_addc_u32 s21, s21, 0
    global_load_dwordx4 a[8:11], v1, s[20:21] offset:0
    global_load_dwordx4 a[12:15], v1, s[20:21] offset:1024
    global_load_dwordx4 a[16:19], v1, s[20:21] offset:2048
    global_load_dwordx4 a[20:23], v1, s[20:21] offset:3072
    s_add_u32 s20, s20, 4096
    s_addc_u32 s21, s21, 0
    global_load_dwordx4 a[24:27], v1, s[20:21] offset:0
    global_load_dwordx4 a[28:31], v1, s[20:21] offset:1024
    global_load_dwordx4 a[32:35], v1, s[20:21] offset:2048
    global_load_dwordx4 a[36:39], v1, s[20:21] offset:3072
    s_add_u32 s20, s20, 4096
    s_addc_u32 s21, s21, 0
    global_load_dwordx4 a[40:43], v1, s[20:21] offset:0
    global_load_dwordx4 a[44:47], v1, s[20:21] offset:1024
    global_load_dwordx4 a[48:51], v1, s[20:21] offset:2048
    global_load_dwordx4 a[52:55], v1, s[20:21] offset:3072
    s_add_u32 s20, s20, 4096
    s_addc_u32 s21, s21, 0
    s_waitcnt vmcnt(32)
    global_load_dwordx4 a[56:59], v1, s[20:21] offset:0
    global_load_dwordx4 a[60:63], v1, s[20:21] offset:1024
    global_load_dwordx4 a[64:67], v1, s[20:21] offset:2048
    global_load_dwordx4 a[68:71], v1, s[20:21] offset:3072
    s_add_u32 s20, s20, 4096
    s_addc_u32 s21, s21, 0
    global_load_dwordx4 a[72:75], v1, s[20:21] offset:0
    global_load_dwordx4 a[76:79], v1, s[20:21] offset:1024
    global_load_dwordx4 a[80:83], v1, s[20:21] offset:2048
    global_load_dwordx4 a[84:87], v1, s[20:21] offset:3072
    s_add_u32 s20, s20, 4096
    s_addc_u32 s21, s21, 0
    global_load_dwordx4 a[88:91], v1, s[20:21] offset:0
    global_load_dwordx4 a[92:95], v1, s[20:21] offset:1024
    global_load_dwordx4 a[96:99], v1, s[20:21] offset:2048
    global_load_dwordx4 a[100:103], v1, s[20:21] offset:3072
    s_add_u32 s20, s20, 4096
    s_addc_u32 s21, s21, 0
    global_load_dwordx4 a[104:107], v1, s[20:21] offset:0
    global_load_dwordx4 a[108:111], v1, s[20:21] offset:1024
    global_load_dwordx4 a[112:115], v1, s[20:21] offset:2048
    global_load_dwordx4 a[116:119], v1, s[20:21] offset:3072
    s_add_u32 s20, s20, 4096
    s_addc_u32 s21, s21, 0
    s_waitcnt vmcnt(32)
    global_load_dwordx4 a[120:123], v1, s[20:21] offset:0
    global_load_dwordx4 a[124:127], v1, s[20:21] offset:1024
    global_load_dwordx4 a[128:131], v1, s[20:21] offset:2048
    global_load_dwordx4 a[132:135], v1, s[20:21] offset:3072
    s_add_u32 s20, s20, 4096
    s_addc_u32 s21, s21, 0
    global_load_dwordx4 a[136:139], v1, s[20:21] offset:0
    global_load_dwordx4 a[140:143], v1, s[20:21] offset:1024
    global_load_dwordx4 a[144:147], v1, s[20:21] offset:2048
    global_load_dwordx4 a[148:151], v1, s[20:21] offset:3072
    s_add_u32 s20, s20, 4096
    s_addc_u32 s21, s21, 0
    global_load_dwordx4 a[152:155], v1, s[20:21] offset:0
    global_load_dwordx4 a[156:159], v1, s[20:21] offset:1024
    global_load_dwordx4 a[160:163], v1, s[20:21] offset:2048
    global_load_dwordx4 a[164:167], v1, s[20:21] offset:3072
    s_add_u32 s20, s20, 4096
    s_addc_u32 s21, s21, 0
    global_load_dwordx4 a[168:171], v1, s[20:21] offset:0
    global_load_dwordx4 a[172:175], v1, s[20:21] offset:1024
    global_load_dwordx4 a[176:179], v1, s[20:21] offset:2048
    global_load_dwordx4 a[180:183], v1, s[20:21] offset:3072
    s_add_u32 s20, s20, 4096
    s_addc_u32 s21, s21, 0
    s_waitcnt vmcnt(32)
    global_load_dwordx4 a[184:187], v1, s[20:21] offset:0
    global_load_dwordx4 a[188:191], v1, s[20:21] offset:1024
    global_load_dwordx4 a[192:195], v1, s[20:21] offset:2048
    global_load_dwordx4 a[196:199], v1, s[20:21] offset:3072
    s_add_u32 s20, s20, 4096
    s_addc_u32 s21, s21, 0
    global_load_dwordx4 a[200:203], v1, s[20:21] offset:0
    global_load_dwordx4 a[204:207], v1, s[20:21] offset:1024
    global_load_dwordx4 a[208:211], v1, s[20:21] offset:2048
    global_load_dwordx4 a[212:215], v1, s[20:21] offset:3072
    s_add_u32 s20, s20, 4096
    s_addc_u32 s21, s21, 0
    global_load_dwordx4 a[216:219], v1, s[20:21] offset:0
    global_load_dwordx4 a[220:223], v1, s[20:21] offset:1024
    global_load_dwordx4 a[224:227], v1, s[20:21] offset:2048
    global_load_dwordx4 a[228:231], v1, s[20:21] offset:3072
    s_add_u32 s20, s20, 4096
    s_addc_u32 s21, s21, 0
    global_load_dwordx4 a[232:235], v1, s[20:21] offset:0
    global_load_dwordx4 a[236:239], v1, s[20:21] offset:1024
    global_load_dwordx4 a[240:243], v1, s[20:21] offset:2048
    global_load_dwordx4 a[244:247], v1, s[20:21] offset:3072
    s_add_u32 s20, s20, 4096
    s_addc_u32 s21, s21, 0
    s_waitcnt vmcnt(32)
    global_load_dwordx4 a[248:251], v1, s[20:21] offset:0
    global_load_dwordx4 a[252:255], v1, s[20:21] offset:1024
    v_lshrrev_b32 v8, 3, v0
    v_and_b32 v9, 7, v0
    s_lshl_b32 s14, s10, 3
    v_add_u32 v8, s14, v8
    v_mul_u32_u24 v2, 896, v8
    v_lshlrev_b32 v10, 4, v9
    v_add_u32 v2, v2, v10
    v_lshrrev_b32 v10, 4, v8
    v_and_b32 v11, 15, v8
    v_lshrrev_b32 v12, 2, v8
    v_and_b32 v12, 1, v12
    v_lshrrev_b32 v13, 3, v8
    v_lshlrev_b32 v13, 2, v13
    v_and_b32 v14, 3, v8
    v_add_u32 v13, v13, v14
    s_cmp_ge_u32 s17, 2
    s_cselect_b64 vcc, -1, 0
    v_cndmask_b32 v10, v10, v12, vcc
    v_cndmask_b32 v11, v11, v13, vcc
    v_mul_u32_u24 v10, 1088, v10
    v_lshlrev_b32 v11, 4, v11
    v_add_u32 v10, v10, v11
    v_lshrrev_b32 v11, 2, v9
    v_mul_u32_u24 v11, 2240, v11
    v_and_b32 v12, 3, v9
    v_mul_u32_u24 v12, 272, v12
    v_add3_u32 v3, v10, v11, v12
    v_lshrrev_b32 v10, 4, v0
    v_mul_u32_u24 v10, 272, v10
    v_and_b32 v11, 15, v0
    v_lshlrev_b32 v11, 4, v11
    v_add_u32 v4, v10, v11
    v_mov_b32 v5, 0
    v_mov_b32 v6, 1
    s_mul_i32 s14, s16, 28672
    s_add_u32 s14, s14, 0x4c00000
    s_add_u32 s22, s4, s14
    s_addc_u32 s23, s5, 0
    s_lshl_b32 s14, s16, 7
    s_add_u32 s14, s14, 0x150a000
    s_add_u32 s24, s4, s14
    s_addc_u32 s25, s5, 0
    s_add_u32 s28, s24, 0x2000
    s_addc_u32 s29, s25, 0
    s_cmp_ge_u32 s17, 2
    s_cbranch_scc1 sequential_preLN__memory_aug_recurrent_mem_tr__mixer_gmlp__prompt_kernel_BE_z2setup
    s_mul_i32 s14, s16, 56
    s_mul_i32 s15, s17, 28
    s_add_u32 s14, s14, s15
    s_mul_i32 s15, s10, 7
    s_add_u32 s14, s14, s15
    s_lshl_b32 s14, s14, 10
    s_add_u32 s14, s14, 0x5000000
    v_lshlrev_b32 v7, 3, v0
    s_nop 0
    s_branch sequential_preLN__memory_aug_recurrent_mem_tr__mixer_gmlp__prompt_kernel_BE_setj
sequential_preLN__memory_aug_recurrent_mem_tr__mixer_gmlp__prompt_kernel_BE_z2setup:
    s_mul_i32 s14, s16, 56
    s_sub_u32 s15, s17, 2
    s_mul_i32 s15, s15, 28
    s_add_u32 s14, s14, s15
    s_mul_i32 s15, s10, 7
    s_add_u32 s14, s14, s15
    s_lshl_b32 s14, s14, 10
    s_add_u32 s14, s14, 0x5400000
    v_mov_b32 v7, v1
    s_nop 1
sequential_preLN__memory_aug_recurrent_mem_tr__mixer_gmlp__prompt_kernel_BE_setj:
    s_add_u32 s26, s4, s14
    s_addc_u32 s27, s5, 0
    v_add_u32 v15, 0x1000, v7
    s_lshl_b32 s14, s16, 1
    s_add_u32 s14, s14, s17
    s_sub_u32 s14, s14, 2
    s_lshl_b32 s14, s14, 8
    s_add_u32 s14, s14, 0x5800000
    s_add_u32 s32, s4, s14
    s_addc_u32 s33, s5, 0
    s_lshl_b32 s14, s10, 8
    s_add_u32 s14, s14, 32768
    v_lshrrev_b32 v16, 4, v0
    v_lshlrev_b32 v16, 6, v16
    v_add_u32 v16, s14, v16
    v_and_b32 v17, 31, v0
    v_lshlrev_b32 v17, 3, v17
    v_lshrrev_b32 v18, 5, v0
    v_lshlrev_b32 v18, 2, v18
    v_add_u32 v18, v17, v18
    v_add_u32 v17, 32768, v18
    v_and_b32 v19, 15, v0
    v_cmp_eq_u32 s[34:35], 0, v19
    s_mov_b32 s50, 0xbdd2d3e8
    s_mov_b32 s51, s50
    s_mov_b32 s54, 0xc0135761
    s_mov_b32 s55, 0x3f803f80
    s_mov_b32 s30, 0
sequential_preLN__memory_aug_recurrent_mem_tr__mixer_gmlp__prompt_kernel_BE_loop:
    s_mov_b32 s13, 131072
sequential_preLN__memory_aug_recurrent_mem_tr__mixer_gmlp__prompt_kernel_BE_wh:
    global_load_dword v11, v5, s[24:25] offset:0 sc1
    s_waitcnt vmcnt(0)
    v_readfirstlane_b32 s14, v11
    s_nop 0
    s_cmp_ge_u32 s14, 7
    s_nop 1
    s_cbranch_scc1 sequential_preLN__memory_aug_recurrent_mem_tr__mixer_gmlp__prompt_kernel_BE_wh_ok
    s_cmp_lt_u32 s30, 15
    s_cbranch_scc0 sequential_preLN__memory_aug_recurrent_mem_tr__mixer_gmlp__prompt_kernel_BE_wh_as
    s_sleep 8
sequential_preLN__memory_aug_recurrent_mem_tr__mixer_gmlp__prompt_kernel_BE_wh_as:
    s_sleep 1
    s_sub_u32 s13, s13, 1
    s_cbranch_scc0 sequential_preLN__memory_aug_recurrent_mem_tr__mixer_gmlp__prompt_kernel_BE_wh
    s_endpgm
sequential_preLN__memory_aug_recurrent_mem_tr__mixer_gmlp__prompt_kernel_BE_wh_ok:
    global_load_dwordx4 v[24:27], v2, s[22:23] offset:0 sc1
    global_load_dwordx4 v[28:31], v2, s[22:23] offset:128 sc1
    global_load_dwordx4 v[32:35], v2, s[22:23] offset:256 sc1
    global_load_dwordx4 v[36:39], v2, s[22:23] offset:384 sc1
    global_load_dwordx4 v[40:43], v2, s[22:23] offset:512 sc1
    global_load_dwordx4 v[44:47], v2, s[22:23] offset:640 sc1
    global_load_dwordx4 v[48:51], v2, s[22:23] offset:768 sc1
    s_waitcnt vmcnt(0)
    v_mov_b32 v60, 0
    v_mov_b32 v61, 0
    v_mov_b32 v62, 0
    v_mov_b32 v63, 0
    v_dot2_f32_bf16 v60, v24, s55, v60
    v_dot2_f32_bf16 v62, v24, v24, v62
    v_dot2_f32_bf16 v61, v25, s55, v61
    v_dot2_f32_bf16 v63, v25, v25, v63
    v_dot2_f32_bf16 v60, v26, s55, v60
    v_dot2_f32_bf16 v62, v26, v26, v62
    v_dot2_f32_bf16 v61, v27, s55, v61
    v_dot2_f32_bf16 v63, v27, v27, v63
    v_dot2_f32_bf16 v60, v28, s55, v60
    v_dot2_f32_bf16 v62, v28, v28, v62
    v_dot2_f32_bf16 v61, v29, s55, v61
    v_dot2_f32_bf16 v63, v29, v29, v63
    v_dot2_f32_bf16 v60, v30, s55, v60
    v_dot2_f32_bf16 v62, v30, v30, v62
    v_dot2_f32_bf16 v61, v31, s55, v61
    v_dot2_f32_bf16 v63, v31, v31, v63
    v_dot2_f32_bf16 v60, v32, s55, v60
    v_dot2_f32_bf16 v62, v32, v32, v62
    v_dot2_f32_bf16 v61, v33, s55, v61
    v_dot2_f32_bf16 v63, v33, v33, v63
    v_dot2_f32_bf16 v60, v34, s55, v60
    v_dot2_f32_bf16 v62, v34, v34, v62
    v_dot2_f32_bf16 v61, v35, s55, v61
    v_dot2_f32_bf16 v63, v35, v35, v63
    v_dot2_f32_bf16 v60, v36, s55, v60
    v_dot2_f32_bf16 v62, v36, v36, v62
    v_dot2_f32_bf16 v61, v37, s55, v61
    v_dot2_f32_bf16 v63, v37, v37, v63
    v_dot2_f32_bf16 v60, v38, s55, v60
    v_dot2_f32_bf16 v62, v38, v38, v62
    v_dot2_f32_bf16 v61, v39, s55, v61
    v_dot2_f32_bf16 v63, v39, v39, v63
    v_dot2_f32_bf16 v60, v40, s55, v60
    v_dot2_f32_bf16 v62, v40, v40, v62
    v_dot2_f32_bf16 v61, v41, s55, v61
    v_dot2_f32_bf16 v63, v41, v41, v63
    v_dot2_f32_bf16 v60, v42, s55, v60
    v_dot2_f32_bf16 v62, v42, v42, v62
    v_dot2_f32_bf16 v61, v43, s55, v61
    v_dot2_f32_bf16 v63, v43, v43, v63
    v_dot2_f32_bf16 v60, v44, s55, v60
    v_dot2_f32_bf16 v62, v44, v44, v62
    v_dot2_f32_bf16 v61, v45, s55, v61
    v_dot2_f32_bf16 v63, v45, v45, v63
    v_dot2_f32_bf16 v60, v46, s55, v60
    v_dot2_f32_bf16 v62, v46, v46, v62
    v_dot2_f32_bf16 v61, v47, s55, v61
    v_dot2_f32_bf16 v63, v47, v47, v63
    v_dot2_f32_bf16 v60, v48, s55, v60
    v_dot2_f32_bf16 v62, v48, v48, v62
    v_dot2_f32_bf16 v61, v49, s55, v61
    v_dot2_f32_bf16 v63, v49, v49, v63
    v_dot2_f32_bf16 v60, v50, s55, v60
    v_dot2_f32_bf16 v62, v50, v50, v62
    v_dot2_f32_bf16 v61, v51, s55, v61
    v_dot2_f32_bf16 v63, v51, v51, v63
    s_nop 1
    v_add_f32 v60, v60, v61
    v_add_f32 v62, v62, v63
    s_nop 0
    v_add_f32_dpp v60, v60, v60 quad_perm:[1,0,3,2] row_mask:0xf bank_mask:0xf
    v_add_f32_dpp v62, v62, v62 quad_perm:[1,0,3,2] row_mask:0xf bank_mask:0xf
    s_nop 0
    v_add_f32_dpp v60, v60, v60 quad_perm:[2,3,0,1] row_mask:0xf bank_mask:0xf
    v_add_f32_dpp v62, v62, v62 quad_perm:[2,3,0,1] row_mask:0xf bank_mask:0xf
    s_nop 0
    v_add_f32_dpp v60, v60, v60 row_half_mirror row_mask:0xf bank_mask:0xf
    v_add_f32_dpp v62, v62, v62 row_half_mirror row_mask:0xf bank_mask:0xf
    v_mul_f32 v60, 0x3b124925, v60
    v_mul_f32 v62, 0x3b124925, v62
    v_fma_f32 v62, -v60, v60, v62
    v_max_f32 v62, 0, v62
    v_cvt_pk_bf16_f32 v62, v62, v62
    v_and_b32 v62, 0xffff0000, v62
    v_add_f32 v62, 0x3727c5ac, v62
    v_cvt_pk_bf16_f32 v62, v62, v62
    v_and_b32 v62, 0xffff0000, v62
    v_sqrt_f32 v62, v62
    s_nop 0
    v_cvt_pk_bf16_f32 v62, v62, v62
    v_and_b32 v62, 0xffff0000, v62
    v_rcp_f32 v62, v62
    v_cvt_pk_bf16_f32 v60, v60, v60
    v_and_b32 v60, 0xffff0000, v60
    v_mul_f32 v60, v60, v62
    v_sub_f32 v60, 0, v60
    v_mov_b32 v61, v60
    v_mov_b32 v63, v62
    v_lshlrev_b32 v64, 16, v24
    v_and_b32 v65, 0xffff0000, v24
    v_pk_fma_f32 v[64:65], v[64:65], v[62:63], v[60:61]
    v_cvt_pk_bf16_f32 v24, v64, v65
    v_lshlrev_b32 v66, 16, v25
    v_and_b32 v67, 0xffff0000, v25
    v_pk_fma_f32 v[66:67], v[66:67], v[62:63], v[60:61]
    v_cvt_pk_bf16_f32 v25, v66, v67
    v_lshlrev_b32 v64, 16, v26
    v_and_b32 v65, 0xffff0000, v26
    v_pk_fma_f32 v[64:65], v[64:65], v[62:63], v[60:61]
    v_cvt_pk_bf16_f32 v26, v64, v65
    v_lshlrev_b32 v66, 16, v27
    v_and_b32 v67, 0xffff0000, v27
    v_pk_fma_f32 v[66:67], v[66:67], v[62:63], v[60:61]
    v_cvt_pk_bf16_f32 v27, v66, v67
    v_lshlrev_b32 v64, 16, v28
    v_and_b32 v65, 0xffff0000, v28
    v_pk_fma_f32 v[64:65], v[64:65], v[62:63], v[60:61]
    v_cvt_pk_bf16_f32 v28, v64, v65
    v_lshlrev_b32 v66, 16, v29
    v_and_b32 v67, 0xffff0000, v29
    v_pk_fma_f32 v[66:67], v[66:67], v[62:63], v[60:61]
    v_cvt_pk_bf16_f32 v29, v66, v67
    v_lshlrev_b32 v64, 16, v30
    v_and_b32 v65, 0xffff0000, v30
    v_pk_fma_f32 v[64:65], v[64:65], v[62:63], v[60:61]
    v_cvt_pk_bf16_f32 v30, v64, v65
    v_lshlrev_b32 v66, 16, v31
    v_and_b32 v67, 0xffff0000, v31
    v_pk_fma_f32 v[66:67], v[66:67], v[62:63], v[60:61]
    v_cvt_pk_bf16_f32 v31, v66, v67
    v_lshlrev_b32 v64, 16, v32
    v_and_b32 v65, 0xffff0000, v32
    v_pk_fma_f32 v[64:65], v[64:65], v[62:63], v[60:61]
    v_cvt_pk_bf16_f32 v32, v64, v65
    v_lshlrev_b32 v66, 16, v33
    v_and_b32 v67, 0xffff0000, v33
    v_pk_fma_f32 v[66:67], v[66:67], v[62:63], v[60:61]
    v_cvt_pk_bf16_f32 v33, v66, v67
    v_lshlrev_b32 v64, 16, v34
    v_and_b32 v65, 0xffff0000, v34
    v_pk_fma_f32 v[64:65], v[64:65], v[62:63], v[60:61]
    v_cvt_pk_bf16_f32 v34, v64, v65
    v_lshlrev_b32 v66, 16, v35
    v_and_b32 v67, 0xffff0000, v35
    v_pk_fma_f32 v[66:67], v[66:67], v[62:63], v[60:61]
    v_cvt_pk_bf16_f32 v35, v66, v67
    v_lshlrev_b32 v64, 16, v36
    v_and_b32 v65, 0xffff0000, v36
    v_pk_fma_f32 v[64:65], v[64:65], v[62:63], v[60:61]
    v_cvt_pk_bf16_f32 v36, v64, v65
    v_lshlrev_b32 v66, 16, v37
    v_and_b32 v67, 0xffff0000, v37
    v_pk_fma_f32 v[66:67], v[66:67], v[62:63], v[60:61]
    v_cvt_pk_bf16_f32 v37, v66, v67
    v_lshlrev_b32 v64, 16, v38
    v_and_b32 v65, 0xffff0000, v38
    v_pk_fma_f32 v[64:65], v[64:65], v[62:63], v[60:61]
    v_cvt_pk_bf16_f32 v38, v64, v65
    v_lshlrev_b32 v66, 16, v39
    v_and_b32 v67, 0xffff0000, v39
    v_pk_fma_f32 v[66:67], v[66:67], v[62:63], v[60:61]
    v_cvt_pk_bf16_f32 v39, v66, v67
    v_lshlrev_b32 v64, 16, v40
    v_and_b32 v65, 0xffff0000, v40
    v_pk_fma_f32 v[64:65], v[64:65], v[62:63], v[60:61]
    v_cvt_pk_bf16_f32 v40, v64, v65
    v_lshlrev_b32 v66, 16, v41
    v_and_b32 v67, 0xffff0000, v41
    v_pk_fma_f32 v[66:67], v[66:67], v[62:63], v[60:61]
    v_cvt_pk_bf16_f32 v41, v66, v67
    v_lshlrev_b32 v64, 16, v42
    v_and_b32 v65, 0xffff0000, v42
    v_pk_fma_f32 v[64:65], v[64:65], v[62:63], v[60:61]
    v_cvt_pk_bf16_f32 v42, v64, v65
    v_lshlrev_b32 v66, 16, v43
    v_and_b32 v67, 0xffff0000, v43
    v_pk_fma_f32 v[66:67], v[66:67], v[62:63], v[60:61]
    v_cvt_pk_bf16_f32 v43, v66, v67
    v_lshlrev_b32 v64, 16, v44
    v_and_b32 v65, 0xffff0000, v44
    v_pk_fma_f32 v[64:65], v[64:65], v[62:63], v[60:61]
    v_cvt_pk_bf16_f32 v44, v64, v65
    v_lshlrev_b32 v66, 16, v45
    v_and_b32 v67, 0xffff0000, v45
    v_pk_fma_f32 v[66:67], v[66:67], v[62:63], v[60:61]
    v_cvt_pk_bf16_f32 v45, v66, v67
    v_lshlrev_b32 v64, 16, v46
    v_and_b32 v65, 0xffff0000, v46
    v_pk_fma_f32 v[64:65], v[64:65], v[62:63], v[60:61]
    v_cvt_pk_bf16_f32 v46, v64, v65
    v_lshlrev_b32 v66, 16, v47
    v_and_b32 v67, 0xffff0000, v47
    v_pk_fma_f32 v[66:67], v[66:67], v[62:63], v[60:61]
    v_cvt_pk_bf16_f32 v47, v66, v67
    v_lshlrev_b32 v64, 16, v48
    v_and_b32 v65, 0xffff0000, v48
    v_pk_fma_f32 v[64:65], v[64:65], v[62:63], v[60:61]
    v_cvt_pk_bf16_f32 v48, v64, v65
    v_lshlrev_b32 v66, 16, v49
    v_and_b32 v67, 0xffff0000, v49
    v_pk_fma_f32 v[66:67], v[66:67], v[62:63], v[60:61]
    v_cvt_pk_bf16_f32 v49, v66, v67
    v_lshlrev_b32 v64, 16, v50
    v_and_b32 v65, 0xffff0000, v50
    v_pk_fma_f32 v[64:65], v[64:65], v[62:63], v[60:61]
    v_cvt_pk_bf16_f32 v50, v64, v65
    v_lshlrev_b32 v66, 16, v51
    v_and_b32 v67, 0xffff0000, v51
    v_pk_fma_f32 v[66:67], v[66:67], v[62:63], v[60:61]
    v_cvt_pk_bf16_f32 v51, v66, v67
    ds_write_b128 v3, v[24:27] offset:0
    ds_write_b128 v3, v[28:31] offset:4480
    ds_write_b128 v3, v[32:35] offset:8960
    ds_write_b128 v3, v[36:39] offset:13440
    ds_write_b128 v3, v[40:43] offset:17920
    ds_write_b128 v3, v[44:47] offset:22400
    ds_write_b128 v3, v[48:51] offset:26880
    s_waitcnt lgkmcnt(0)
    s_barrier
    s_cmp_ge_u32 s17, 2
    s_cbranch_scc1 sequential_preLN__memory_aug_recurrent_mem_tr__mixer_gmlp__prompt_kernel_BE_z2
    v_mov_b32 v112, s54
    v_mov_b32 v113, s54
    ds_read_b128 v[80:83], v4 offset:0
    ds_read_b128 v[84:87], v4 offset:1088
    ds_read_b128 v[88:91], v4 offset:2240
    ds_read_b128 v[92:95], v4 offset:3328
    s_waitcnt lgkmcnt(2)
    v_mfma_f32_16x16x32_bf16 v[24:27], v[120:123], v[80:83], 0
    v_mfma_f32_16x16x32_bf16 v[52:55], v[120:123], v[84:87], 0
    ds_read_b128 v[96:99], v4 offset:4480
    ds_read_b128 v[100:103], v4 offset:5568
    v_mfma_f32_16x16x32_bf16 v[28:31], v[176:179], v[80:83], 0
    v_mfma_f32_16x16x32_bf16 v[56:59], v[176:179], v[84:87], 0
    v_mfma_f32_16x16x32_bf16 v[32:35], v[232:235], v[80:83], 0
    v_mfma_f32_16x16x32_bf16 v[60:63], v[232:235], v[84:87], 0
    v_mfma_f32_16x16x32_bf16 v[36:39], a[32:35], v[80:83], 0
    v_mfma_f32_16x16x32_bf16 v[64:67], a[32:35], v[84:87], 0
    s_waitcnt lgkmcnt(2)
    v_mfma_f32_16x16x32_bf16 v[24:27], v[124:127], v[88:91], v[24:27]
    v_mfma_f32_16x16x32_bf16 v[52:55], v[124:127], v[92:95], v[52:55]
    ds_read_b128 v[80:83], v4 offset:6720
    ds_read_b128 v[84:87], v4 offset:7808
    v_mfma_f32_16x16x32_bf16 v[28:31], v[180:183], v[88:91], v[28:31]
    v_mfma_f32_16x16x32_bf16 v[56:59], v[180:183], v[92:95], v[56:59]
    v_mfma_f32_16x16x32_bf16 v[32:35], v[236:239], v[88:91], v[32:35]
    v_mfma_f32_16x16x32_bf16 v[60:63], v[236:239], v[92:95], v[60:63]
    v_mfma_f32_16x16x32_bf16 v[36:39], a[36:39], v[88:91], v[36:39]
    v_mfma_f32_16x16x32_bf16 v[64:67], a[36:39], v[92:95], v[64:67]
    s_waitcnt lgkmcnt(2)
    v_mfma_f32_16x16x32_bf16 v[24:27], v[128:131], v[96:99], v[24:27]
    v_mfma_f32_16x16x32_bf16 v[52:55], v[128:131], v[100:103], v[52:55]
    ds_read_b128 v[88:91], v4 offset:8960
    ds_read_b128 v[92:95], v4 offset:10048
    v_mfma_f32_16x16x32_bf16 v[28:31], v[184:187], v[96:99], v[28:31]
    v_mfma_f32_16x16x32_bf16 v[56:59], v[184:187], v[100:103], v[56:59]
    v_mfma_f32_16x16x32_bf16 v[32:35], v[240:243], v[96:99], v[32:35]
    v_mfma_f32_16x16x32_bf16 v[60:63], v[240:243], v[100:103], v[60:63]
    v_mfma_f32_16x16x32_bf16 v[36:39], a[40:43], v[96:99], v[36:39]
    v_mfma_f32_16x16x32_bf16 v[64:67], a[40:43], v[100:103], v[64:67]
    s_waitcnt lgkmcnt(2)
    v_mfma_f32_16x16x32_bf16 v[24:27], v[132:135], v[80:83], v[24:27]
    v_mfma_f32_16x16x32_bf16 v[52:55], v[132:135], v[84:87], v[52:55]
    ds_read_b128 v[96:99], v4 offset:11200
    ds_read_b128 v[100:103], v4 offset:12288
    v_mfma_f32_16x16x32_bf16 v[28:31], v[188:191], v[80:83], v[28:31]
    v_mfma_f32_16x16x32_bf16 v[56:59], v[188:191], v[84:87], v[56:59]
    v_mfma_f32_16x16x32_bf16 v[32:35], v[244:247], v[80:83], v[32:35]
    v_mfma_f32_16x16x32_bf16 v[60:63], v[244:247], v[84:87], v[60:63]
    v_mfma_f32_16x16x32_bf16 v[36:39], a[44:47], v[80:83], v[36:39]
    v_mfma_f32_16x16x32_bf16 v[64:67], a[44:47], v[84:87], v[64:67]
    s_waitcnt lgkmcnt(2)
    v_mfma_f32_16x16x32_bf16 v[24:27], v[136:139], v[88:91], v[24:27]
    v_mfma_f32_16x16x32_bf16 v[52:55], v[136:139], v[92:95], v[52:55]
    ds_read_b128 v[80:83], v4 offset:13440
    ds_read_b128 v[84:87], v4 offset:14528
    v_mfma_f32_16x16x32_bf16 v[28:31], v[192:195], v[88:91], v[28:31]
    v_mfma_f32_16x16x32_bf16 v[56:59], v[192:195], v[92:95], v[56:59]
    v_mfma_f32_16x16x32_bf16 v[32:35], v[248:251], v[88:91], v[32:35]
    v_mfma_f32_16x16x32_bf16 v[60:63], v[248:251], v[92:95], v[60:63]
    v_mfma_f32_16x16x32_bf16 v[36:39], a[48:51], v[88:91], v[36:39]
    v_mfma_f32_16x16x32_bf16 v[64:67], a[48:51], v[92:95], v[64:67]
    s_waitcnt lgkmcnt(2)
    v_mfma_f32_16x16x32_bf16 v[24:27], v[140:143], v[96:99], v[24:27]
    v_mfma_f32_16x16x32_bf16 v[52:55], v[140:143], v[100:103], v[52:55]
    ds_read_b128 v[88:91], v4 offset:15680
    ds_read_b128 v[92:95], v4 offset:16768
    v_mfma_f32_16x16x32_bf16 v[28:31], v[196:199], v[96:99], v[28:31]
    v_mfma_f32_16x16x32_bf16 v[56:59], v[196:199], v[100:103], v[56:59]
    v_mfma_f32_16x16x32_bf16 v[32:35], v[252:255], v[96:99], v[32:35]
    v_mfma_f32_16x16x32_bf16 v[60:63], v[252:255], v[100:103], v[60:63]
    v_mfma_f32_16x16x32_bf16 v[36:39], a[52:55], v[96:99], v[36:39]
    v_mfma_f32_16x16x32_bf16 v[64:67], a[52:55], v[100:103], v[64:67]
    s_waitcnt lgkmcnt(2)
    v_mfma_f32_16x16x32_bf16 v[24:27], v[144:147], v[80:83], v[24:27]
    v_mfma_f32_16x16x32_bf16 v[52:55], v[144:147], v[84:87], v[52:55]
    ds_read_b128 v[96:99], v4 offset:17920
    ds_read_b128 v[100:103], v4 offset:19008
    v_mfma_f32_16x16x32_bf16 v[28:31], v[200:203], v[80:83], v[28:31]
    v_mfma_f32_16x16x32_bf16 v[56:59], v[200:203], v[84:87], v[56:59]
    v_mfma_f32_16x16x32_bf16 v[32:35], a[0:3], v[80:83], v[32:35]
    v_mfma_f32_16x16x32_bf16 v[60:63], a[0:3], v[84:87], v[60:63]
    v_mfma_f32_16x16x32_bf16 v[36:39], a[56:59], v[80:83], v[36:39]
    v_mfma_f32_16x16x32_bf16 v[64:67], a[56:59], v[84:87], v[64:67]
    s_waitcnt lgkmcnt(2)
    v_mfma_f32_16x16x32_bf16 v[24:27], v[148:151], v[88:91], v[24:27]
    v_mfma_f32_16x16x32_bf16 v[52:55], v[148:151], v[92:95], v[52:55]
    ds_read_b128 v[80:83], v4 offset:20160
    ds_read_b128 v[84:87], v4 offset:21248
    v_mfma_f32_16x16x32_bf16 v[28:31], v[204:207], v[88:91], v[28:31]
    v_mfma_f32_16x16x32_bf16 v[56:59], v[204:207], v[92:95], v[56:59]
    v_mfma_f32_16x16x32_bf16 v[32:35], a[4:7], v[88:91], v[32:35]
    v_mfma_f32_16x16x32_bf16 v[60:63], a[4:7], v[92:95], v[60:63]
    v_mfma_f32_16x16x32_bf16 v[36:39], a[60:63], v[88:91], v[36:39]
    v_mfma_f32_16x16x32_bf16 v[64:67], a[60:63], v[92:95], v[64:67]
    s_waitcnt lgkmcnt(2)
    v_mfma_f32_16x16x32_bf16 v[24:27], v[152:155], v[96:99], v[24:27]
    v_mfma_f32_16x16x32_bf16 v[52:55], v[152:155], v[100:103], v[52:55]
    ds_read_b128 v[88:91], v4 offset:22400
    ds_read_b128 v[92:95], v4 offset:23488
    v_mfma_f32_16x16x32_bf16 v[28:31], v[208:211], v[96:99], v[28:31]
    v_mfma_f32_16x16x32_bf16 v[56:59], v[208:211], v[100:103], v[56:59]
    v_mfma_f32_16x16x32_bf16 v[32:35], a[8:11], v[96:99], v[32:35]
    v_mfma_f32_16x16x32_bf16 v[60:63], a[8:11], v[100:103], v[60:63]
    v_mfma_f32_16x16x32_bf16 v[36:39], a[64:67], v[96:99], v[36:39]
    v_mfma_f32_16x16x32_bf16 v[64:67], a[64:67], v[100:103], v[64:67]
    s_waitcnt lgkmcnt(2)
    v_mfma_f32_16x16x32_bf16 v[24:27], v[156:159], v[80:83], v[24:27]
    v_mfma_f32_16x16x32_bf16 v[52:55], v[156:159], v[84:87], v[52:55]
    ds_read_b128 v[96:99], v4 offset:24640
    ds_read_b128 v[100:103], v4 offset:25728
    v_mfma_f32_16x16x32_bf16 v[28:31], v[212:215], v[80:83], v[28:31]
    v_mfma_f32_16x16x32_bf16 v[56:59], v[212:215], v[84:87], v[56:59]
    v_mfma_f32_16x16x32_bf16 v[32:35], a[12:15], v[80:83], v[32:35]
    v_mfma_f32_16x16x32_bf16 v[60:63], a[12:15], v[84:87], v[60:63]
    v_mfma_f32_16x16x32_bf16 v[36:39], a[68:71], v[80:83], v[36:39]
    v_mfma_f32_16x16x32_bf16 v[64:67], a[68:71], v[84:87], v[64:67]
    s_waitcnt lgkmcnt(2)
    v_mfma_f32_16x16x32_bf16 v[24:27], v[160:163], v[88:91], v[24:27]
    v_mfma_f32_16x16x32_bf16 v[52:55], v[160:163], v[92:95], v[52:55]
    ds_read_b128 v[80:83], v4 offset:26880
    ds_read_b128 v[84:87], v4 offset:27968
    v_mfma_f32_16x16x32_bf16 v[28:31], v[216:219], v[88:91], v[28:31]
    v_mfma_f32_16x16x32_bf16 v[56:59], v[216:219], v[92:95], v[56:59]
    v_mfma_f32_16x16x32_bf16 v[32:35], a[16:19], v[88:91], v[32:35]
    v_mfma_f32_16x16x32_bf16 v[60:63], a[16:19], v[92:95], v[60:63]
    v_mfma_f32_16x16x32_bf16 v[36:39], a[72:75], v[88:91], v[36:39]
    v_mfma_f32_16x16x32_bf16 v[64:67], a[72:75], v[92:95], v[64:67]
    s_waitcnt lgkmcnt(2)
    v_mfma_f32_16x16x32_bf16 v[24:27], v[164:167], v[96:99], v[24:27]
    v_mfma_f32_16x16x32_bf16 v[52:55], v[164:167], v[100:103], v[52:55]
    ds_read_b128 v[88:91], v4 offset:29120
    ds_read_b128 v[92:95], v4 offset:30208
    v_mfma_f32_16x16x32_bf16 v[28:31], v[220:223], v[96:99], v[28:31]
    v_mfma_f32_16x16x32_bf16 v[56:59], v[220:223], v[100:103], v[56:59]
    v_mfma_f32_16x16x32_bf16 v[32:35], a[20:23], v[96:99], v[32:35]
    v_mfma_f32_16x16x32_bf16 v[60:63], a[20:23], v[100:103], v[60:63]
    v_mfma_f32_16x16x32_bf16 v[36:39], a[76:79], v[96:99], v[36:39]
    v_mfma_f32_16x16x32_bf16 v[64:67], a[76:79], v[100:103], v[64:67]
    s_waitcnt lgkmcnt(2)
    v_mfma_f32_16x16x32_bf16 v[24:27], v[168:171], v[80:83], v[24:27]
    v_mfma_f32_16x16x32_bf16 v[52:55], v[168:171], v[84:87], v[52:55]
    ds_read_b128 v[96:99], v4 offset:0
    ds_read_b128 v[100:103], v4 offset:1088
    v_mfma_f32_16x16x32_bf16 v[28:31], v[224:227], v[80:83], v[28:31]
    v_mfma_f32_16x16x32_bf16 v[56:59], v[224:227], v[84:87], v[56:59]
    v_mfma_f32_16x16x32_bf16 v[32:35], a[24:27], v[80:83], v[32:35]
    v_mfma_f32_16x16x32_bf16 v[60:63], a[24:27], v[84:87], v[60:63]
    v_mfma_f32_16x16x32_bf16 v[36:39], a[80:83], v[80:83], v[36:39]
    v_mfma_f32_16x16x32_bf16 v[64:67], a[80:83], v[84:87], v[64:67]
    s_waitcnt lgkmcnt(2)
    v_mfma_f32_16x16x32_bf16 v[24:27], v[172:175], v[88:91], v[24:27]
    v_mfma_f32_16x16x32_bf16 v[52:55], v[172:175], v[92:95], v[52:55]
    ds_read_b128 v[80:83], v4 offset:2240
    ds_read_b128 v[84:87], v4 offset:3328
    v_mfma_f32_16x16x32_bf16 v[28:31], v[228:231], v[88:91], v[28:31]
    v_mfma_f32_16x16x32_bf16 v[56:59], v[228:231], v[92:95], v[56:59]
    v_mfma_f32_16x16x32_bf16 v[32:35], a[28:31], v[88:91], v[32:35]
    v_mfma_f32_16x16x32_bf16 v[60:63], a[28:31], v[92:95], v[60:63]
    v_mfma_f32_16x16x32_bf16 v[36:39], a[84:87], v[88:91], v[36:39]
    v_mfma_f32_16x16x32_bf16 v[64:67], a[84:87], v[92:95], v[64:67]
    s_waitcnt lgkmcnt(2)
    v_mfma_f32_16x16x32_bf16 v[40:43], a[88:91], v[96:99], 0
    v_mfma_f32_16x16x32_bf16 v[68:71], a[88:91], v[100:103], 0
    ds_read_b128 v[88:91], v4 offset:4480
    ds_read_b128 v[92:95], v4 offset:5568
    v_mfma_f32_16x16x32_bf16 v[44:47], a[144:147], v[96:99], 0
    v_mfma_f32_16x16x32_bf16 v[72:75], a[144:147], v[100:103], 0
    v_mfma_f32_16x16x32_bf16 v[48:51], a[200:203], v[96:99], 0
    v_mfma_f32_16x16x32_bf16 v[76:79], a[200:203], v[100:103], 0
    s_waitcnt lgkmcnt(2)
    v_mfma_f32_16x16x32_bf16 v[40:43], a[92:95], v[80:83], v[40:43]
    v_cvt_pk_bf16_f32 v108, v24, v25
    v_cvt_pk_bf16_f32 v109, v26, v27
    v_lshlrev_b32 v24, 16, v108
    v_and_b32 v25, 0xffff0000, v108
    v_mfma_f32_16x16x32_bf16 v[68:71], a[92:95], v[84:87], v[68:71]
    ds_read_b128 v[96:99], v4 offset:6720
    ds_read_b128 v[100:103], v4 offset:7808
    v_lshlrev_b32 v26, 16, v109
    v_and_b32 v27, 0xffff0000, v109
    v_pk_mul_f32 v[108:109], v[24:25], v[24:25]
    v_pk_mul_f32 v[110:111], v[26:27], v[26:27]
    v_mfma_f32_16x16x32_bf16 v[44:47], a[148:151], v[80:83], v[44:47]
    v_pk_fma_f32 v[108:109], v[108:109], s[50:51], v[112:113]
    v_pk_fma_f32 v[110:111], v[110:111], s[50:51], v[112:113]
    v_pk_mul_f32 v[108:109], v[108:109], v[24:25]
    v_pk_mul_f32 v[110:111], v[110:111], v[26:27]
    v_mfma_f32_16x16x32_bf16 v[72:75], a[148:151], v[84:87], v[72:75]
    v_exp_f32 v108, v108
    v_exp_f32 v109, v109
    v_exp_f32 v110, v110
    v_exp_f32 v111, v111
    v_mfma_f32_16x16x32_bf16 v[48:51], a[204:207], v[80:83], v[48:51]
    v_pk_add_f32 v[108:109], v[108:109], 1.0 op_sel_hi:[1,0]
    v_pk_add_f32 v[110:111], v[110:111], 1.0 op_sel_hi:[1,0]
    v_rcp_f32 v108, v108
    v_rcp_f32 v109, v109
    v_mfma_f32_16x16x32_bf16 v[76:79], a[204:207], v[84:87], v[76:79]
    v_rcp_f32 v110, v110
    v_rcp_f32 v111, v111
    v_pk_mul_f32 v[24:25], v[24:25], v[108:109]
    v_pk_mul_f32 v[26:27], v[26:27], v[110:111]
    s_waitcnt lgkmcnt(2)
    v_mfma_f32_16x16x32_bf16 v[40:43], a[96:99], v[88:91], v[40:43]
    v_cvt_pk_bf16_f32 v114, v24, v25
    v_cvt_pk_bf16_f32 v115, v26, v27
    global_store_dwordx2 v7, v[114:115], s[26:27] offset:0 sc1
    v_cvt_pk_bf16_f32 v108, v52, v53
    v_mfma_f32_16x16x32_bf16 v[68:71], a[96:99], v[92:95], v[68:71]
    ds_read_b128 v[80:83], v4 offset:8960
    ds_read_b128 v[84:87], v4 offset:10048
    v_cvt_pk_bf16_f32 v109, v54, v55
    v_lshlrev_b32 v52, 16, v108
    v_and_b32 v53, 0xffff0000, v108
    v_lshlrev_b32 v54, 16, v109
    v_mfma_f32_16x16x32_bf16 v[44:47], a[152:155], v[88:91], v[44:47]
    v_and_b32 v55, 0xffff0000, v109
    v_pk_mul_f32 v[108:109], v[52:53], v[52:53]
    v_pk_mul_f32 v[110:111], v[54:55], v[54:55]
    v_pk_fma_f32 v[108:109], v[108:109], s[50:51], v[112:113]
    v_mfma_f32_16x16x32_bf16 v[72:75], a[152:155], v[92:95], v[72:75]
    v_pk_fma_f32 v[110:111], v[110:111], s[50:51], v[112:113]
    v_pk_mul_f32 v[108:109], v[108:109], v[52:53]
    v_pk_mul_f32 v[110:111], v[110:111], v[54:55]
    v_exp_f32 v108, v108
    v_mfma_f32_16x16x32_bf16 v[48:51], a[208:211], v[88:91], v[48:51]
    v_exp_f32 v109, v109
    v_exp_f32 v110, v110
    v_exp_f32 v111, v111
    v_pk_add_f32 v[108:109], v[108:109], 1.0 op_sel_hi:[1,0]
    v_mfma_f32_16x16x32_bf16 v[76:79], a[208:211], v[92:95], v[76:79]
    v_pk_add_f32 v[110:111], v[110:111], 1.0 op_sel_hi:[1,0]
    v_rcp_f32 v108, v108
    v_rcp_f32 v109, v109
    v_rcp_f32 v110, v110
    s_waitcnt lgkmcnt(2)
    v_mfma_f32_16x16x32_bf16 v[40:43], a[100:103], v[96:99], v[40:43]
    v_rcp_f32 v111, v111
    v_pk_mul_f32 v[52:53], v[52:53], v[108:109]
    v_pk_mul_f32 v[54:55], v[54:55], v[110:111]
    v_cvt_pk_bf16_f32 v116, v52, v53
    v_mfma_f32_16x16x32_bf16 v[68:71], a[100:103], v[100:103], v[68:71]
    ds_read_b128 v[88:91], v4 offset:11200
    ds_read_b128 v[92:95], v4 offset:12288
    v_cvt_pk_bf16_f32 v117, v54, v55
    global_store_dwordx2 v7, v[116:117], s[26:27] offset:512 sc1
    v_cvt_pk_bf16_f32 v108, v28, v29
    v_cvt_pk_bf16_f32 v109, v30, v31
    v_mfma_f32_16x16x32_bf16 v[44:47], a[156:159], v[96:99], v[44:47]
    v_lshlrev_b32 v28, 16, v108
    v_and_b32 v29, 0xffff0000, v108
    v_lshlrev_b32 v30, 16, v109
    v_and_b32 v31, 0xffff0000, v109
    v_mfma_f32_16x16x32_bf16 v[72:75], a[156:159], v[100:103], v[72:75]
    v_pk_mul_f32 v[108:109], v[28:29], v[28:29]
    v_pk_mul_f32 v[110:111], v[30:31], v[30:31]
    v_pk_fma_f32 v[108:109], v[108:109], s[50:51], v[112:113]
    v_pk_fma_f32 v[110:111], v[110:111], s[50:51], v[112:113]
    v_mfma_f32_16x16x32_bf16 v[48:51], a[212:215], v[96:99], v[48:51]
    v_pk_mul_f32 v[108:109], v[108:109], v[28:29]
    v_pk_mul_f32 v[110:111], v[110:111], v[30:31]
    v_exp_f32 v108, v108
    v_exp_f32 v109, v109
    v_mfma_f32_16x16x32_bf16 v[76:79], a[212:215], v[100:103], v[76:79]
    v_exp_f32 v110, v110
    v_exp_f32 v111, v111
    v_pk_add_f32 v[108:109], v[108:109], 1.0 op_sel_hi:[1,0]
    v_pk_add_f32 v[110:111], v[110:111], 1.0 op_sel_hi:[1,0]
    s_waitcnt lgkmcnt(2)
    v_mfma_f32_16x16x32_bf16 v[40:43], a[104:107], v[80:83], v[40:43]
    v_rcp_f32 v108, v108
    v_rcp_f32 v109, v109
    v_rcp_f32 v110, v110
    v_rcp_f32 v111, v111
    v_mfma_f32_16x16x32_bf16 v[68:71], a[104:107], v[84:87], v[68:71]
    ds_read_b128 v[96:99], v4 offset:13440
    ds_read_b128 v[100:103], v4 offset:14528
    v_pk_mul_f32 v[28:29], v[28:29], v[108:109]
    v_pk_mul_f32 v[30:31], v[30:31], v[110:111]
    v_cvt_pk_bf16_f32 v114, v28, v29
    v_cvt_pk_bf16_f32 v115, v30, v31
    v_mfma_f32_16x16x32_bf16 v[44:47], a[160:163], v[80:83], v[44:47]
    global_store_dwordx2 v7, v[114:115], s[26:27] offset:1024 sc1
    v_cvt_pk_bf16_f32 v108, v56, v57
    v_cvt_pk_bf16_f32 v109, v58, v59
    v_lshlrev_b32 v56, 16, v108
    v_mfma_f32_16x16x32_bf16 v[72:75], a[160:163], v[84:87], v[72:75]
    v_and_b32 v57, 0xffff0000, v108
    v_lshlrev_b32 v58, 16, v109
    v_and_b32 v59, 0xffff0000, v109
    v_pk_mul_f32 v[108:109], v[56:57], v[56:57]
    v_mfma_f32_16x16x32_bf16 v[48:51], a[216:219], v[80:83], v[48:51]
    v_pk_mul_f32 v[110:111], v[58:59], v[58:59]
    v_pk_fma_f32 v[108:109], v[108:109], s[50:51], v[112:113]
    v_pk_fma_f32 v[110:111], v[110:111], s[50:51], v[112:113]
    v_pk_mul_f32 v[108:109], v[108:109], v[56:57]
    v_mfma_f32_16x16x32_bf16 v[76:79], a[216:219], v[84:87], v[76:79]
    v_pk_mul_f32 v[110:111], v[110:111], v[58:59]
    v_exp_f32 v108, v108
    v_exp_f32 v109, v109
    v_exp_f32 v110, v110
    s_waitcnt lgkmcnt(2)
    v_mfma_f32_16x16x32_bf16 v[40:43], a[108:111], v[88:91], v[40:43]
    v_exp_f32 v111, v111
    v_pk_add_f32 v[108:109], v[108:109], 1.0 op_sel_hi:[1,0]
    v_pk_add_f32 v[110:111], v[110:111], 1.0 op_sel_hi:[1,0]
    v_rcp_f32 v108, v108
    v_mfma_f32_16x16x32_bf16 v[68:71], a[108:111], v[92:95], v[68:71]
    ds_read_b128 v[80:83], v4 offset:15680
    ds_read_b128 v[84:87], v4 offset:16768
    v_rcp_f32 v109, v109
    v_rcp_f32 v110, v110
    v_rcp_f32 v111, v111
    v_pk_mul_f32 v[56:57], v[56:57], v[108:109]
    v_mfma_f32_16x16x32_bf16 v[44:47], a[164:167], v[88:91], v[44:47]
    v_pk_mul_f32 v[58:59], v[58:59], v[110:111]
    v_cvt_pk_bf16_f32 v116, v56, v57
    v_cvt_pk_bf16_f32 v117, v58, v59
    global_store_dwordx2 v7, v[116:117], s[26:27] offset:1536 sc1
    v_mfma_f32_16x16x32_bf16 v[72:75], a[164:167], v[92:95], v[72:75]
    v_cvt_pk_bf16_f32 v108, v32, v33
    v_cvt_pk_bf16_f32 v109, v34, v35
    v_lshlrev_b32 v32, 16, v108
    v_and_b32 v33, 0xffff0000, v108
    v_mfma_f32_16x16x32_bf16 v[48:51], a[220:223], v[88:91], v[48:51]
    v_lshlrev_b32 v34, 16, v109
    v_and_b32 v35, 0xffff0000, v109
    v_pk_mul_f32 v[108:109], v[32:33], v[32:33]
    v_pk_mul_f32 v[110:111], v[34:35], v[34:35]
    v_mfma_f32_16x16x32_bf16 v[76:79], a[220:223], v[92:95], v[76:79]
    v_pk_fma_f32 v[108:109], v[108:109], s[50:51], v[112:113]
    v_pk_fma_f32 v[110:111], v[110:111], s[50:51], v[112:113]
    v_pk_mul_f32 v[108:109], v[108:109], v[32:33]
    v_pk_mul_f32 v[110:111], v[110:111], v[34:35]
    s_waitcnt lgkmcnt(2)
    v_mfma_f32_16x16x32_bf16 v[40:43], a[112:115], v[96:99], v[40:43]
    v_exp_f32 v108, v108
    v_exp_f32 v109, v109
    v_exp_f32 v110, v110
    v_exp_f32 v111, v111
    v_mfma_f32_16x16x32_bf16 v[68:71], a[112:115], v[100:103], v[68:71]
    ds_read_b128 v[88:91], v4 offset:17920
    ds_read_b128 v[92:95], v4 offset:19008
    v_pk_add_f32 v[108:109], v[108:109], 1.0 op_sel_hi:[1,0]
    v_pk_add_f32 v[110:111], v[110:111], 1.0 op_sel_hi:[1,0]
    v_rcp_f32 v108, v108
    v_rcp_f32 v109, v109
    v_mfma_f32_16x16x32_bf16 v[44:47], a[168:171], v[96:99], v[44:47]
    v_rcp_f32 v110, v110
    v_rcp_f32 v111, v111
    v_pk_mul_f32 v[32:33], v[32:33], v[108:109]
    v_pk_mul_f32 v[34:35], v[34:35], v[110:111]
    v_mfma_f32_16x16x32_bf16 v[72:75], a[168:171], v[100:103], v[72:75]
    v_cvt_pk_bf16_f32 v114, v32, v33
    v_cvt_pk_bf16_f32 v115, v34, v35
    global_store_dwordx2 v7, v[114:115], s[26:27] offset:2048 sc1
    v_cvt_pk_bf16_f32 v108, v60, v61
    v_mfma_f32_16x16x32_bf16 v[48:51], a[224:227], v[96:99], v[48:51]
    v_cvt_pk_bf16_f32 v109, v62, v63
    v_lshlrev_b32 v60, 16, v108
    v_and_b32 v61, 0xffff0000, v108
    v_lshlrev_b32 v62, 16, v109
    v_mfma_f32_16x16x32_bf16 v[76:79], a[224:227], v[100:103], v[76:79]
    v_and_b32 v63, 0xffff0000, v109
    v_pk_mul_f32 v[108:109], v[60:61], v[60:61]
    v_pk_mul_f32 v[110:111], v[62:63], v[62:63]
    v_pk_fma_f32 v[108:109], v[108:109], s[50:51], v[112:113]
    s_waitcnt lgkmcnt(2)
    v_mfma_f32_16x16x32_bf16 v[40:43], a[116:119], v[80:83], v[40:43]
    v_pk_fma_f32 v[110:111], v[110:111], s[50:51], v[112:113]
    v_pk_mul_f32 v[108:109], v[108:109], v[60:61]
    v_pk_mul_f32 v[110:111], v[110:111], v[62:63]
    v_exp_f32 v108, v108
    v_mfma_f32_16x16x32_bf16 v[68:71], a[116:119], v[84:87], v[68:71]
    ds_read_b128 v[96:99], v4 offset:20160
    ds_read_b128 v[100:103], v4 offset:21248
    v_exp_f32 v109, v109
    v_exp_f32 v110, v110
    v_exp_f32 v111, v111
    v_pk_add_f32 v[108:109], v[108:109], 1.0 op_sel_hi:[1,0]
    v_mfma_f32_16x16x32_bf16 v[44:47], a[172:175], v[80:83], v[44:47]
    v_pk_add_f32 v[110:111], v[110:111], 1.0 op_sel_hi:[1,0]
    v_rcp_f32 v108, v108
    v_rcp_f32 v109, v109
    v_rcp_f32 v110, v110
    v_mfma_f32_16x16x32_bf16 v[72:75], a[172:175], v[84:87], v[72:75]
    v_rcp_f32 v111, v111
    v_pk_mul_f32 v[60:61], v[60:61], v[108:109]
    v_pk_mul_f32 v[62:63], v[62:63], v[110:111]
    v_cvt_pk_bf16_f32 v116, v60, v61
    v_mfma_f32_16x16x32_bf16 v[48:51], a[228:231], v[80:83], v[48:51]
    v_cvt_pk_bf16_f32 v117, v62, v63
    global_store_dwordx2 v7, v[116:117], s[26:27] offset:2560 sc1
    v_cvt_pk_bf16_f32 v108, v36, v37
    v_cvt_pk_bf16_f32 v109, v38, v39
    v_mfma_f32_16x16x32_bf16 v[76:79], a[228:231], v[84:87], v[76:79]
    v_lshlrev_b32 v36, 16, v108
    v_and_b32 v37, 0xffff0000, v108
    v_lshlrev_b32 v38, 16, v109
    v_and_b32 v39, 0xffff0000, v109
    s_waitcnt lgkmcnt(2)
    v_mfma_f32_16x16x32_bf16 v[40:43], a[120:123], v[88:91], v[40:43]
    v_pk_mul_f32 v[108:109], v[36:37], v[36:37]
    v_pk_mul_f32 v[110:111], v[38:39], v[38:39]
    v_pk_fma_f32 v[108:109], v[108:109], s[50:51], v[112:113]
    v_pk_fma_f32 v[110:111], v[110:111], s[50:51], v[112:113]
    v_mfma_f32_16x16x32_bf16 v[68:71], a[120:123], v[92:95], v[68:71]
    ds_read_b128 v[80:83], v4 offset:22400
    ds_read_b128 v[84:87], v4 offset:23488
    v_pk_mul_f32 v[108:109], v[108:109], v[36:37]
    v_pk_mul_f32 v[110:111], v[110:111], v[38:39]
    v_exp_f32 v108, v108
    v_exp_f32 v109, v109
    v_mfma_f32_16x16x32_bf16 v[44:47], a[176:179], v[88:91], v[44:47]
    v_exp_f32 v110, v110
    v_exp_f32 v111, v111
    v_pk_add_f32 v[108:109], v[108:109], 1.0 op_sel_hi:[1,0]
    v_pk_add_f32 v[110:111], v[110:111], 1.0 op_sel_hi:[1,0]
    v_mfma_f32_16x16x32_bf16 v[72:75], a[176:179], v[92:95], v[72:75]
    v_rcp_f32 v108, v108
    v_rcp_f32 v109, v109
    v_rcp_f32 v110, v110
    v_rcp_f32 v111, v111
    v_mfma_f32_16x16x32_bf16 v[48:51], a[232:235], v[88:91], v[48:51]
    v_pk_mul_f32 v[36:37], v[36:37], v[108:109]
    v_pk_mul_f32 v[38:39], v[38:39], v[110:111]
    v_cvt_pk_bf16_f32 v114, v36, v37
    v_cvt_pk_bf16_f32 v115, v38, v39
    v_mfma_f32_16x16x32_bf16 v[76:79], a[232:235], v[92:95], v[76:79]
    global_store_dwordx2 v7, v[114:115], s[26:27] offset:3072 sc1
    v_cvt_pk_bf16_f32 v108, v64, v65
    v_cvt_pk_bf16_f32 v109, v66, v67
    v_lshlrev_b32 v64, 16, v108
    s_waitcnt lgkmcnt(2)
    v_mfma_f32_16x16x32_bf16 v[40:43], a[124:127], v[96:99], v[40:43]
    v_and_b32 v65, 0xffff0000, v108
    v_lshlrev_b32 v66, 16, v109
    v_and_b32 v67, 0xffff0000, v109
    v_pk_mul_f32 v[108:109], v[64:65], v[64:65]
    v_mfma_f32_16x16x32_bf16 v[68:71], a[124:127], v[100:103], v[68:71]
    ds_read_b128 v[88:91], v4 offset:24640
    ds_read_b128 v[92:95], v4 offset:25728
    v_pk_mul_f32 v[110:111], v[66:67], v[66:67]
    v_pk_fma_f32 v[108:109], v[108:109], s[50:51], v[112:113]
    v_pk_fma_f32 v[110:111], v[110:111], s[50:51], v[112:113]
    v_pk_mul_f32 v[108:109], v[108:109], v[64:65]
    v_mfma_f32_16x16x32_bf16 v[44:47], a[180:183], v[96:99], v[44:47]
    v_pk_mul_f32 v[110:111], v[110:111], v[66:67]
    v_exp_f32 v108, v108
    v_exp_f32 v109, v109
    v_exp_f32 v110, v110
    v_mfma_f32_16x16x32_bf16 v[72:75], a[180:183], v[100:103], v[72:75]
    v_exp_f32 v111, v111
    v_pk_add_f32 v[108:109], v[108:109], 1.0 op_sel_hi:[1,0]
    v_pk_add_f32 v[110:111], v[110:111], 1.0 op_sel_hi:[1,0]
    v_rcp_f32 v108, v108
    v_mfma_f32_16x16x32_bf16 v[48:51], a[236:239], v[96:99], v[48:51]
    v_rcp_f32 v109, v109
    v_rcp_f32 v110, v110
    v_rcp_f32 v111, v111
    v_pk_mul_f32 v[64:65], v[64:65], v[108:109]
    v_mfma_f32_16x16x32_bf16 v[76:79], a[236:239], v[100:103], v[76:79]
    v_pk_mul_f32 v[66:67], v[66:67], v[110:111]
    v_cvt_pk_bf16_f32 v116, v64, v65
    v_cvt_pk_bf16_f32 v117, v66, v67
    global_store_dwordx2 v7, v[116:117], s[26:27] offset:3584 sc1
    s_waitcnt lgkmcnt(2)
    v_mfma_f32_16x16x32_bf16 v[40:43], a[128:131], v[80:83], v[40:43]
    v_mfma_f32_16x16x32_bf16 v[68:71], a[128:131], v[84:87], v[68:71]
    ds_read_b128 v[96:99], v4 offset:26880
    ds_read_b128 v[100:103], v4 offset:27968
    v_mfma_f32_16x16x32_bf16 v[44:47], a[184:187], v[80:83], v[44:47]
    v_mfma_f32_16x16x32_bf16 v[72:75], a[184:187], v[84:87], v[72:75]
    v_mfma_f32_16x16x32_bf16 v[48:51], a[240:243], v[80:83], v[48:51]
    v_mfma_f32_16x16x32_bf16 v[76:79], a[240:243], v[84:87], v[76:79]
    s_waitcnt lgkmcnt(2)
    v_mfma_f32_16x16x32_bf16 v[40:43], a[132:135], v[88:91], v[40:43]
    v_mfma_f32_16x16x32_bf16 v[68:71], a[132:135], v[92:95], v[68:71]
    ds_read_b128 v[80:83], v4 offset:29120
    ds_read_b128 v[84:87], v4 offset:30208
    v_mfma_f32_16x16x32_bf16 v[44:47], a[188:191], v[88:91], v[44:47]
    v_mfma_f32_16x16x32_bf16 v[72:75], a[188:191], v[92:95], v[72:75]
    v_mfma_f32_16x16x32_bf16 v[48:51], a[244:247], v[88:91], v[48:51]
    v_mfma_f32_16x16x32_bf16 v[76:79], a[244:247], v[92:95], v[76:79]
    s_waitcnt lgkmcnt(2)
    v_mfma_f32_16x16x32_bf16 v[40:43], a[136:139], v[96:99], v[40:43]
    v_mfma_f32_16x16x32_bf16 v[68:71], a[136:139], v[100:103], v[68:71]
    v_mfma_f32_16x16x32_bf16 v[44:47], a[192:195], v[96:99], v[44:47]
    v_mfma_f32_16x16x32_bf16 v[72:75], a[192:195], v[100:103], v[72:75]
    v_mfma_f32_16x16x32_bf16 v[48:51], a[248:251], v[96:99], v[48:51]
    v_mfma_f32_16x16x32_bf16 v[76:79], a[248:251], v[100:103], v[76:79]
    s_waitcnt lgkmcnt(0)
    v_mfma_f32_16x16x32_bf16 v[40:43], a[140:143], v[80:83], v[40:43]
    v_mfma_f32_16x16x32_bf16 v[68:71], a[140:143], v[84:87], v[68:71]
    v_mfma_f32_16x16x32_bf16 v[44:47], a[196:199], v[80:83], v[44:47]
    v_mfma_f32_16x16x32_bf16 v[72:75], a[196:199], v[84:87], v[72:75]
    v_mfma_f32_16x16x32_bf16 v[48:51], a[252:255], v[80:83], v[48:51]
    v_mfma_f32_16x16x32_bf16 v[76:79], a[252:255], v[84:87], v[76:79]
    s_nop 2
    v_cvt_pk_bf16_f32 v108, v40, v41
    v_cvt_pk_bf16_f32 v109, v42, v43
    v_lshlrev_b32 v40, 16, v108
    v_and_b32 v41, 0xffff0000, v108
    v_lshlrev_b32 v42, 16, v109
    v_and_b32 v43, 0xffff0000, v109
    v_pk_mul_f32 v[108:109], v[40:41], v[40:41]
    v_pk_mul_f32 v[110:111], v[42:43], v[42:43]
    v_pk_fma_f32 v[108:109], v[108:109], s[50:51], v[112:113]
    v_pk_fma_f32 v[110:111], v[110:111], s[50:51], v[112:113]
    v_pk_mul_f32 v[108:109], v[108:109], v[40:41]
    v_pk_mul_f32 v[110:111], v[110:111], v[42:43]
    v_exp_f32 v108, v108
    v_exp_f32 v109, v109
    v_exp_f32 v110, v110
    v_exp_f32 v111, v111
    v_pk_add_f32 v[108:109], v[108:109], 1.0 op_sel_hi:[1,0]
    v_pk_add_f32 v[110:111], v[110:111], 1.0 op_sel_hi:[1,0]
    v_rcp_f32 v108, v108
    v_rcp_f32 v109, v109
    v_rcp_f32 v110, v110
    v_rcp_f32 v111, v111
    v_pk_mul_f32 v[40:41], v[40:41], v[108:109]
    v_pk_mul_f32 v[42:43], v[42:43], v[110:111]
    v_cvt_pk_bf16_f32 v114, v40, v41
    v_cvt_pk_bf16_f32 v115, v42, v43
    global_store_dwordx2 v15, v[114:115], s[26:27] offset:0 sc1
    v_cvt_pk_bf16_f32 v108, v68, v69
    v_cvt_pk_bf16_f32 v109, v70, v71
    v_lshlrev_b32 v68, 16, v108
    v_and_b32 v69, 0xffff0000, v108
    v_lshlrev_b32 v70, 16, v109
    v_and_b32 v71, 0xffff0000, v109
    v_pk_mul_f32 v[108:109], v[68:69], v[68:69]
    v_pk_mul_f32 v[110:111], v[70:71], v[70:71]
    v_pk_fma_f32 v[108:109], v[108:109], s[50:51], v[112:113]
    v_pk_fma_f32 v[110:111], v[110:111], s[50:51], v[112:113]
    v_pk_mul_f32 v[108:109], v[108:109], v[68:69]
    v_pk_mul_f32 v[110:111], v[110:111], v[70:71]
    v_exp_f32 v108, v108
    v_exp_f32 v109, v109
    v_exp_f32 v110, v110
    v_exp_f32 v111, v111
    v_pk_add_f32 v[108:109], v[108:109], 1.0 op_sel_hi:[1,0]
    v_pk_add_f32 v[110:111], v[110:111], 1.0 op_sel_hi:[1,0]
    v_rcp_f32 v108, v108
    v_rcp_f32 v109, v109
    v_rcp_f32 v110, v110
    v_rcp_f32 v111, v111
    v_pk_mul_f32 v[68:69], v[68:69], v[108:109]
    v_pk_mul_f32 v[70:71], v[70:71], v[110:111]
    v_cvt_pk_bf16_f32 v116, v68, v69
    v_cvt_pk_bf16_f32 v117, v70, v71
    global_store_dwordx2 v15, v[116:117], s[26:27] offset:512 sc1
    v_cvt_pk_bf16_f32 v108, v44, v45
    v_cvt_pk_bf16_f32 v109, v46, v47
    v_lshlrev_b32 v44, 16, v108
    v_and_b32 v45, 0xffff0000, v108
    v_lshlrev_b32 v46, 16, v109
    v_and_b32 v47, 0xffff0000, v109
    v_pk_mul_f32 v[108:109], v[44:45], v[44:45]
    v_pk_mul_f32 v[110:111], v[46:47], v[46:47]
    v_pk_fma_f32 v[108:109], v[108:109], s[50:51], v[112:113]
    v_pk_fma_f32 v[110:111], v[110:111], s[50:51], v[112:113]
    v_pk_mul_f32 v[108:109], v[108:109], v[44:45]
    v_pk_mul_f32 v[110:111], v[110:111], v[46:47]
    v_exp_f32 v108, v108
    v_exp_f32 v109, v109
    v_exp_f32 v110, v110
    v_exp_f32 v111, v111
    v_pk_add_f32 v[108:109], v[108:109], 1.0 op_sel_hi:[1,0]
    v_pk_add_f32 v[110:111], v[110:111], 1.0 op_sel_hi:[1,0]
    v_rcp_f32 v108, v108
    v_rcp_f32 v109, v109
    v_rcp_f32 v110, v110
    v_rcp_f32 v111, v111
    v_pk_mul_f32 v[44:45], v[44:45], v[108:109]
    v_pk_mul_f32 v[46:47], v[46:47], v[110:111]
    v_cvt_pk_bf16_f32 v114, v44, v45
    v_cvt_pk_bf16_f32 v115, v46, v47
    global_store_dwordx2 v15, v[114:115], s[26:27] offset:1024 sc1
    v_cvt_pk_bf16_f32 v108, v72, v73
    v_cvt_pk_bf16_f32 v109, v74, v75
    v_lshlrev_b32 v72, 16, v108
    v_and_b32 v73, 0xffff0000, v108
    v_lshlrev_b32 v74, 16, v109
    v_and_b32 v75, 0xffff0000, v109
    v_pk_mul_f32 v[108:109], v[72:73], v[72:73]
    v_pk_mul_f32 v[110:111], v[74:75], v[74:75]
    v_pk_fma_f32 v[108:109], v[108:109], s[50:51], v[112:113]
    v_pk_fma_f32 v[110:111], v[110:111], s[50:51], v[112:113]
    v_pk_mul_f32 v[108:109], v[108:109], v[72:73]
    v_pk_mul_f32 v[110:111], v[110:111], v[74:75]
    v_exp_f32 v108, v108
    v_exp_f32 v109, v109
    v_exp_f32 v110, v110
    v_exp_f32 v111, v111
    v_pk_add_f32 v[108:109], v[108:109], 1.0 op_sel_hi:[1,0]
    v_pk_add_f32 v[110:111], v[110:111], 1.0 op_sel_hi:[1,0]
    v_rcp_f32 v108, v108
    v_rcp_f32 v109, v109
    v_rcp_f32 v110, v110
    v_rcp_f32 v111, v111
    v_pk_mul_f32 v[72:73], v[72:73], v[108:109]
    v_pk_mul_f32 v[74:75], v[74:75], v[110:111]
    v_cvt_pk_bf16_f32 v116, v72, v73
    v_cvt_pk_bf16_f32 v117, v74, v75
    global_store_dwordx2 v15, v[116:117], s[26:27] offset:1536 sc1
    v_cvt_pk_bf16_f32 v108, v48, v49
    v_cvt_pk_bf16_f32 v109, v50, v51
    v_lshlrev_b32 v48, 16, v108
    v_and_b32 v49, 0xffff0000, v108
    v_lshlrev_b32 v50, 16, v109
    v_and_b32 v51, 0xffff0000, v109
    v_pk_mul_f32 v[108:109], v[48:49], v[48:49]
    v_pk_mul_f32 v[110:111], v[50:51], v[50:51]
    v_pk_fma_f32 v[108:109], v[108:109], s[50:51], v[112:113]
    v_pk_fma_f32 v[110:111], v[110:111], s[50:51], v[112:113]
    v_pk_mul_f32 v[108:109], v[108:109], v[48:49]
    v_pk_mul_f32 v[110:111], v[110:111], v[50:51]
    v_exp_f32 v108, v108
    v_exp_f32 v109, v109
    v_exp_f32 v110, v110
    v_exp_f32 v111, v111
    v_pk_add_f32 v[108:109], v[108:109], 1.0 op_sel_hi:[1,0]
    v_pk_add_f32 v[110:111], v[110:111], 1.0 op_sel_hi:[1,0]
    v_rcp_f32 v108, v108
    v_rcp_f32 v109, v109
    v_rcp_f32 v110, v110
    v_rcp_f32 v111, v111
    v_pk_mul_f32 v[48:49], v[48:49], v[108:109]
    v_pk_mul_f32 v[50:51], v[50:51], v[110:111]
    v_cvt_pk_bf16_f32 v114, v48, v49
    v_cvt_pk_bf16_f32 v115, v50, v51
    global_store_dwordx2 v15, v[114:115], s[26:27] offset:2048 sc1
    v_cvt_pk_bf16_f32 v108, v76, v77
    v_cvt_pk_bf16_f32 v109, v78, v79
    v_lshlrev_b32 v76, 16, v108
    v_and_b32 v77, 0xffff0000, v108
    v_lshlrev_b32 v78, 16, v109
    v_and_b32 v79, 0xffff0000, v109
    v_pk_mul_f32 v[108:109], v[76:77], v[76:77]
    v_pk_mul_f32 v[110:111], v[78:79], v[78:79]
    v_pk_fma_f32 v[108:109], v[108:109], s[50:51], v[112:113]
    v_pk_fma_f32 v[110:111], v[110:111], s[50:51], v[112:113]
    v_pk_mul_f32 v[108:109], v[108:109], v[76:77]
    v_pk_mul_f32 v[110:111], v[110:111], v[78:79]
    v_exp_f32 v108, v108
    v_exp_f32 v109, v109
    v_exp_f32 v110, v110
    v_exp_f32 v111, v111
    v_pk_add_f32 v[108:109], v[108:109], 1.0 op_sel_hi:[1,0]
    v_pk_add_f32 v[110:111], v[110:111], 1.0 op_sel_hi:[1,0]
    v_rcp_f32 v108, v108
    v_rcp_f32 v109, v109
    v_rcp_f32 v110, v110
    v_rcp_f32 v111, v111
    v_pk_mul_f32 v[76:77], v[76:77], v[108:109]
    v_pk_mul_f32 v[78:79], v[78:79], v[110:111]
    v_cvt_pk_bf16_f32 v116, v76, v77
    v_cvt_pk_bf16_f32 v117, v78, v79
    global_store_dwordx2 v15, v[116:117], s[26:27] offset:2560 sc1
    s_branch sequential_preLN__memory_aug_recurrent_mem_tr__mixer_gmlp__prompt_kernel_BE_fin
sequential_preLN__memory_aug_recurrent_mem_tr__mixer_gmlp__prompt_kernel_BE_z2:
    v_mov_b32 v112, s54
    v_mov_b32 v113, s54
    v_mov_b32 v116, 0
    v_mov_b32 v117, 0
    v_mov_b32 v118, 0
    v_mov_b32 v119, 0
    v_mov_b32 v8, 0
    v_mov_b32 v9, 0
    v_mov_b32 v10, 0
    v_mov_b32 v12, 0
    v_mov_b32 v13, 0
    v_mov_b32 v14, 0
    v_mov_b32 v19, 0
    v_mov_b32 v20, 0
    v_mov_b32 v21, 0
    v_mov_b32 v22, 0
    v_mov_b32 v23, 0
    v_mov_b32 v104, 0
    ds_read_b128 v[80:83], v4 offset:0
    ds_read_b128 v[84:87], v4 offset:1088
    ds_read_b128 v[88:91], v4 offset:2240
    ds_read_b128 v[92:95], v4 offset:3328
    s_waitcnt lgkmcnt(2)
    v_mfma_f32_16x16x32_bf16 v[24:27], v[80:83], v[120:123], 0
    v_mfma_f32_16x16x32_bf16 v[52:55], v[84:87], v[120:123], 0
    ds_read_b128 v[96:99], v4 offset:4480
    ds_read_b128 v[100:103], v4 offset:5568
    v_mfma_f32_16x16x32_bf16 v[28:31], v[80:83], v[176:179], 0
    v_mfma_f32_16x16x32_bf16 v[56:59], v[84:87], v[176:179], 0
    v_mfma_f32_16x16x32_bf16 v[32:35], v[80:83], v[232:235], 0
    v_mfma_f32_16x16x32_bf16 v[60:63], v[84:87], v[232:235], 0
    v_mfma_f32_16x16x32_bf16 v[36:39], v[80:83], a[32:35], 0
    v_mfma_f32_16x16x32_bf16 v[64:67], v[84:87], a[32:35], 0
    s_waitcnt lgkmcnt(2)
    v_mfma_f32_16x16x32_bf16 v[24:27], v[88:91], v[124:127], v[24:27]
    v_mfma_f32_16x16x32_bf16 v[52:55], v[92:95], v[124:127], v[52:55]
    ds_read_b128 v[80:83], v4 offset:6720
    ds_read_b128 v[84:87], v4 offset:7808
    v_mfma_f32_16x16x32_bf16 v[28:31], v[88:91], v[180:183], v[28:31]
    v_mfma_f32_16x16x32_bf16 v[56:59], v[92:95], v[180:183], v[56:59]
    v_mfma_f32_16x16x32_bf16 v[32:35], v[88:91], v[236:239], v[32:35]
    v_mfma_f32_16x16x32_bf16 v[60:63], v[92:95], v[236:239], v[60:63]
    v_mfma_f32_16x16x32_bf16 v[36:39], v[88:91], a[36:39], v[36:39]
    v_mfma_f32_16x16x32_bf16 v[64:67], v[92:95], a[36:39], v[64:67]
    s_waitcnt lgkmcnt(2)
    v_mfma_f32_16x16x32_bf16 v[24:27], v[96:99], v[128:131], v[24:27]
    v_mfma_f32_16x16x32_bf16 v[52:55], v[100:103], v[128:131], v[52:55]
    ds_read_b128 v[88:91], v4 offset:8960
    ds_read_b128 v[92:95], v4 offset:10048
    v_mfma_f32_16x16x32_bf16 v[28:31], v[96:99], v[184:187], v[28:31]
    v_mfma_f32_16x16x32_bf16 v[56:59], v[100:103], v[184:187], v[56:59]
    v_mfma_f32_16x16x32_bf16 v[32:35], v[96:99], v[240:243], v[32:35]
    v_mfma_f32_16x16x32_bf16 v[60:63], v[100:103], v[240:243], v[60:63]
    v_mfma_f32_16x16x32_bf16 v[36:39], v[96:99], a[40:43], v[36:39]
    v_mfma_f32_16x16x32_bf16 v[64:67], v[100:103], a[40:43], v[64:67]
    s_waitcnt lgkmcnt(2)
    v_mfma_f32_16x16x32_bf16 v[24:27], v[80:83], v[132:135], v[24:27]
    v_mfma_f32_16x16x32_bf16 v[52:55], v[84:87], v[132:135], v[52:55]
    ds_read_b128 v[96:99], v4 offset:11200
    ds_read_b128 v[100:103], v4 offset:12288
    v_mfma_f32_16x16x32_bf16 v[28:31], v[80:83], v[188:191], v[28:31]
    v_mfma_f32_16x16x32_bf16 v[56:59], v[84:87], v[188:191], v[56:59]
    v_mfma_f32_16x16x32_bf16 v[32:35], v[80:83], v[244:247], v[32:35]
    v_mfma_f32_16x16x32_bf16 v[60:63], v[84:87], v[244:247], v[60:63]
    v_mfma_f32_16x16x32_bf16 v[36:39], v[80:83], a[44:47], v[36:39]
    v_mfma_f32_16x16x32_bf16 v[64:67], v[84:87], a[44:47], v[64:67]
    s_waitcnt lgkmcnt(2)
    v_mfma_f32_16x16x32_bf16 v[24:27], v[88:91], v[136:139], v[24:27]
    v_mfma_f32_16x16x32_bf16 v[52:55], v[92:95], v[136:139], v[52:55]
    ds_read_b128 v[80:83], v4 offset:13440
    ds_read_b128 v[84:87], v4 offset:14528
    v_mfma_f32_16x16x32_bf16 v[28:31], v[88:91], v[192:195], v[28:31]
    v_mfma_f32_16x16x32_bf16 v[56:59], v[92:95], v[192:195], v[56:59]
    v_mfma_f32_16x16x32_bf16 v[32:35], v[88:91], v[248:251], v[32:35]
    v_mfma_f32_16x16x32_bf16 v[60:63], v[92:95], v[248:251], v[60:63]
    v_mfma_f32_16x16x32_bf16 v[36:39], v[88:91], a[48:51], v[36:39]
    v_mfma_f32_16x16x32_bf16 v[64:67], v[92:95], a[48:51], v[64:67]
    s_waitcnt lgkmcnt(2)
    v_mfma_f32_16x16x32_bf16 v[24:27], v[96:99], v[140:143], v[24:27]
    v_mfma_f32_16x16x32_bf16 v[52:55], v[100:103], v[140:143], v[52:55]
    ds_read_b128 v[88:91], v4 offset:15680
    ds_read_b128 v[92:95], v4 offset:16768
    v_mfma_f32_16x16x32_bf16 v[28:31], v[96:99], v[196:199], v[28:31]
    v_mfma_f32_16x16x32_bf16 v[56:59], v[100:103], v[196:199], v[56:59]
    v_mfma_f32_16x16x32_bf16 v[32:35], v[96:99], v[252:255], v[32:35]
    v_mfma_f32_16x16x32_bf16 v[60:63], v[100:103], v[252:255], v[60:63]
    v_mfma_f32_16x16x32_bf16 v[36:39], v[96:99], a[52:55], v[36:39]
    v_mfma_f32_16x16x32_bf16 v[64:67], v[100:103], a[52:55], v[64:67]
    s_waitcnt lgkmcnt(2)
    v_mfma_f32_16x16x32_bf16 v[24:27], v[80:83], v[144:147], v[24:27]
    v_mfma_f32_16x16x32_bf16 v[52:55], v[84:87], v[144:147], v[52:55]
    ds_read_b128 v[96:99], v4 offset:17920
    ds_read_b128 v[100:103], v4 offset:19008
    v_mfma_f32_16x16x32_bf16 v[28:31], v[80:83], v[200:203], v[28:31]
    v_mfma_f32_16x16x32_bf16 v[56:59], v[84:87], v[200:203], v[56:59]
    v_mfma_f32_16x16x32_bf16 v[32:35], v[80:83], a[0:3], v[32:35]
    v_mfma_f32_16x16x32_bf16 v[60:63], v[84:87], a[0:3], v[60:63]
    v_mfma_f32_16x16x32_bf16 v[36:39], v[80:83], a[56:59], v[36:39]
    v_mfma_f32_16x16x32_bf16 v[64:67], v[84:87], a[56:59], v[64:67]
    s_waitcnt lgkmcnt(2)
    v_mfma_f32_16x16x32_bf16 v[24:27], v[88:91], v[148:151], v[24:27]
    v_mfma_f32_16x16x32_bf16 v[52:55], v[92:95], v[148:151], v[52:55]
    ds_read_b128 v[80:83], v4 offset:20160
    ds_read_b128 v[84:87], v4 offset:21248
    v_mfma_f32_16x16x32_bf16 v[28:31], v[88:91], v[204:207], v[28:31]
    v_mfma_f32_16x16x32_bf16 v[56:59], v[92:95], v[204:207], v[56:59]
    v_mfma_f32_16x16x32_bf16 v[32:35], v[88:91], a[4:7], v[32:35]
    v_mfma_f32_16x16x32_bf16 v[60:63], v[92:95], a[4:7], v[60:63]
    v_mfma_f32_16x16x32_bf16 v[36:39], v[88:91], a[60:63], v[36:39]
    v_mfma_f32_16x16x32_bf16 v[64:67], v[92:95], a[60:63], v[64:67]
    s_waitcnt lgkmcnt(2)
    v_mfma_f32_16x16x32_bf16 v[24:27], v[96:99], v[152:155], v[24:27]
    v_mfma_f32_16x16x32_bf16 v[52:55], v[100:103], v[152:155], v[52:55]
    ds_read_b128 v[88:91], v4 offset:22400
    ds_read_b128 v[92:95], v4 offset:23488
    v_mfma_f32_16x16x32_bf16 v[28:31], v[96:99], v[208:211], v[28:31]
    v_mfma_f32_16x16x32_bf16 v[56:59], v[100:103], v[208:211], v[56:59]
    v_mfma_f32_16x16x32_bf16 v[32:35], v[96:99], a[8:11], v[32:35]
    v_mfma_f32_16x16x32_bf16 v[60:63], v[100:103], a[8:11], v[60:63]
    v_mfma_f32_16x16x32_bf16 v[36:39], v[96:99], a[64:67], v[36:39]
    v_mfma_f32_16x16x32_bf16 v[64:67], v[100:103], a[64:67], v[64:67]
    s_waitcnt lgkmcnt(2)
    v_mfma_f32_16x16x32_bf16 v[24:27], v[80:83], v[156:159], v[24:27]
    v_mfma_f32_16x16x32_bf16 v[52:55], v[84:87], v[156:159], v[52:55]
    ds_read_b128 v[96:99], v4 offset:24640
    ds_read_b128 v[100:103], v4 offset:25728
    v_mfma_f32_16x16x32_bf16 v[28:31], v[80:83], v[212:215], v[28:31]
    v_mfma_f32_16x16x32_bf16 v[56:59], v[84:87], v[212:215], v[56:59]
    v_mfma_f32_16x16x32_bf16 v[32:35], v[80:83], a[12:15], v[32:35]
    v_mfma_f32_16x16x32_bf16 v[60:63], v[84:87], a[12:15], v[60:63]
    v_mfma_f32_16x16x32_bf16 v[36:39], v[80:83], a[68:71], v[36:39]
    v_mfma_f32_16x16x32_bf16 v[64:67], v[84:87], a[68:71], v[64:67]
    s_waitcnt lgkmcnt(2)
    v_mfma_f32_16x16x32_bf16 v[24:27], v[88:91], v[160:163], v[24:27]
    v_mfma_f32_16x16x32_bf16 v[52:55], v[92:95], v[160:163], v[52:55]
    ds_read_b128 v[80:83], v4 offset:26880
    ds_read_b128 v[84:87], v4 offset:27968
    v_mfma_f32_16x16x32_bf16 v[28:31], v[88:91], v[216:219], v[28:31]
    v_mfma_f32_16x16x32_bf16 v[56:59], v[92:95], v[216:219], v[56:59]
    v_mfma_f32_16x16x32_bf16 v[32:35], v[88:91], a[16:19], v[32:35]
    v_mfma_f32_16x16x32_bf16 v[60:63], v[92:95], a[16:19], v[60:63]
    v_mfma_f32_16x16x32_bf16 v[36:39], v[88:91], a[72:75], v[36:39]
    v_mfma_f32_16x16x32_bf16 v[64:67], v[92:95], a[72:75], v[64:67]
    s_waitcnt lgkmcnt(2)
    v_mfma_f32_16x16x32_bf16 v[24:27], v[96:99], v[164:167], v[24:27]
    v_mfma_f32_16x16x32_bf16 v[52:55], v[100:103], v[164:167], v[52:55]
    ds_read_b128 v[88:91], v4 offset:29120
    ds_read_b128 v[92:95], v4 offset:30208
    v_mfma_f32_16x16x32_bf16 v[28:31], v[96:99], v[220:223], v[28:31]
    v_mfma_f32_16x16x32_bf16 v[56:59], v[100:103], v[220:223], v[56:59]
    v_mfma_f32_16x16x32_bf16 v[32:35], v[96:99], a[20:23], v[32:35]
    v_mfma_f32_16x16x32_bf16 v[60:63], v[100:103], a[20:23], v[60:63]
    v_mfma_f32_16x16x32_bf16 v[36:39], v[96:99], a[76:79], v[36:39]
    v_mfma_f32_16x16x32_bf16 v[64:67], v[100:103], a[76:79], v[64:67]
    s_waitcnt lgkmcnt(2)
    v_mfma_f32_16x16x32_bf16 v[24:27], v[80:83], v[168:171], v[24:27]
    v_mfma_f32_16x16x32_bf16 v[52:55], v[84:87], v[168:171], v[52:55]
    ds_read_b128 v[96:99], v4 offset:0
    ds_read_b128 v[100:103], v4 offset:1088
    v_mfma_f32_16x16x32_bf16 v[28:31], v[80:83], v[224:227], v[28:31]
    v_mfma_f32_16x16x32_bf16 v[56:59], v[84:87], v[224:227], v[56:59]
    v_mfma_f32_16x16x32_bf16 v[32:35], v[80:83], a[24:27], v[32:35]
    v_mfma_f32_16x16x32_bf16 v[60:63], v[84:87], a[24:27], v[60:63]
    v_mfma_f32_16x16x32_bf16 v[36:39], v[80:83], a[80:83], v[36:39]
    v_mfma_f32_16x16x32_bf16 v[64:67], v[84:87], a[80:83], v[64:67]
    s_waitcnt lgkmcnt(2)
    v_mfma_f32_16x16x32_bf16 v[24:27], v[88:91], v[172:175], v[24:27]
    v_mfma_f32_16x16x32_bf16 v[52:55], v[92:95], v[172:175], v[52:55]
    ds_read_b128 v[80:83], v4 offset:2240
    ds_read_b128 v[84:87], v4 offset:3328
    v_mfma_f32_16x16x32_bf16 v[28:31], v[88:91], v[228:231], v[28:31]
    v_mfma_f32_16x16x32_bf16 v[56:59], v[92:95], v[228:231], v[56:59]
    v_mfma_f32_16x16x32_bf16 v[32:35], v[88:91], a[28:31], v[32:35]
    v_mfma_f32_16x16x32_bf16 v[60:63], v[92:95], a[28:31], v[60:63]
    v_mfma_f32_16x16x32_bf16 v[36:39], v[88:91], a[84:87], v[36:39]
    v_mfma_f32_16x16x32_bf16 v[64:67], v[92:95], a[84:87], v[64:67]
    s_waitcnt lgkmcnt(2)
    v_mfma_f32_16x16x32_bf16 v[40:43], v[96:99], a[88:91], 0
    v_mfma_f32_16x16x32_bf16 v[68:71], v[100:103], a[88:91], 0
    ds_read_b128 v[88:91], v4 offset:4480
    ds_read_b128 v[92:95], v4 offset:5568
    v_mfma_f32_16x16x32_bf16 v[44:47], v[96:99], a[144:147], 0
    v_mfma_f32_16x16x32_bf16 v[72:75], v[100:103], a[144:147], 0
    v_mfma_f32_16x16x32_bf16 v[48:51], v[96:99], a[200:203], 0
    v_mfma_f32_16x16x32_bf16 v[76:79], v[100:103], a[200:203], 0
    s_waitcnt lgkmcnt(2)
    v_mfma_f32_16x16x32_bf16 v[40:43], v[80:83], a[92:95], v[40:43]
    v_cvt_pk_bf16_f32 v108, v24, v25
    v_cvt_pk_bf16_f32 v109, v26, v27
    v_lshlrev_b32 v24, 16, v108
    v_and_b32 v25, 0xffff0000, v108
    v_mfma_f32_16x16x32_bf16 v[68:71], v[84:87], a[92:95], v[68:71]
    ds_read_b128 v[96:99], v4 offset:6720
    ds_read_b128 v[100:103], v4 offset:7808
    v_lshlrev_b32 v26, 16, v109
    v_and_b32 v27, 0xffff0000, v109
    v_pk_mul_f32 v[108:109], v[24:25], v[24:25]
    v_pk_mul_f32 v[110:111], v[26:27], v[26:27]
    v_mfma_f32_16x16x32_bf16 v[44:47], v[80:83], a[148:151], v[44:47]
    v_pk_fma_f32 v[108:109], v[108:109], s[50:51], v[112:113]
    v_pk_fma_f32 v[110:111], v[110:111], s[50:51], v[112:113]
    v_pk_mul_f32 v[108:109], v[108:109], v[24:25]
    v_pk_mul_f32 v[110:111], v[110:111], v[26:27]
    v_mfma_f32_16x16x32_bf16 v[72:75], v[84:87], a[148:151], v[72:75]
    v_exp_f32 v108, v108
    v_exp_f32 v109, v109
    v_exp_f32 v110, v110
    v_exp_f32 v111, v111
    v_mfma_f32_16x16x32_bf16 v[48:51], v[80:83], a[204:207], v[48:51]
    v_pk_add_f32 v[108:109], v[108:109], 1.0 op_sel_hi:[1,0]
    v_pk_add_f32 v[110:111], v[110:111], 1.0 op_sel_hi:[1,0]
    v_rcp_f32 v108, v108
    v_rcp_f32 v109, v109
    v_mfma_f32_16x16x32_bf16 v[76:79], v[84:87], a[204:207], v[76:79]
    v_rcp_f32 v110, v110
    v_rcp_f32 v111, v111
    v_pk_mul_f32 v[24:25], v[24:25], v[108:109]
    v_pk_mul_f32 v[26:27], v[26:27], v[110:111]
    s_waitcnt lgkmcnt(2)
    v_mfma_f32_16x16x32_bf16 v[40:43], v[88:91], a[96:99], v[40:43]
    v_add_f32 v116, v116, v24
    v_fmac_f32 v13, v24, v24
    v_add_f32 v117, v117, v25
    v_fmac_f32 v14, v25, v25
    v_mfma_f32_16x16x32_bf16 v[68:71], v[92:95], a[96:99], v[68:71]
    ds_read_b128 v[80:83], v4 offset:8960
    ds_read_b128 v[84:87], v4 offset:10048
    v_add_f32 v118, v118, v26
    v_fmac_f32 v19, v26, v26
    v_add_f32 v119, v119, v27
    v_fmac_f32 v20, v27, v27
    v_mfma_f32_16x16x32_bf16 v[44:47], v[88:91], a[152:155], v[44:47]
    v_cvt_pk_bf16_f32 v108, v52, v53
    v_cvt_pk_bf16_f32 v109, v54, v55
    v_lshlrev_b32 v52, 16, v108
    v_and_b32 v53, 0xffff0000, v108
    v_mfma_f32_16x16x32_bf16 v[72:75], v[92:95], a[152:155], v[72:75]
    v_lshlrev_b32 v54, 16, v109
    v_and_b32 v55, 0xffff0000, v109
    v_pk_mul_f32 v[108:109], v[52:53], v[52:53]
    v_pk_mul_f32 v[110:111], v[54:55], v[54:55]
    v_mfma_f32_16x16x32_bf16 v[48:51], v[88:91], a[208:211], v[48:51]
    v_pk_fma_f32 v[108:109], v[108:109], s[50:51], v[112:113]
    v_pk_fma_f32 v[110:111], v[110:111], s[50:51], v[112:113]
    v_pk_mul_f32 v[108:109], v[108:109], v[52:53]
    v_pk_mul_f32 v[110:111], v[110:111], v[54:55]
    v_mfma_f32_16x16x32_bf16 v[76:79], v[92:95], a[208:211], v[76:79]
    v_exp_f32 v108, v108
    v_exp_f32 v109, v109
    v_exp_f32 v110, v110
    v_exp_f32 v111, v111
    s_waitcnt lgkmcnt(2)
    v_mfma_f32_16x16x32_bf16 v[40:43], v[96:99], a[100:103], v[40:43]
    v_pk_add_f32 v[108:109], v[108:109], 1.0 op_sel_hi:[1,0]
    v_pk_add_f32 v[110:111], v[110:111], 1.0 op_sel_hi:[1,0]
    v_rcp_f32 v108, v108
    v_rcp_f32 v109, v109
    v_mfma_f32_16x16x32_bf16 v[68:71], v[100:103], a[100:103], v[68:71]
    ds_read_b128 v[88:91], v4 offset:11200
    ds_read_b128 v[92:95], v4 offset:12288
    v_rcp_f32 v110, v110
    v_rcp_f32 v111, v111
    v_pk_mul_f32 v[52:53], v[52:53], v[108:109]
    v_pk_mul_f32 v[54:55], v[54:55], v[110:111]
    v_mfma_f32_16x16x32_bf16 v[44:47], v[96:99], a[156:159], v[44:47]
    v_add_f32 v8, v8, v52
    v_fmac_f32 v21, v52, v52
    v_add_f32 v9, v9, v53
    v_fmac_f32 v22, v53, v53
    v_mfma_f32_16x16x32_bf16 v[72:75], v[100:103], a[156:159], v[72:75]
    v_add_f32 v10, v10, v54
    v_fmac_f32 v23, v54, v54
    v_add_f32 v12, v12, v55
    v_fmac_f32 v104, v55, v55
    v_mfma_f32_16x16x32_bf16 v[48:51], v[96:99], a[212:215], v[48:51]
    v_cvt_pk_bf16_f32 v24, v24, v25
    v_cvt_pk_bf16_f32 v25, v26, v27
    v_cvt_pk_bf16_f32 v26, v52, v53
    v_cvt_pk_bf16_f32 v27, v54, v55
    v_mfma_f32_16x16x32_bf16 v[76:79], v[100:103], a[212:215], v[76:79]
    global_store_dwordx4 v7, v[24:27], s[26:27] offset:0 sc1
    v_cvt_pk_bf16_f32 v108, v28, v29
    v_cvt_pk_bf16_f32 v109, v30, v31
    v_lshlrev_b32 v28, 16, v108
    s_waitcnt lgkmcnt(2)
    v_mfma_f32_16x16x32_bf16 v[40:43], v[80:83], a[104:107], v[40:43]
    v_and_b32 v29, 0xffff0000, v108
    v_lshlrev_b32 v30, 16, v109
    v_and_b32 v31, 0xffff0000, v109
    v_pk_mul_f32 v[108:109], v[28:29], v[28:29]
    v_mfma_f32_16x16x32_bf16 v[68:71], v[84:87], a[104:107], v[68:71]
    ds_read_b128 v[96:99], v4 offset:13440
    ds_read_b128 v[100:103], v4 offset:14528
    v_pk_mul_f32 v[110:111], v[30:31], v[30:31]
    v_pk_fma_f32 v[108:109], v[108:109], s[50:51], v[112:113]
    v_pk_fma_f32 v[110:111], v[110:111], s[50:51], v[112:113]
    v_pk_mul_f32 v[108:109], v[108:109], v[28:29]
    v_mfma_f32_16x16x32_bf16 v[44:47], v[80:83], a[160:163], v[44:47]
    v_pk_mul_f32 v[110:111], v[110:111], v[30:31]
    v_exp_f32 v108, v108
    v_exp_f32 v109, v109
    v_exp_f32 v110, v110
    v_mfma_f32_16x16x32_bf16 v[72:75], v[84:87], a[160:163], v[72:75]
    v_exp_f32 v111, v111
    v_pk_add_f32 v[108:109], v[108:109], 1.0 op_sel_hi:[1,0]
    v_pk_add_f32 v[110:111], v[110:111], 1.0 op_sel_hi:[1,0]
    v_rcp_f32 v108, v108
    v_mfma_f32_16x16x32_bf16 v[48:51], v[80:83], a[216:219], v[48:51]
    v_rcp_f32 v109, v109
    v_rcp_f32 v110, v110
    v_rcp_f32 v111, v111
    v_pk_mul_f32 v[28:29], v[28:29], v[108:109]
    v_mfma_f32_16x16x32_bf16 v[76:79], v[84:87], a[216:219], v[76:79]
    v_pk_mul_f32 v[30:31], v[30:31], v[110:111]
    v_add_f32 v116, v116, v28
    v_fmac_f32 v13, v28, v28
    v_add_f32 v117, v117, v29
    s_waitcnt lgkmcnt(2)
    v_mfma_f32_16x16x32_bf16 v[40:43], v[88:91], a[108:111], v[40:43]
    v_fmac_f32 v14, v29, v29
    v_add_f32 v118, v118, v30
    v_fmac_f32 v19, v30, v30
    v_add_f32 v119, v119, v31
    v_mfma_f32_16x16x32_bf16 v[68:71], v[92:95], a[108:111], v[68:71]
    ds_read_b128 v[80:83], v4 offset:15680
    ds_read_b128 v[84:87], v4 offset:16768
    v_fmac_f32 v20, v31, v31
    v_cvt_pk_bf16_f32 v108, v56, v57
    v_cvt_pk_bf16_f32 v109, v58, v59
    v_lshlrev_b32 v56, 16, v108
    v_mfma_f32_16x16x32_bf16 v[44:47], v[88:91], a[164:167], v[44:47]
    v_and_b32 v57, 0xffff0000, v108
    v_lshlrev_b32 v58, 16, v109
    v_and_b32 v59, 0xffff0000, v109
    v_pk_mul_f32 v[108:109], v[56:57], v[56:57]
    v_mfma_f32_16x16x32_bf16 v[72:75], v[92:95], a[164:167], v[72:75]
    v_pk_mul_f32 v[110:111], v[58:59], v[58:59]
    v_pk_fma_f32 v[108:109], v[108:109], s[50:51], v[112:113]
    v_pk_fma_f32 v[110:111], v[110:111], s[50:51], v[112:113]
    v_pk_mul_f32 v[108:109], v[108:109], v[56:57]
    v_mfma_f32_16x16x32_bf16 v[48:51], v[88:91], a[220:223], v[48:51]
    v_pk_mul_f32 v[110:111], v[110:111], v[58:59]
    v_exp_f32 v108, v108
    v_exp_f32 v109, v109
    v_exp_f32 v110, v110
    v_mfma_f32_16x16x32_bf16 v[76:79], v[92:95], a[220:223], v[76:79]
    v_exp_f32 v111, v111
    v_pk_add_f32 v[108:109], v[108:109], 1.0 op_sel_hi:[1,0]
    v_pk_add_f32 v[110:111], v[110:111], 1.0 op_sel_hi:[1,0]
    v_rcp_f32 v108, v108
    s_waitcnt lgkmcnt(2)
    v_mfma_f32_16x16x32_bf16 v[40:43], v[96:99], a[112:115], v[40:43]
    v_rcp_f32 v109, v109
    v_rcp_f32 v110, v110
    v_rcp_f32 v111, v111
    v_pk_mul_f32 v[56:57], v[56:57], v[108:109]
    v_mfma_f32_16x16x32_bf16 v[68:71], v[100:103], a[112:115], v[68:71]
    ds_read_b128 v[88:91], v4 offset:17920
    ds_read_b128 v[92:95], v4 offset:19008
    v_pk_mul_f32 v[58:59], v[58:59], v[110:111]
    v_add_f32 v8, v8, v56
    v_fmac_f32 v21, v56, v56
    v_add_f32 v9, v9, v57
    v_mfma_f32_16x16x32_bf16 v[44:47], v[96:99], a[168:171], v[44:47]
    v_fmac_f32 v22, v57, v57
    v_add_f32 v10, v10, v58
    v_fmac_f32 v23, v58, v58
    v_add_f32 v12, v12, v59
    v_mfma_f32_16x16x32_bf16 v[72:75], v[100:103], a[168:171], v[72:75]
    v_fmac_f32 v104, v59, v59
    v_cvt_pk_bf16_f32 v28, v28, v29
    v_cvt_pk_bf16_f32 v29, v30, v31
    v_cvt_pk_bf16_f32 v30, v56, v57
    v_mfma_f32_16x16x32_bf16 v[48:51], v[96:99], a[224:227], v[48:51]
    v_cvt_pk_bf16_f32 v31, v58, v59
    global_store_dwordx4 v7, v[28:31], s[26:27] offset:1024 sc1
    v_cvt_pk_bf16_f32 v108, v32, v33
    v_cvt_pk_bf16_f32 v109, v34, v35
    v_mfma_f32_16x16x32_bf16 v[76:79], v[100:103], a[224:227], v[76:79]
    v_lshlrev_b32 v32, 16, v108
    v_and_b32 v33, 0xffff0000, v108
    v_lshlrev_b32 v34, 16, v109
    v_and_b32 v35, 0xffff0000, v109
    s_waitcnt lgkmcnt(2)
    v_mfma_f32_16x16x32_bf16 v[40:43], v[80:83], a[116:119], v[40:43]
    v_pk_mul_f32 v[108:109], v[32:33], v[32:33]
    v_pk_mul_f32 v[110:111], v[34:35], v[34:35]
    v_pk_fma_f32 v[108:109], v[108:109], s[50:51], v[112:113]
    v_pk_fma_f32 v[110:111], v[110:111], s[50:51], v[112:113]
    v_mfma_f32_16x16x32_bf16 v[68:71], v[84:87], a[116:119], v[68:71]
    ds_read_b128 v[96:99], v4 offset:20160
    ds_read_b128 v[100:103], v4 offset:21248
    v_pk_mul_f32 v[108:109], v[108:109], v[32:33]
    v_pk_mul_f32 v[110:111], v[110:111], v[34:35]
    v_exp_f32 v108, v108
    v_exp_f32 v109, v109
    v_mfma_f32_16x16x32_bf16 v[44:47], v[80:83], a[172:175], v[44:47]
    v_exp_f32 v110, v110
    v_exp_f32 v111, v111
    v_pk_add_f32 v[108:109], v[108:109], 1.0 op_sel_hi:[1,0]
    v_pk_add_f32 v[110:111], v[110:111], 1.0 op_sel_hi:[1,0]
    v_mfma_f32_16x16x32_bf16 v[72:75], v[84:87], a[172:175], v[72:75]
    v_rcp_f32 v108, v108
    v_rcp_f32 v109, v109
    v_rcp_f32 v110, v110
    v_rcp_f32 v111, v111
    v_mfma_f32_16x16x32_bf16 v[48:51], v[80:83], a[228:231], v[48:51]
    v_pk_mul_f32 v[32:33], v[32:33], v[108:109]
    v_pk_mul_f32 v[34:35], v[34:35], v[110:111]
    v_add_f32 v116, v116, v32
    v_fmac_f32 v13, v32, v32
    v_mfma_f32_16x16x32_bf16 v[76:79], v[84:87], a[228:231], v[76:79]
    v_add_f32 v117, v117, v33
    v_fmac_f32 v14, v33, v33
    v_add_f32 v118, v118, v34
    v_fmac_f32 v19, v34, v34
    s_waitcnt lgkmcnt(2)
    v_mfma_f32_16x16x32_bf16 v[40:43], v[88:91], a[120:123], v[40:43]
    v_add_f32 v119, v119, v35
    v_fmac_f32 v20, v35, v35
    v_cvt_pk_bf16_f32 v108, v60, v61
    v_cvt_pk_bf16_f32 v109, v62, v63
    v_mfma_f32_16x16x32_bf16 v[68:71], v[92:95], a[120:123], v[68:71]
    ds_read_b128 v[80:83], v4 offset:22400
    ds_read_b128 v[84:87], v4 offset:23488
    v_lshlrev_b32 v60, 16, v108
    v_and_b32 v61, 0xffff0000, v108
    v_lshlrev_b32 v62, 16, v109
    v_and_b32 v63, 0xffff0000, v109
    v_mfma_f32_16x16x32_bf16 v[44:47], v[88:91], a[176:179], v[44:47]
    v_pk_mul_f32 v[108:109], v[60:61], v[60:61]
    v_pk_mul_f32 v[110:111], v[62:63], v[62:63]
    v_pk_fma_f32 v[108:109], v[108:109], s[50:51], v[112:113]
    v_pk_fma_f32 v[110:111], v[110:111], s[50:51], v[112:113]
    v_mfma_f32_16x16x32_bf16 v[72:75], v[92:95], a[176:179], v[72:75]
    v_pk_mul_f32 v[108:109], v[108:109], v[60:61]
    v_pk_mul_f32 v[110:111], v[110:111], v[62:63]
    v_exp_f32 v108, v108
    v_exp_f32 v109, v109
    v_mfma_f32_16x16x32_bf16 v[48:51], v[88:91], a[232:235], v[48:51]
    v_exp_f32 v110, v110
    v_exp_f32 v111, v111
    v_pk_add_f32 v[108:109], v[108:109], 1.0 op_sel_hi:[1,0]
    v_pk_add_f32 v[110:111], v[110:111], 1.0 op_sel_hi:[1,0]
    v_mfma_f32_16x16x32_bf16 v[76:79], v[92:95], a[232:235], v[76:79]
    v_rcp_f32 v108, v108
    v_rcp_f32 v109, v109
    v_rcp_f32 v110, v110
    v_rcp_f32 v111, v111
    s_waitcnt lgkmcnt(2)
    v_mfma_f32_16x16x32_bf16 v[40:43], v[96:99], a[124:127], v[40:43]
    v_pk_mul_f32 v[60:61], v[60:61], v[108:109]
    v_pk_mul_f32 v[62:63], v[62:63], v[110:111]
    v_add_f32 v8, v8, v60
    v_fmac_f32 v21, v60, v60
    v_mfma_f32_16x16x32_bf16 v[68:71], v[100:103], a[124:127], v[68:71]
    ds_read_b128 v[88:91], v4 offset:24640
    ds_read_b128 v[92:95], v4 offset:25728
    v_add_f32 v9, v9, v61
    v_fmac_f32 v22, v61, v61
    v_add_f32 v10, v10, v62
    v_fmac_f32 v23, v62, v62
    v_mfma_f32_16x16x32_bf16 v[44:47], v[96:99], a[180:183], v[44:47]
    v_add_f32 v12, v12, v63
    v_fmac_f32 v104, v63, v63
    v_cvt_pk_bf16_f32 v32, v32, v33
    v_cvt_pk_bf16_f32 v33, v34, v35
    v_mfma_f32_16x16x32_bf16 v[72:75], v[100:103], a[180:183], v[72:75]
    v_cvt_pk_bf16_f32 v34, v60, v61
    v_cvt_pk_bf16_f32 v35, v62, v63
    global_store_dwordx4 v7, v[32:35], s[26:27] offset:2048 sc1
    v_cvt_pk_bf16_f32 v108, v36, v37
    v_mfma_f32_16x16x32_bf16 v[48:51], v[96:99], a[236:239], v[48:51]
    v_cvt_pk_bf16_f32 v109, v38, v39
    v_lshlrev_b32 v36, 16, v108
    v_and_b32 v37, 0xffff0000, v108
    v_lshlrev_b32 v38, 16, v109
    v_mfma_f32_16x16x32_bf16 v[76:79], v[100:103], a[236:239], v[76:79]
    v_and_b32 v39, 0xffff0000, v109
    v_pk_mul_f32 v[108:109], v[36:37], v[36:37]
    v_pk_mul_f32 v[110:111], v[38:39], v[38:39]
    v_pk_fma_f32 v[108:109], v[108:109], s[50:51], v[112:113]
    s_waitcnt lgkmcnt(2)
    v_mfma_f32_16x16x32_bf16 v[40:43], v[80:83], a[128:131], v[40:43]
    v_pk_fma_f32 v[110:111], v[110:111], s[50:51], v[112:113]
    v_pk_mul_f32 v[108:109], v[108:109], v[36:37]
    v_pk_mul_f32 v[110:111], v[110:111], v[38:39]
    v_exp_f32 v108, v108
    v_mfma_f32_16x16x32_bf16 v[68:71], v[84:87], a[128:131], v[68:71]
    ds_read_b128 v[96:99], v4 offset:26880
    ds_read_b128 v[100:103], v4 offset:27968
    v_exp_f32 v109, v109
    v_exp_f32 v110, v110
    v_exp_f32 v111, v111
    v_pk_add_f32 v[108:109], v[108:109], 1.0 op_sel_hi:[1,0]
    v_mfma_f32_16x16x32_bf16 v[44:47], v[80:83], a[184:187], v[44:47]
    v_pk_add_f32 v[110:111], v[110:111], 1.0 op_sel_hi:[1,0]
    v_rcp_f32 v108, v108
    v_rcp_f32 v109, v109
    v_rcp_f32 v110, v110
    v_mfma_f32_16x16x32_bf16 v[72:75], v[84:87], a[184:187], v[72:75]
    v_rcp_f32 v111, v111
    v_pk_mul_f32 v[36:37], v[36:37], v[108:109]
    v_pk_mul_f32 v[38:39], v[38:39], v[110:111]
    v_add_f32 v116, v116, v36
    v_mfma_f32_16x16x32_bf16 v[48:51], v[80:83], a[240:243], v[48:51]
    v_fmac_f32 v13, v36, v36
    v_add_f32 v117, v117, v37
    v_fmac_f32 v14, v37, v37
    v_add_f32 v118, v118, v38
    v_mfma_f32_16x16x32_bf16 v[76:79], v[84:87], a[240:243], v[76:79]
    v_fmac_f32 v19, v38, v38
    v_add_f32 v119, v119, v39
    v_fmac_f32 v20, v39, v39
    v_cvt_pk_bf16_f32 v108, v64, v65
    s_waitcnt lgkmcnt(2)
    v_mfma_f32_16x16x32_bf16 v[40:43], v[88:91], a[132:135], v[40:43]
    v_cvt_pk_bf16_f32 v109, v66, v67
    v_lshlrev_b32 v64, 16, v108
    v_and_b32 v65, 0xffff0000, v108
    v_lshlrev_b32 v66, 16, v109
    v_mfma_f32_16x16x32_bf16 v[68:71], v[92:95], a[132:135], v[68:71]
    ds_read_b128 v[80:83], v4 offset:29120
    ds_read_b128 v[84:87], v4 offset:30208
    v_and_b32 v67, 0xffff0000, v109
    v_pk_mul_f32 v[108:109], v[64:65], v[64:65]
    v_pk_mul_f32 v[110:111], v[66:67], v[66:67]
    v_pk_fma_f32 v[108:109], v[108:109], s[50:51], v[112:113]
    v_mfma_f32_16x16x32_bf16 v[44:47], v[88:91], a[188:191], v[44:47]
    v_pk_fma_f32 v[110:111], v[110:111], s[50:51], v[112:113]
    v_pk_mul_f32 v[108:109], v[108:109], v[64:65]
    v_pk_mul_f32 v[110:111], v[110:111], v[66:67]
    v_exp_f32 v108, v108
    v_mfma_f32_16x16x32_bf16 v[72:75], v[92:95], a[188:191], v[72:75]
    v_exp_f32 v109, v109
    v_exp_f32 v110, v110
    v_exp_f32 v111, v111
    v_pk_add_f32 v[108:109], v[108:109], 1.0 op_sel_hi:[1,0]
    v_mfma_f32_16x16x32_bf16 v[48:51], v[88:91], a[244:247], v[48:51]
    v_pk_add_f32 v[110:111], v[110:111], 1.0 op_sel_hi:[1,0]
    v_rcp_f32 v108, v108
    v_rcp_f32 v109, v109
    v_rcp_f32 v110, v110
    v_mfma_f32_16x16x32_bf16 v[76:79], v[92:95], a[244:247], v[76:79]
    v_rcp_f32 v111, v111
    v_pk_mul_f32 v[64:65], v[64:65], v[108:109]
    v_pk_mul_f32 v[66:67], v[66:67], v[110:111]
    v_add_f32 v8, v8, v64
    s_waitcnt lgkmcnt(2)
    v_mfma_f32_16x16x32_bf16 v[40:43], v[96:99], a[136:139], v[40:43]
    v_fmac_f32 v21, v64, v64
    v_add_f32 v9, v9, v65
    v_fmac_f32 v22, v65, v65
    v_add_f32 v10, v10, v66
    v_mfma_f32_16x16x32_bf16 v[68:71], v[100:103], a[136:139], v[68:71]
    v_fmac_f32 v23, v66, v66
    v_add_f32 v12, v12, v67
    v_fmac_f32 v104, v67, v67
    v_cvt_pk_bf16_f32 v36, v36, v37
    v_mfma_f32_16x16x32_bf16 v[44:47], v[96:99], a[192:195], v[44:47]
    v_cvt_pk_bf16_f32 v37, v38, v39
    v_cvt_pk_bf16_f32 v38, v64, v65
    v_cvt_pk_bf16_f32 v39, v66, v67
    global_store_dwordx4 v7, v[36:39], s[26:27] offset:3072 sc1
    v_mfma_f32_16x16x32_bf16 v[72:75], v[100:103], a[192:195], v[72:75]
    v_mfma_f32_16x16x32_bf16 v[48:51], v[96:99], a[248:251], v[48:51]
    v_mfma_f32_16x16x32_bf16 v[76:79], v[100:103], a[248:251], v[76:79]
    s_waitcnt lgkmcnt(0)
    v_mfma_f32_16x16x32_bf16 v[40:43], v[80:83], a[140:143], v[40:43]
    v_mfma_f32_16x16x32_bf16 v[68:71], v[84:87], a[140:143], v[68:71]
    v_mfma_f32_16x16x32_bf16 v[44:47], v[80:83], a[196:199], v[44:47]
    v_mfma_f32_16x16x32_bf16 v[72:75], v[84:87], a[196:199], v[72:75]
    v_mfma_f32_16x16x32_bf16 v[48:51], v[80:83], a[252:255], v[48:51]
    v_mfma_f32_16x16x32_bf16 v[76:79], v[84:87], a[252:255], v[76:79]
    s_nop 2
    v_cvt_pk_bf16_f32 v108, v40, v41
    v_cvt_pk_bf16_f32 v109, v42, v43
    v_lshlrev_b32 v40, 16, v108
    v_and_b32 v41, 0xffff0000, v108
    v_lshlrev_b32 v42, 16, v109
    v_and_b32 v43, 0xffff0000, v109
    v_pk_mul_f32 v[108:109], v[40:41], v[40:41]
    v_pk_mul_f32 v[110:111], v[42:43], v[42:43]
    v_pk_fma_f32 v[108:109], v[108:109], s[50:51], v[112:113]
    v_pk_fma_f32 v[110:111], v[110:111], s[50:51], v[112:113]
    v_pk_mul_f32 v[108:109], v[108:109], v[40:41]
    v_pk_mul_f32 v[110:111], v[110:111], v[42:43]
    v_exp_f32 v108, v108
    v_exp_f32 v109, v109
    v_exp_f32 v110, v110
    v_exp_f32 v111, v111
    v_pk_add_f32 v[108:109], v[108:109], 1.0 op_sel_hi:[1,0]
    v_pk_add_f32 v[110:111], v[110:111], 1.0 op_sel_hi:[1,0]
    v_rcp_f32 v108, v108
    v_rcp_f32 v109, v109
    v_rcp_f32 v110, v110
    v_rcp_f32 v111, v111
    v_pk_mul_f32 v[40:41], v[40:41], v[108:109]
    v_pk_mul_f32 v[42:43], v[42:43], v[110:111]
    v_add_f32 v116, v116, v40
    v_fmac_f32 v13, v40, v40
    v_add_f32 v117, v117, v41
    v_fmac_f32 v14, v41, v41
    v_add_f32 v118, v118, v42
    v_fmac_f32 v19, v42, v42
    v_add_f32 v119, v119, v43
    v_fmac_f32 v20, v43, v43
    v_cvt_pk_bf16_f32 v108, v68, v69
    v_cvt_pk_bf16_f32 v109, v70, v71
    v_lshlrev_b32 v68, 16, v108
    v_and_b32 v69, 0xffff0000, v108
    v_lshlrev_b32 v70, 16, v109
    v_and_b32 v71, 0xffff0000, v109
    v_pk_mul_f32 v[108:109], v[68:69], v[68:69]
    v_pk_mul_f32 v[110:111], v[70:71], v[70:71]
    v_pk_fma_f32 v[108:109], v[108:109], s[50:51], v[112:113]
    v_pk_fma_f32 v[110:111], v[110:111], s[50:51], v[112:113]
    v_pk_mul_f32 v[108:109], v[108:109], v[68:69]
    v_pk_mul_f32 v[110:111], v[110:111], v[70:71]
    v_exp_f32 v108, v108
    v_exp_f32 v109, v109
    v_exp_f32 v110, v110
    v_exp_f32 v111, v111
    v_pk_add_f32 v[108:109], v[108:109], 1.0 op_sel_hi:[1,0]
    v_pk_add_f32 v[110:111], v[110:111], 1.0 op_sel_hi:[1,0]
    v_rcp_f32 v108, v108
    v_rcp_f32 v109, v109
    v_rcp_f32 v110, v110
    v_rcp_f32 v111, v111
    v_pk_mul_f32 v[68:69], v[68:69], v[108:109]
    v_pk_mul_f32 v[70:71], v[70:71], v[110:111]
    v_add_f32 v8, v8, v68
    v_fmac_f32 v21, v68, v68
    v_add_f32 v9, v9, v69
    v_fmac_f32 v22, v69, v69
    v_add_f32 v10, v10, v70
    v_fmac_f32 v23, v70, v70
    v_add_f32 v12, v12, v71
    v_fmac_f32 v104, v71, v71
    v_cvt_pk_bf16_f32 v40, v40, v41
    v_cvt_pk_bf16_f32 v41, v42, v43
    v_cvt_pk_bf16_f32 v42, v68, v69
    v_cvt_pk_bf16_f32 v43, v70, v71
    global_store_dwordx4 v15, v[40:43], s[26:27] offset:0 sc1
    v_cvt_pk_bf16_f32 v108, v44, v45
    v_cvt_pk_bf16_f32 v109, v46, v47
    v_lshlrev_b32 v44, 16, v108
    v_and_b32 v45, 0xffff0000, v108
    v_lshlrev_b32 v46, 16, v109
    v_and_b32 v47, 0xffff0000, v109
    v_pk_mul_f32 v[108:109], v[44:45], v[44:45]
    v_pk_mul_f32 v[110:111], v[46:47], v[46:47]
    v_pk_fma_f32 v[108:109], v[108:109], s[50:51], v[112:113]
    v_pk_fma_f32 v[110:111], v[110:111], s[50:51], v[112:113]
    v_pk_mul_f32 v[108:109], v[108:109], v[44:45]
    v_pk_mul_f32 v[110:111], v[110:111], v[46:47]
    v_exp_f32 v108, v108
    v_exp_f32 v109, v109
    v_exp_f32 v110, v110
    v_exp_f32 v111, v111
    v_pk_add_f32 v[108:109], v[108:109], 1.0 op_sel_hi:[1,0]
    v_pk_add_f32 v[110:111], v[110:111], 1.0 op_sel_hi:[1,0]
    v_rcp_f32 v108, v108
    v_rcp_f32 v109, v109
    v_rcp_f32 v110, v110
    v_rcp_f32 v111, v111
    v_pk_mul_f32 v[44:45], v[44:45], v[108:109]
    v_pk_mul_f32 v[46:47], v[46:47], v[110:111]
    v_add_f32 v116, v116, v44
    v_fmac_f32 v13, v44, v44
    v_add_f32 v117, v117, v45
    v_fmac_f32 v14, v45, v45
    v_add_f32 v118, v118, v46
    v_fmac_f32 v19, v46, v46
    v_add_f32 v119, v119, v47
    v_fmac_f32 v20, v47, v47
    v_cvt_pk_bf16_f32 v108, v72, v73
    v_cvt_pk_bf16_f32 v109, v74, v75
    v_lshlrev_b32 v72, 16, v108
    v_and_b32 v73, 0xffff0000, v108
    v_lshlrev_b32 v74, 16, v109
    v_and_b32 v75, 0xffff0000, v109
    v_pk_mul_f32 v[108:109], v[72:73], v[72:73]
    v_pk_mul_f32 v[110:111], v[74:75], v[74:75]
    v_pk_fma_f32 v[108:109], v[108:109], s[50:51], v[112:113]
    v_pk_fma_f32 v[110:111], v[110:111], s[50:51], v[112:113]
    v_pk_mul_f32 v[108:109], v[108:109], v[72:73]
    v_pk_mul_f32 v[110:111], v[110:111], v[74:75]
    v_exp_f32 v108, v108
    v_exp_f32 v109, v109
    v_exp_f32 v110, v110
    v_exp_f32 v111, v111
    v_pk_add_f32 v[108:109], v[108:109], 1.0 op_sel_hi:[1,0]
    v_pk_add_f32 v[110:111], v[110:111], 1.0 op_sel_hi:[1,0]
    v_rcp_f32 v108, v108
    v_rcp_f32 v109, v109
    v_rcp_f32 v110, v110
    v_rcp_f32 v111, v111
    v_pk_mul_f32 v[72:73], v[72:73], v[108:109]
    v_pk_mul_f32 v[74:75], v[74:75], v[110:111]
    v_add_f32 v8, v8, v72
    v_fmac_f32 v21, v72, v72
    v_add_f32 v9, v9, v73
    v_fmac_f32 v22, v73, v73
    v_add_f32 v10, v10, v74
    v_fmac_f32 v23, v74, v74
    v_add_f32 v12, v12, v75
    v_fmac_f32 v104, v75, v75
    v_cvt_pk_bf16_f32 v44, v44, v45
    v_cvt_pk_bf16_f32 v45, v46, v47
    v_cvt_pk_bf16_f32 v46, v72, v73
    v_cvt_pk_bf16_f32 v47, v74, v75
    global_store_dwordx4 v15, v[44:47], s[26:27] offset:1024 sc1
    v_cvt_pk_bf16_f32 v108, v48, v49
    v_cvt_pk_bf16_f32 v109, v50, v51
    v_lshlrev_b32 v48, 16, v108
    v_and_b32 v49, 0xffff0000, v108
    v_lshlrev_b32 v50, 16, v109
    v_and_b32 v51, 0xffff0000, v109
    v_pk_mul_f32 v[108:109], v[48:49], v[48:49]
    v_pk_mul_f32 v[110:111], v[50:51], v[50:51]
    v_pk_fma_f32 v[108:109], v[108:109], s[50:51], v[112:113]
    v_pk_fma_f32 v[110:111], v[110:111], s[50:51], v[112:113]
    v_pk_mul_f32 v[108:109], v[108:109], v[48:49]
    v_pk_mul_f32 v[110:111], v[110:111], v[50:51]
    v_exp_f32 v108, v108
    v_exp_f32 v109, v109
    v_exp_f32 v110, v110
    v_exp_f32 v111, v111
    v_pk_add_f32 v[108:109], v[108:109], 1.0 op_sel_hi:[1,0]
    v_pk_add_f32 v[110:111], v[110:111], 1.0 op_sel_hi:[1,0]
    v_rcp_f32 v108, v108
    v_rcp_f32 v109, v109
    v_rcp_f32 v110, v110
    v_rcp_f32 v111, v111
    v_pk_mul_f32 v[48:49], v[48:49], v[108:109]
    v_pk_mul_f32 v[50:51], v[50:51], v[110:111]
    v_add_f32 v116, v116, v48
    v_fmac_f32 v13, v48, v48
    v_add_f32 v117, v117, v49
    v_fmac_f32 v14, v49, v49
    v_add_f32 v118, v118, v50
    v_fmac_f32 v19, v50, v50
    v_add_f32 v119, v119, v51
    v_fmac_f32 v20, v51, v51
    v_cvt_pk_bf16_f32 v108, v76, v77
    v_cvt_pk_bf16_f32 v109, v78, v79
    v_lshlrev_b32 v76, 16, v108
    v_and_b32 v77, 0xffff0000, v108
    v_lshlrev_b32 v78, 16, v109
    v_and_b32 v79, 0xffff0000, v109
    v_pk_mul_f32 v[108:109], v[76:77], v[76:77]
    v_pk_mul_f32 v[110:111], v[78:79], v[78:79]
    v_pk_fma_f32 v[108:109], v[108:109], s[50:51], v[112:113]
    v_pk_fma_f32 v[110:111], v[110:111], s[50:51], v[112:113]
    v_pk_mul_f32 v[108:109], v[108:109], v[76:77]
    v_pk_mul_f32 v[110:111], v[110:111], v[78:79]
    v_exp_f32 v108, v108
    v_exp_f32 v109, v109
    v_exp_f32 v110, v110
    v_exp_f32 v111, v111
    v_pk_add_f32 v[108:109], v[108:109], 1.0 op_sel_hi:[1,0]
    v_pk_add_f32 v[110:111], v[110:111], 1.0 op_sel_hi:[1,0]
    v_rcp_f32 v108, v108
    v_rcp_f32 v109, v109
    v_rcp_f32 v110, v110
    v_rcp_f32 v111, v111
    v_pk_mul_f32 v[76:77], v[76:77], v[108:109]
    v_pk_mul_f32 v[78:79], v[78:79], v[110:111]
    v_add_f32 v8, v8, v76
    v_fmac_f32 v21, v76, v76
    v_add_f32 v9, v9, v77
    v_fmac_f32 v22, v77, v77
    v_add_f32 v10, v10, v78
    v_fmac_f32 v23, v78, v78
    v_add_f32 v12, v12, v79
    v_fmac_f32 v104, v79, v79
    v_cvt_pk_bf16_f32 v48, v48, v49
    v_cvt_pk_bf16_f32 v49, v50, v51
    v_cvt_pk_bf16_f32 v50, v76, v77
    v_cvt_pk_bf16_f32 v51, v78, v79
    global_store_dwordx4 v15, v[48:51], s[26:27] offset:2048 sc1
    v_add_f32_dpp v116, v116, v116 quad_perm:[1,0,3,2] row_mask:0xf bank_mask:0xf
    v_add_f32_dpp v117, v117, v117 quad_perm:[1,0,3,2] row_mask:0xf bank_mask:0xf
    v_add_f32_dpp v118, v118, v118 quad_perm:[1,0,3,2] row_mask:0xf bank_mask:0xf
    v_add_f32_dpp v119, v119, v119 quad_perm:[1,0,3,2] row_mask:0xf bank_mask:0xf
    v_add_f32_dpp v8, v8, v8 quad_perm:[1,0,3,2] row_mask:0xf bank_mask:0xf
    v_add_f32_dpp v9, v9, v9 quad_perm:[1,0,3,2] row_mask:0xf bank_mask:0xf
    v_add_f32_dpp v10, v10, v10 quad_perm:[1,0,3,2] row_mask:0xf bank_mask:0xf
    v_add_f32_dpp v12, v12, v12 quad_perm:[1,0,3,2] row_mask:0xf bank_mask:0xf
    v_add_f32_dpp v13, v13, v13 quad_perm:[1,0,3,2] row_mask:0xf bank_mask:0xf
    v_add_f32_dpp v14, v14, v14 quad_perm:[1,0,3,2] row_mask:0xf bank_mask:0xf
    v_add_f32_dpp v19, v19, v19 quad_perm:[1,0,3,2] row_mask:0xf bank_mask:0xf
    v_add_f32_dpp v20, v20, v20 quad_perm:[1,0,3,2] row_mask:0xf bank_mask:0xf
    v_add_f32_dpp v21, v21, v21 quad_perm:[1,0,3,2] row_mask:0xf bank_mask:0xf
    v_add_f32_dpp v22, v22, v22 quad_perm:[1,0,3,2] row_mask:0xf bank_mask:0xf
    v_add_f32_dpp v23, v23, v23 quad_perm:[1,0,3,2] row_mask:0xf bank_mask:0xf
    v_add_f32_dpp v104, v104, v104 quad_perm:[1,0,3,2] row_mask:0xf bank_mask:0xf
    v_add_f32_dpp v116, v116, v116 quad_perm:[2,3,0,1] row_mask:0xf bank_mask:0xf
    v_add_f32_dpp v117, v117, v117 quad_perm:[2,3,0,1] row_mask:0xf bank_mask:0xf
    v_add_f32_dpp v118, v118, v118 quad_perm:[2,3,0,1] row_mask:0xf bank_mask:0xf
    v_add_f32_dpp v119, v119, v119 quad_perm:[2,3,0,1] row_mask:0xf bank_mask:0xf
    v_add_f32_dpp v8, v8, v8 quad_perm:[2,3,0,1] row_mask:0xf bank_mask:0xf
    v_add_f32_dpp v9, v9, v9 quad_perm:[2,3,0,1] row_mask:0xf bank_mask:0xf
    v_add_f32_dpp v10, v10, v10 quad_perm:[2,3,0,1] row_mask:0xf bank_mask:0xf
    v_add_f32_dpp v12, v12, v12 quad_perm:[2,3,0,1] row_mask:0xf bank_mask:0xf
    v_add_f32_dpp v13, v13, v13 quad_perm:[2,3,0,1] row_mask:0xf bank_mask:0xf
    v_add_f32_dpp v14, v14, v14 quad_perm:[2,3,0,1] row_mask:0xf bank_mask:0xf
    v_add_f32_dpp v19, v19, v19 quad_perm:[2,3,0,1] row_mask:0xf bank_mask:0xf
    v_add_f32_dpp v20, v20, v20 quad_perm:[2,3,0,1] row_mask:0xf bank_mask:0xf
    v_add_f32_dpp v21, v21, v21 quad_perm:[2,3,0,1] row_mask:0xf bank_mask:0xf
    v_add_f32_dpp v22, v22, v22 quad_perm:[2,3,0,1] row_mask:0xf bank_mask:0xf
    v_add_f32_dpp v23, v23, v23 quad_perm:[2,3,0,1] row_mask:0xf bank_mask:0xf
    v_add_f32_dpp v104, v104, v104 quad_perm:[2,3,0,1] row_mask:0xf bank_mask:0xf
    v_add_f32_dpp v116, v116, v116 row_half_mirror row_mask:0xf bank_mask:0xf
    v_add_f32_dpp v117, v117, v117 row_half_mirror row_mask:0xf bank_mask:0xf
    v_add_f32_dpp v118, v118, v118 row_half_mirror row_mask:0xf bank_mask:0xf
    v_add_f32_dpp v119, v119, v119 row_half_mirror row_mask:0xf bank_mask:0xf
    v_add_f32_dpp v8, v8, v8 row_half_mirror row_mask:0xf bank_mask:0xf
    v_add_f32_dpp v9, v9, v9 row_half_mirror row_mask:0xf bank_mask:0xf
    v_add_f32_dpp v10, v10, v10 row_half_mirror row_mask:0xf bank_mask:0xf
    v_add_f32_dpp v12, v12, v12 row_half_mirror row_mask:0xf bank_mask:0xf
    v_add_f32_dpp v13, v13, v13 row_half_mirror row_mask:0xf bank_mask:0xf
    v_add_f32_dpp v14, v14, v14 row_half_mirror row_mask:0xf bank_mask:0xf
    v_add_f32_dpp v19, v19, v19 row_half_mirror row_mask:0xf bank_mask:0xf
    v_add_f32_dpp v20, v20, v20 row_half_mirror row_mask:0xf bank_mask:0xf
    v_add_f32_dpp v21, v21, v21 row_half_mirror row_mask:0xf bank_mask:0xf
    v_add_f32_dpp v22, v22, v22 row_half_mirror row_mask:0xf bank_mask:0xf
    v_add_f32_dpp v23, v23, v23 row_half_mirror row_mask:0xf bank_mask:0xf
    v_add_f32_dpp v104, v104, v104 row_half_mirror row_mask:0xf bank_mask:0xf
    v_add_f32_dpp v116, v116, v116 row_mirror row_mask:0xf bank_mask:0xf
    v_add_f32_dpp v117, v117, v117 row_mirror row_mask:0xf bank_mask:0xf
    v_add_f32_dpp v118, v118, v118 row_mirror row_mask:0xf bank_mask:0xf
    v_add_f32_dpp v119, v119, v119 row_mirror row_mask:0xf bank_mask:0xf
    v_add_f32_dpp v8, v8, v8 row_mirror row_mask:0xf bank_mask:0xf
    v_add_f32_dpp v9, v9, v9 row_mirror row_mask:0xf bank_mask:0xf
    v_add_f32_dpp v10, v10, v10 row_mirror row_mask:0xf bank_mask:0xf
    v_add_f32_dpp v12, v12, v12 row_mirror row_mask:0xf bank_mask:0xf
    v_add_f32_dpp v13, v13, v13 row_mirror row_mask:0xf bank_mask:0xf
    v_add_f32_dpp v14, v14, v14 row_mirror row_mask:0xf bank_mask:0xf
    v_add_f32_dpp v19, v19, v19 row_mirror row_mask:0xf bank_mask:0xf
    v_add_f32_dpp v20, v20, v20 row_mirror row_mask:0xf bank_mask:0xf
    v_add_f32_dpp v21, v21, v21 row_mirror row_mask:0xf bank_mask:0xf
    v_add_f32_dpp v22, v22, v22 row_mirror row_mask:0xf bank_mask:0xf
    v_add_f32_dpp v23, v23, v23 row_mirror row_mask:0xf bank_mask:0xf
    v_add_f32_dpp v104, v104, v104 row_mirror row_mask:0xf bank_mask:0xf
    s_mov_b64 exec, s[34:35]
    v_mov_b32 v96, v116
    v_mov_b32 v97, v13
    ds_write_b64 v16, v[96:97] offset:0
    v_mov_b32 v96, v117
    v_mov_b32 v97, v14
    ds_write_b64 v16, v[96:97] offset:8
    v_mov_b32 v96, v118
    v_mov_b32 v97, v19
    ds_write_b64 v16, v[96:97] offset:16
    v_mov_b32 v96, v119
    v_mov_b32 v97, v20
    ds_write_b64 v16, v[96:97] offset:24
    v_mov_b32 v96, v8
    v_mov_b32 v97, v21
    ds_write_b64 v16, v[96:97] offset:32
    v_mov_b32 v96, v9
    v_mov_b32 v97, v22
    ds_write_b64 v16, v[96:97] offset:40
    v_mov_b32 v96, v10
    v_mov_b32 v97, v23
    ds_write_b64 v16, v[96:97] offset:48
    v_mov_b32 v96, v12
    v_mov_b32 v97, v104
    ds_write_b64 v16, v[96:97] offset:56
    s_mov_b64 exec, -1
    s_waitcnt lgkmcnt(0)
    s_barrier
    s_cmp_lg_u32 s10, 0
    s_nop 0
    s_cbranch_scc1 sequential_preLN__memory_aug_recurrent_mem_tr__mixer_gmlp__prompt_kernel_BE_fin
    ds_read_b32 v96, v17 offset:0
    ds_read_b32 v97, v17 offset:256
    ds_read_b32 v98, v17 offset:512
    ds_read_b32 v99, v17 offset:768
    s_waitcnt lgkmcnt(0)
    v_add_f32 v96, v96, v97
    v_add_f32 v98, v98, v99
    v_add_f32 v96, v96, v98
    global_store_dword v18, v96, s[32:33] sc1
    s_nop 0
sequential_preLN__memory_aug_recurrent_mem_tr__mixer_gmlp__prompt_kernel_BE_fin:
    s_waitcnt vmcnt(0)
    s_barrier
    s_cmp_lg_u32 s10, 0
    s_cbranch_scc1 sequential_preLN__memory_aug_recurrent_mem_tr__mixer_gmlp__prompt_kernel_BE_flag
    s_mov_b64 exec, 1
    global_atomic_add v5, v6, s[28:29] offset:0
    s_mov_b64 exec, -1
    s_nop 4
sequential_preLN__memory_aug_recurrent_mem_tr__mixer_gmlp__prompt_kernel_BE_flag:
    s_add_u32 s22, s22, 114688
    s_addc_u32 s23, s23, 0
    s_add_u32 s24, s24, 512
    s_addc_u32 s25, s25, 0
    s_add_u32 s28, s28, 512
    s_addc_u32 s29, s29, 0
    s_add_u32 s26, s26, 229376
    s_addc_u32 s27, s27, 0
    s_add_u32 s32, s32, 2048
    s_addc_u32 s33, s33, 0
    s_add_u32 s30, s30, 1
    s_cmp_lt_u32 s30, 16
    s_cbranch_scc1 sequential_preLN__memory_aug_recurrent_mem_tr__mixer_gmlp__prompt_kernel_BE_loop
    s_waitcnt vmcnt(0) lgkmcnt(0)
    s_barrier
    s_branch sequential_preLN__memory_aug_recurrent_mem_tr__mixer_gmlp__prompt_kernel_DL0
sequential_preLN__memory_aug_recurrent_mem_tr__mixer_gmlp__prompt_kernel_GA:
    s_cmp_lg_u32 s10, 0
    s_cbranch_scc1 sequential_preLN__memory_aug_recurrent_mem_tr__mixer_gmlp__prompt_kernel_GA_all_pwj
    s_mov_b32 s13, 131072
    s_add_u32 s76, s4, 0x1580000
    s_addc_u32 s77, s5, 0
    v_mbcnt_lo_u32_b32 v20, -1, 0
    v_mbcnt_hi_u32_b32 v20, -1, v20
    v_lshlrev_b32 v20, 4, v20
    s_nop 1
sequential_preLN__memory_aug_recurrent_mem_tr__mixer_gmlp__prompt_kernel_GA_all_pw:
    global_load_dwordx4 v[22:25], v20, s[76:77] sc1
    s_waitcnt vmcnt(0)
    v_xor_b32 v22, s78, v22
    v_xor_b32 v23, s78, v23
    v_xor_b32 v24, s78, v24
    v_xor_b32 v25, s78, v25
    v_or_b32 v22, v22, v23
    v_or_b32 v24, v24, v25
    v_or_b32 v22, v22, v24
    v_cmp_ne_u32 vcc, 0, v22
    s_nop 0
    s_cbranch_vccz sequential_preLN__memory_aug_recurrent_mem_tr__mixer_gmlp__prompt_kernel_GA_all_pwok
    s_sleep 16
    s_sub_u32 s13, s13, 1
    s_cbranch_scc0 sequential_preLN__memory_aug_recurrent_mem_tr__mixer_gmlp__prompt_kernel_GA_all_pw
    s_endpgm
sequential_preLN__memory_aug_recurrent_mem_tr__mixer_gmlp__prompt_kernel_GA_all_pwok:
    buffer_inv sc1
    s_waitcnt vmcnt(0)
sequential_preLN__memory_aug_recurrent_mem_tr__mixer_gmlp__prompt_kernel_GA_all_pwj:
    s_barrier
    v_lshlrev_b32 v1, 4, v1
    v_and_b32 v0, 63, v0
    s_load_dwordx2 s[38:39], s[0:1], 72
    s_load_dwordx2 s[40:41], s[0:1], 80
    s_mov_b32 s13, 131072
    v_mbcnt_lo_u32_b32 v20, -1, 0
    v_mbcnt_hi_u32_b32 v20, -1, v20
    v_and_b32 v20, 7, v20
    v_lshlrev_b32 v20, 5, v20
    s_nop 1
sequential_preLN__memory_aug_recurrent_mem_tr__mixer_gmlp__prompt_kernel_GAa_rc:
    global_load_dword v21, v20, s[6:7] sc1
    s_waitcnt vmcnt(0)
    v_readlane_b32 s68, v21, 0
    v_readlane_b32 s69, v21, 1
    v_readlane_b32 s70, v21, 2
    v_readlane_b32 s71, v21, 3
    v_readlane_b32 s72, v21, 4
    v_readlane_b32 s73, v21, 5
    v_readlane_b32 s74, v21, 6
    v_readlane_b32 s75, v21, 7
    s_add_u32 s14, s68, s69
    s_add_u32 s14, s14, s70
    s_add_u32 s14, s14, s71
    s_add_u32 s14, s14, s72
    s_add_u32 s14, s14, s73
    s_add_u32 s14, s14, s74
    s_add_u32 s14, s14, s75
    s_cmp_ge_u32 s14, 256
    s_cbranch_scc1 sequential_preLN__memory_aug_recurrent_mem_tr__mixer_gmlp__prompt_kernel_GAa_rcok
    s_sleep 1
    s_sub_u32 s13, s13, 1
    s_cbranch_scc0 sequential_preLN__memory_aug_recurrent_mem_tr__mixer_gmlp__prompt_kernel_GAa_rc
    s_endpgm
sequential_preLN__memory_aug_recurrent_mem_tr__mixer_gmlp__prompt_kernel_GAa_rcok:
    s_mul_i32 s56, s3, 28
    s_add_u32 s56, s56, s79
    s_cmp_lt_u32 s79, 28
    s_cselect_b32 s15, 1, 0
    s_cmp_lt_u32 s3, 8
    s_cselect_b32 s14, s15, 0
    s_cmp_lg_u32 s14, 0
    s_cbranch_scc1 sequential_preLN__memory_aug_recurrent_mem_tr__mixer_gmlp__prompt_kernel_GAa_dad
    s_sub_u32 s76, s79, 28
    s_cmp_lt_u32 s3, 8
    s_cselect_b32 s76, s76, 0x1000
    s_max_u32 s14, s68, 28
    s_sub_u32 s14, s14, 28
    s_cmp_gt_u32 s3, 0
    s_cselect_b32 s14, s14, 0
    s_add_u32 s76, s76, s14
    s_max_u32 s14, s69, 28
    s_sub_u32 s14, s14, 28
    s_cmp_gt_u32 s3, 1
    s_cselect_b32 s14, s14, 0
    s_add_u32 s76, s76, s14
    s_max_u32 s14, s70, 28
    s_sub_u32 s14, s14, 28
    s_cmp_gt_u32 s3, 2
    s_cselect_b32 s14, s14, 0
    s_add_u32 s76, s76, s14
    s_max_u32 s14, s71, 28
    s_sub_u32 s14, s14, 28
    s_cmp_gt_u32 s3, 3
    s_cselect_b32 s14, s14, 0
    s_add_u32 s76, s76, s14
    s_max_u32 s14, s72, 28
    s_sub_u32 s14, s14, 28
    s_cmp_gt_u32 s3, 4
    s_cselect_b32 s14, s14, 0
    s_add_u32 s76, s76, s14
    s_max_u32 s14, s73, 28
    s_sub_u32 s14, s14, 28
    s_cmp_gt_u32 s3, 5
    s_cselect_b32 s14, s14, 0
    s_add_u32 s76, s76, s14
    s_max_u32 s14, s74, 28
    s_sub_u32 s14, s14, 28
    s_cmp_gt_u32 s3, 6
    s_cselect_b32 s14, s14, 0
    s_add_u32 s76, s76, s14
    s_max_u32 s14, s75, 28
    s_sub_u32 s14, s14, 28
    s_cmp_gt_u32 s3, 7
    s_cselect_b32 s14, s14, 0
    s_add_u32 s76, s76, s14
    s_mov_b32 s56, 224
    s_min_u32 s14, s68, 28
    s_sub_u32 s15, 28, s14
    s_cmp_lt_u32 s76, s15
    s_cbranch_scc0 sequential_preLN__memory_aug_recurrent_mem_tr__mixer_gmlp__prompt_kernel_GAa_dn0
    s_add_u32 s56, s14, s76
    s_add_u32 s56, s56, 0
    s_branch sequential_preLN__memory_aug_recurrent_mem_tr__mixer_gmlp__prompt_kernel_GAa_dad
sequential_preLN__memory_aug_recurrent_mem_tr__mixer_gmlp__prompt_kernel_GAa_dn0:
    s_sub_u32 s76, s76, s15
    s_min_u32 s14, s69, 28
    s_sub_u32 s15, 28, s14
    s_cmp_lt_u32 s76, s15
    s_cbranch_scc0 sequential_preLN__memory_aug_recurrent_mem_tr__mixer_gmlp__prompt_kernel_GAa_dn1
    s_add_u32 s56, s14, s76
    s_add_u32 s56, s56, 28
    s_branch sequential_preLN__memory_aug_recurrent_mem_tr__mixer_gmlp__prompt_kernel_GAa_dad
sequential_preLN__memory_aug_recurrent_mem_tr__mixer_gmlp__prompt_kernel_GAa_dn1:
    s_sub_u32 s76, s76, s15
    s_min_u32 s14, s70, 28
    s_sub_u32 s15, 28, s14
    s_cmp_lt_u32 s76, s15
    s_cbranch_scc0 sequential_preLN__memory_aug_recurrent_mem_tr__mixer_gmlp__prompt_kernel_GAa_dn2
    s_add_u32 s56, s14, s76
    s_add_u32 s56, s56, 56
    s_branch sequential_preLN__memory_aug_recurrent_mem_tr__mixer_gmlp__prompt_kernel_GAa_dad
sequential_preLN__memory_aug_recurrent_mem_tr__mixer_gmlp__prompt_kernel_GAa_dn2:
    s_sub_u32 s76, s76, s15
    s_min_u32 s14, s71, 28
    s_sub_u32 s15, 28, s14
    s_cmp_lt_u32 s76, s15
    s_cbranch_scc0 sequential_preLN__memory_aug_recurrent_mem_tr__mixer_gmlp__prompt_kernel_GAa_dn3
    s_add_u32 s56, s14, s76
    s_add_u32 s56, s56, 84
    s_branch sequential_preLN__memory_aug_recurrent_mem_tr__mixer_gmlp__prompt_kernel_GAa_dad
sequential_preLN__memory_aug_recurrent_mem_tr__mixer_gmlp__prompt_kernel_GAa_dn3:
    s_sub_u32 s76, s76, s15
    s_min_u32 s14, s72, 28
    s_sub_u32 s15, 28, s14
    s_cmp_lt_u32 s76, s15
    s_cbranch_scc0 sequential_preLN__memory_aug_recurrent_mem_tr__mixer_gmlp__prompt_kernel_GAa_dn4
    s_add_u32 s56, s14, s76
    s_add_u32 s56, s56, 112
    s_branch sequential_preLN__memory_aug_recurrent_mem_tr__mixer_gmlp__prompt_kernel_GAa_dad
sequential_preLN__memory_aug_recurrent_mem_tr__mixer_gmlp__prompt_kernel_GAa_dn4:
    s_sub_u32 s76, s76, s15
    s_min_u32 s14, s73, 28
    s_sub_u32 s15, 28, s14
    s_cmp_lt_u32 s76, s15
    s_cbranch_scc0 sequential_preLN__memory_aug_recurrent_mem_tr__mixer_gmlp__prompt_kernel_GAa_dn5
    s_add_u32 s56, s14, s76
    s_add_u32 s56, s56, 140
    s_branch sequential_preLN__memory_aug_recurrent_mem_tr__mixer_gmlp__prompt_kernel_GAa_dad
sequential_preLN__memory_aug_recurrent_mem_tr__mixer_gmlp__prompt_kernel_GAa_dn5:
    s_sub_u32 s76, s76, s15
    s_min_u32 s14, s74, 28
    s_sub_u32 s15, 28, s14
    s_cmp_lt_u32 s76, s15
    s_cbranch_scc0 sequential_preLN__memory_aug_recurrent_mem_tr__mixer_gmlp__prompt_kernel_GAa_dn6
    s_add_u32 s56, s14, s76
    s_add_u32 s56, s56, 168
    s_branch sequential_preLN__memory_aug_recurrent_mem_tr__mixer_gmlp__prompt_kernel_GAa_dad
sequential_preLN__memory_aug_recurrent_mem_tr__mixer_gmlp__prompt_kernel_GAa_dn6:
    s_sub_u32 s76, s76, s15
    s_min_u32 s14, s75, 28
    s_sub_u32 s15, 28, s14
    s_cmp_lt_u32 s76, s15
    s_cbranch_scc0 sequential_preLN__memory_aug_recurrent_mem_tr__mixer_gmlp__prompt_kernel_GAa_dn7
    s_add_u32 s56, s14, s76
    s_add_u32 s56, s56, 196
    s_branch sequential_preLN__memory_aug_recurrent_mem_tr__mixer_gmlp__prompt_kernel_GAa_dad
sequential_preLN__memory_aug_recurrent_mem_tr__mixer_gmlp__prompt_kernel_GAa_dn7:
    s_sub_u32 s76, s76, s15
sequential_preLN__memory_aug_recurrent_mem_tr__mixer_gmlp__prompt_kernel_GAa_dad:
    s_cmp_ge_u32 s56, 224
    s_cbranch_scc1 sequential_preLN__memory_aug_recurrent_mem_tr__mixer_gmlp__prompt_kernel_GA_nowo
    s_mul_i32 s57, s56, 9363
    s_lshr_b32 s57, s57, 16
    s_mul_i32 s58, s57, 7
    s_sub_u32 s58, s56, s58
    s_lshl_b32 s59, s58, 2
    s_add_u32 s59, s59, s10
    s_mul_i32 s14, s59, 28672
    s_add_u32 s14, s14, 0x1b00000
    s_add_u32 s60, s4, s14
    s_addc_u32 s61, s5, 0
    s_mul_i32 s15, s10, 28672
    s_add_u32 s15, s15, 12288
    s_add_u32 m0, s15, 0
    s_nop 0
    global_load_lds_dwordx4 v1, s[60:61] offset:0
    global_load_lds_dwordx4 v1, s[60:61] offset:1024
    global_load_lds_dwordx4 v1, s[60:61] offset:2048
    global_load_lds_dwordx4 v1, s[60:61] offset:3072
    s_add_u32 m0, s15, 4096
    s_add_u32 s60, s60, 4096
    s_addc_u32 s61, s61, 0
    global_load_lds_dwordx4 v1, s[60:61] offset:0
    global_load_lds_dwordx4 v1, s[60:61] offset:1024
    global_load_lds_dwordx4 v1, s[60:61] offset:2048
    global_load_lds_dwordx4 v1, s[60:61] offset:3072
    s_add_u32 m0, s15, 8192
    s_add_u32 s60, s60, 4096
    s_addc_u32 s61, s61, 0
    global_load_lds_dwordx4 v1, s[60:61] offset:0
    global_load_lds_dwordx4 v1, s[60:61] offset:1024
    global_load_lds_dwordx4 v1, s[60:61] offset:2048
    global_load_lds_dwordx4 v1, s[60:61] offset:3072
    s_add_u32 m0, s15, 12288
    s_add_u32 s60, s60, 4096
    s_addc_u32 s61, s61, 0
    global_load_lds_dwordx4 v1, s[60:61] offset:0
    global_load_lds_dwordx4 v1, s[60:61] offset:1024
    global_load_lds_dwordx4 v1, s[60:61] offset:2048
    global_load_lds_dwordx4 v1, s[60:61] offset:3072
    s_add_u32 m0, s15, 16384
    s_add_u32 s60, s60, 4096
    s_addc_u32 s61, s61, 0
    global_load_lds_dwordx4 v1, s[60:61] offset:0
    global_load_lds_dwordx4 v1, s[60:61] offset:1024
    global_load_lds_dwordx4 v1, s[60:61] offset:2048
    global_load_lds_dwordx4 v1, s[60:61] offset:3072
    s_add_u32 m0, s15, 20480
    s_add_u32 s60, s60, 4096
    s_addc_u32 s61, s61, 0
    global_load_lds_dwordx4 v1, s[60:61] offset:0
    global_load_lds_dwordx4 v1, s[60:61] offset:1024
    global_load_lds_dwordx4 v1, s[60:61] offset:2048
    global_load_lds_dwordx4 v1, s[60:61] offset:3072
    s_add_u32 m0, s15, 24576
    s_add_u32 s60, s60, 4096
    s_addc_u32 s61, s61, 0
    global_load_lds_dwordx4 v1, s[60:61] offset:0
    global_load_lds_dwordx4 v1, s[60:61] offset:1024
    global_load_lds_dwordx4 v1, s[60:61] offset:2048
    global_load_lds_dwordx4 v1, s[60:61] offset:3072
sequential_preLN__memory_aug_recurrent_mem_tr__mixer_gmlp__prompt_kernel_GA_nowo:
    s_waitcnt vmcnt(0)
    s_barrier
    v_mov_b64 v[24:25], 0
    v_mov_b64 v[26:27], 0
    v_mov_b64 v[28:29], 0
    v_mov_b64 v[30:31], 0
    v_mov_b64 v[32:33], 0
    v_mov_b64 v[34:35], 0
    v_mov_b64 v[36:37], 0
    v_mov_b64 v[38:39], 0
    v_mov_b64 v[40:41], 0
    v_mov_b64 v[42:43], 0
    v_mov_b64 v[44:45], 0
    v_mov_b64 v[46:47], 0
    v_mov_b64 v[48:49], 0
    v_mov_b64 v[50:51], 0
    v_mov_b64 v[52:53], 0
    v_mov_b64 v[54:55], 0
    v_mov_b64 v[56:57], 0
    v_mov_b64 v[58:59], 0
    v_mov_b64 v[60:61], 0
    v_mov_b64 v[62:63], 0
    v_mov_b64 v[64:65], 0
    v_mov_b64 v[66:67], 0
    v_mov_b64 v[68:69], 0
    v_mov_b64 v[70:71], 0
    v_mov_b64 v[72:73], 0
    v_mov_b64 v[74:75], 0
    v_mov_b64 v[76:77], 0
    v_mov_b64 v[78:79], 0
    v_mov_b64 v[80:81], 0
    v_mov_b64 v[82:83], 0
    v_mov_b64 v[84:85], 0
    v_mov_b64 v[86:87], 0
    v_mov_b64 v[88:89], 0
    v_mov_b64 v[90:91], 0
    v_mov_b64 v[92:93], 0
    v_mov_b64 v[94:95], 0
    v_mov_b64 v[96:97], 0
    v_mov_b64 v[98:99], 0
    v_mov_b64 v[100:101], 0
    v_mov_b64 v[102:103], 0
    v_mov_b64 v[104:105], 0
    v_mov_b64 v[106:107], 0
    v_mov_b64 v[108:109], 0
    v_mov_b64 v[110:111], 0
    v_mov_b64 v[112:113], 0
    v_mov_b64 v[114:115], 0
    v_mov_b64 v[116:117], 0
    v_mov_b64 v[118:119], 0
    v_mov_b64 v[120:121], 0
    v_mov_b64 v[122:123], 0
    v_mov_b64 v[124:125], 0
    v_mov_b64 v[126:127], 0
    v_mov_b64 v[128:129], 0
    v_mov_b64 v[130:131], 0
    v_mov_b64 v[132:133], 0
    v_mov_b64 v[134:135], 0
    v_mov_b32 v184, 0
    v_mov_b32 v185, 0
    v_add_u32 v7, 0x1000, v1
    v_add_u32 v8, 0x2000, v1
    v_add_u32 v9, 0x3000, v1
    v_and_b32 v10, 15, v0
    v_lshlrev_b32 v10, 12, v10
    v_lshrrev_b32 v11, 4, v0
    v_lshlrev_b32 v12, 4, v11
    v_add_u32 v10, v10, v12
    v_add_u32 v12, 0x10000, v10
    s_lshl_b32 s14, s9, 17
    v_and_b32 v13, 31, v0
    v_lshlrev_b32 v13, 3, v13
    s_lshl_b32 s15, s10, 8
    s_add_u32 s15, s15, 0
    v_add_u32 v14, s15, v13
    v_lshlrev_b32 v15, 6, v11
    v_add_u32 v15, s15, v15
    s_waitcnt lgkmcnt(0)
    s_add_u32 s38, s38, s14
    s_addc_u32 s39, s39, 0
    s_mul_i32 s14, s10, 14336
    s_add_u32 s14, s14, 0x5400000
    s_add_u32 s20, s4, s14
    s_addc_u32 s21, s5, 0
    s_add_u32 s22, s4, 0x5800000
    s_addc_u32 s23, s5, 0
    s_add_u32 s24, s4, 0x150c000
    s_addc_u32 s25, s5, 0
    v_mov_b32 v5, 0
    v_mov_b32 v6, 1
    s_mov_b32 s50, 0x3a924925
    s_cmp_lt_u32 s9, 61
    s_cselect_b32 s31, 60, 62
    global_load_dwordx4 v[136:139], v10, s[38:39]
    global_load_dwordx4 v[140:143], v12, s[38:39]
    s_mov_b32 s13, 131072
sequential_preLN__memory_aug_recurrent_mem_tr__mixer_gmlp__prompt_kernel_GA_w0:
    global_load_dword v11, v5, s[24:25] offset:0 sc1
    s_waitcnt vmcnt(0)
    v_readfirstlane_b32 s14, v11
    s_nop 0
    s_cmp_ge_u32 s14, 4
    s_nop 1
    s_cbranch_scc1 sequential_preLN__memory_aug_recurrent_mem_tr__mixer_gmlp__prompt_kernel_GA_w0_ok
    s_sleep 4
    s_sub_u32 s13, s13, 1
    s_cbranch_scc0 sequential_preLN__memory_aug_recurrent_mem_tr__mixer_gmlp__prompt_kernel_GA_w0
    s_endpgm
sequential_preLN__memory_aug_recurrent_mem_tr__mixer_gmlp__prompt_kernel_GA_w0_ok:
    global_load_dwordx2 v[152:153], v13, s[22:23] sc1
    global_load_dwordx2 v[154:155], v13, s[22:23] offset:256 sc1
    global_load_dwordx4 a[0:3], v1, s[20:21] offset:0 sc1
    global_load_dwordx4 a[4:7], v1, s[20:21] offset:1024 sc1
    global_load_dwordx4 a[8:11], v1, s[20:21] offset:2048 sc1
    global_load_dwordx4 a[12:15], v1, s[20:21] offset:3072 sc1
    global_load_dwordx4 a[16:19], v7, s[20:21] offset:0 sc1
    global_load_dwordx4 a[20:23], v7, s[20:21] offset:1024 sc1
    global_load_dwordx4 a[24:27], v7, s[20:21] offset:2048 sc1
    global_load_dwordx4 a[28:31], v7, s[20:21] offset:3072 sc1
    global_load_dwordx4 a[32:35], v8, s[20:21] offset:0 sc1
    global_load_dwordx4 a[36:39], v8, s[20:21] offset:1024 sc1
    global_load_dwordx4 a[40:43], v8, s[20:21] offset:2048 sc1
    global_load_dwordx4 a[44:47], v8, s[20:21] offset:3072 sc1
    global_load_dwordx4 a[48:51], v9, s[20:21] offset:0 sc1
    global_load_dwordx4 a[52:55], v9, s[20:21] offset:1024 sc1
    s_add_u32 s20, s20, 57344
    s_addc_u32 s21, s21, 0
    s_add_u32 s38, s38, 64
    s_addc_u32 s39, s39, 0
    s_add_u32 s22, s22, 512
    s_addc_u32 s23, s23, 0
    s_mov_b32 s30, 0
sequential_preLN__memory_aug_recurrent_mem_tr__mixer_gmlp__prompt_kernel_GA_loop:
    s_add_u32 s24, s24, 128
    s_addc_u32 s25, s25, 0
    global_load_dwordx4 v[144:147], v10, s[38:39]
    global_load_dwordx4 v[148:151], v12, s[38:39]
    s_mov_b32 s13, 131072
sequential_preLN__memory_aug_recurrent_mem_tr__mixer_gmlp__prompt_kernel_GA_w1:
    global_load_dword v11, v5, s[24:25] offset:0 sc1
    s_waitcnt vmcnt(0)
    v_readfirstlane_b32 s14, v11
    s_nop 0
    s_cmp_ge_u32 s14, 4
    s_nop 1
    s_cbranch_scc1 sequential_preLN__memory_aug_recurrent_mem_tr__mixer_gmlp__prompt_kernel_GA_w1_ok
    s_cmp_lt_u32 s30, 58
    s_cbranch_scc0 sequential_preLN__memory_aug_recurrent_mem_tr__mixer_gmlp__prompt_kernel_GA_w1_as
    s_sleep 8
sequential_preLN__memory_aug_recurrent_mem_tr__mixer_gmlp__prompt_kernel_GA_w1_as:
    s_sleep 1
    s_sub_u32 s13, s13, 1
    s_cbranch_scc0 sequential_preLN__memory_aug_recurrent_mem_tr__mixer_gmlp__prompt_kernel_GA_w1
    s_endpgm
sequential_preLN__memory_aug_recurrent_mem_tr__mixer_gmlp__prompt_kernel_GA_w1_ok:
    global_load_dwordx2 v[156:157], v13, s[22:23] sc1
    global_load_dwordx2 v[158:159], v13, s[22:23] offset:256 sc1
    global_load_dwordx4 a[56:59], v1, s[20:21] offset:0 sc1
    global_load_dwordx4 a[60:63], v1, s[20:21] offset:1024 sc1
    global_load_dwordx4 a[64:67], v1, s[20:21] offset:2048 sc1
    global_load_dwordx4 a[68:71], v1, s[20:21] offset:3072 sc1
    global_load_dwordx4 a[72:75], v7, s[20:21] offset:0 sc1
    global_load_dwordx4 a[76:79], v7, s[20:21] offset:1024 sc1
    global_load_dwordx4 a[80:83], v7, s[20:21] offset:2048 sc1
    global_load_dwordx4 a[84:87], v7, s[20:21] offset:3072 sc1
    global_load_dwordx4 a[88:91], v8, s[20:21] offset:0 sc1
    global_load_dwordx4 a[92:95], v8, s[20:21] offset:1024 sc1
    global_load_dwordx4 a[96:99], v8, s[20:21] offset:2048 sc1
    global_load_dwordx4 a[100:103], v8, s[20:21] offset:3072 sc1
    global_load_dwordx4 a[104:107], v9, s[20:21] offset:0 sc1
    global_load_dwordx4 a[108:111], v9, s[20:21] offset:1024 sc1
    s_add_u32 s20, s20, 57344
    s_addc_u32 s21, s21, 0
    s_add_u32 s38, s38, 64
    s_addc_u32 s39, s39, 0
    s_add_u32 s22, s22, 512
    s_addc_u32 s23, s23, 0
    s_cmp_eq_u32 s30, s31
    s_cbranch_scc0 sequential_preLN__memory_aug_recurrent_mem_tr__mixer_gmlp__prompt_kernel_GA_noz1
    s_mul_i32 s14, s9, 56
    s_mul_i32 s15, s10, 14
    s_add_u32 s14, s14, s15
    s_lshl_b32 s14, s14, 10
    s_add_u32 s14, s14, 0x5000000
    s_add_u32 s26, s4, s14
    s_addc_u32 s27, s5, 0
    v_lshlrev_b32 v242, 3, v0
    v_add_u32 v243, 0x1000, v242
    v_add_u32 v244, 0x2000, v242
    v_add_u32 v245, 0x3000, v242
    global_load_dwordx2 v[186:187], v242, s[26:27] offset:0 sc1
    global_load_dwordx2 v[188:189], v242, s[26:27] offset:512 sc1
    global_load_dwordx2 v[190:191], v242, s[26:27] offset:1024 sc1
    global_load_dwordx2 v[192:193], v242, s[26:27] offset:1536 sc1
    global_load_dwordx2 v[194:195], v242, s[26:27] offset:2048 sc1
    global_load_dwordx2 v[196:197], v242, s[26:27] offset:2560 sc1
    global_load_dwordx2 v[198:199], v242, s[26:27] offset:3072 sc1
    global_load_dwordx2 v[200:201], v242, s[26:27] offset:3584 sc1
    global_load_dwordx2 v[202:203], v243, s[26:27] offset:0 sc1
    global_load_dwordx2 v[204:205], v243, s[26:27] offset:512 sc1
    global_load_dwordx2 v[206:207], v243, s[26:27] offset:1024 sc1
    global_load_dwordx2 v[208:209], v243, s[26:27] offset:1536 sc1
    global_load_dwordx2 v[210:211], v243, s[26:27] offset:2048 sc1
    global_load_dwordx2 v[212:213], v243, s[26:27] offset:2560 sc1
    global_load_dwordx2 v[214:215], v243, s[26:27] offset:3072 sc1
    global_load_dwordx2 v[216:217], v243, s[26:27] offset:3584 sc1
    global_load_dwordx2 v[218:219], v244, s[26:27] offset:0 sc1
    global_load_dwordx2 v[220:221], v244, s[26:27] offset:512 sc1
    global_load_dwordx2 v[222:223], v244, s[26:27] offset:1024 sc1
    global_load_dwordx2 v[224:225], v244, s[26:27] offset:1536 sc1
    global_load_dwordx2 v[226:227], v244, s[26:27] offset:2048 sc1
    global_load_dwordx2 v[228:229], v244, s[26:27] offset:2560 sc1
    global_load_dwordx2 v[230:231], v244, s[26:27] offset:3072 sc1
    global_load_dwordx2 v[232:233], v244, s[26:27] offset:3584 sc1
    global_load_dwordx2 v[234:235], v245, s[26:27] offset:0 sc1
    global_load_dwordx2 v[236:237], v245, s[26:27] offset:512 sc1
    global_load_dwordx2 v[238:239], v245, s[26:27] offset:1024 sc1
    global_load_dwordx2 v[240:241], v245, s[26:27] offset:1536 sc1
    s_lshl_b32 s14, s9, 6
    s_add_u32 s40, s40, s14
    s_addc_u32 s41, s41, 0
    v_and_b32 v246, 15, v0
    v_lshlrev_b32 v246, 1, v246
    global_load_ushort v247, v246, s[40:41]
    global_load_ushort v248, v246, s[40:41] offset:32
    s_waitcnt vmcnt(46)
    s_branch sequential_preLN__memory_aug_recurrent_mem_tr__mixer_gmlp__prompt_kernel_GA_z1j
sequential_preLN__memory_aug_recurrent_mem_tr__mixer_gmlp__prompt_kernel_GA_noz1:
    s_waitcnt vmcnt(16)
sequential_preLN__memory_aug_recurrent_mem_tr__mixer_gmlp__prompt_kernel_GA_z1j:
    v_add_f32 v16, v152, v154
    v_add_f32 v17, v153, v155
    v_mul_f32 v16, s50, v16
    v_mul_f32 v17, s50, v17
    v_fma_f32 v17, -v16, v16, v17
    v_max_f32 v17, 0, v17
    v_cvt_pk_bf16_f32 v17, v17, v17
    v_and_b32 v17, 0xffff0000, v17
    v_add_f32 v17, 0x3727c5ac, v17
    v_cvt_pk_bf16_f32 v17, v17, v17
    v_and_b32 v17, 0xffff0000, v17
    v_sqrt_f32 v17, v17
    s_nop 0
    v_cvt_pk_bf16_f32 v17, v17, v17
    v_and_b32 v17, 0xffff0000, v17
    v_rcp_f32 v17, v17
    v_cvt_pk_bf16_f32 v16, v16, v16
    v_and_b32 v16, 0xffff0000, v16
    v_mov_b32 v18, v17
    v_mov_b32 v19, v16
    ds_write_b64 v14, v[18:19]
    s_waitcnt lgkmcnt(0)
    ds_read_b128 v[168:171], v15 offset:0
    ds_read_b128 v[172:175], v15 offset:16
    ds_read_b128 v[176:179], v15 offset:32
    ds_read_b128 v[180:183], v15 offset:48
    s_waitcnt lgkmcnt(0)
    v_lshlrev_b32 v16, 16, v136
    v_and_b32 v17, 0xffff0000, v136
    v_mul_f32 v16, v16, v168
    v_mul_f32 v17, v17, v170
    v_cvt_pk_bf16_f32 v160, v16, v17
    v_lshlrev_b32 v16, 16, v160
    v_and_b32 v17, 0xffff0000, v160
    v_fmac_f32 v184, v16, v169
    v_fmac_f32 v184, v17, v171
    v_lshlrev_b32 v16, 16, v137
    v_and_b32 v17, 0xffff0000, v137
    v_mul_f32 v16, v16, v172
    v_mul_f32 v17, v17, v174
    v_cvt_pk_bf16_f32 v161, v16, v17
    v_lshlrev_b32 v16, 16, v161
    v_and_b32 v17, 0xffff0000, v161
    v_fmac_f32 v184, v16, v173
    v_fmac_f32 v184, v17, v175
    v_lshlrev_b32 v16, 16, v138
    v_and_b32 v17, 0xffff0000, v138
    v_mul_f32 v16, v16, v176
    v_mul_f32 v17, v17, v178
    v_cvt_pk_bf16_f32 v162, v16, v17
    v_lshlrev_b32 v16, 16, v162
    v_and_b32 v17, 0xffff0000, v162
    v_fmac_f32 v184, v16, v177
    v_fmac_f32 v184, v17, v179
    v_lshlrev_b32 v16, 16, v139
    v_and_b32 v17, 0xffff0000, v139
    v_mul_f32 v16, v16, v180
    v_mul_f32 v17, v17, v182
    v_cvt_pk_bf16_f32 v163, v16, v17
    v_lshlrev_b32 v16, 16, v163
    v_and_b32 v17, 0xffff0000, v163
    v_fmac_f32 v184, v16, v181
    v_fmac_f32 v184, v17, v183
    v_lshlrev_b32 v16, 16, v140
    v_and_b32 v17, 0xffff0000, v140
    v_mul_f32 v16, v16, v168
    v_mul_f32 v17, v17, v170
    v_cvt_pk_bf16_f32 v164, v16, v17
    v_lshlrev_b32 v16, 16, v164
    v_and_b32 v17, 0xffff0000, v164
    v_fmac_f32 v185, v16, v169
    v_fmac_f32 v185, v17, v171
    v_lshlrev_b32 v16, 16, v141
    v_and_b32 v17, 0xffff0000, v141
    v_mul_f32 v16, v16, v172
    v_mul_f32 v17, v17, v174
    v_cvt_pk_bf16_f32 v165, v16, v17
    v_lshlrev_b32 v16, 16, v165
    v_and_b32 v17, 0xffff0000, v165
    v_fmac_f32 v185, v16, v173
    v_fmac_f32 v185, v17, v175
    v_lshlrev_b32 v16, 16, v142
    v_and_b32 v17, 0xffff0000, v142
    v_mul_f32 v16, v16, v176
    v_mul_f32 v17, v17, v178
    v_cvt_pk_bf16_f32 v166, v16, v17
    v_lshlrev_b32 v16, 16, v166
    v_and_b32 v17, 0xffff0000, v166
    v_fmac_f32 v185, v16, v177
    v_fmac_f32 v185, v17, v179
    v_lshlrev_b32 v16, 16, v143
    v_and_b32 v17, 0xffff0000, v143
    v_mul_f32 v16, v16, v180
    v_mul_f32 v17, v17, v182
    v_cvt_pk_bf16_f32 v167, v16, v17
    v_lshlrev_b32 v16, 16, v167
    v_and_b32 v17, 0xffff0000, v167
    v_fmac_f32 v185, v16, v181
    v_fmac_f32 v185, v17, v183
    v_mfma_f32_16x16x32_bf16 v[24:27], a[0:3], v[160:163], v[24:27]
    v_mfma_f32_16x16x32_bf16 v[28:31], a[0:3], v[164:167], v[28:31]
    v_mfma_f32_16x16x32_bf16 v[32:35], a[4:7], v[160:163], v[32:35]
    v_mfma_f32_16x16x32_bf16 v[36:39], a[4:7], v[164:167], v[36:39]
    v_mfma_f32_16x16x32_bf16 v[40:43], a[8:11], v[160:163], v[40:43]
    v_mfma_f32_16x16x32_bf16 v[44:47], a[8:11], v[164:167], v[44:47]
    v_mfma_f32_16x16x32_bf16 v[48:51], a[12:15], v[160:163], v[48:51]
    v_mfma_f32_16x16x32_bf16 v[52:55], a[12:15], v[164:167], v[52:55]
    v_mfma_f32_16x16x32_bf16 v[56:59], a[16:19], v[160:163], v[56:59]
    v_mfma_f32_16x16x32_bf16 v[60:63], a[16:19], v[164:167], v[60:63]
    v_mfma_f32_16x16x32_bf16 v[64:67], a[20:23], v[160:163], v[64:67]
    v_mfma_f32_16x16x32_bf16 v[68:71], a[20:23], v[164:167], v[68:71]
    v_mfma_f32_16x16x32_bf16 v[72:75], a[24:27], v[160:163], v[72:75]
    v_mfma_f32_16x16x32_bf16 v[76:79], a[24:27], v[164:167], v[76:79]
    v_mfma_f32_16x16x32_bf16 v[80:83], a[28:31], v[160:163], v[80:83]
    v_mfma_f32_16x16x32_bf16 v[84:87], a[28:31], v[164:167], v[84:87]
    v_mfma_f32_16x16x32_bf16 v[88:91], a[32:35], v[160:163], v[88:91]
    v_mfma_f32_16x16x32_bf16 v[92:95], a[32:35], v[164:167], v[92:95]
    v_mfma_f32_16x16x32_bf16 v[96:99], a[36:39], v[160:163], v[96:99]
    v_mfma_f32_16x16x32_bf16 v[100:103], a[36:39], v[164:167], v[100:103]
    v_mfma_f32_16x16x32_bf16 v[104:107], a[40:43], v[160:163], v[104:107]
    v_mfma_f32_16x16x32_bf16 v[108:111], a[40:43], v[164:167], v[108:111]
    v_mfma_f32_16x16x32_bf16 v[112:115], a[44:47], v[160:163], v[112:115]
    v_mfma_f32_16x16x32_bf16 v[116:119], a[44:47], v[164:167], v[116:119]
    v_mfma_f32_16x16x32_bf16 v[120:123], a[48:51], v[160:163], v[120:123]
    v_mfma_f32_16x16x32_bf16 v[124:127], a[48:51], v[164:167], v[124:127]
    v_mfma_f32_16x16x32_bf16 v[128:131], a[52:55], v[160:163], v[128:131]
    v_mfma_f32_16x16x32_bf16 v[132:135], a[52:55], v[164:167], v[132:135]
    s_cmp_eq_u32 s30, 62
    s_nop 5
    s_cbranch_scc1 sequential_preLN__memory_aug_recurrent_mem_tr__mixer_gmlp__prompt_kernel_GA_lastseg
    s_add_u32 s24, s24, 128
    s_addc_u32 s25, s25, 0
    global_load_dwordx4 v[136:139], v10, s[38:39]
    global_load_dwordx4 v[140:143], v12, s[38:39]
    s_mov_b32 s13, 131072
sequential_preLN__memory_aug_recurrent_mem_tr__mixer_gmlp__prompt_kernel_GA_w2:
    global_load_dword v11, v5, s[24:25] offset:0 sc1
    s_waitcnt vmcnt(0)
    v_readfirstlane_b32 s14, v11
    s_nop 0
    s_cmp_ge_u32 s14, 4
    s_nop 1
    s_cbranch_scc1 sequential_preLN__memory_aug_recurrent_mem_tr__mixer_gmlp__prompt_kernel_GA_w2_ok
    s_cmp_lt_u32 s30, 58
    s_cbranch_scc0 sequential_preLN__memory_aug_recurrent_mem_tr__mixer_gmlp__prompt_kernel_GA_w2_as
    s_sleep 8
sequential_preLN__memory_aug_recurrent_mem_tr__mixer_gmlp__prompt_kernel_GA_w2_as:
    s_sleep 1
    s_sub_u32 s13, s13, 1
    s_cbranch_scc0 sequential_preLN__memory_aug_recurrent_mem_tr__mixer_gmlp__prompt_kernel_GA_w2
    s_endpgm
sequential_preLN__memory_aug_recurrent_mem_tr__mixer_gmlp__prompt_kernel_GA_w2_ok:
    global_load_dwordx2 v[152:153], v13, s[22:23] sc1
    global_load_dwordx2 v[154:155], v13, s[22:23] offset:256 sc1
    global_load_dwordx4 a[0:3], v1, s[20:21] offset:0 sc1
    global_load_dwordx4 a[4:7], v1, s[20:21] offset:1024 sc1
    global_load_dwordx4 a[8:11], v1, s[20:21] offset:2048 sc1
    global_load_dwordx4 a[12:15], v1, s[20:21] offset:3072 sc1
    global_load_dwordx4 a[16:19], v7, s[20:21] offset:0 sc1
    global_load_dwordx4 a[20:23], v7, s[20:21] offset:1024 sc1
    global_load_dwordx4 a[24:27], v7, s[20:21] offset:2048 sc1
    global_load_dwordx4 a[28:31], v7, s[20:21] offset:3072 sc1
    global_load_dwordx4 a[32:35], v8, s[20:21] offset:0 sc1
    global_load_dwordx4 a[36:39], v8, s[20:21] offset:1024 sc1
    global_load_dwordx4 a[40:43], v8, s[20:21] offset:2048 sc1
    global_load_dwordx4 a[44:47], v8, s[20:21] offset:3072 sc1
    global_load_dwordx4 a[48:51], v9, s[20:21] offset:0 sc1
    global_load_dwordx4 a[52:55], v9, s[20:21] offset:1024 sc1
    s_add_u32 s20, s20, 57344
    s_addc_u32 s21, s21, 0
    s_add_u32 s38, s38, 64
    s_addc_u32 s39, s39, 0
    s_add_u32 s22, s22, 512
    s_addc_u32 s23, s23, 0
    s_waitcnt vmcnt(16)
    v_add_f32 v16, v156, v158
    v_add_f32 v17, v157, v159
    v_mul_f32 v16, s50, v16
    v_mul_f32 v17, s50, v17
    v_fma_f32 v17, -v16, v16, v17
    v_max_f32 v17, 0, v17
    v_cvt_pk_bf16_f32 v17, v17, v17
    v_and_b32 v17, 0xffff0000, v17
    v_add_f32 v17, 0x3727c5ac, v17
    v_cvt_pk_bf16_f32 v17, v17, v17
    v_and_b32 v17, 0xffff0000, v17
    v_sqrt_f32 v17, v17
    s_nop 0
    v_cvt_pk_bf16_f32 v17, v17, v17
    v_and_b32 v17, 0xffff0000, v17
    v_rcp_f32 v17, v17
    v_cvt_pk_bf16_f32 v16, v16, v16
    v_and_b32 v16, 0xffff0000, v16
    v_mov_b32 v18, v17
    v_mov_b32 v19, v16
    ds_write_b64 v14, v[18:19]
    s_waitcnt lgkmcnt(0)
    ds_read_b128 v[168:171], v15 offset:0
    ds_read_b128 v[172:175], v15 offset:16
    ds_read_b128 v[176:179], v15 offset:32
    ds_read_b128 v[180:183], v15 offset:48
    s_waitcnt lgkmcnt(0)
    v_lshlrev_b32 v16, 16, v144
    v_and_b32 v17, 0xffff0000, v144
    v_mul_f32 v16, v16, v168
    v_mul_f32 v17, v17, v170
    v_cvt_pk_bf16_f32 v160, v16, v17
    v_lshlrev_b32 v16, 16, v160
    v_and_b32 v17, 0xffff0000, v160
    v_fmac_f32 v184, v16, v169
    v_fmac_f32 v184, v17, v171
    v_lshlrev_b32 v16, 16, v145
    v_and_b32 v17, 0xffff0000, v145
    v_mul_f32 v16, v16, v172
    v_mul_f32 v17, v17, v174
    v_cvt_pk_bf16_f32 v161, v16, v17
    v_lshlrev_b32 v16, 16, v161
    v_and_b32 v17, 0xffff0000, v161
    v_fmac_f32 v184, v16, v173
    v_fmac_f32 v184, v17, v175
    v_lshlrev_b32 v16, 16, v146
    v_and_b32 v17, 0xffff0000, v146
    v_mul_f32 v16, v16, v176
    v_mul_f32 v17, v17, v178
    v_cvt_pk_bf16_f32 v162, v16, v17
    v_lshlrev_b32 v16, 16, v162
    v_and_b32 v17, 0xffff0000, v162
    v_fmac_f32 v184, v16, v177
    v_fmac_f32 v184, v17, v179
    v_lshlrev_b32 v16, 16, v147
    v_and_b32 v17, 0xffff0000, v147
    v_mul_f32 v16, v16, v180
    v_mul_f32 v17, v17, v182
    v_cvt_pk_bf16_f32 v163, v16, v17
    v_lshlrev_b32 v16, 16, v163
    v_and_b32 v17, 0xffff0000, v163
    v_fmac_f32 v184, v16, v181
    v_fmac_f32 v184, v17, v183
    v_lshlrev_b32 v16, 16, v148
    v_and_b32 v17, 0xffff0000, v148
    v_mul_f32 v16, v16, v168
    v_mul_f32 v17, v17, v170
    v_cvt_pk_bf16_f32 v164, v16, v17
    v_lshlrev_b32 v16, 16, v164
    v_and_b32 v17, 0xffff0000, v164
    v_fmac_f32 v185, v16, v169
    v_fmac_f32 v185, v17, v171
    v_lshlrev_b32 v16, 16, v149
    v_and_b32 v17, 0xffff0000, v149
    v_mul_f32 v16, v16, v172
    v_mul_f32 v17, v17, v174
    v_cvt_pk_bf16_f32 v165, v16, v17
    v_lshlrev_b32 v16, 16, v165
    v_and_b32 v17, 0xffff0000, v165
    v_fmac_f32 v185, v16, v173
    v_fmac_f32 v185, v17, v175
    v_lshlrev_b32 v16, 16, v150
    v_and_b32 v17, 0xffff0000, v150
    v_mul_f32 v16, v16, v176
    v_mul_f32 v17, v17, v178
    v_cvt_pk_bf16_f32 v166, v16, v17
    v_lshlrev_b32 v16, 16, v166
    v_and_b32 v17, 0xffff0000, v166
    v_fmac_f32 v185, v16, v177
    v_fmac_f32 v185, v17, v179
    v_lshlrev_b32 v16, 16, v151
    v_and_b32 v17, 0xffff0000, v151
    v_mul_f32 v16, v16, v180
    v_mul_f32 v17, v17, v182
    v_cvt_pk_bf16_f32 v167, v16, v17
    v_lshlrev_b32 v16, 16, v167
    v_and_b32 v17, 0xffff0000, v167
    v_fmac_f32 v185, v16, v181
    v_fmac_f32 v185, v17, v183
    v_mfma_f32_16x16x32_bf16 v[24:27], a[56:59], v[160:163], v[24:27]
    v_mfma_f32_16x16x32_bf16 v[28:31], a[56:59], v[164:167], v[28:31]
    v_mfma_f32_16x16x32_bf16 v[32:35], a[60:63], v[160:163], v[32:35]
    v_mfma_f32_16x16x32_bf16 v[36:39], a[60:63], v[164:167], v[36:39]
    v_mfma_f32_16x16x32_bf16 v[40:43], a[64:67], v[160:163], v[40:43]
    v_mfma_f32_16x16x32_bf16 v[44:47], a[64:67], v[164:167], v[44:47]
    v_mfma_f32_16x16x32_bf16 v[48:51], a[68:71], v[160:163], v[48:51]
    v_mfma_f32_16x16x32_bf16 v[52:55], a[68:71], v[164:167], v[52:55]
    v_mfma_f32_16x16x32_bf16 v[56:59], a[72:75], v[160:163], v[56:59]
    v_mfma_f32_16x16x32_bf16 v[60:63], a[72:75], v[164:167], v[60:63]
    v_mfma_f32_16x16x32_bf16 v[64:67], a[76:79], v[160:163], v[64:67]
    v_mfma_f32_16x16x32_bf16 v[68:71], a[76:79], v[164:167], v[68:71]
    v_mfma_f32_16x16x32_bf16 v[72:75], a[80:83], v[160:163], v[72:75]
    v_mfma_f32_16x16x32_bf16 v[76:79], a[80:83], v[164:167], v[76:79]
    v_mfma_f32_16x16x32_bf16 v[80:83], a[84:87], v[160:163], v[80:83]
    v_mfma_f32_16x16x32_bf16 v[84:87], a[84:87], v[164:167], v[84:87]
    v_mfma_f32_16x16x32_bf16 v[88:91], a[88:91], v[160:163], v[88:91]
    v_mfma_f32_16x16x32_bf16 v[92:95], a[88:91], v[164:167], v[92:95]
    v_mfma_f32_16x16x32_bf16 v[96:99], a[92:95], v[160:163], v[96:99]
    v_mfma_f32_16x16x32_bf16 v[100:103], a[92:95], v[164:167], v[100:103]
    v_mfma_f32_16x16x32_bf16 v[104:107], a[96:99], v[160:163], v[104:107]
    v_mfma_f32_16x16x32_bf16 v[108:111], a[96:99], v[164:167], v[108:111]
    v_mfma_f32_16x16x32_bf16 v[112:115], a[100:103], v[160:163], v[112:115]
    v_mfma_f32_16x16x32_bf16 v[116:119], a[100:103], v[164:167], v[116:119]
    v_mfma_f32_16x16x32_bf16 v[120:123], a[104:107], v[160:163], v[120:123]
    v_mfma_f32_16x16x32_bf16 v[124:127], a[104:107], v[164:167], v[124:127]
    v_mfma_f32_16x16x32_bf16 v[128:131], a[108:111], v[160:163], v[128:131]
    v_mfma_f32_16x16x32_bf16 v[132:135], a[108:111], v[164:167], v[132:135]
    s_add_u32 s30, s30, 2
    s_nop 5
    s_branch sequential_preLN__memory_aug_recurrent_mem_tr__mixer_gmlp__prompt_kernel_GA_loop
sequential_preLN__memory_aug_recurrent_mem_tr__mixer_gmlp__prompt_kernel_GA_lastseg:
    s_cmp_eq_u32 s31, 62
    s_cbranch_scc1 sequential_preLN__memory_aug_recurrent_mem_tr__mixer_gmlp__prompt_kernel_GA_lastz
    s_waitcnt vmcnt(14)
    s_branch sequential_preLN__memory_aug_recurrent_mem_tr__mixer_gmlp__prompt_kernel_GA_lastc
sequential_preLN__memory_aug_recurrent_mem_tr__mixer_gmlp__prompt_kernel_GA_lastz:
    s_waitcnt vmcnt(44)
sequential_preLN__memory_aug_recurrent_mem_tr__mixer_gmlp__prompt_kernel_GA_lastc:
    v_add_f32 v16, v156, v158
    v_add_f32 v17, v157, v159
    v_mul_f32 v16, s50, v16
    v_mul_f32 v17, s50, v17
    v_fma_f32 v17, -v16, v16, v17
    v_max_f32 v17, 0, v17
    v_cvt_pk_bf16_f32 v17, v17, v17
    v_and_b32 v17, 0xffff0000, v17
    v_add_f32 v17, 0x3727c5ac, v17
    v_cvt_pk_bf16_f32 v17, v17, v17
    v_and_b32 v17, 0xffff0000, v17
    v_sqrt_f32 v17, v17
    s_nop 0
    v_cvt_pk_bf16_f32 v17, v17, v17
    v_and_b32 v17, 0xffff0000, v17
    v_rcp_f32 v17, v17
    v_cvt_pk_bf16_f32 v16, v16, v16
    v_and_b32 v16, 0xffff0000, v16
    v_mov_b32 v18, v17
    v_mov_b32 v19, v16
    ds_write_b64 v14, v[18:19]
    s_waitcnt lgkmcnt(0)
    ds_read_b128 v[168:171], v15 offset:0
    ds_read_b128 v[172:175], v15 offset:16
    ds_read_b128 v[176:179], v15 offset:32
    ds_read_b128 v[180:183], v15 offset:48
    s_waitcnt lgkmcnt(0)
    v_lshlrev_b32 v16, 16, v144
    v_and_b32 v17, 0xffff0000, v144
    v_mul_f32 v16, v16, v168
    v_mul_f32 v17, v17, v170
    v_cvt_pk_bf16_f32 v160, v16, v17
    v_lshlrev_b32 v16, 16, v160
    v_and_b32 v17, 0xffff0000, v160
    v_fmac_f32 v184, v16, v169
    v_fmac_f32 v184, v17, v171
    v_lshlrev_b32 v16, 16, v145
    v_and_b32 v17, 0xffff0000, v145
    v_mul_f32 v16, v16, v172
    v_mul_f32 v17, v17, v174
    v_cvt_pk_bf16_f32 v161, v16, v17
    v_lshlrev_b32 v16, 16, v161
    v_and_b32 v17, 0xffff0000, v161
    v_fmac_f32 v184, v16, v173
    v_fmac_f32 v184, v17, v175
    v_lshlrev_b32 v16, 16, v146
    v_and_b32 v17, 0xffff0000, v146
    v_mul_f32 v16, v16, v176
    v_mul_f32 v17, v17, v178
    v_cvt_pk_bf16_f32 v162, v16, v17
    v_lshlrev_b32 v16, 16, v162
    v_and_b32 v17, 0xffff0000, v162
    v_fmac_f32 v184, v16, v177
    v_fmac_f32 v184, v17, v179
    v_lshlrev_b32 v16, 16, v147
    v_and_b32 v17, 0xffff0000, v147
    v_mul_f32 v16, v16, v180
    v_mul_f32 v17, v17, v182
    v_cvt_pk_bf16_f32 v163, v16, v17
    v_lshlrev_b32 v16, 16, v163
    v_and_b32 v17, 0xffff0000, v163
    v_fmac_f32 v184, v16, v181
    v_fmac_f32 v184, v17, v183
    v_lshlrev_b32 v16, 16, v148
    v_and_b32 v17, 0xffff0000, v148
    v_mul_f32 v16, v16, v168
    v_mul_f32 v17, v17, v170
    v_cvt_pk_bf16_f32 v164, v16, v17
    v_lshlrev_b32 v16, 16, v164
    v_and_b32 v17, 0xffff0000, v164
    v_fmac_f32 v185, v16, v169
    v_fmac_f32 v185, v17, v171
    v_lshlrev_b32 v16, 16, v149
    v_and_b32 v17, 0xffff0000, v149
    v_mul_f32 v16, v16, v172
    v_mul_f32 v17, v17, v174
    v_cvt_pk_bf16_f32 v165, v16, v17
    v_lshlrev_b32 v16, 16, v165
    v_and_b32 v17, 0xffff0000, v165
    v_fmac_f32 v185, v16, v173
    v_fmac_f32 v185, v17, v175
    v_lshlrev_b32 v16, 16, v150
    v_and_b32 v17, 0xffff0000, v150
    v_mul_f32 v16, v16, v176
    v_mul_f32 v17, v17, v178
    v_cvt_pk_bf16_f32 v166, v16, v17
    v_lshlrev_b32 v16, 16, v166
    v_and_b32 v17, 0xffff0000, v166
    v_fmac_f32 v185, v16, v177
    v_fmac_f32 v185, v17, v179
    v_lshlrev_b32 v16, 16, v151
    v_and_b32 v17, 0xffff0000, v151
    v_mul_f32 v16, v16, v180
    v_mul_f32 v17, v17, v182
    v_cvt_pk_bf16_f32 v167, v16, v17
    v_lshlrev_b32 v16, 16, v167
    v_and_b32 v17, 0xffff0000, v167
    v_fmac_f32 v185, v16, v181
    v_fmac_f32 v185, v17, v183
    s_cmp_eq_u32 s31, 62
    s_cbranch_scc1 sequential_preLN__memory_aug_recurrent_mem_tr__mixer_gmlp__prompt_kernel_GA_lt1
    s_waitcnt vmcnt(0)
sequential_preLN__memory_aug_recurrent_mem_tr__mixer_gmlp__prompt_kernel_GA_lt1:
    s_waitcnt vmcnt(30)
    v_mfma_f32_16x16x32_bf16 v[24:27], a[56:59], v[160:163], v[24:27]
    v_mfma_f32_16x16x32_bf16 v[28:31], a[56:59], v[164:167], v[28:31]
    v_mfma_f32_16x16x32_bf16 v[32:35], a[60:63], v[160:163], v[32:35]
    v_mfma_f32_16x16x32_bf16 v[36:39], a[60:63], v[164:167], v[36:39]
    v_mfma_f32_16x16x32_bf16 v[40:43], a[64:67], v[160:163], v[40:43]
    v_mfma_f32_16x16x32_bf16 v[44:47], a[64:67], v[164:167], v[44:47]
    v_mfma_f32_16x16x32_bf16 v[48:51], a[68:71], v[160:163], v[48:51]
    v_mfma_f32_16x16x32_bf16 v[52:55], a[68:71], v[164:167], v[52:55]
    v_mfma_f32_16x16x32_bf16 v[56:59], a[72:75], v[160:163], v[56:59]
    v_mfma_f32_16x16x32_bf16 v[60:63], a[72:75], v[164:167], v[60:63]
    v_mfma_f32_16x16x32_bf16 v[64:67], a[76:79], v[160:163], v[64:67]
    v_mfma_f32_16x16x32_bf16 v[68:71], a[76:79], v[164:167], v[68:71]
    v_mfma_f32_16x16x32_bf16 v[72:75], a[80:83], v[160:163], v[72:75]
    v_mfma_f32_16x16x32_bf16 v[76:79], a[80:83], v[164:167], v[76:79]
    v_mfma_f32_16x16x32_bf16 v[80:83], a[84:87], v[160:163], v[80:83]
    v_mfma_f32_16x16x32_bf16 v[84:87], a[84:87], v[164:167], v[84:87]
    v_mfma_f32_16x16x32_bf16 v[88:91], a[88:91], v[160:163], v[88:91]
    v_mfma_f32_16x16x32_bf16 v[92:95], a[88:91], v[164:167], v[92:95]
    v_mfma_f32_16x16x32_bf16 v[96:99], a[92:95], v[160:163], v[96:99]
    v_mfma_f32_16x16x32_bf16 v[100:103], a[92:95], v[164:167], v[100:103]
    v_mfma_f32_16x16x32_bf16 v[104:107], a[96:99], v[160:163], v[104:107]
    v_mfma_f32_16x16x32_bf16 v[108:111], a[96:99], v[164:167], v[108:111]
    v_mfma_f32_16x16x32_bf16 v[112:115], a[100:103], v[160:163], v[112:115]
    v_mfma_f32_16x16x32_bf16 v[116:119], a[100:103], v[164:167], v[116:119]
    v_mfma_f32_16x16x32_bf16 v[120:123], a[104:107], v[160:163], v[120:123]
    v_mfma_f32_16x16x32_bf16 v[124:127], a[104:107], v[164:167], v[124:127]
    v_mfma_f32_16x16x32_bf16 v[128:131], a[108:111], v[160:163], v[128:131]
    v_mfma_f32_16x16x32_bf16 v[132:135], a[108:111], v[164:167], v[132:135]
    v_mov_b32 v16, v184
    s_nop 1
    v_permlane16_swap_b32 v184, v16
    v_add_f32 v184, v184, v16
    v_mov_b32 v16, v184
    s_nop 1
    v_permlane32_swap_b32 v184, v16
    v_add_f32 v184, v184, v16
    v_mov_b32 v16, v185
    s_nop 1
    v_permlane16_swap_b32 v185, v16
    v_add_f32 v185, v185, v16
    v_mov_b32 v16, v185
    s_nop 1
    v_permlane32_swap_b32 v185, v16
    v_add_f32 v185, v185, v16
    s_mul_i32 s14, s9, 28
    s_mul_i32 s15, s10, 7
    s_add_u32 s14, s14, s15
    s_lshl_b32 s14, s14, 11
    s_add_u32 s14, s14, 0x5c00000
    s_add_u32 s28, s4, s14
    s_addc_u32 s29, s5, 0
    s_waitcnt vmcnt(0)
    v_lshlrev_b32 v247, 16, v247
    v_sub_f32 v160, v247, v184
    v_mov_b32 v161, v160
    v_lshlrev_b32 v248, 16, v248
    v_sub_f32 v162, v248, v185
    v_mov_b32 v163, v162
    v_pk_add_f32 v[24:25], v[24:25], v[160:161]
    v_pk_add_f32 v[26:27], v[26:27], v[160:161]
    v_lshlrev_b32 v136, 16, v186
    v_and_b32 v137, 0xffff0000, v186
    v_lshlrev_b32 v138, 16, v187
    v_and_b32 v139, 0xffff0000, v187
    v_pk_mul_f32 v[24:25], v[24:25], v[136:137]
    v_pk_mul_f32 v[26:27], v[26:27], v[138:139]
    v_cvt_pk_bf16_f32 v144, v24, v25
    v_cvt_pk_bf16_f32 v145, v26, v27
    v_pk_add_f32 v[32:33], v[32:33], v[160:161]
    v_pk_add_f32 v[34:35], v[34:35], v[160:161]
    v_lshlrev_b32 v136, 16, v190
    v_and_b32 v137, 0xffff0000, v190
    v_lshlrev_b32 v138, 16, v191
    v_and_b32 v139, 0xffff0000, v191
    v_pk_mul_f32 v[32:33], v[32:33], v[136:137]
    v_pk_mul_f32 v[34:35], v[34:35], v[138:139]
    v_cvt_pk_bf16_f32 v146, v32, v33
    v_cvt_pk_bf16_f32 v147, v34, v35
    global_store_dwordx4 v1, v[144:147], s[28:29] offset:0 sc1
    v_pk_add_f32 v[28:29], v[28:29], v[162:163]
    v_pk_add_f32 v[30:31], v[30:31], v[162:163]
    v_lshlrev_b32 v136, 16, v188
    v_and_b32 v137, 0xffff0000, v188
    v_lshlrev_b32 v138, 16, v189
    v_and_b32 v139, 0xffff0000, v189
    v_pk_mul_f32 v[28:29], v[28:29], v[136:137]
    v_pk_mul_f32 v[30:31], v[30:31], v[138:139]
    v_cvt_pk_bf16_f32 v148, v28, v29
    v_cvt_pk_bf16_f32 v149, v30, v31
    v_pk_add_f32 v[36:37], v[36:37], v[162:163]
    v_pk_add_f32 v[38:39], v[38:39], v[162:163]
    v_lshlrev_b32 v136, 16, v192
    v_and_b32 v137, 0xffff0000, v192
    v_lshlrev_b32 v138, 16, v193
    v_and_b32 v139, 0xffff0000, v193
    v_pk_mul_f32 v[36:37], v[36:37], v[136:137]
    v_pk_mul_f32 v[38:39], v[38:39], v[138:139]
    v_cvt_pk_bf16_f32 v150, v36, v37
    v_cvt_pk_bf16_f32 v151, v38, v39
    global_store_dwordx4 v1, v[148:151], s[28:29] offset:1024 sc1
    v_pk_add_f32 v[40:41], v[40:41], v[160:161]
    v_pk_add_f32 v[42:43], v[42:43], v[160:161]
    v_lshlrev_b32 v136, 16, v194
    v_and_b32 v137, 0xffff0000, v194
    v_lshlrev_b32 v138, 16, v195
    v_and_b32 v139, 0xffff0000, v195
    v_pk_mul_f32 v[40:41], v[40:41], v[136:137]
    v_pk_mul_f32 v[42:43], v[42:43], v[138:139]
    v_cvt_pk_bf16_f32 v152, v40, v41
    v_cvt_pk_bf16_f32 v153, v42, v43
    v_pk_add_f32 v[48:49], v[48:49], v[160:161]
    v_pk_add_f32 v[50:51], v[50:51], v[160:161]
    v_lshlrev_b32 v136, 16, v198
    v_and_b32 v137, 0xffff0000, v198
    v_lshlrev_b32 v138, 16, v199
    v_and_b32 v139, 0xffff0000, v199
    v_pk_mul_f32 v[48:49], v[48:49], v[136:137]
    v_pk_mul_f32 v[50:51], v[50:51], v[138:139]
    v_cvt_pk_bf16_f32 v154, v48, v49
    v_cvt_pk_bf16_f32 v155, v50, v51
    global_store_dwordx4 v1, v[152:155], s[28:29] offset:2048 sc1
    v_pk_add_f32 v[44:45], v[44:45], v[162:163]
    v_pk_add_f32 v[46:47], v[46:47], v[162:163]
    v_lshlrev_b32 v136, 16, v196
    v_and_b32 v137, 0xffff0000, v196
    v_lshlrev_b32 v138, 16, v197
    v_and_b32 v139, 0xffff0000, v197
    v_pk_mul_f32 v[44:45], v[44:45], v[136:137]
    v_pk_mul_f32 v[46:47], v[46:47], v[138:139]
    v_cvt_pk_bf16_f32 v156, v44, v45
    v_cvt_pk_bf16_f32 v157, v46, v47
    v_pk_add_f32 v[52:53], v[52:53], v[162:163]
    v_pk_add_f32 v[54:55], v[54:55], v[162:163]
    v_lshlrev_b32 v136, 16, v200
    v_and_b32 v137, 0xffff0000, v200
    v_lshlrev_b32 v138, 16, v201
    v_and_b32 v139, 0xffff0000, v201
    v_pk_mul_f32 v[52:53], v[52:53], v[136:137]
    v_pk_mul_f32 v[54:55], v[54:55], v[138:139]
    v_cvt_pk_bf16_f32 v158, v52, v53
    v_cvt_pk_bf16_f32 v159, v54, v55
    global_store_dwordx4 v1, v[156:159], s[28:29] offset:3072 sc1
    v_pk_add_f32 v[56:57], v[56:57], v[160:161]
    v_pk_add_f32 v[58:59], v[58:59], v[160:161]
    v_lshlrev_b32 v136, 16, v202
    v_and_b32 v137, 0xffff0000, v202
    v_lshlrev_b32 v138, 16, v203
    v_and_b32 v139, 0xffff0000, v203
    v_pk_mul_f32 v[56:57], v[56:57], v[136:137]
    v_pk_mul_f32 v[58:59], v[58:59], v[138:139]
    v_cvt_pk_bf16_f32 v144, v56, v57
    v_cvt_pk_bf16_f32 v145, v58, v59
    v_pk_add_f32 v[64:65], v[64:65], v[160:161]
    v_pk_add_f32 v[66:67], v[66:67], v[160:161]
    v_lshlrev_b32 v136, 16, v206
    v_and_b32 v137, 0xffff0000, v206
    v_lshlrev_b32 v138, 16, v207
    v_and_b32 v139, 0xffff0000, v207
    v_pk_mul_f32 v[64:65], v[64:65], v[136:137]
    v_pk_mul_f32 v[66:67], v[66:67], v[138:139]
    v_cvt_pk_bf16_f32 v146, v64, v65
    v_cvt_pk_bf16_f32 v147, v66, v67
    global_store_dwordx4 v7, v[144:147], s[28:29] offset:0 sc1
    v_pk_add_f32 v[60:61], v[60:61], v[162:163]
    v_pk_add_f32 v[62:63], v[62:63], v[162:163]
    v_lshlrev_b32 v136, 16, v204
    v_and_b32 v137, 0xffff0000, v204
    v_lshlrev_b32 v138, 16, v205
    v_and_b32 v139, 0xffff0000, v205
    v_pk_mul_f32 v[60:61], v[60:61], v[136:137]
    v_pk_mul_f32 v[62:63], v[62:63], v[138:139]
    v_cvt_pk_bf16_f32 v148, v60, v61
    v_cvt_pk_bf16_f32 v149, v62, v63
    v_pk_add_f32 v[68:69], v[68:69], v[162:163]
    v_pk_add_f32 v[70:71], v[70:71], v[162:163]
    v_lshlrev_b32 v136, 16, v208
    v_and_b32 v137, 0xffff0000, v208
    v_lshlrev_b32 v138, 16, v209
    v_and_b32 v139, 0xffff0000, v209
    v_pk_mul_f32 v[68:69], v[68:69], v[136:137]
    v_pk_mul_f32 v[70:71], v[70:71], v[138:139]
    v_cvt_pk_bf16_f32 v150, v68, v69
    v_cvt_pk_bf16_f32 v151, v70, v71
    global_store_dwordx4 v7, v[148:151], s[28:29] offset:1024 sc1
    v_pk_add_f32 v[72:73], v[72:73], v[160:161]
    v_pk_add_f32 v[74:75], v[74:75], v[160:161]
    v_lshlrev_b32 v136, 16, v210
    v_and_b32 v137, 0xffff0000, v210
    v_lshlrev_b32 v138, 16, v211
    v_and_b32 v139, 0xffff0000, v211
    v_pk_mul_f32 v[72:73], v[72:73], v[136:137]
    v_pk_mul_f32 v[74:75], v[74:75], v[138:139]
    v_cvt_pk_bf16_f32 v152, v72, v73
    v_cvt_pk_bf16_f32 v153, v74, v75
    v_pk_add_f32 v[80:81], v[80:81], v[160:161]
    v_pk_add_f32 v[82:83], v[82:83], v[160:161]
    v_lshlrev_b32 v136, 16, v214
    v_and_b32 v137, 0xffff0000, v214
    v_lshlrev_b32 v138, 16, v215
    v_and_b32 v139, 0xffff0000, v215
    v_pk_mul_f32 v[80:81], v[80:81], v[136:137]
    v_pk_mul_f32 v[82:83], v[82:83], v[138:139]
    v_cvt_pk_bf16_f32 v154, v80, v81
    v_cvt_pk_bf16_f32 v155, v82, v83
    global_store_dwordx4 v7, v[152:155], s[28:29] offset:2048 sc1
    v_pk_add_f32 v[76:77], v[76:77], v[162:163]
    v_pk_add_f32 v[78:79], v[78:79], v[162:163]
    v_lshlrev_b32 v136, 16, v212
    v_and_b32 v137, 0xffff0000, v212
    v_lshlrev_b32 v138, 16, v213
    v_and_b32 v139, 0xffff0000, v213
    v_pk_mul_f32 v[76:77], v[76:77], v[136:137]
    v_pk_mul_f32 v[78:79], v[78:79], v[138:139]
    v_cvt_pk_bf16_f32 v156, v76, v77
    v_cvt_pk_bf16_f32 v157, v78, v79
    v_pk_add_f32 v[84:85], v[84:85], v[162:163]
    v_pk_add_f32 v[86:87], v[86:87], v[162:163]
    v_lshlrev_b32 v136, 16, v216
    v_and_b32 v137, 0xffff0000, v216
    v_lshlrev_b32 v138, 16, v217
    v_and_b32 v139, 0xffff0000, v217
    v_pk_mul_f32 v[84:85], v[84:85], v[136:137]
    v_pk_mul_f32 v[86:87], v[86:87], v[138:139]
    v_cvt_pk_bf16_f32 v158, v84, v85
    v_cvt_pk_bf16_f32 v159, v86, v87
    global_store_dwordx4 v7, v[156:159], s[28:29] offset:3072 sc1
    v_pk_add_f32 v[88:89], v[88:89], v[160:161]
    v_pk_add_f32 v[90:91], v[90:91], v[160:161]
    v_lshlrev_b32 v136, 16, v218
    v_and_b32 v137, 0xffff0000, v218
    v_lshlrev_b32 v138, 16, v219
    v_and_b32 v139, 0xffff0000, v219
    v_pk_mul_f32 v[88:89], v[88:89], v[136:137]
    v_pk_mul_f32 v[90:91], v[90:91], v[138:139]
    v_cvt_pk_bf16_f32 v144, v88, v89
    v_cvt_pk_bf16_f32 v145, v90, v91
    v_pk_add_f32 v[96:97], v[96:97], v[160:161]
    v_pk_add_f32 v[98:99], v[98:99], v[160:161]
    v_lshlrev_b32 v136, 16, v222
    v_and_b32 v137, 0xffff0000, v222
    v_lshlrev_b32 v138, 16, v223
    v_and_b32 v139, 0xffff0000, v223
    v_pk_mul_f32 v[96:97], v[96:97], v[136:137]
    v_pk_mul_f32 v[98:99], v[98:99], v[138:139]
    v_cvt_pk_bf16_f32 v146, v96, v97
    v_cvt_pk_bf16_f32 v147, v98, v99
    global_store_dwordx4 v8, v[144:147], s[28:29] offset:0 sc1
    v_pk_add_f32 v[92:93], v[92:93], v[162:163]
    v_pk_add_f32 v[94:95], v[94:95], v[162:163]
    v_lshlrev_b32 v136, 16, v220
    v_and_b32 v137, 0xffff0000, v220
    v_lshlrev_b32 v138, 16, v221
    v_and_b32 v139, 0xffff0000, v221
    v_pk_mul_f32 v[92:93], v[92:93], v[136:137]
    v_pk_mul_f32 v[94:95], v[94:95], v[138:139]
    v_cvt_pk_bf16_f32 v148, v92, v93
    v_cvt_pk_bf16_f32 v149, v94, v95
    v_pk_add_f32 v[100:101], v[100:101], v[162:163]
    v_pk_add_f32 v[102:103], v[102:103], v[162:163]
    v_lshlrev_b32 v136, 16, v224
    v_and_b32 v137, 0xffff0000, v224
    v_lshlrev_b32 v138, 16, v225
    v_and_b32 v139, 0xffff0000, v225
    v_pk_mul_f32 v[100:101], v[100:101], v[136:137]
    v_pk_mul_f32 v[102:103], v[102:103], v[138:139]
    v_cvt_pk_bf16_f32 v150, v100, v101
    v_cvt_pk_bf16_f32 v151, v102, v103
    global_store_dwordx4 v8, v[148:151], s[28:29] offset:1024 sc1
    v_pk_add_f32 v[104:105], v[104:105], v[160:161]
    v_pk_add_f32 v[106:107], v[106:107], v[160:161]
    v_lshlrev_b32 v136, 16, v226
    v_and_b32 v137, 0xffff0000, v226
    v_lshlrev_b32 v138, 16, v227
    v_and_b32 v139, 0xffff0000, v227
    v_pk_mul_f32 v[104:105], v[104:105], v[136:137]
    v_pk_mul_f32 v[106:107], v[106:107], v[138:139]
    v_cvt_pk_bf16_f32 v152, v104, v105
    v_cvt_pk_bf16_f32 v153, v106, v107
    v_pk_add_f32 v[112:113], v[112:113], v[160:161]
    v_pk_add_f32 v[114:115], v[114:115], v[160:161]
    v_lshlrev_b32 v136, 16, v230
    v_and_b32 v137, 0xffff0000, v230
    v_lshlrev_b32 v138, 16, v231
    v_and_b32 v139, 0xffff0000, v231
    v_pk_mul_f32 v[112:113], v[112:113], v[136:137]
    v_pk_mul_f32 v[114:115], v[114:115], v[138:139]
    v_cvt_pk_bf16_f32 v154, v112, v113
    v_cvt_pk_bf16_f32 v155, v114, v115
    global_store_dwordx4 v8, v[152:155], s[28:29] offset:2048 sc1
    v_pk_add_f32 v[108:109], v[108:109], v[162:163]
    v_pk_add_f32 v[110:111], v[110:111], v[162:163]
    v_lshlrev_b32 v136, 16, v228
    v_and_b32 v137, 0xffff0000, v228
    v_lshlrev_b32 v138, 16, v229
    v_and_b32 v139, 0xffff0000, v229
    v_pk_mul_f32 v[108:109], v[108:109], v[136:137]
    v_pk_mul_f32 v[110:111], v[110:111], v[138:139]
    v_cvt_pk_bf16_f32 v156, v108, v109
    v_cvt_pk_bf16_f32 v157, v110, v111
    v_pk_add_f32 v[116:117], v[116:117], v[162:163]
    v_pk_add_f32 v[118:119], v[118:119], v[162:163]
    v_lshlrev_b32 v136, 16, v232
    v_and_b32 v137, 0xffff0000, v232
    v_lshlrev_b32 v138, 16, v233
    v_and_b32 v139, 0xffff0000, v233
    v_pk_mul_f32 v[116:117], v[116:117], v[136:137]
    v_pk_mul_f32 v[118:119], v[118:119], v[138:139]
    v_cvt_pk_bf16_f32 v158, v116, v117
    v_cvt_pk_bf16_f32 v159, v118, v119
    global_store_dwordx4 v8, v[156:159], s[28:29] offset:3072 sc1
    v_pk_add_f32 v[120:121], v[120:121], v[160:161]
    v_pk_add_f32 v[122:123], v[122:123], v[160:161]
    v_lshlrev_b32 v136, 16, v234
    v_and_b32 v137, 0xffff0000, v234
    v_lshlrev_b32 v138, 16, v235
    v_and_b32 v139, 0xffff0000, v235
    v_pk_mul_f32 v[120:121], v[120:121], v[136:137]
    v_pk_mul_f32 v[122:123], v[122:123], v[138:139]
    v_cvt_pk_bf16_f32 v144, v120, v121
    v_cvt_pk_bf16_f32 v145, v122, v123
    v_pk_add_f32 v[128:129], v[128:129], v[160:161]
    v_pk_add_f32 v[130:131], v[130:131], v[160:161]
    v_lshlrev_b32 v136, 16, v238
    v_and_b32 v137, 0xffff0000, v238
    v_lshlrev_b32 v138, 16, v239
    v_and_b32 v139, 0xffff0000, v239
    v_pk_mul_f32 v[128:129], v[128:129], v[136:137]
    v_pk_mul_f32 v[130:131], v[130:131], v[138:139]
    v_cvt_pk_bf16_f32 v146, v128, v129
    v_cvt_pk_bf16_f32 v147, v130, v131
    global_store_dwordx4 v9, v[144:147], s[28:29] offset:0 sc1
    v_pk_add_f32 v[124:125], v[124:125], v[162:163]
    v_pk_add_f32 v[126:127], v[126:127], v[162:163]
    v_lshlrev_b32 v136, 16, v236
    v_and_b32 v137, 0xffff0000, v236
    v_lshlrev_b32 v138, 16, v237
    v_and_b32 v139, 0xffff0000, v237
    v_pk_mul_f32 v[124:125], v[124:125], v[136:137]
    v_pk_mul_f32 v[126:127], v[126:127], v[138:139]
    v_cvt_pk_bf16_f32 v148, v124, v125
    v_cvt_pk_bf16_f32 v149, v126, v127
    v_pk_add_f32 v[132:133], v[132:133], v[162:163]
    v_pk_add_f32 v[134:135], v[134:135], v[162:163]
    v_lshlrev_b32 v136, 16, v240
    v_and_b32 v137, 0xffff0000, v240
    v_lshlrev_b32 v138, 16, v241
    v_and_b32 v139, 0xffff0000, v241
    v_pk_mul_f32 v[132:133], v[132:133], v[136:137]
    v_pk_mul_f32 v[134:135], v[134:135], v[138:139]
    v_cvt_pk_bf16_f32 v150, v132, v133
    v_cvt_pk_bf16_f32 v151, v134, v135
    global_store_dwordx4 v9, v[148:151], s[28:29] offset:1024 sc1
    s_waitcnt vmcnt(0)
    s_barrier
    s_lshl_b32 s14, s9, 7
    s_add_u32 s14, s14, 0x150e000
    s_add_u32 s24, s4, s14
    s_addc_u32 s25, s5, 0
    s_cmp_lg_u32 s10, 0
    s_cbranch_scc1 sequential_preLN__memory_aug_recurrent_mem_tr__mixer_gmlp__prompt_kernel_GA_yflag
    s_mov_b64 exec, 1
    global_atomic_add v5, v6, s[24:25] offset:0
    s_mov_b64 exec, -1
    s_nop 4
sequential_preLN__memory_aug_recurrent_mem_tr__mixer_gmlp__prompt_kernel_GA_yflag:
    s_mov_b32 s30, 63
    s_cmp_ge_u32 s56, 224
    s_cbranch_scc1 sequential_preLN__memory_aug_recurrent_mem_tr__mixer_gmlp__prompt_kernel_DL_end
    s_branch sequential_preLN__memory_aug_recurrent_mem_tr__mixer_gmlp__prompt_kernel_DL
sequential_preLN__memory_aug_recurrent_mem_tr__mixer_gmlp__prompt_kernel_DLR:
    s_cmp_lg_u32 s10, 0
    s_cbranch_scc1 sequential_preLN__memory_aug_recurrent_mem_tr__mixer_gmlp__prompt_kernel_DL_all_pwj
    s_mov_b32 s13, 131072
    s_add_u32 s76, s4, 0x1580000
    s_addc_u32 s77, s5, 0
    v_mbcnt_lo_u32_b32 v20, -1, 0
    v_mbcnt_hi_u32_b32 v20, -1, v20
    v_lshlrev_b32 v20, 4, v20
    s_nop 1
sequential_preLN__memory_aug_recurrent_mem_tr__mixer_gmlp__prompt_kernel_DL_all_pw:
    global_load_dwordx4 v[22:25], v20, s[76:77] sc1
    s_waitcnt vmcnt(0)
    v_xor_b32 v22, s78, v22
    v_xor_b32 v23, s78, v23
    v_xor_b32 v24, s78, v24
    v_xor_b32 v25, s78, v25
    v_or_b32 v22, v22, v23
    v_or_b32 v24, v24, v25
    v_or_b32 v22, v22, v24
    v_cmp_ne_u32 vcc, 0, v22
    s_nop 0
    s_cbranch_vccz sequential_preLN__memory_aug_recurrent_mem_tr__mixer_gmlp__prompt_kernel_DL_all_pwok
    s_sleep 16
    s_sub_u32 s13, s13, 1
    s_cbranch_scc0 sequential_preLN__memory_aug_recurrent_mem_tr__mixer_gmlp__prompt_kernel_DL_all_pw
    s_endpgm
sequential_preLN__memory_aug_recurrent_mem_tr__mixer_gmlp__prompt_kernel_DL_all_pwok:
    buffer_inv sc1
    s_waitcnt vmcnt(0)
sequential_preLN__memory_aug_recurrent_mem_tr__mixer_gmlp__prompt_kernel_DL_all_pwj:
    s_barrier
sequential_preLN__memory_aug_recurrent_mem_tr__mixer_gmlp__prompt_kernel_DL0:
    s_mov_b32 s13, 131072
    v_mbcnt_lo_u32_b32 v20, -1, 0
    v_mbcnt_hi_u32_b32 v20, -1, v20
    v_and_b32 v20, 7, v20
    v_lshlrev_b32 v20, 5, v20
    s_nop 1
sequential_preLN__memory_aug_recurrent_mem_tr__mixer_gmlp__prompt_kernel_DLa_rc:
    global_load_dword v21, v20, s[6:7] sc1
    s_waitcnt vmcnt(0)
    v_readlane_b32 s68, v21, 0
    v_readlane_b32 s69, v21, 1
    v_readlane_b32 s70, v21, 2
    v_readlane_b32 s71, v21, 3
    v_readlane_b32 s72, v21, 4
    v_readlane_b32 s73, v21, 5
    v_readlane_b32 s74, v21, 6
    v_readlane_b32 s75, v21, 7
    s_add_u32 s14, s68, s69
    s_add_u32 s14, s14, s70
    s_add_u32 s14, s14, s71
    s_add_u32 s14, s14, s72
    s_add_u32 s14, s14, s73
    s_add_u32 s14, s14, s74
    s_add_u32 s14, s14, s75
    s_cmp_ge_u32 s14, 256
    s_cbranch_scc1 sequential_preLN__memory_aug_recurrent_mem_tr__mixer_gmlp__prompt_kernel_DLa_rcok
    s_sleep 1
    s_sub_u32 s13, s13, 1
    s_cbranch_scc0 sequential_preLN__memory_aug_recurrent_mem_tr__mixer_gmlp__prompt_kernel_DLa_rc
    s_endpgm
sequential_preLN__memory_aug_recurrent_mem_tr__mixer_gmlp__prompt_kernel_DLa_rcok:
    s_mul_i32 s56, s3, 28
    s_add_u32 s56, s56, s79
    s_cmp_lt_u32 s79, 28
    s_cselect_b32 s15, 1, 0
    s_cmp_lt_u32 s3, 8
    s_cselect_b32 s14, s15, 0
    s_cmp_lg_u32 s14, 0
    s_cbranch_scc1 sequential_preLN__memory_aug_recurrent_mem_tr__mixer_gmlp__prompt_kernel_DLa_dad
    s_sub_u32 s76, s79, 28
    s_cmp_lt_u32 s3, 8
    s_cselect_b32 s76, s76, 0x1000
    s_max_u32 s14, s68, 28
    s_sub_u32 s14, s14, 28
    s_cmp_gt_u32 s3, 0
    s_cselect_b32 s14, s14, 0
    s_add_u32 s76, s76, s14
    s_max_u32 s14, s69, 28
    s_sub_u32 s14, s14, 28
    s_cmp_gt_u32 s3, 1
    s_cselect_b32 s14, s14, 0
    s_add_u32 s76, s76, s14
    s_max_u32 s14, s70, 28
    s_sub_u32 s14, s14, 28
    s_cmp_gt_u32 s3, 2
    s_cselect_b32 s14, s14, 0
    s_add_u32 s76, s76, s14
    s_max_u32 s14, s71, 28
    s_sub_u32 s14, s14, 28
    s_cmp_gt_u32 s3, 3
    s_cselect_b32 s14, s14, 0
    s_add_u32 s76, s76, s14
    s_max_u32 s14, s72, 28
    s_sub_u32 s14, s14, 28
    s_cmp_gt_u32 s3, 4
    s_cselect_b32 s14, s14, 0
    s_add_u32 s76, s76, s14
    s_max_u32 s14, s73, 28
    s_sub_u32 s14, s14, 28
    s_cmp_gt_u32 s3, 5
    s_cselect_b32 s14, s14, 0
    s_add_u32 s76, s76, s14
    s_max_u32 s14, s74, 28
    s_sub_u32 s14, s14, 28
    s_cmp_gt_u32 s3, 6
    s_cselect_b32 s14, s14, 0
    s_add_u32 s76, s76, s14
    s_max_u32 s14, s75, 28
    s_sub_u32 s14, s14, 28
    s_cmp_gt_u32 s3, 7
    s_cselect_b32 s14, s14, 0
    s_add_u32 s76, s76, s14
    s_mov_b32 s56, 224
    s_min_u32 s14, s68, 28
    s_sub_u32 s15, 28, s14
    s_cmp_lt_u32 s76, s15
    s_cbranch_scc0 sequential_preLN__memory_aug_recurrent_mem_tr__mixer_gmlp__prompt_kernel_DLa_dn0
    s_add_u32 s56, s14, s76
    s_add_u32 s56, s56, 0
    s_branch sequential_preLN__memory_aug_recurrent_mem_tr__mixer_gmlp__prompt_kernel_DLa_dad
sequential_preLN__memory_aug_recurrent_mem_tr__mixer_gmlp__prompt_kernel_DLa_dn0:
    s_sub_u32 s76, s76, s15
    s_min_u32 s14, s69, 28
    s_sub_u32 s15, 28, s14
    s_cmp_lt_u32 s76, s15
    s_cbranch_scc0 sequential_preLN__memory_aug_recurrent_mem_tr__mixer_gmlp__prompt_kernel_DLa_dn1
    s_add_u32 s56, s14, s76
    s_add_u32 s56, s56, 28
    s_branch sequential_preLN__memory_aug_recurrent_mem_tr__mixer_gmlp__prompt_kernel_DLa_dad
sequential_preLN__memory_aug_recurrent_mem_tr__mixer_gmlp__prompt_kernel_DLa_dn1:
    s_sub_u32 s76, s76, s15
    s_min_u32 s14, s70, 28
    s_sub_u32 s15, 28, s14
    s_cmp_lt_u32 s76, s15
    s_cbranch_scc0 sequential_preLN__memory_aug_recurrent_mem_tr__mixer_gmlp__prompt_kernel_DLa_dn2
    s_add_u32 s56, s14, s76
    s_add_u32 s56, s56, 56
    s_branch sequential_preLN__memory_aug_recurrent_mem_tr__mixer_gmlp__prompt_kernel_DLa_dad
sequential_preLN__memory_aug_recurrent_mem_tr__mixer_gmlp__prompt_kernel_DLa_dn2:
    s_sub_u32 s76, s76, s15
    s_min_u32 s14, s71, 28
    s_sub_u32 s15, 28, s14
    s_cmp_lt_u32 s76, s15
    s_cbranch_scc0 sequential_preLN__memory_aug_recurrent_mem_tr__mixer_gmlp__prompt_kernel_DLa_dn3
    s_add_u32 s56, s14, s76
    s_add_u32 s56, s56, 84
    s_branch sequential_preLN__memory_aug_recurrent_mem_tr__mixer_gmlp__prompt_kernel_DLa_dad
sequential_preLN__memory_aug_recurrent_mem_tr__mixer_gmlp__prompt_kernel_DLa_dn3:
    s_sub_u32 s76, s76, s15
    s_min_u32 s14, s72, 28
    s_sub_u32 s15, 28, s14
    s_cmp_lt_u32 s76, s15
    s_cbranch_scc0 sequential_preLN__memory_aug_recurrent_mem_tr__mixer_gmlp__prompt_kernel_DLa_dn4
    s_add_u32 s56, s14, s76
    s_add_u32 s56, s56, 112
    s_branch sequential_preLN__memory_aug_recurrent_mem_tr__mixer_gmlp__prompt_kernel_DLa_dad
sequential_preLN__memory_aug_recurrent_mem_tr__mixer_gmlp__prompt_kernel_DLa_dn4:
    s_sub_u32 s76, s76, s15
    s_min_u32 s14, s73, 28
    s_sub_u32 s15, 28, s14
    s_cmp_lt_u32 s76, s15
    s_cbranch_scc0 sequential_preLN__memory_aug_recurrent_mem_tr__mixer_gmlp__prompt_kernel_DLa_dn5
    s_add_u32 s56, s14, s76
    s_add_u32 s56, s56, 140
    s_branch sequential_preLN__memory_aug_recurrent_mem_tr__mixer_gmlp__prompt_kernel_DLa_dad
sequential_preLN__memory_aug_recurrent_mem_tr__mixer_gmlp__prompt_kernel_DLa_dn5:
    s_sub_u32 s76, s76, s15
    s_min_u32 s14, s74, 28
    s_sub_u32 s15, 28, s14
    s_cmp_lt_u32 s76, s15
    s_cbranch_scc0 sequential_preLN__memory_aug_recurrent_mem_tr__mixer_gmlp__prompt_kernel_DLa_dn6
    s_add_u32 s56, s14, s76
    s_add_u32 s56, s56, 168
    s_branch sequential_preLN__memory_aug_recurrent_mem_tr__mixer_gmlp__prompt_kernel_DLa_dad
sequential_preLN__memory_aug_recurrent_mem_tr__mixer_gmlp__prompt_kernel_DLa_dn6:
    s_sub_u32 s76, s76, s15
    s_min_u32 s14, s75, 28
    s_sub_u32 s15, 28, s14
    s_cmp_lt_u32 s76, s15
    s_cbranch_scc0 sequential_preLN__memory_aug_recurrent_mem_tr__mixer_gmlp__prompt_kernel_DLa_dn7
    s_add_u32 s56, s14, s76
    s_add_u32 s56, s56, 196
    s_branch sequential_preLN__memory_aug_recurrent_mem_tr__mixer_gmlp__prompt_kernel_DLa_dad
sequential_preLN__memory_aug_recurrent_mem_tr__mixer_gmlp__prompt_kernel_DLa_dn7:
    s_sub_u32 s76, s76, s15
sequential_preLN__memory_aug_recurrent_mem_tr__mixer_gmlp__prompt_kernel_DLa_dad:
    s_cmp_ge_u32 s56, 224
    s_cbranch_scc1 sequential_preLN__memory_aug_recurrent_mem_tr__mixer_gmlp__prompt_kernel_DL_end
    v_mbcnt_lo_u32_b32 v0, -1, 0
    v_mbcnt_hi_u32_b32 v0, -1, v0
    v_lshlrev_b32 v1, 4, v0
    s_mul_i32 s57, s56, 9363
    s_lshr_b32 s57, s57, 16
    s_mul_i32 s58, s57, 7
    s_sub_u32 s58, s56, s58
    s_lshl_b32 s59, s58, 2
    s_add_u32 s59, s59, s10
    s_mul_i32 s14, s59, 28672
    s_add_u32 s14, s14, 0x1b00000
    s_add_u32 s60, s4, s14
    s_addc_u32 s61, s5, 0
    s_mul_i32 s15, s10, 28672
    s_add_u32 s15, s15, 12288
    s_add_u32 m0, s15, 0
    s_nop 0
    global_load_lds_dwordx4 v1, s[60:61] offset:0
    global_load_lds_dwordx4 v1, s[60:61] offset:1024
    global_load_lds_dwordx4 v1, s[60:61] offset:2048
    global_load_lds_dwordx4 v1, s[60:61] offset:3072
    s_add_u32 m0, s15, 4096
    s_add_u32 s60, s60, 4096
    s_addc_u32 s61, s61, 0
    global_load_lds_dwordx4 v1, s[60:61] offset:0
    global_load_lds_dwordx4 v1, s[60:61] offset:1024
    global_load_lds_dwordx4 v1, s[60:61] offset:2048
    global_load_lds_dwordx4 v1, s[60:61] offset:3072
    s_add_u32 m0, s15, 8192
    s_add_u32 s60, s60, 4096
    s_addc_u32 s61, s61, 0
    global_load_lds_dwordx4 v1, s[60:61] offset:0
    global_load_lds_dwordx4 v1, s[60:61] offset:1024
    global_load_lds_dwordx4 v1, s[60:61] offset:2048
    global_load_lds_dwordx4 v1, s[60:61] offset:3072
    s_add_u32 m0, s15, 12288
    s_add_u32 s60, s60, 4096
    s_addc_u32 s61, s61, 0
    global_load_lds_dwordx4 v1, s[60:61] offset:0
    global_load_lds_dwordx4 v1, s[60:61] offset:1024
    global_load_lds_dwordx4 v1, s[60:61] offset:2048
    global_load_lds_dwordx4 v1, s[60:61] offset:3072
    s_add_u32 m0, s15, 16384
    s_add_u32 s60, s60, 4096
    s_addc_u32 s61, s61, 0
    global_load_lds_dwordx4 v1, s[60:61] offset:0
    global_load_lds_dwordx4 v1, s[60:61] offset:1024
    global_load_lds_dwordx4 v1, s[60:61] offset:2048
    global_load_lds_dwordx4 v1, s[60:61] offset:3072
    s_add_u32 m0, s15, 20480
    s_add_u32 s60, s60, 4096
    s_addc_u32 s61, s61, 0
    global_load_lds_dwordx4 v1, s[60:61] offset:0
    global_load_lds_dwordx4 v1, s[60:61] offset:1024
    global_load_lds_dwordx4 v1, s[60:61] offset:2048
    global_load_lds_dwordx4 v1, s[60:61] offset:3072
    s_add_u32 m0, s15, 24576
    s_add_u32 s60, s60, 4096
    s_addc_u32 s61, s61, 0
    global_load_lds_dwordx4 v1, s[60:61] offset:0
    global_load_lds_dwordx4 v1, s[60:61] offset:1024
    global_load_lds_dwordx4 v1, s[60:61] offset:2048
    global_load_lds_dwordx4 v1, s[60:61] offset:3072
    s_waitcnt vmcnt(0)
    s_barrier
sequential_preLN__memory_aug_recurrent_mem_tr__mixer_gmlp__prompt_kernel_DL:
    v_mbcnt_lo_u32_b32 v0, -1, 0
    v_mbcnt_hi_u32_b32 v0, -1, v0
    v_lshlrev_b32 v1, 4, v0
    s_load_dwordx2 s[62:63], s[0:1], 96
    v_mov_b32 v5, 0
    v_lshrrev_b32 v10, 3, v0
    v_mul_u32_u24 v10, 896, v10
    v_and_b32 v11, 7, v0
    v_lshlrev_b32 v11, 4, v11
    s_lshl_b32 s15, s58, 7
    s_mul_i32 s14, s57, 57344
    s_add_u32 s15, s15, s14
    s_mul_i32 s14, s10, 14336
    s_add_u32 s15, s15, s14
    v_add3_u32 v10, v10, v11, s15
    v_add_u32 v12, 7168, v10
    s_mul_i32 s14, s10, 2304
    s_add_u32 s14, s14, 2048
    v_and_b32 v13, 15, v0
    v_mul_u32_u24 v13, 144, v13
    v_lshrrev_b32 v14, 4, v0
    v_lshlrev_b32 v14, 3, v14
    v_add3_u32 v13, v13, v14, s14
    v_lshrrev_b32 v14, 3, v0
    v_mul_u32_u24 v14, 144, v14
    v_add3_u32 v14, v14, v11, s14
    s_lshr_b32 s16, s10, 1
    s_lshl_b32 s17, s57, 1
    s_add_u32 s16, s16, s17
    s_lshl_b32 s14, s16, 7
    s_add_u32 s14, s14, 0x150e000
    s_add_u32 s64, s4, s14
    s_addc_u32 s65, s5, 0
    s_mul_i32 s14, s16, 57344
    s_and_b32 s15, s10, 1
    s_lshl_b32 s15, s15, 10
    s_add_u32 s14, s14, s15
    s_add_u32 s14, s14, 0x5c00000
    s_add_u32 s66, s4, s14
    s_addc_u32 s67, s5, 0
    s_add_u32 s68, s4, 0x4c00000
    s_addc_u32 s69, s5, 0
    v_add_u32 v2, 12288, v1
    v_add_u32 v3, 69632, v1
    v_add_u32 v7, 0x800, v1
    s_lshl_b32 s14, s16, 7
    s_add_u32 s14, s14, 0x150a000
    s_add_u32 s70, s4, s14
    s_addc_u32 s71, s5, 0
    s_mov_b32 s13, 131072
sequential_preLN__memory_aug_recurrent_mem_tr__mixer_gmlp__prompt_kernel_DL_wh:
    global_load_dword v11, v5, s[70:71] offset:0 sc1
    s_waitcnt vmcnt(0)
    v_readfirstlane_b32 s14, v11
    s_nop 0
    s_cmp_ge_u32 s14, 7
    s_nop 1
    s_cbranch_scc1 sequential_preLN__memory_aug_recurrent_mem_tr__mixer_gmlp__prompt_kernel_DL_wh_ok
    s_sleep 16
    s_sub_u32 s13, s13, 1
    s_cbranch_scc0 sequential_preLN__memory_aug_recurrent_mem_tr__mixer_gmlp__prompt_kernel_DL_wh
    s_endpgm
sequential_preLN__memory_aug_recurrent_mem_tr__mixer_gmlp__prompt_kernel_DL_wh_ok:
    global_load_dwordx4 v[140:143], v10, s[68:69] sc1
    global_load_dwordx4 v[144:147], v12, s[68:69] sc1
    s_add_u32 s70, s4, 0x150df00
    s_addc_u32 s71, s5, 0
    s_mov_b32 s13, 131072
sequential_preLN__memory_aug_recurrent_mem_tr__mixer_gmlp__prompt_kernel_DL_wz:
    global_load_dword v11, v5, s[70:71] offset:0 sc1
    s_waitcnt vmcnt(0)
    v_readfirstlane_b32 s14, v11
    s_nop 0
    s_cmp_ge_u32 s14, 4
    s_nop 1
    s_cbranch_scc1 sequential_preLN__memory_aug_recurrent_mem_tr__mixer_gmlp__prompt_kernel_DL_wz_ok
    s_sleep 24
    s_sub_u32 s13, s13, 1
    s_cbranch_scc0 sequential_preLN__memory_aug_recurrent_mem_tr__mixer_gmlp__prompt_kernel_DL_wz
    s_endpgm
sequential_preLN__memory_aug_recurrent_mem_tr__mixer_gmlp__prompt_kernel_DL_wz_ok:
    s_mov_b32 s13, 131072
sequential_preLN__memory_aug_recurrent_mem_tr__mixer_gmlp__prompt_kernel_DL_w0:
    global_load_dword v11, v5, s[64:65] offset:0 sc1
    s_waitcnt vmcnt(0)
    v_readfirstlane_b32 s14, v11
    s_nop 0
    s_cmp_ge_u32 s14, 1
    s_nop 1
    s_cbranch_scc1 sequential_preLN__memory_aug_recurrent_mem_tr__mixer_gmlp__prompt_kernel_DL_w0_ok
    s_sleep 1
    s_sub_u32 s13, s13, 1
    s_cbranch_scc0 sequential_preLN__memory_aug_recurrent_mem_tr__mixer_gmlp__prompt_kernel_DL_w0
    s_endpgm
sequential_preLN__memory_aug_recurrent_mem_tr__mixer_gmlp__prompt_kernel_DL_w0_ok:
    s_mov_b32 s30, 58
    global_load_dwordx4 v[24:27], v1, s[66:67] sc1
    global_load_dwordx4 v[28:31], v7, s[66:67] sc1
    s_add_u32 s66, s66, 4096
    s_addc_u32 s67, s67, 0
    global_load_dwordx4 v[32:35], v1, s[66:67] sc1
    global_load_dwordx4 v[36:39], v7, s[66:67] sc1
    s_add_u32 s66, s66, 4096
    s_addc_u32 s67, s67, 0
    global_load_dwordx4 v[40:43], v1, s[66:67] sc1
    global_load_dwordx4 v[44:47], v7, s[66:67] sc1
    s_add_u32 s66, s66, 4096
    s_addc_u32 s67, s67, 0
    global_load_dwordx4 v[48:51], v1, s[66:67] sc1
    global_load_dwordx4 v[52:55], v7, s[66:67] sc1
    s_add_u32 s66, s66, 4096
    s_addc_u32 s67, s67, 0
    global_load_dwordx4 v[56:59], v1, s[66:67] sc1
    global_load_dwordx4 v[60:63], v7, s[66:67] sc1
    s_add_u32 s66, s66, 4096
    s_addc_u32 s67, s67, 0
    global_load_dwordx4 v[64:67], v1, s[66:67] sc1
    global_load_dwordx4 v[68:71], v7, s[66:67] sc1
    s_add_u32 s66, s66, 4096
    s_addc_u32 s67, s67, 0
    global_load_dwordx4 v[72:75], v1, s[66:67] sc1
    global_load_dwordx4 v[76:79], v7, s[66:67] sc1
    s_add_u32 s66, s66, 4096
    s_addc_u32 s67, s67, 0
    global_load_dwordx4 v[80:83], v1, s[66:67] sc1
    global_load_dwordx4 v[84:87], v7, s[66:67] sc1
    s_add_u32 s66, s66, 4096
    s_addc_u32 s67, s67, 0
    global_load_dwordx4 v[88:91], v1, s[66:67] sc1
    global_load_dwordx4 v[92:95], v7, s[66:67] sc1
    s_add_u32 s66, s66, 4096
    s_addc_u32 s67, s67, 0
    global_load_dwordx4 v[96:99], v1, s[66:67] sc1
    global_load_dwordx4 v[100:103], v7, s[66:67] sc1
    s_add_u32 s66, s66, 4096
    s_addc_u32 s67, s67, 0
    global_load_dwordx4 v[104:107], v1, s[66:67] sc1
    global_load_dwordx4 v[108:111], v7, s[66:67] sc1
    s_add_u32 s66, s66, 4096
    s_addc_u32 s67, s67, 0
    global_load_dwordx4 v[112:115], v1, s[66:67] sc1
    global_load_dwordx4 v[116:119], v7, s[66:67] sc1
    s_add_u32 s66, s66, 4096
    s_addc_u32 s67, s67, 0
    global_load_dwordx4 v[120:123], v1, s[66:67] sc1
    global_load_dwordx4 v[124:127], v7, s[66:67] sc1
    s_add_u32 s66, s66, 4096
    s_addc_u32 s67, s67, 0
    global_load_dwordx4 v[128:131], v1, s[66:67] sc1
    global_load_dwordx4 v[132:135], v7, s[66:67] sc1
    s_add_u32 s66, s66, 4096
    s_addc_u32 s67, s67, 0
    s_waitcnt lgkmcnt(0)
    ds_read_b128 v[166:169], v2 offset:0
    ds_read_b128 v[170:173], v2 offset:28672
    ds_read_b128 v[174:177], v3 offset:0
    ds_read_b128 v[178:181], v3 offset:28672
    ds_read_b128 v[182:185], v2 offset:1024
    ds_read_b128 v[186:189], v2 offset:29696
    s_waitcnt vmcnt(27)
    s_waitcnt lgkmcnt(5)
    v_mfma_f32_16x16x32_bf16 v[150:153], v[166:169], v[24:27], 0
    ds_read_b128 v[190:193], v3 offset:1024
    s_waitcnt lgkmcnt(5)
    v_mfma_f32_16x16x32_bf16 v[154:157], v[170:173], v[24:27], 0
    ds_read_b128 v[194:197], v3 offset:29696
    s_waitcnt lgkmcnt(5)
    v_mfma_f32_16x16x32_bf16 v[158:161], v[174:177], v[24:27], 0
    ds_read_b128 v[166:169], v2 offset:2048
    s_waitcnt lgkmcnt(5)
    v_mfma_f32_16x16x32_bf16 v[162:165], v[178:181], v[24:27], 0
    ds_read_b128 v[170:173], v2 offset:30720
    s_waitcnt vmcnt(26)
    s_waitcnt lgkmcnt(5)
    v_mfma_f32_16x16x32_bf16 v[150:153], v[182:185], v[28:31], v[150:153]
    ds_read_b128 v[174:177], v3 offset:2048
    s_waitcnt lgkmcnt(5)
    v_mfma_f32_16x16x32_bf16 v[154:157], v[186:189], v[28:31], v[154:157]
    ds_read_b128 v[178:181], v3 offset:30720
    s_waitcnt lgkmcnt(5)
    v_mfma_f32_16x16x32_bf16 v[158:161], v[190:193], v[28:31], v[158:161]
    ds_read_b128 v[182:185], v2 offset:3072
    s_waitcnt lgkmcnt(5)
    v_mfma_f32_16x16x32_bf16 v[162:165], v[194:197], v[28:31], v[162:165]
    ds_read_b128 v[186:189], v2 offset:31744
    s_waitcnt vmcnt(25)
    s_waitcnt lgkmcnt(5)
    v_mfma_f32_16x16x32_bf16 v[150:153], v[166:169], v[32:35], v[150:153]
    ds_read_b128 v[190:193], v3 offset:3072
    s_waitcnt lgkmcnt(5)
    v_mfma_f32_16x16x32_bf16 v[154:157], v[170:173], v[32:35], v[154:157]
    ds_read_b128 v[194:197], v3 offset:31744
    s_waitcnt lgkmcnt(5)
    v_mfma_f32_16x16x32_bf16 v[158:161], v[174:177], v[32:35], v[158:161]
    ds_read_b128 v[166:169], v2 offset:4096
    s_waitcnt lgkmcnt(5)
    v_mfma_f32_16x16x32_bf16 v[162:165], v[178:181], v[32:35], v[162:165]
    ds_read_b128 v[170:173], v2 offset:32768
    s_waitcnt vmcnt(24)
    s_waitcnt lgkmcnt(5)
    v_mfma_f32_16x16x32_bf16 v[150:153], v[182:185], v[36:39], v[150:153]
    ds_read_b128 v[174:177], v3 offset:4096
    s_waitcnt lgkmcnt(5)
    v_mfma_f32_16x16x32_bf16 v[154:157], v[186:189], v[36:39], v[154:157]
    ds_read_b128 v[178:181], v3 offset:32768
    s_waitcnt lgkmcnt(5)
    v_mfma_f32_16x16x32_bf16 v[158:161], v[190:193], v[36:39], v[158:161]
    ds_read_b128 v[182:185], v2 offset:5120
    s_waitcnt lgkmcnt(5)
    v_mfma_f32_16x16x32_bf16 v[162:165], v[194:197], v[36:39], v[162:165]
    ds_read_b128 v[186:189], v2 offset:33792
    s_waitcnt vmcnt(23)
    s_waitcnt lgkmcnt(5)
    v_mfma_f32_16x16x32_bf16 v[150:153], v[166:169], v[40:43], v[150:153]
    ds_read_b128 v[190:193], v3 offset:5120
    s_waitcnt lgkmcnt(5)
    v_mfma_f32_16x16x32_bf16 v[154:157], v[170:173], v[40:43], v[154:157]
    ds_read_b128 v[194:197], v3 offset:33792
    s_waitcnt lgkmcnt(5)
    v_mfma_f32_16x16x32_bf16 v[158:161], v[174:177], v[40:43], v[158:161]
    ds_read_b128 v[166:169], v2 offset:6144
    s_waitcnt lgkmcnt(5)
    v_mfma_f32_16x16x32_bf16 v[162:165], v[178:181], v[40:43], v[162:165]
    ds_read_b128 v[170:173], v2 offset:34816
    s_waitcnt vmcnt(22)
    s_waitcnt lgkmcnt(5)
    v_mfma_f32_16x16x32_bf16 v[150:153], v[182:185], v[44:47], v[150:153]
    ds_read_b128 v[174:177], v3 offset:6144
    s_waitcnt lgkmcnt(5)
    v_mfma_f32_16x16x32_bf16 v[154:157], v[186:189], v[44:47], v[154:157]
    ds_read_b128 v[178:181], v3 offset:34816
    s_waitcnt lgkmcnt(5)
    v_mfma_f32_16x16x32_bf16 v[158:161], v[190:193], v[44:47], v[158:161]
    ds_read_b128 v[182:185], v2 offset:7168
    s_waitcnt lgkmcnt(5)
    v_mfma_f32_16x16x32_bf16 v[162:165], v[194:197], v[44:47], v[162:165]
    ds_read_b128 v[186:189], v2 offset:35840
    s_waitcnt vmcnt(21)
    s_waitcnt lgkmcnt(5)
    v_mfma_f32_16x16x32_bf16 v[150:153], v[166:169], v[48:51], v[150:153]
    ds_read_b128 v[190:193], v3 offset:7168
    s_waitcnt lgkmcnt(5)
    v_mfma_f32_16x16x32_bf16 v[154:157], v[170:173], v[48:51], v[154:157]
    ds_read_b128 v[194:197], v3 offset:35840
    s_waitcnt lgkmcnt(5)
    v_mfma_f32_16x16x32_bf16 v[158:161], v[174:177], v[48:51], v[158:161]
    ds_read_b128 v[166:169], v2 offset:8192
    s_waitcnt lgkmcnt(5)
    v_mfma_f32_16x16x32_bf16 v[162:165], v[178:181], v[48:51], v[162:165]
    ds_read_b128 v[170:173], v2 offset:36864
    s_waitcnt vmcnt(20)
    s_waitcnt lgkmcnt(5)
    v_mfma_f32_16x16x32_bf16 v[150:153], v[182:185], v[52:55], v[150:153]
    ds_read_b128 v[174:177], v3 offset:8192
    s_waitcnt lgkmcnt(5)
    v_mfma_f32_16x16x32_bf16 v[154:157], v[186:189], v[52:55], v[154:157]
    ds_read_b128 v[178:181], v3 offset:36864
    s_waitcnt lgkmcnt(5)
    v_mfma_f32_16x16x32_bf16 v[158:161], v[190:193], v[52:55], v[158:161]
    ds_read_b128 v[182:185], v2 offset:9216
    s_waitcnt lgkmcnt(5)
    v_mfma_f32_16x16x32_bf16 v[162:165], v[194:197], v[52:55], v[162:165]
    ds_read_b128 v[186:189], v2 offset:37888
    s_waitcnt vmcnt(19)
    s_waitcnt lgkmcnt(5)
    v_mfma_f32_16x16x32_bf16 v[150:153], v[166:169], v[56:59], v[150:153]
    ds_read_b128 v[190:193], v3 offset:9216
    s_waitcnt lgkmcnt(5)
    v_mfma_f32_16x16x32_bf16 v[154:157], v[170:173], v[56:59], v[154:157]
    ds_read_b128 v[194:197], v3 offset:37888
    s_waitcnt lgkmcnt(5)
    v_mfma_f32_16x16x32_bf16 v[158:161], v[174:177], v[56:59], v[158:161]
    ds_read_b128 v[166:169], v2 offset:10240
    s_waitcnt lgkmcnt(5)
    v_mfma_f32_16x16x32_bf16 v[162:165], v[178:181], v[56:59], v[162:165]
    ds_read_b128 v[170:173], v2 offset:38912
    s_waitcnt vmcnt(18)
    s_waitcnt lgkmcnt(5)
    v_mfma_f32_16x16x32_bf16 v[150:153], v[182:185], v[60:63], v[150:153]
    ds_read_b128 v[174:177], v3 offset:10240
    s_waitcnt lgkmcnt(5)
    v_mfma_f32_16x16x32_bf16 v[154:157], v[186:189], v[60:63], v[154:157]
    ds_read_b128 v[178:181], v3 offset:38912
    s_waitcnt lgkmcnt(5)
    v_mfma_f32_16x16x32_bf16 v[158:161], v[190:193], v[60:63], v[158:161]
    ds_read_b128 v[182:185], v2 offset:11264
    s_waitcnt lgkmcnt(5)
    v_mfma_f32_16x16x32_bf16 v[162:165], v[194:197], v[60:63], v[162:165]
    ds_read_b128 v[186:189], v2 offset:39936
    s_waitcnt vmcnt(17)
    s_waitcnt lgkmcnt(5)
    v_mfma_f32_16x16x32_bf16 v[150:153], v[166:169], v[64:67], v[150:153]
    ds_read_b128 v[190:193], v3 offset:11264
    s_waitcnt lgkmcnt(5)
    v_mfma_f32_16x16x32_bf16 v[154:157], v[170:173], v[64:67], v[154:157]
    ds_read_b128 v[194:197], v3 offset:39936
    s_waitcnt lgkmcnt(5)
    v_mfma_f32_16x16x32_bf16 v[158:161], v[174:177], v[64:67], v[158:161]
    ds_read_b128 v[166:169], v2 offset:12288
    s_waitcnt lgkmcnt(5)
    v_mfma_f32_16x16x32_bf16 v[162:165], v[178:181], v[64:67], v[162:165]
    ds_read_b128 v[170:173], v2 offset:40960
    s_waitcnt vmcnt(16)
    s_waitcnt lgkmcnt(5)
    v_mfma_f32_16x16x32_bf16 v[150:153], v[182:185], v[68:71], v[150:153]
    ds_read_b128 v[174:177], v3 offset:12288
    s_waitcnt lgkmcnt(5)
    v_mfma_f32_16x16x32_bf16 v[154:157], v[186:189], v[68:71], v[154:157]
    ds_read_b128 v[178:181], v3 offset:40960
    s_waitcnt lgkmcnt(5)
    v_mfma_f32_16x16x32_bf16 v[158:161], v[190:193], v[68:71], v[158:161]
    ds_read_b128 v[182:185], v2 offset:13312
    s_waitcnt lgkmcnt(5)
    v_mfma_f32_16x16x32_bf16 v[162:165], v[194:197], v[68:71], v[162:165]
    ds_read_b128 v[186:189], v2 offset:41984
    s_waitcnt vmcnt(15)
    s_waitcnt lgkmcnt(5)
    v_mfma_f32_16x16x32_bf16 v[150:153], v[166:169], v[72:75], v[150:153]
    ds_read_b128 v[190:193], v3 offset:13312
    s_waitcnt lgkmcnt(5)
    v_mfma_f32_16x16x32_bf16 v[154:157], v[170:173], v[72:75], v[154:157]
    ds_read_b128 v[194:197], v3 offset:41984
    s_waitcnt lgkmcnt(5)
    v_mfma_f32_16x16x32_bf16 v[158:161], v[174:177], v[72:75], v[158:161]
    ds_read_b128 v[166:169], v2 offset:14336
    s_waitcnt lgkmcnt(5)
    v_mfma_f32_16x16x32_bf16 v[162:165], v[178:181], v[72:75], v[162:165]
    ds_read_b128 v[170:173], v2 offset:43008
    s_waitcnt vmcnt(14)
    s_waitcnt lgkmcnt(5)
    v_mfma_f32_16x16x32_bf16 v[150:153], v[182:185], v[76:79], v[150:153]
    ds_read_b128 v[174:177], v3 offset:14336
    s_waitcnt lgkmcnt(5)
    v_mfma_f32_16x16x32_bf16 v[154:157], v[186:189], v[76:79], v[154:157]
    ds_read_b128 v[178:181], v3 offset:43008
    s_waitcnt lgkmcnt(5)
    v_mfma_f32_16x16x32_bf16 v[158:161], v[190:193], v[76:79], v[158:161]
    ds_read_b128 v[182:185], v2 offset:15360
    s_waitcnt lgkmcnt(5)
    v_mfma_f32_16x16x32_bf16 v[162:165], v[194:197], v[76:79], v[162:165]
    ds_read_b128 v[186:189], v2 offset:44032
    s_waitcnt vmcnt(13)
    s_waitcnt lgkmcnt(5)
    v_mfma_f32_16x16x32_bf16 v[150:153], v[166:169], v[80:83], v[150:153]
    ds_read_b128 v[190:193], v3 offset:15360
    s_waitcnt lgkmcnt(5)
    v_mfma_f32_16x16x32_bf16 v[154:157], v[170:173], v[80:83], v[154:157]
    ds_read_b128 v[194:197], v3 offset:44032
    s_waitcnt lgkmcnt(5)
    v_mfma_f32_16x16x32_bf16 v[158:161], v[174:177], v[80:83], v[158:161]
    ds_read_b128 v[166:169], v2 offset:16384
    s_waitcnt lgkmcnt(5)
    v_mfma_f32_16x16x32_bf16 v[162:165], v[178:181], v[80:83], v[162:165]
    ds_read_b128 v[170:173], v2 offset:45056
    s_waitcnt vmcnt(12)
    s_waitcnt lgkmcnt(5)
    v_mfma_f32_16x16x32_bf16 v[150:153], v[182:185], v[84:87], v[150:153]
    ds_read_b128 v[174:177], v3 offset:16384
    s_waitcnt lgkmcnt(5)
    v_mfma_f32_16x16x32_bf16 v[154:157], v[186:189], v[84:87], v[154:157]
    ds_read_b128 v[178:181], v3 offset:45056
    s_waitcnt lgkmcnt(5)
    v_mfma_f32_16x16x32_bf16 v[158:161], v[190:193], v[84:87], v[158:161]
    ds_read_b128 v[182:185], v2 offset:17408
    s_waitcnt lgkmcnt(5)
    v_mfma_f32_16x16x32_bf16 v[162:165], v[194:197], v[84:87], v[162:165]
    ds_read_b128 v[186:189], v2 offset:46080
    s_waitcnt vmcnt(11)
    s_waitcnt lgkmcnt(5)
    v_mfma_f32_16x16x32_bf16 v[150:153], v[166:169], v[88:91], v[150:153]
    ds_read_b128 v[190:193], v3 offset:17408
    s_waitcnt lgkmcnt(5)
    v_mfma_f32_16x16x32_bf16 v[154:157], v[170:173], v[88:91], v[154:157]
    ds_read_b128 v[194:197], v3 offset:46080
    s_waitcnt lgkmcnt(5)
    v_mfma_f32_16x16x32_bf16 v[158:161], v[174:177], v[88:91], v[158:161]
    ds_read_b128 v[166:169], v2 offset:18432
    s_waitcnt lgkmcnt(5)
    v_mfma_f32_16x16x32_bf16 v[162:165], v[178:181], v[88:91], v[162:165]
    ds_read_b128 v[170:173], v2 offset:47104
    s_waitcnt vmcnt(10)
    s_waitcnt lgkmcnt(5)
    v_mfma_f32_16x16x32_bf16 v[150:153], v[182:185], v[92:95], v[150:153]
    ds_read_b128 v[174:177], v3 offset:18432
    s_waitcnt lgkmcnt(5)
    v_mfma_f32_16x16x32_bf16 v[154:157], v[186:189], v[92:95], v[154:157]
    ds_read_b128 v[178:181], v3 offset:47104
    s_waitcnt lgkmcnt(5)
    v_mfma_f32_16x16x32_bf16 v[158:161], v[190:193], v[92:95], v[158:161]
    ds_read_b128 v[182:185], v2 offset:19456
    s_waitcnt lgkmcnt(5)
    v_mfma_f32_16x16x32_bf16 v[162:165], v[194:197], v[92:95], v[162:165]
    ds_read_b128 v[186:189], v2 offset:48128
    s_waitcnt vmcnt(9)
    s_waitcnt lgkmcnt(5)
    v_mfma_f32_16x16x32_bf16 v[150:153], v[166:169], v[96:99], v[150:153]
    ds_read_b128 v[190:193], v3 offset:19456
    s_waitcnt lgkmcnt(5)
    v_mfma_f32_16x16x32_bf16 v[154:157], v[170:173], v[96:99], v[154:157]
    ds_read_b128 v[194:197], v3 offset:48128
    s_waitcnt lgkmcnt(5)
    v_mfma_f32_16x16x32_bf16 v[158:161], v[174:177], v[96:99], v[158:161]
    ds_read_b128 v[166:169], v2 offset:20480
    s_waitcnt lgkmcnt(5)
    v_mfma_f32_16x16x32_bf16 v[162:165], v[178:181], v[96:99], v[162:165]
    ds_read_b128 v[170:173], v2 offset:49152
    s_waitcnt vmcnt(8)
    s_waitcnt lgkmcnt(5)
    v_mfma_f32_16x16x32_bf16 v[150:153], v[182:185], v[100:103], v[150:153]
    ds_read_b128 v[174:177], v3 offset:20480
    s_waitcnt lgkmcnt(5)
    v_mfma_f32_16x16x32_bf16 v[154:157], v[186:189], v[100:103], v[154:157]
    ds_read_b128 v[178:181], v3 offset:49152
    s_waitcnt lgkmcnt(5)
    v_mfma_f32_16x16x32_bf16 v[158:161], v[190:193], v[100:103], v[158:161]
    ds_read_b128 v[182:185], v2 offset:21504
    s_waitcnt lgkmcnt(5)
    v_mfma_f32_16x16x32_bf16 v[162:165], v[194:197], v[100:103], v[162:165]
    ds_read_b128 v[186:189], v2 offset:50176
    s_waitcnt vmcnt(7)
    s_waitcnt lgkmcnt(5)
    v_mfma_f32_16x16x32_bf16 v[150:153], v[166:169], v[104:107], v[150:153]
    ds_read_b128 v[190:193], v3 offset:21504
    s_waitcnt lgkmcnt(5)
    v_mfma_f32_16x16x32_bf16 v[154:157], v[170:173], v[104:107], v[154:157]
    ds_read_b128 v[194:197], v3 offset:50176
    s_waitcnt lgkmcnt(5)
    v_mfma_f32_16x16x32_bf16 v[158:161], v[174:177], v[104:107], v[158:161]
    ds_read_b128 v[166:169], v2 offset:22528
    s_waitcnt lgkmcnt(5)
    v_mfma_f32_16x16x32_bf16 v[162:165], v[178:181], v[104:107], v[162:165]
    ds_read_b128 v[170:173], v2 offset:51200
    s_waitcnt vmcnt(6)
    s_waitcnt lgkmcnt(5)
    v_mfma_f32_16x16x32_bf16 v[150:153], v[182:185], v[108:111], v[150:153]
    ds_read_b128 v[174:177], v3 offset:22528
    s_waitcnt lgkmcnt(5)
    v_mfma_f32_16x16x32_bf16 v[154:157], v[186:189], v[108:111], v[154:157]
    ds_read_b128 v[178:181], v3 offset:51200
    s_waitcnt lgkmcnt(5)
    v_mfma_f32_16x16x32_bf16 v[158:161], v[190:193], v[108:111], v[158:161]
    ds_read_b128 v[182:185], v2 offset:23552
    s_waitcnt lgkmcnt(5)
    v_mfma_f32_16x16x32_bf16 v[162:165], v[194:197], v[108:111], v[162:165]
    ds_read_b128 v[186:189], v2 offset:52224
    s_waitcnt vmcnt(5)
    s_waitcnt lgkmcnt(5)
    v_mfma_f32_16x16x32_bf16 v[150:153], v[166:169], v[112:115], v[150:153]
    ds_read_b128 v[190:193], v3 offset:23552
    s_waitcnt lgkmcnt(5)
    v_mfma_f32_16x16x32_bf16 v[154:157], v[170:173], v[112:115], v[154:157]
    ds_read_b128 v[194:197], v3 offset:52224
    s_waitcnt lgkmcnt(5)
    v_mfma_f32_16x16x32_bf16 v[158:161], v[174:177], v[112:115], v[158:161]
    ds_read_b128 v[166:169], v2 offset:24576
    s_waitcnt lgkmcnt(5)
    v_mfma_f32_16x16x32_bf16 v[162:165], v[178:181], v[112:115], v[162:165]
    ds_read_b128 v[170:173], v2 offset:53248
    s_waitcnt vmcnt(4)
    s_waitcnt lgkmcnt(5)
    v_mfma_f32_16x16x32_bf16 v[150:153], v[182:185], v[116:119], v[150:153]
    ds_read_b128 v[174:177], v3 offset:24576
    s_waitcnt lgkmcnt(5)
    v_mfma_f32_16x16x32_bf16 v[154:157], v[186:189], v[116:119], v[154:157]
    ds_read_b128 v[178:181], v3 offset:53248
    s_waitcnt lgkmcnt(5)
    v_mfma_f32_16x16x32_bf16 v[158:161], v[190:193], v[116:119], v[158:161]
    ds_read_b128 v[182:185], v2 offset:25600
    s_waitcnt lgkmcnt(5)
    v_mfma_f32_16x16x32_bf16 v[162:165], v[194:197], v[116:119], v[162:165]
    ds_read_b128 v[186:189], v2 offset:54272
    s_waitcnt vmcnt(3)
    s_waitcnt lgkmcnt(5)
    v_mfma_f32_16x16x32_bf16 v[150:153], v[166:169], v[120:123], v[150:153]
    ds_read_b128 v[190:193], v3 offset:25600
    s_waitcnt lgkmcnt(5)
    v_mfma_f32_16x16x32_bf16 v[154:157], v[170:173], v[120:123], v[154:157]
    ds_read_b128 v[194:197], v3 offset:54272
    s_waitcnt lgkmcnt(5)
    v_mfma_f32_16x16x32_bf16 v[158:161], v[174:177], v[120:123], v[158:161]
    ds_read_b128 v[166:169], v2 offset:26624
    s_waitcnt lgkmcnt(5)
    v_mfma_f32_16x16x32_bf16 v[162:165], v[178:181], v[120:123], v[162:165]
    ds_read_b128 v[170:173], v2 offset:55296
    s_waitcnt vmcnt(2)
    s_waitcnt lgkmcnt(5)
    v_mfma_f32_16x16x32_bf16 v[150:153], v[182:185], v[124:127], v[150:153]
    ds_read_b128 v[174:177], v3 offset:26624
    s_waitcnt lgkmcnt(5)
    v_mfma_f32_16x16x32_bf16 v[154:157], v[186:189], v[124:127], v[154:157]
    ds_read_b128 v[178:181], v3 offset:55296
    s_waitcnt lgkmcnt(5)
    v_mfma_f32_16x16x32_bf16 v[158:161], v[190:193], v[124:127], v[158:161]
    ds_read_b128 v[182:185], v2 offset:27648
    s_waitcnt lgkmcnt(5)
    v_mfma_f32_16x16x32_bf16 v[162:165], v[194:197], v[124:127], v[162:165]
    ds_read_b128 v[186:189], v2 offset:56320
    s_waitcnt vmcnt(1)
    s_waitcnt lgkmcnt(5)
    v_mfma_f32_16x16x32_bf16 v[150:153], v[166:169], v[128:131], v[150:153]
    ds_read_b128 v[190:193], v3 offset:27648
    s_waitcnt lgkmcnt(5)
    v_mfma_f32_16x16x32_bf16 v[154:157], v[170:173], v[128:131], v[154:157]
    ds_read_b128 v[194:197], v3 offset:56320
    s_waitcnt lgkmcnt(5)
    v_mfma_f32_16x16x32_bf16 v[158:161], v[174:177], v[128:131], v[158:161]
    s_waitcnt lgkmcnt(4)
    v_mfma_f32_16x16x32_bf16 v[162:165], v[178:181], v[128:131], v[162:165]
    s_waitcnt vmcnt(0)
    s_waitcnt lgkmcnt(3)
    v_mfma_f32_16x16x32_bf16 v[150:153], v[182:185], v[132:135], v[150:153]
    s_waitcnt lgkmcnt(2)
    v_mfma_f32_16x16x32_bf16 v[154:157], v[186:189], v[132:135], v[154:157]
    s_waitcnt lgkmcnt(1)
    v_mfma_f32_16x16x32_bf16 v[158:161], v[190:193], v[132:135], v[158:161]
    s_waitcnt lgkmcnt(0)
    v_mfma_f32_16x16x32_bf16 v[162:165], v[194:197], v[132:135], v[162:165]
    s_waitcnt vmcnt(0) lgkmcnt(0)
    s_mov_b32 s30, 60
    v_cvt_pk_bf16_f32 v112, v150, v151
    v_cvt_pk_bf16_f32 v113, v152, v153
    ds_write_b64 v13, v[112:113] offset:0
    v_cvt_pk_bf16_f32 v114, v154, v155
    v_cvt_pk_bf16_f32 v115, v156, v157
    ds_write_b64 v13, v[114:115] offset:32
    v_cvt_pk_bf16_f32 v116, v158, v159
    v_cvt_pk_bf16_f32 v117, v160, v161
    ds_write_b64 v13, v[116:117] offset:64
    v_cvt_pk_bf16_f32 v118, v162, v163
    v_cvt_pk_bf16_f32 v119, v164, v165
    ds_write_b64 v13, v[118:119] offset:96
    ds_read_b128 v[120:123], v14
    ds_read_b128 v[124:127], v14 offset:1152
    s_waitcnt lgkmcnt(0)
    v_lshlrev_b32 v128, 16, v120
    v_and_b32 v129, 0xffff0000, v120
    v_lshlrev_b32 v130, 16, v140
    v_and_b32 v131, 0xffff0000, v140
    v_pk_add_f32 v[128:129], v[128:129], v[130:131]
    v_cvt_pk_bf16_f32 v120, v128, v129
    v_lshlrev_b32 v128, 16, v121
    v_and_b32 v129, 0xffff0000, v121
    v_lshlrev_b32 v130, 16, v141
    v_and_b32 v131, 0xffff0000, v141
    v_pk_add_f32 v[128:129], v[128:129], v[130:131]
    v_cvt_pk_bf16_f32 v121, v128, v129
    v_lshlrev_b32 v128, 16, v122
    v_and_b32 v129, 0xffff0000, v122
    v_lshlrev_b32 v130, 16, v142
    v_and_b32 v131, 0xffff0000, v142
    v_pk_add_f32 v[128:129], v[128:129], v[130:131]
    v_cvt_pk_bf16_f32 v122, v128, v129
    v_lshlrev_b32 v128, 16, v123
    v_and_b32 v129, 0xffff0000, v123
    v_lshlrev_b32 v130, 16, v143
    v_and_b32 v131, 0xffff0000, v143
    v_pk_add_f32 v[128:129], v[128:129], v[130:131]
    v_cvt_pk_bf16_f32 v123, v128, v129
    global_store_dwordx4 v10, v[120:123], s[62:63]
    v_lshlrev_b32 v128, 16, v124
    v_and_b32 v129, 0xffff0000, v124
    v_lshlrev_b32 v130, 16, v144
    v_and_b32 v131, 0xffff0000, v144
    v_pk_add_f32 v[128:129], v[128:129], v[130:131]
    v_cvt_pk_bf16_f32 v124, v128, v129
    v_lshlrev_b32 v128, 16, v125
    v_and_b32 v129, 0xffff0000, v125
    v_lshlrev_b32 v130, 16, v145
    v_and_b32 v131, 0xffff0000, v145
    v_pk_add_f32 v[128:129], v[128:129], v[130:131]
    v_cvt_pk_bf16_f32 v125, v128, v129
    v_lshlrev_b32 v128, 16, v126
    v_and_b32 v129, 0xffff0000, v126
    v_lshlrev_b32 v130, 16, v146
    v_and_b32 v131, 0xffff0000, v146
    v_pk_add_f32 v[128:129], v[128:129], v[130:131]
    v_cvt_pk_bf16_f32 v126, v128, v129
    v_lshlrev_b32 v128, 16, v127
    v_and_b32 v129, 0xffff0000, v127
    v_lshlrev_b32 v130, 16, v147
    v_and_b32 v131, 0xffff0000, v147
    v_pk_add_f32 v[128:129], v[128:129], v[130:131]
    v_cvt_pk_bf16_f32 v127, v128, v129
    global_store_dwordx4 v12, v[124:127], s[62:63]
    s_waitcnt vmcnt(0)
    s_mov_b32 s30, 62
sequential_preLN__memory_aug_recurrent_mem_tr__mixer_gmlp__prompt_kernel_DL_end:
    s_endpgm
.section .rodata,"a"
.p2align 6
.amdhsa_kernel sequential_preLN__memory_aug_recurrent_mem_tr__mixer_gmlp__prompt_kernel
  .amdhsa_next_free_vgpr 512
  .amdhsa_next_free_sgpr 102
  .amdhsa_accum_offset 256
  .amdhsa_group_segment_fixed_size 0
  .amdhsa_kernarg_size 120
  .amdhsa_user_sgpr_count 2
  .amdhsa_user_sgpr_kernarg_segment_ptr 1
  .amdhsa_system_sgpr_workgroup_id_x 1
  .amdhsa_float_denorm_mode_32 3
.end_amdhsa_kernel
```
